```python
import torch

def _softmax(x, axis=-1):
    return torch.softmax(x, dim=axis)
def _gelu(x):
    return torch.nn.functional.gelu(x, approximate="tanh")
def _silu(x):
    return torch.nn.functional.silu(x)
def _sigmoid(x):
    return torch.sigmoid(x)
def _layernorm(x, axis=-1, eps=1e-5):
    m = x.mean(dim=axis, keepdim=True)
    v = x.var(dim=axis, keepdim=True, unbiased=False)
    return (x - m) / torch.sqrt(v + eps)
def _scatter_add(tgt, idx, src, axis=0):
    return tgt.clone().index_add_(axis, idx, src)
def _segment_sum(src, seg, n):
    out = torch.zeros((n,) + src.shape[1:], dtype=src.dtype)
    return out.index_add_(0, seg, src)
def _pad(x, pw):
    flat = tuple(v for pair in reversed(pw) for v in pair)
    return torch.nn.functional.pad(x, flat)

kernel_name = 'recurrent_scan__linear_kernel_hedgehog__swiglu_ffn__prompt'

def setup_inputs():

    _w = (lambda a: (lambda t: t.to(torch.bfloat16) if t.is_floating_point() else t)(torch.as_tensor(a)))
    def _A_setup():
        B, S, D, H = 1, 2048, 640, 32
        Dh = D // H
        return {
            "x": _w((lambda *s: torch.randn(*s, dtype=torch.bfloat16) * 0.05)(B, S, D)),
            "wqkv": _w((lambda *s: torch.randn(*s, dtype=torch.bfloat16) * 0.2)(D, 3 * D)),
            "w_phi": _w((lambda *s: torch.randn(*s, dtype=torch.bfloat16) * 0.2)(H, Dh, Dh) * (Dh ** -0.5)),
            "wo": _w((lambda *s: torch.randn(*s, dtype=torch.bfloat16) * 0.05)(D, D)),
        }
    _A_in = _A_setup()

    def _B_setup():
        B, S, D, F = 1, 2048, 640, 1728
        return {
            "x": _w((lambda *s: torch.randn(*s, dtype=torch.bfloat16) * 0.05)(B, S, D)),
            "w_gate": _w((lambda *s: torch.randn(*s, dtype=torch.bfloat16) * 0.05)(D, F)),
            "w_up": _w((lambda *s: torch.randn(*s, dtype=torch.bfloat16) * 0.05)(D, F)),
            "w_down": _w((lambda *s: torch.randn(*s, dtype=torch.bfloat16) * 0.05)(F, D)),
        }
    _B_in = _B_setup()

    return {
        "A_x": _A_in["x"],
        "A_wqkv": _A_in["wqkv"],
        "A_w_phi": _A_in["w_phi"],
        "A_wo": _A_in["wo"],
        "B_x": _B_in["x"],
        "B_w_gate": _B_in["w_gate"],
        "B_w_up": _B_in["w_up"],
        "B_w_down": _B_in["w_down"],
    }

def reference(A_x, A_wqkv, A_w_phi, A_wo, B_x, B_w_gate, B_w_up, B_w_down):
    def _A_ref(x, wqkv, w_phi, wo):
        B, S, D = x.shape
        H = 32; Dh = D // H
        qkv = (lambda x, *d: x.permute(*d))((x @ wqkv).reshape(B, S, 3, H, Dh), 2, 0, 3, 1, 4)
        q, k, v = qkv[0], qkv[1], qkv[2]
        pq = torch.einsum("bhsd,hdf->bhsf", q, w_phi)
        pk = torch.einsum("bhsd,hdf->bhsf", k, w_phi)
        phi_q = torch.concatenate([_softmax(pq, axis=-1), _softmax(-pq, axis=-1)], axis=-1)
        phi_k = torch.concatenate([_softmax(pk, axis=-1), _softmax(-pk, axis=-1)], axis=-1)
        kv = torch.einsum("bhsf,bhsd->bhfd", phi_k, v)
        z  = torch.einsum("bhsf->bhf", phi_k)
        num = torch.einsum("bhqf,bhfd->bhqd", phi_q, kv)
        den = torch.einsum("bhqf,bhf->bhq", phi_q, z)[..., None] + 1e-6
        o = num / den
        return (lambda x, *d: x.permute(*d))(o, 0, 2, 1, 3).reshape(B, S, D) @ wo

    def _B_ref(x, w_gate, w_up, w_down):
        g = _silu(x @ w_gate)
        u = x @ w_up
        return (g * u) @ w_down

    x = A_x
    xn = _layernorm(x, axis=-1)
    s = _A_ref(xn, A_wqkv, A_w_phi, A_wo)
    g = _silu(_B_ref(xn, B_w_gate, B_w_up, B_w_down))
    return x + s * g
```

```asm
; @launch grid=(256,1,1) block=(512,1,1) lds=163840
.amdgcn_target "amdgcn-amd-amdhsa--gfx950"
.text
.globl recurrent_scan__linear_kernel_hedgehog__swiglu_ffn__prompt_kernel
.p2align 8
.type recurrent_scan__linear_kernel_hedgehog__swiglu_ffn__prompt_kernel,@function
recurrent_scan__linear_kernel_hedgehog__swiglu_ffn__prompt_kernel:
K1_start:
    s_load_dwordx4 s[4:7], s[0:1], 0
    s_load_dwordx4 s[8:11], s[0:1], 40
    s_load_dwordx4 s[12:15], s[0:1], 72
    s_cmp_ge_u32 s2, 256
    s_cbranch_scc1 K1_end
    v_lshrrev_b32 v1, 6, v0
    v_and_b32 v0, 63, v0
    v_readfirstlane_b32 s3, v1
    s_and_b32 s30, s2, 7
    s_lshr_b32 s31, s2, 3
    s_lshr_b32 s32, s30, 2
    s_lshl_b32 s32, s32, 2
    s_and_b32 s33, s31, 3
    s_add_u32 s32, s32, s33
    s_and_b32 s30, s30, 3
    s_lshr_b32 s31, s31, 2
    s_mov_b32 s78, 0
    v_lshrrev_b32 v7, 3, v0
    v_and_b32 v8, 7, v0
    v_lshrrev_b32 v9, 1, v7
    v_xor_b32_e64 v8, v8, v9
    v_mul_u32_u24 v7, 1280, v7
    v_lshl_add_u32 v2, v8, 4, v7
    v_xor_b32 v3, 64, v2
    s_mov_b32 s18, 2621440
    s_mov_b32 s19, 0x20000
    s_mov_b32 s22, 268435456
    s_mov_b32 s23, 0x20000
    s_lshl_b32 s28, s30, 3
    s_add_u32 s28, s28, s31
    s_cmp_ge_u32 s28, 23
    s_cselect_b32 s34, 7, 0
    s_and_b32 s34, s34, s31
    s_cmp_eq_u32 s34, 7
    s_cbranch_scc1 K1_spare
    s_cmp_lt_u32 s3, 4
    s_cbranch_scc1 K1_compute
    s_sub_u32 s41, s3, 4
    s_lshl_b32 s40, s32, 8
    s_lshl_b32 s36, s41, 6
    s_add_u32 s40, s40, s36
    s_mul_i32 s40, s40, 1280
    s_mul_i32 s43, s41, 24576
    s_waitcnt lgkmcnt(0)
    s_mov_b32 s16, s4
    s_mov_b32 s17, s5
    s_mov_b32 s20, s14
    s_mov_b32 s21, s15
    s_mov_b32 s14, s12
    s_mov_b32 s15, s13
    s_add_u32 s48, s40, 0
    s_add_u32 m0, s43, 0
    s_nop 0
    buffer_load_dwordx4 v2, s[16:19], s48 offen  lds
    s_add_u32 s48, s40, 10240
    s_add_u32 m0, s43, 1024
    s_nop 0
    buffer_load_dwordx4 v3, s[16:19], s48 offen  lds
    s_add_u32 s48, s40, 20480
    s_add_u32 m0, s43, 2048
    s_nop 0
    buffer_load_dwordx4 v2, s[16:19], s48 offen  lds
    s_add_u32 s48, s40, 30720
    s_add_u32 m0, s43, 3072
    s_nop 0
    buffer_load_dwordx4 v3, s[16:19], s48 offen  lds
    s_add_u32 s48, s40, 40960
    s_add_u32 m0, s43, 4096
    s_nop 0
    buffer_load_dwordx4 v2, s[16:19], s48 offen  lds
    s_add_u32 s48, s40, 51200
    s_add_u32 m0, s43, 5120
    s_nop 0
    buffer_load_dwordx4 v3, s[16:19], s48 offen  lds
    s_add_u32 s48, s40, 61440
    s_add_u32 m0, s43, 6144
    s_nop 0
    buffer_load_dwordx4 v2, s[16:19], s48 offen  lds
    s_add_u32 s48, s40, 71680
    s_add_u32 m0, s43, 7168
    s_nop 0
    buffer_load_dwordx4 v3, s[16:19], s48 offen  lds
    s_lshl_b32 s35, s30, 1
    s_add_u32 s35, s35, s31
    s_add_u32 s29, s35, 18
    s_add_u32 s36, s30, 26
    s_cmp_eq_u32 s31, 2
    s_cselect_b32 s34, 2, 1
    s_cselect_b32 s35, s30, s35
    s_cselect_b32 s29, s36, s29
    s_mul_i32 s36, s30, 5
    s_lshl_b32 s37, s30, 2
    s_add_u32 s37, s37, 2
    s_min_u32 s36, s36, s37
    s_add_u32 s36, s36, s31
    s_sub_u32 s36, s36, 3
    s_cmp_ge_u32 s31, 3
    s_cselect_b32 s34, 0, s34
    s_cselect_b32 s35, s36, s35
    s_cselect_b32 s29, s36, s29
    s_lshr_b32 s58, s41, 1
    s_and_b32 s59, s41, 1
    s_mov_b32 s26, 2457600
    s_mov_b32 s60, 3840
    s_mov_b32 s61, 20
    s_mov_b32 s38, 3277
    s_mul_i32 s37, s35, 160
    s_add_u32 s37, s37, 1280
    s_mul_i32 s39, s35, 320
    s_cmp_eq_u32 s34, 2
    s_cselect_b32 s37, s39, s37
    s_cselect_b32 s39, 0, 1120
    s_mul_i32 s62, s41, 3
    s_lshl_b32 s57, s41, 1
    s_add_u32 s57, s57, 2
    s_min_u32 s62, s62, s57
    s_mov_b32 s63, 9
    s_mov_b32 s64, 0
    s_mov_b32 s65, 10240
    s_cmp_eq_u32 s34, 0
    s_cbranch_scc0 K1_lp_go
    s_mov_b32 s26, 2211840
    s_mov_b32 s60, 3456
    s_mov_b32 s61, 12
    s_mov_b32 s38, 5462
    s_mul_i32 s37, s35, 192
    s_mov_b32 s39, 0
    s_mul_i32 s62, s59, 3
    s_mov_b32 s63, 5
    s_mul_i32 s64, s58, 6144
    s_mov_b32 s65, 12288
K1_lp_go:
    s_mov_b32 s27, 0x20000
    s_lshl_b32 s42, s60, 5
    v_mov_b32 v10, s39
    s_cmp_lt_u32 s41, 2
    s_cselect_b32 s24, s8, s10
    s_cselect_b32 s25, s9, s11
    s_cmp_eq_u32 s34, 0
    s_cselect_b32 s24, s24, s6
    s_cselect_b32 s25, s25, s7
    s_add_u32 s36, s62, 0
    s_min_u32 s36, s36, s63
    s_lshl_b32 s44, s36, 10
    s_add_u32 s44, s44, s64
    s_lshl_b32 s36, s36, 6
    v_add_u32 v7, s36, v0
    v_mul_u32_u24 v8, s38, v7
    v_lshrrev_b32 v8, 16, v8
    v_mul_u32_u24 v9, s61, v8
    v_sub_u32 v9, v7, v9
    v_bfe_u32 v11, v8, 3, 1
    v_lshlrev_b32 v11, 1, v11
    v_xor_b32 v9, v9, v11
    v_mul_u32_u24_e64 v8, s60, v8
    v_lshl_add_u32 v8, v9, 4, v8
    v_cmp_le_u32 vcc, 10, v9
    s_nop 1
    v_cndmask_b32 v9, 0, v10, vcc
    v_add3_u32 v4, v8, v9, s37
    s_add_u32 m0, s44, 98304
    s_nop 0
    buffer_load_dwordx4 v4, s[24:27], 0 offen  lds
    s_add_u32 s36, s62, 1
    s_min_u32 s36, s36, s63
    s_lshl_b32 s45, s36, 10
    s_add_u32 s45, s45, s64
    s_lshl_b32 s36, s36, 6
    v_add_u32 v7, s36, v0
    v_mul_u32_u24 v8, s38, v7
    v_lshrrev_b32 v8, 16, v8
    v_mul_u32_u24 v9, s61, v8
    v_sub_u32 v9, v7, v9
    v_bfe_u32 v11, v8, 3, 1
    v_lshlrev_b32 v11, 1, v11
    v_xor_b32 v9, v9, v11
    v_mul_u32_u24_e64 v8, s60, v8
    v_lshl_add_u32 v8, v9, 4, v8
    v_cmp_le_u32 vcc, 10, v9
    s_nop 1
    v_cndmask_b32 v9, 0, v10, vcc
    v_add3_u32 v5, v8, v9, s37
    s_add_u32 m0, s45, 98304
    s_nop 0
    buffer_load_dwordx4 v5, s[24:27], 0 offen  lds
    s_add_u32 s36, s62, 2
    s_min_u32 s36, s36, s63
    s_lshl_b32 s46, s36, 10
    s_add_u32 s46, s46, s64
    s_lshl_b32 s36, s36, 6
    v_add_u32 v7, s36, v0
    v_mul_u32_u24 v8, s38, v7
    v_lshrrev_b32 v8, 16, v8
    v_mul_u32_u24 v9, s61, v8
    v_sub_u32 v9, v7, v9
    v_bfe_u32 v11, v8, 3, 1
    v_lshlrev_b32 v11, 1, v11
    v_xor_b32 v9, v9, v11
    v_mul_u32_u24_e64 v8, s60, v8
    v_lshl_add_u32 v8, v9, 4, v8
    v_cmp_le_u32 vcc, 10, v9
    s_nop 1
    v_cndmask_b32 v9, 0, v10, vcc
    v_add3_u32 v6, v8, v9, s37
    s_add_u32 m0, s46, 98304
    s_nop 0
    buffer_load_dwordx4 v6, s[24:27], 0 offen  lds
    s_add_u32 s36, s44, s65
    s_add_u32 m0, s36, 98304
    s_nop 0
    buffer_load_dwordx4 v4, s[24:27], s42 offen  lds
    s_add_u32 s36, s45, s65
    s_add_u32 m0, s36, 98304
    s_nop 0
    buffer_load_dwordx4 v5, s[24:27], s42 offen  lds
    s_add_u32 s36, s46, s65
    s_add_u32 m0, s36, 98304
    s_nop 0
    buffer_load_dwordx4 v6, s[24:27], s42 offen  lds
    s_load_dwordx2 s[70:71], s[0:1], 24
    s_load_dwordx2 s[72:73], s[0:1], 56
    s_lshl_b32 s66, s32, 8
    s_lshl_b32 s36, s28, 3
    s_add_u32 s66, s66, s36
    s_lshl_b32 s36, s41, 1
    s_add_u32 s66, s66, s36
    s_lshl_b32 s56, s32, 4
    s_lshl_b32 s57, s59, 3
    s_add_u32 s56, s56, s57
    s_lshl_b32 s52, s29, 4
    s_mul_i32 s53, s52, 768
    s_mul_i32 s57, s41, 192
    s_add_u32 s53, s53, s57
    s_add_u32 s53, s53, 20512768
    s_lshl_b32 s57, s32, 1
    s_add_u32 s52, s52, s57
    s_add_u32 s52, s52, s59
    s_mul_i32 s52, s52, 768
    s_add_u32 s52, s52, 20512768
    v_lshrrev_b32 v12, 4, v0
    v_and_b32_e64 v13, 15, v0
    v_mov_b32 v14, 0x7ffffff0
    v_mul_lo_u32 v7, v12, s60
    v_lshl_add_u32 v7, v13, 4, v7
    s_mul_i32 s50, s56, s60
    s_add_u32 s50, s50, s37
    s_lshl_b32 s51, s60, 2
    s_cmp_eq_u32 s34, 0
    s_cbranch_scc0 K1_l_qkv
    v_cmp_gt_u32 vcc, 12, v13
    s_nop 1
    v_cndmask_b32 v7, v14, v7, vcc
    s_mul_i32 s57, s58, 384
    s_add_u32 s52, s52, s57
    v_bfe_u32 v36, v0, 4, 1
    v_mul_u32_u24 v36, 1280, v36
    v_and_b32 v37, 15, v0
    v_lshl_add_u32 v36, v37, 4, v36
    s_mul_i32 s69, s66, 1280
    buffer_load_dwordx4 v[16:19], v36, s[16:19], s69 offen offset:0
    s_mul_i32 s48, s51, 0
    s_add_u32 s48, s48, s50
    buffer_load_dwordx4 v[80:83], v7, s[24:27], s48 offen
    s_mul_i32 s48, s51, 1
    s_add_u32 s48, s48, s50
    buffer_load_dwordx4 v[84:87], v7, s[24:27], s48 offen
    buffer_load_dwordx4 v[20:23], v36, s[16:19], s69 offen offset:256
    s_mul_i32 s48, s51, 32
    s_add_u32 s48, s48, s50
    buffer_load_dwordx4 v[88:91], v7, s[24:27], s48 offen
    s_mul_i32 s48, s51, 33
    s_add_u32 s48, s48, s50
    buffer_load_dwordx4 v[92:95], v7, s[24:27], s48 offen
    s_waitcnt vmcnt(9)
    s_barrier
    s_add_u32 s47, s78, 1
    s_sub_u32 s48, s47, 10
    s_cselect_b32 s47, s47, s48
    s_lshl_b32 s47, s47, 7
    s_add_u32 s47, s47, s40
    s_add_u32 s48, s47, 0
    s_add_u32 m0, s43, 8192
    s_nop 0
    buffer_load_dwordx4 v2, s[16:19], s48 offen  lds
    s_add_u32 s48, s47, 10240
    s_add_u32 m0, s43, 9216
    s_nop 0
    buffer_load_dwordx4 v3, s[16:19], s48 offen  lds
    s_add_u32 s48, s47, 20480
    s_add_u32 m0, s43, 10240
    s_nop 0
    buffer_load_dwordx4 v2, s[16:19], s48 offen  lds
    s_add_u32 s48, s47, 30720
    s_add_u32 m0, s43, 11264
    s_nop 0
    buffer_load_dwordx4 v3, s[16:19], s48 offen  lds
    s_add_u32 s47, s78, 1
    s_sub_u32 s48, s47, 10
    s_cselect_b32 s47, s47, s48
    s_lshl_b32 s47, s47, 7
    s_add_u32 s47, s47, s40
    s_add_u32 s48, s47, 40960
    s_add_u32 m0, s43, 12288
    s_nop 0
    buffer_load_dwordx4 v2, s[16:19], s48 offen  lds
    s_add_u32 s48, s47, 51200
    s_add_u32 m0, s43, 13312
    s_nop 0
    buffer_load_dwordx4 v3, s[16:19], s48 offen  lds
    s_add_u32 s48, s47, 61440
    s_add_u32 m0, s43, 14336
    s_nop 0
    buffer_load_dwordx4 v2, s[16:19], s48 offen  lds
    s_add_u32 s48, s47, 71680
    s_add_u32 m0, s43, 15360
    s_nop 0
    buffer_load_dwordx4 v3, s[16:19], s48 offen  lds
    s_lshl_b32 s49, s78, 1
    s_add_u32 s49, s49, 2
    s_sub_u32 s48, s49, 20
    s_cselect_b32 s49, s49, s48
    s_mul_i32 s49, s49, s42
    s_add_u32 m0, s44, 122880
    s_nop 0
    buffer_load_dwordx4 v4, s[24:27], s49 offen  lds
    s_add_u32 m0, s45, 122880
    s_nop 0
    buffer_load_dwordx4 v5, s[24:27], s49 offen  lds
    s_add_u32 m0, s46, 122880
    s_nop 0
    buffer_load_dwordx4 v6, s[24:27], s49 offen  lds
    s_lshl_b32 s49, s78, 1
    s_add_u32 s49, s49, 3
    s_sub_u32 s48, s49, 20
    s_cselect_b32 s49, s49, s48
    s_mul_i32 s49, s49, s42
    s_add_u32 m0, s44, 135168
    s_nop 0
    buffer_load_dwordx4 v4, s[24:27], s49 offen  lds
    s_add_u32 m0, s45, 135168
    s_nop 0
    buffer_load_dwordx4 v5, s[24:27], s49 offen  lds
    s_add_u32 m0, s46, 135168
    s_nop 0
    buffer_load_dwordx4 v6, s[24:27], s49 offen  lds
    s_add_u32 s47, s78, 2
    s_sub_u32 s48, s47, 10
    s_cselect_b32 s47, s47, s48
    s_lshl_b32 s47, s47, 7
    s_add_u32 s47, s47, s40
    s_add_u32 s48, s47, 0
    s_add_u32 m0, s43, 16384
    s_nop 0
    buffer_load_dwordx4 v2, s[16:19], s48 offen  lds
    s_add_u32 s48, s47, 10240
    s_add_u32 m0, s43, 17408
    s_nop 0
    buffer_load_dwordx4 v3, s[16:19], s48 offen  lds
    s_add_u32 s48, s47, 20480
    s_add_u32 m0, s43, 18432
    s_nop 0
    buffer_load_dwordx4 v2, s[16:19], s48 offen  lds
    s_add_u32 s48, s47, 30720
    s_add_u32 m0, s43, 19456
    s_nop 0
    buffer_load_dwordx4 v3, s[16:19], s48 offen  lds
    v_and_b32 v128, 15, v0
    v_mov_b32 v129, 0x3f80
    v_mov_b32 v130, 0x3f800000
    v_cmp_eq_u32 vcc, 0, v128
    s_nop 1
    v_cndmask_b32 v124, 0, v129, vcc
    v_cmp_eq_u32 vcc, 1, v128
    s_nop 1
    v_cndmask_b32 v124, v124, v130, vcc
    v_cmp_eq_u32 vcc, 2, v128
    s_nop 1
    v_cndmask_b32 v125, 0, v129, vcc
    v_cmp_eq_u32 vcc, 3, v128
    s_nop 1
    v_cndmask_b32 v125, v125, v130, vcc
    v_cmp_eq_u32 vcc, 4, v128
    s_nop 1
    v_cndmask_b32 v126, 0, v129, vcc
    v_cmp_eq_u32 vcc, 5, v128
    s_nop 1
    v_cndmask_b32 v126, v126, v130, vcc
    v_cmp_eq_u32 vcc, 6, v128
    s_nop 1
    v_cndmask_b32 v127, 0, v129, vcc
    v_cmp_eq_u32 vcc, 7, v128
    s_nop 1
    v_cndmask_b32 v127, v127, v130, vcc
    buffer_load_dwordx4 v[24:27], v36, s[16:19], s69 offen offset:512
    s_mul_i32 s48, s51, 64
    s_add_u32 s48, s48, s50
    buffer_load_dwordx4 v[96:99], v7, s[24:27], s48 offen
    s_mul_i32 s48, s51, 65
    s_add_u32 s48, s48, s50
    buffer_load_dwordx4 v[100:103], v7, s[24:27], s48 offen
    s_waitcnt vmcnt(27)
    s_barrier
    s_add_u32 s47, s78, 2
    s_sub_u32 s48, s47, 10
    s_cselect_b32 s47, s47, s48
    s_lshl_b32 s47, s47, 7
    s_add_u32 s47, s47, s40
    s_add_u32 s48, s47, 40960
    s_add_u32 m0, s43, 20480
    s_nop 0
    buffer_load_dwordx4 v2, s[16:19], s48 offen  lds
    s_add_u32 s48, s47, 51200
    s_add_u32 m0, s43, 21504
    s_nop 0
    buffer_load_dwordx4 v3, s[16:19], s48 offen  lds
    s_add_u32 s48, s47, 61440
    s_add_u32 m0, s43, 22528
    s_nop 0
    buffer_load_dwordx4 v2, s[16:19], s48 offen  lds
    s_add_u32 s48, s47, 71680
    s_add_u32 m0, s43, 23552
    s_nop 0
    buffer_load_dwordx4 v3, s[16:19], s48 offen  lds
    s_lshl_b32 s49, s78, 1
    s_add_u32 s49, s49, 4
    s_sub_u32 s48, s49, 20
    s_cselect_b32 s49, s49, s48
    s_mul_i32 s49, s49, s42
    s_add_u32 m0, s44, 147456
    s_nop 0
    buffer_load_dwordx4 v4, s[24:27], s49 offen  lds
    s_add_u32 m0, s45, 147456
    s_nop 0
    buffer_load_dwordx4 v5, s[24:27], s49 offen  lds
    s_add_u32 m0, s46, 147456
    s_nop 0
    buffer_load_dwordx4 v6, s[24:27], s49 offen  lds
    buffer_load_dwordx4 v[28:31], v36, s[16:19], s69 offen offset:768
    s_mul_i32 s48, s51, 96
    s_add_u32 s48, s48, s50
    buffer_load_dwordx4 v[104:107], v7, s[24:27], s48 offen
    s_mul_i32 s48, s51, 97
    s_add_u32 s48, s48, s50
    buffer_load_dwordx4 v[108:111], v7, s[24:27], s48 offen
    s_waitcnt vmcnt(20)
    s_barrier
    s_add_u32 s47, s78, 3
    s_sub_u32 s48, s47, 10
    s_cselect_b32 s47, s47, s48
    s_lshl_b32 s47, s47, 7
    s_add_u32 s47, s47, s40
    s_add_u32 s48, s47, 0
    s_add_u32 m0, s43, 0
    s_nop 0
    buffer_load_dwordx4 v2, s[16:19], s48 offen  lds
    s_add_u32 s48, s47, 10240
    s_add_u32 m0, s43, 1024
    s_nop 0
    buffer_load_dwordx4 v3, s[16:19], s48 offen  lds
    s_add_u32 s48, s47, 20480
    s_add_u32 m0, s43, 2048
    s_nop 0
    buffer_load_dwordx4 v2, s[16:19], s48 offen  lds
    s_add_u32 s48, s47, 30720
    s_add_u32 m0, s43, 3072
    s_nop 0
    buffer_load_dwordx4 v3, s[16:19], s48 offen  lds
    s_lshl_b32 s49, s78, 1
    s_add_u32 s49, s49, 5
    s_sub_u32 s48, s49, 20
    s_cselect_b32 s49, s49, s48
    s_mul_i32 s49, s49, s42
    s_add_u32 m0, s44, 98304
    s_nop 0
    buffer_load_dwordx4 v4, s[24:27], s49 offen  lds
    s_add_u32 m0, s45, 98304
    s_nop 0
    buffer_load_dwordx4 v5, s[24:27], s49 offen  lds
    s_add_u32 m0, s46, 98304
    s_nop 0
    buffer_load_dwordx4 v6, s[24:27], s49 offen  lds
    buffer_load_dwordx4 v[32:35], v36, s[16:19], s69 offen offset:1024
    s_mul_i32 s48, s51, 128
    s_add_u32 s48, s48, s50
    buffer_load_dwordx4 v[112:115], v7, s[24:27], s48 offen
    s_mul_i32 s48, s51, 129
    s_add_u32 s48, s48, s50
    buffer_load_dwordx4 v[116:119], v7, s[24:27], s48 offen
    s_waitcnt vmcnt(27)
    s_barrier
    s_add_u32 s47, s78, 3
    s_sub_u32 s48, s47, 10
    s_cselect_b32 s47, s47, s48
    s_lshl_b32 s47, s47, 7
    s_add_u32 s47, s47, s40
    s_add_u32 s48, s47, 40960
    s_add_u32 m0, s43, 4096
    s_nop 0
    buffer_load_dwordx4 v2, s[16:19], s48 offen  lds
    s_add_u32 s48, s47, 51200
    s_add_u32 m0, s43, 5120
    s_nop 0
    buffer_load_dwordx4 v3, s[16:19], s48 offen  lds
    s_add_u32 s48, s47, 61440
    s_add_u32 m0, s43, 6144
    s_nop 0
    buffer_load_dwordx4 v2, s[16:19], s48 offen  lds
    s_add_u32 s48, s47, 71680
    s_add_u32 m0, s43, 7168
    s_nop 0
    buffer_load_dwordx4 v3, s[16:19], s48 offen  lds
    s_lshl_b32 s49, s78, 1
    s_add_u32 s49, s49, 6
    s_sub_u32 s48, s49, 20
    s_cselect_b32 s49, s49, s48
    s_mul_i32 s49, s49, s42
    s_add_u32 m0, s44, 110592
    s_nop 0
    buffer_load_dwordx4 v4, s[24:27], s49 offen  lds
    s_add_u32 m0, s45, 110592
    s_nop 0
    buffer_load_dwordx4 v5, s[24:27], s49 offen  lds
    s_add_u32 m0, s46, 110592
    s_nop 0
    buffer_load_dwordx4 v6, s[24:27], s49 offen  lds
    s_waitcnt vmcnt(20)
    s_barrier
    s_add_u32 s47, s78, 4
    s_sub_u32 s48, s47, 10
    s_cselect_b32 s47, s47, s48
    s_lshl_b32 s47, s47, 7
    s_add_u32 s47, s47, s40
    s_add_u32 s48, s47, 0
    s_add_u32 m0, s43, 8192
    s_nop 0
    buffer_load_dwordx4 v2, s[16:19], s48 offen  lds
    s_add_u32 s48, s47, 10240
    s_add_u32 m0, s43, 9216
    s_nop 0
    buffer_load_dwordx4 v3, s[16:19], s48 offen  lds
    s_add_u32 s48, s47, 20480
    s_add_u32 m0, s43, 10240
    s_nop 0
    buffer_load_dwordx4 v2, s[16:19], s48 offen  lds
    s_add_u32 s48, s47, 30720
    s_add_u32 m0, s43, 11264
    s_nop 0
    buffer_load_dwordx4 v3, s[16:19], s48 offen  lds
    s_lshl_b32 s49, s78, 1
    s_add_u32 s49, s49, 7
    s_sub_u32 s48, s49, 20
    s_cselect_b32 s49, s49, s48
    s_mul_i32 s49, s49, s42
    s_add_u32 m0, s44, 122880
    s_nop 0
    buffer_load_dwordx4 v4, s[24:27], s49 offen  lds
    s_add_u32 m0, s45, 122880
    s_nop 0
    buffer_load_dwordx4 v5, s[24:27], s49 offen  lds
    s_add_u32 m0, s46, 122880
    s_nop 0
    buffer_load_dwordx4 v6, s[24:27], s49 offen  lds
    s_waitcnt vmcnt(14)
    s_setprio 3
    v_mfma_f32_16x16x32_bf16 v[120:123], v[124:127], v[80:83], 0
    v_mfma_f32_16x16x32_bf16 v[120:123], v[124:127], v[84:87], v[120:123]
    v_mfma_f32_16x16x32_bf16 v[120:123], v[124:127], v[88:91], v[120:123]
    v_mfma_f32_16x16x32_bf16 v[120:123], v[124:127], v[92:95], v[120:123]
    v_mfma_f32_16x16x32_bf16 v[120:123], v[124:127], v[96:99], v[120:123]
    v_mfma_f32_16x16x32_bf16 v[120:123], v[124:127], v[100:103], v[120:123]
    v_mfma_f32_16x16x32_bf16 v[120:123], v[124:127], v[104:107], v[120:123]
    v_mfma_f32_16x16x32_bf16 v[120:123], v[124:127], v[108:111], v[120:123]
    v_mfma_f32_16x16x32_bf16 v[120:123], v[124:127], v[112:115], v[120:123]
    v_mfma_f32_16x16x32_bf16 v[120:123], v[124:127], v[116:119], v[120:123]
    s_nop 0
    v_mov_b32 v40, 0x3f803f80
    v_dot2_f32_bf16 v36, v16, v40, 0
    v_dot2_f32_bf16 v37, v16, v16, 0
    v_dot2_f32_bf16 v41, v17, v40, 0
    v_dot2_f32_bf16 v42, v17, v17, 0
    v_dot2_f32_bf16 v36, v18, v40, v36
    v_dot2_f32_bf16 v37, v18, v18, v37
    v_dot2_f32_bf16 v41, v19, v40, v41
    v_dot2_f32_bf16 v42, v19, v19, v42
    v_dot2_f32_bf16 v36, v20, v40, v36
    v_dot2_f32_bf16 v37, v20, v20, v37
    v_dot2_f32_bf16 v41, v21, v40, v41
    v_dot2_f32_bf16 v42, v21, v21, v42
    v_dot2_f32_bf16 v36, v22, v40, v36
    v_dot2_f32_bf16 v37, v22, v22, v37
    v_dot2_f32_bf16 v41, v23, v40, v41
    v_dot2_f32_bf16 v42, v23, v23, v42
    v_dot2_f32_bf16 v36, v24, v40, v36
    v_dot2_f32_bf16 v37, v24, v24, v37
    v_dot2_f32_bf16 v41, v25, v40, v41
    v_dot2_f32_bf16 v42, v25, v25, v42
    v_dot2_f32_bf16 v36, v26, v40, v36
    v_dot2_f32_bf16 v37, v26, v26, v37
    v_dot2_f32_bf16 v41, v27, v40, v41
    v_dot2_f32_bf16 v42, v27, v27, v42
    v_dot2_f32_bf16 v36, v28, v40, v36
    v_dot2_f32_bf16 v37, v28, v28, v37
    v_dot2_f32_bf16 v41, v29, v40, v41
    v_dot2_f32_bf16 v42, v29, v29, v42
    v_dot2_f32_bf16 v36, v30, v40, v36
    v_dot2_f32_bf16 v37, v30, v30, v37
    v_dot2_f32_bf16 v41, v31, v40, v41
    v_dot2_f32_bf16 v42, v31, v31, v42
    v_dot2_f32_bf16 v36, v32, v40, v36
    v_dot2_f32_bf16 v37, v32, v32, v37
    v_dot2_f32_bf16 v41, v33, v40, v41
    v_dot2_f32_bf16 v42, v33, v33, v42
    v_dot2_f32_bf16 v36, v34, v40, v36
    v_dot2_f32_bf16 v37, v34, v34, v37
    v_dot2_f32_bf16 v41, v35, v40, v41
    v_dot2_f32_bf16 v42, v35, v35, v42
    s_setprio 0
    s_barrier
    s_add_u32 s47, s78, 4
    s_sub_u32 s48, s47, 10
    s_cselect_b32 s47, s47, s48
    s_lshl_b32 s47, s47, 7
    s_add_u32 s47, s47, s40
    s_add_u32 s48, s47, 40960
    s_add_u32 m0, s43, 12288
    s_nop 0
    buffer_load_dwordx4 v2, s[16:19], s48 offen  lds
    s_add_u32 s48, s47, 51200
    s_add_u32 m0, s43, 13312
    s_nop 0
    buffer_load_dwordx4 v3, s[16:19], s48 offen  lds
    s_add_u32 s48, s47, 61440
    s_add_u32 m0, s43, 14336
    s_nop 0
    buffer_load_dwordx4 v2, s[16:19], s48 offen  lds
    s_add_u32 s48, s47, 71680
    s_add_u32 m0, s43, 15360
    s_nop 0
    buffer_load_dwordx4 v3, s[16:19], s48 offen  lds
    s_lshl_b32 s49, s78, 1
    s_add_u32 s49, s49, 8
    s_sub_u32 s48, s49, 20
    s_cselect_b32 s49, s49, s48
    s_mul_i32 s49, s49, s42
    s_add_u32 m0, s44, 135168
    s_nop 0
    buffer_load_dwordx4 v4, s[24:27], s49 offen  lds
    s_add_u32 m0, s45, 135168
    s_nop 0
    buffer_load_dwordx4 v5, s[24:27], s49 offen  lds
    s_add_u32 m0, s46, 135168
    s_nop 0
    buffer_load_dwordx4 v6, s[24:27], s49 offen  lds
    s_setprio 3
    s_nop 2
    v_add_f32 v36, v36, v41
    v_add_f32 v37, v37, v42
    s_nop 0
    v_add_f32_dpp v36, v36, v36 row_ror:8 row_mask:0xf bank_mask:0xf
    v_add_f32_dpp v37, v37, v37 row_ror:8 row_mask:0xf bank_mask:0xf
    s_nop 0
    v_add_f32_dpp v36, v36, v36 row_ror:4 row_mask:0xf bank_mask:0xf
    v_add_f32_dpp v37, v37, v37 row_ror:4 row_mask:0xf bank_mask:0xf
    s_nop 0
    v_add_f32_dpp v36, v36, v36 row_ror:2 row_mask:0xf bank_mask:0xf
    v_add_f32_dpp v37, v37, v37 row_ror:2 row_mask:0xf bank_mask:0xf
    s_nop 0
    s_nop 0
    v_add_f32_dpp v36, v36, v36 row_ror:1 row_mask:0xf bank_mask:0xf
    v_add_f32_dpp v37, v37, v37 row_ror:1 row_mask:0xf bank_mask:0xf
    v_mul_f32 v36, 0x3acccccd, v36
    v_mul_f32 v37, 0x3acccccd, v37
    v_fma_f32 v37, -v36, v36, v37
    v_max_f32_e64 v37, 0, v37
    v_cvt_pk_bf16_f32 v36, v36, v36
    v_lshlrev_b32_e64 v36, 16, v36
    v_cvt_pk_bf16_f32 v37, v37, v37
    v_lshlrev_b32_e64 v37, 16, v37
    v_add_f32 v37, 0x3727c5ac, v37
    v_cvt_pk_bf16_f32 v37, v37, v37
    v_lshlrev_b32 v37, 16, v37
    v_sqrt_f32_e64 v37, v37
    s_nop 0
    v_cvt_pk_bf16_f32 v37, v37, v37
    v_lshlrev_b32 v37, 16, v37
    v_rcp_f32 v37, v37
    v_bfe_u32 v16, v0, 4, 1
    v_lshlrev_b32 v16, 3, v16
    s_lshl_b32 s67, s41, 4
    s_add_u32 s67, s67, 159744
    v_add_u32 v16, s67, v16
    ds_write_b64 v16, v[36:37]
    v_and_b32 v80, 15, v0
    v_lshlrev_b32 v80, 5, v80
    v_lshrrev_b32 v81, 4, v0
    v_lshl_add_u32 v80, v81, 4, v80
    s_mul_i32 s48, s41, 384
    s_add_u32 s48, s48, 159872
    v_add_u32 v80, s48, v80
    s_mov_b64 exec, 268374015
    ds_write_b128 v80, v[120:123]
    s_mov_b64 exec, -1
    s_waitcnt lgkmcnt(0)
    s_setprio 0
    s_waitcnt vmcnt(14)
    s_barrier
    s_add_u32 s47, s78, 5
    s_sub_u32 s48, s47, 10
    s_cselect_b32 s47, s47, s48
    s_lshl_b32 s47, s47, 7
    s_add_u32 s47, s47, s40
    s_add_u32 s48, s47, 0
    s_add_u32 m0, s43, 16384
    s_nop 0
    buffer_load_dwordx4 v2, s[16:19], s48 offen  lds
    s_add_u32 s48, s47, 10240
    s_add_u32 m0, s43, 17408
    s_nop 0
    buffer_load_dwordx4 v3, s[16:19], s48 offen  lds
    s_add_u32 s48, s47, 20480
    s_add_u32 m0, s43, 18432
    s_nop 0
    buffer_load_dwordx4 v2, s[16:19], s48 offen  lds
    s_add_u32 s48, s47, 30720
    s_add_u32 m0, s43, 19456
    s_nop 0
    buffer_load_dwordx4 v3, s[16:19], s48 offen  lds
    s_lshl_b32 s49, s78, 1
    s_add_u32 s49, s49, 9
    s_sub_u32 s48, s49, 20
    s_cselect_b32 s49, s49, s48
    s_mul_i32 s49, s49, s42
    s_add_u32 m0, s44, 147456
    s_nop 0
    buffer_load_dwordx4 v4, s[24:27], s49 offen  lds
    s_add_u32 m0, s45, 147456
    s_nop 0
    buffer_load_dwordx4 v5, s[24:27], s49 offen  lds
    s_add_u32 m0, s46, 147456
    s_nop 0
    buffer_load_dwordx4 v6, s[24:27], s49 offen  lds
    s_mul_i32 s30, s32, 30
    s_add_u32 s30, s30, s29
    s_lshl_b32 s30, s30, 2
    s_add_u32 s30, s30, s41
    s_waitcnt lgkmcnt(0)
    s_cmp_lt_u32 s30, 740
    s_mov_b32 s76, 2146435072
    s_cselect_b32 s76, 13631488, s76
    s_cselect_b32 s77, 0, 2146435072
    s_mul_i32 s74, s30, 6554
    s_lshr_b32 s74, s74, 16
    s_mul_i32 s75, s74, 10
    s_sub_u32 s75, s30, s75
    s_cmp_lt_u32 s74, 54
    s_cselect_b32 s4, s72, s70
    s_cselect_b32 s5, s73, s71
    s_mov_b32 s6, 819200
    s_cselect_b32 s6, 2211840, s6
    s_mov_b32 s7, 0x20000
    s_cselect_b32 s31, 4, 20
    s_lshl_b32 s36, s74, 5
    s_mov_b32 s38, 16
    s_cmp_lt_u32 s74, 54
    s_cbranch_scc1 LG_rl
    s_sub_u32 s33, s74, 54
    s_mul_i32 s36, s33, 205
    s_lshr_b32 s36, s36, 10
    s_mul_i32 s48, s36, 5
    s_sub_u32 s33, s33, s48
    s_mul_i32 s36, s36, 160
    s_lshl_b32 s48, s33, 3
    s_cmp_ge_u32 s33, 3
    s_cselect_b32 s47, 56, 0
    s_add_u32 s48, s48, s47
    s_add_u32 s36, s36, s48
    s_cmp_eq_u32 s33, 2
    s_cselect_b32 s38, 80, 4
LG_rl:
    v_lshrrev_b32_e64 v8, 5, v0
    v_mul_lo_u32 v8, v8, s38
    v_bfe_u32 v9, v0, 3, 2
    v_add_u32_e64 v8, v8, v9
    v_mul_u32_u24 v8, 1280, v8
    v_and_b32_e64 v9, 7, v0
    v_lshl_add_u32 v8, v9, 4, v8
    s_mul_i32 s36, s36, 1280
    s_lshl_b32 s47, s75, 7
    s_add_u32 s47, s47, s36
    s_add_u32 s47, s47, s77
    s_mul_i32 s31, s31, 1280
    buffer_load_dwordx4 v[140:143], v8, s[4:7], s47 offen
    s_add_u32 s47, s47, s31
    buffer_load_dwordx4 v[144:147], v8, s[4:7], s47 offen
    s_add_u32 s47, s47, s31
    buffer_load_dwordx4 v[148:151], v8, s[4:7], s47 offen
    s_add_u32 s47, s47, s31
    buffer_load_dwordx4 v[152:155], v8, s[4:7], s47 offen
    s_waitcnt vmcnt(18)
    s_barrier
    s_add_u32 s47, s78, 5
    s_sub_u32 s48, s47, 10
    s_cselect_b32 s47, s47, s48
    s_lshl_b32 s47, s47, 7
    s_add_u32 s47, s47, s40
    s_add_u32 s48, s47, 40960
    s_add_u32 m0, s43, 20480
    s_nop 0
    buffer_load_dwordx4 v2, s[16:19], s48 offen  lds
    s_add_u32 s48, s47, 51200
    s_add_u32 m0, s43, 21504
    s_nop 0
    buffer_load_dwordx4 v3, s[16:19], s48 offen  lds
    s_add_u32 s48, s47, 61440
    s_add_u32 m0, s43, 22528
    s_nop 0
    buffer_load_dwordx4 v2, s[16:19], s48 offen  lds
    s_add_u32 s48, s47, 71680
    s_add_u32 m0, s43, 23552
    s_nop 0
    buffer_load_dwordx4 v3, s[16:19], s48 offen  lds
    s_lshl_b32 s49, s78, 1
    s_add_u32 s49, s49, 10
    s_sub_u32 s48, s49, 20
    s_cselect_b32 s49, s49, s48
    s_mul_i32 s49, s49, s42
    s_add_u32 m0, s44, 98304
    s_nop 0
    buffer_load_dwordx4 v4, s[24:27], s49 offen  lds
    s_add_u32 m0, s45, 98304
    s_nop 0
    buffer_load_dwordx4 v5, s[24:27], s49 offen  lds
    s_add_u32 m0, s46, 98304
    s_nop 0
    buffer_load_dwordx4 v6, s[24:27], s49 offen  lds
    s_mul_i32 s31, s30, 3277
    s_lshr_b32 s31, s31, 16
    s_mul_i32 s31, s31, 54
    s_add_u32 s31, s31, s30
    s_add_u32 s31, s31, 54
    s_lshl_b32 s31, s31, 12
    s_add_u32 s31, s31, 3145728
    s_lshl_b32 s33, s30, 12
    s_add_u32 s33, s33, 18350080
    s_cmp_lt_u32 s30, 640
    s_cselect_b32 s31, s31, s33
    s_cmp_lt_u32 s30, 768
    s_cselect_b32 s31, s31, 2146435072
    v_lshlrev_b32 v176, 4, v0
    v_mov_b32 v172, -1
    v_mov_b32 v173, -1
    v_mov_b32 v174, -1
    v_mov_b32 v175, -1
    buffer_store_dwordx4 v[172:175], v176, s[20:23], s31 offen offset:0 sc1
    buffer_store_dwordx4 v[172:175], v176, s[20:23], s31 offen offset:1024 sc1
    buffer_store_dwordx4 v[172:175], v176, s[20:23], s31 offen offset:2048 sc1
    buffer_store_dwordx4 v[172:175], v176, s[20:23], s31 offen offset:3072 sc1
    s_waitcnt vmcnt(22)
    s_barrier
    s_add_u32 s47, s78, 6
    s_sub_u32 s48, s47, 10
    s_cselect_b32 s47, s47, s48
    s_lshl_b32 s47, s47, 7
    s_add_u32 s47, s47, s40
    s_add_u32 s48, s47, 0
    s_add_u32 m0, s43, 0
    s_nop 0
    buffer_load_dwordx4 v2, s[16:19], s48 offen  lds
    s_add_u32 s48, s47, 10240
    s_add_u32 m0, s43, 1024
    s_nop 0
    buffer_load_dwordx4 v3, s[16:19], s48 offen  lds
    s_add_u32 s48, s47, 20480
    s_add_u32 m0, s43, 2048
    s_nop 0
    buffer_load_dwordx4 v2, s[16:19], s48 offen  lds
    s_add_u32 s48, s47, 30720
    s_add_u32 m0, s43, 3072
    s_nop 0
    buffer_load_dwordx4 v3, s[16:19], s48 offen  lds
    s_lshl_b32 s49, s78, 1
    s_add_u32 s49, s49, 11
    s_sub_u32 s48, s49, 20
    s_cselect_b32 s49, s49, s48
    s_mul_i32 s49, s49, s42
    s_add_u32 m0, s44, 110592
    s_nop 0
    buffer_load_dwordx4 v4, s[24:27], s49 offen  lds
    s_add_u32 m0, s45, 110592
    s_nop 0
    buffer_load_dwordx4 v5, s[24:27], s49 offen  lds
    s_add_u32 m0, s46, 110592
    s_nop 0
    buffer_load_dwordx4 v6, s[24:27], s49 offen  lds
    s_add_u32 s47, s43, 4096
    v_lshlrev_b32 v10, 4, v0
    v_add_u32 v8, s47, v10
    v_lshrrev_b32 v9, 4, v0
    v_lshlrev_b32 v9, 10, v9
    v_bfe_u32 v11, v0, 2, 2
    v_lshl_add_u32 v9, v11, 7, v9
    v_and_b32_e64 v11, 3, v0
    v_lshl_add_u32 v9, v11, 3, v9
    v_add_u32 v9, s47, v9
    s_waitcnt vmcnt(18)
    ds_write_b128 v8, v[140:143] offset:0
    ds_write_b128 v8, v[144:147] offset:1024
    ds_write_b128 v8, v[148:151] offset:2048
    ds_write_b128 v8, v[152:155] offset:3072
    s_barrier
    s_lshl_b32 s49, s78, 1
    s_add_u32 s49, s49, 12
    s_sub_u32 s48, s49, 20
    s_cselect_b32 s49, s49, s48
    s_mul_i32 s49, s49, s42
    s_add_u32 m0, s44, 122880
    s_nop 0
    buffer_load_dwordx4 v4, s[24:27], s49 offen  lds
    s_add_u32 m0, s45, 122880
    s_nop 0
    buffer_load_dwordx4 v5, s[24:27], s49 offen  lds
    s_add_u32 m0, s46, 122880
    s_nop 0
    buffer_load_dwordx4 v6, s[24:27], s49 offen  lds
    s_waitcnt lgkmcnt(0)
    ds_read_b64_tr_b16 v[156:157], v9 offset:0
    ds_read_b64_tr_b16 v[158:159], v9 offset:512
    ds_read_b64_tr_b16 v[160:161], v9 offset:32
    ds_read_b64_tr_b16 v[162:163], v9 offset:544
    ds_read_b64_tr_b16 v[164:165], v9 offset:64
    ds_read_b64_tr_b16 v[166:167], v9 offset:576
    ds_read_b64_tr_b16 v[168:169], v9 offset:96
    ds_read_b64_tr_b16 v[170:171], v9 offset:608
    s_lshl_b32 s47, s75, 2
    s_add_u32 s47, s47, 0
    s_mul_i32 s48, s47, 205
    s_lshr_b32 s48, s48, 10
    s_mul_i32 s49, s48, 5
    s_sub_u32 s47, s47, s49
    s_mul_i32 s48, s48, 74
    s_add_u32 s48, s48, s74
    s_mul_i32 s48, s48, 5
    s_add_u32 s48, s48, s47
    s_lshl_b32 s48, s48, 10
    s_add_u32 s48, s48, s76
    s_waitcnt lgkmcnt(6)
    buffer_store_dwordx4 v[156:159], v10, s[20:23], s48 offen sc1
    s_lshl_b32 s47, s75, 2
    s_add_u32 s47, s47, 1
    s_mul_i32 s48, s47, 205
    s_lshr_b32 s48, s48, 10
    s_mul_i32 s49, s48, 5
    s_sub_u32 s47, s47, s49
    s_mul_i32 s48, s48, 74
    s_add_u32 s48, s48, s74
    s_mul_i32 s48, s48, 5
    s_add_u32 s48, s48, s47
    s_lshl_b32 s48, s48, 10
    s_add_u32 s48, s48, s76
    s_waitcnt lgkmcnt(4)
    buffer_store_dwordx4 v[160:163], v10, s[20:23], s48 offen sc1
    s_lshl_b32 s47, s75, 2
    s_add_u32 s47, s47, 2
    s_mul_i32 s48, s47, 205
    s_lshr_b32 s48, s48, 10
    s_mul_i32 s49, s48, 5
    s_sub_u32 s47, s47, s49
    s_mul_i32 s48, s48, 74
    s_add_u32 s48, s48, s74
    s_mul_i32 s48, s48, 5
    s_add_u32 s48, s48, s47
    s_lshl_b32 s48, s48, 10
    s_add_u32 s48, s48, s76
    s_waitcnt lgkmcnt(2)
    buffer_store_dwordx4 v[164:167], v10, s[20:23], s48 offen sc1
    s_lshl_b32 s47, s75, 2
    s_add_u32 s47, s47, 3
    s_mul_i32 s48, s47, 205
    s_lshr_b32 s48, s48, 10
    s_mul_i32 s49, s48, 5
    s_sub_u32 s47, s47, s49
    s_mul_i32 s48, s48, 74
    s_add_u32 s48, s48, s74
    s_mul_i32 s48, s48, 5
    s_add_u32 s48, s48, s47
    s_lshl_b32 s48, s48, 10
    s_add_u32 s48, s48, s76
    s_waitcnt lgkmcnt(0)
    buffer_store_dwordx4 v[168:171], v10, s[20:23], s48 offen sc1
    s_add_u32 s47, s78, 6
    s_sub_u32 s48, s47, 10
    s_cselect_b32 s47, s47, s48
    s_lshl_b32 s47, s47, 7
    s_add_u32 s47, s47, s40
    s_add_u32 s48, s47, 40960
    s_add_u32 m0, s43, 4096
    s_nop 0
    buffer_load_dwordx4 v2, s[16:19], s48 offen  lds
    s_add_u32 s48, s47, 51200
    s_add_u32 m0, s43, 5120
    s_nop 0
    buffer_load_dwordx4 v3, s[16:19], s48 offen  lds
    s_add_u32 s48, s47, 61440
    s_add_u32 m0, s43, 6144
    s_nop 0
    buffer_load_dwordx4 v2, s[16:19], s48 offen  lds
    s_add_u32 s48, s47, 71680
    s_add_u32 m0, s43, 7168
    s_nop 0
    buffer_load_dwordx4 v3, s[16:19], s48 offen  lds
    s_waitcnt vmcnt(22)
    s_barrier
    s_add_u32 s47, s78, 7
    s_sub_u32 s48, s47, 10
    s_cselect_b32 s47, s47, s48
    s_lshl_b32 s47, s47, 7
    s_add_u32 s47, s47, s40
    s_add_u32 s48, s47, 0
    s_add_u32 m0, s43, 8192
    s_nop 0
    buffer_load_dwordx4 v2, s[16:19], s48 offen  lds
    s_add_u32 s48, s47, 10240
    s_add_u32 m0, s43, 9216
    s_nop 0
    buffer_load_dwordx4 v3, s[16:19], s48 offen  lds
    s_add_u32 s48, s47, 20480
    s_add_u32 m0, s43, 10240
    s_nop 0
    buffer_load_dwordx4 v2, s[16:19], s48 offen  lds
    s_add_u32 s48, s47, 30720
    s_add_u32 m0, s43, 11264
    s_nop 0
    buffer_load_dwordx4 v3, s[16:19], s48 offen  lds
    s_lshl_b32 s49, s78, 1
    s_add_u32 s49, s49, 13
    s_sub_u32 s48, s49, 20
    s_cselect_b32 s49, s49, s48
    s_mul_i32 s49, s49, s42
    s_add_u32 m0, s44, 135168
    s_nop 0
    buffer_load_dwordx4 v4, s[24:27], s49 offen  lds
    s_add_u32 m0, s45, 135168
    s_nop 0
    buffer_load_dwordx4 v5, s[24:27], s49 offen  lds
    s_add_u32 m0, s46, 135168
    s_nop 0
    buffer_load_dwordx4 v6, s[24:27], s49 offen  lds
    s_waitcnt vmcnt(18)
    s_barrier
    s_add_u32 s47, s78, 7
    s_sub_u32 s48, s47, 10
    s_cselect_b32 s47, s47, s48
    s_lshl_b32 s47, s47, 7
    s_add_u32 s47, s47, s40
    s_add_u32 s48, s47, 40960
    s_add_u32 m0, s43, 12288
    s_nop 0
    buffer_load_dwordx4 v2, s[16:19], s48 offen  lds
    s_add_u32 s48, s47, 51200
    s_add_u32 m0, s43, 13312
    s_nop 0
    buffer_load_dwordx4 v3, s[16:19], s48 offen  lds
    s_add_u32 s48, s47, 61440
    s_add_u32 m0, s43, 14336
    s_nop 0
    buffer_load_dwordx4 v2, s[16:19], s48 offen  lds
    s_add_u32 s48, s47, 71680
    s_add_u32 m0, s43, 15360
    s_nop 0
    buffer_load_dwordx4 v3, s[16:19], s48 offen  lds
    s_lshl_b32 s49, s78, 1
    s_add_u32 s49, s49, 14
    s_sub_u32 s48, s49, 20
    s_cselect_b32 s49, s49, s48
    s_mul_i32 s49, s49, s42
    s_add_u32 m0, s44, 147456
    s_nop 0
    buffer_load_dwordx4 v4, s[24:27], s49 offen  lds
    s_add_u32 m0, s45, 147456
    s_nop 0
    buffer_load_dwordx4 v5, s[24:27], s49 offen  lds
    s_add_u32 m0, s46, 147456
    s_nop 0
    buffer_load_dwordx4 v6, s[24:27], s49 offen  lds
    s_waitcnt vmcnt(14)
    s_barrier
    s_cmp_lg_u32 s41, 0
    s_cbranch_scc1 LG_cs
    s_and_b32 s67, s2, 1
    s_lshl_b32 s67, s67, 6
    s_add_u32 s67, s67, 4
    v_mov_b32 v130, s67
    v_mov_b32 v131, 1
    s_mov_b64 exec, 1
    global_atomic_add v130, v131, s[14:15]
    s_mov_b64 exec, -1
LG_cs:
    s_add_u32 s47, s78, 8
    s_sub_u32 s48, s47, 10
    s_cselect_b32 s47, s47, s48
    s_lshl_b32 s47, s47, 7
    s_add_u32 s47, s47, s40
    s_add_u32 s48, s47, 0
    s_add_u32 m0, s43, 16384
    s_nop 0
    buffer_load_dwordx4 v2, s[16:19], s48 offen  lds
    s_add_u32 s48, s47, 10240
    s_add_u32 m0, s43, 17408
    s_nop 0
    buffer_load_dwordx4 v3, s[16:19], s48 offen  lds
    s_add_u32 s48, s47, 20480
    s_add_u32 m0, s43, 18432
    s_nop 0
    buffer_load_dwordx4 v2, s[16:19], s48 offen  lds
    s_add_u32 s48, s47, 30720
    s_add_u32 m0, s43, 19456
    s_nop 0
    buffer_load_dwordx4 v3, s[16:19], s48 offen  lds
    s_lshl_b32 s49, s78, 1
    s_add_u32 s49, s49, 15
    s_sub_u32 s48, s49, 20
    s_cselect_b32 s49, s49, s48
    s_mul_i32 s49, s49, s42
    s_add_u32 m0, s44, 98304
    s_nop 0
    buffer_load_dwordx4 v4, s[24:27], s49 offen  lds
    s_add_u32 m0, s45, 98304
    s_nop 0
    buffer_load_dwordx4 v5, s[24:27], s49 offen  lds
    s_add_u32 m0, s46, 98304
    s_nop 0
    buffer_load_dwordx4 v6, s[24:27], s49 offen  lds
    s_waitcnt vmcnt(14)
    s_barrier
    s_add_u32 s47, s78, 8
    s_sub_u32 s48, s47, 10
    s_cselect_b32 s47, s47, s48
    s_lshl_b32 s47, s47, 7
    s_add_u32 s47, s47, s40
    s_add_u32 s48, s47, 40960
    s_add_u32 m0, s43, 20480
    s_nop 0
    buffer_load_dwordx4 v2, s[16:19], s48 offen  lds
    s_add_u32 s48, s47, 51200
    s_add_u32 m0, s43, 21504
    s_nop 0
    buffer_load_dwordx4 v3, s[16:19], s48 offen  lds
    s_add_u32 s48, s47, 61440
    s_add_u32 m0, s43, 22528
    s_nop 0
    buffer_load_dwordx4 v2, s[16:19], s48 offen  lds
    s_add_u32 s48, s47, 71680
    s_add_u32 m0, s43, 23552
    s_nop 0
    buffer_load_dwordx4 v3, s[16:19], s48 offen  lds
    s_lshl_b32 s49, s78, 1
    s_add_u32 s49, s49, 16
    s_sub_u32 s48, s49, 20
    s_cselect_b32 s49, s49, s48
    s_mul_i32 s49, s49, s42
    s_add_u32 m0, s44, 110592
    s_nop 0
    buffer_load_dwordx4 v4, s[24:27], s49 offen  lds
    s_add_u32 m0, s45, 110592
    s_nop 0
    buffer_load_dwordx4 v5, s[24:27], s49 offen  lds
    s_add_u32 m0, s46, 110592
    s_nop 0
    buffer_load_dwordx4 v6, s[24:27], s49 offen  lds
    s_waitcnt vmcnt(14)
    s_barrier
    s_add_u32 s47, s78, 9
    s_sub_u32 s48, s47, 10
    s_cselect_b32 s47, s47, s48
    s_lshl_b32 s47, s47, 7
    s_add_u32 s47, s47, s40
    s_add_u32 s48, s47, 0
    s_add_u32 m0, s43, 0
    s_nop 0
    buffer_load_dwordx4 v2, s[16:19], s48 offen  lds
    s_add_u32 s48, s47, 10240
    s_add_u32 m0, s43, 1024
    s_nop 0
    buffer_load_dwordx4 v3, s[16:19], s48 offen  lds
    s_add_u32 s48, s47, 20480
    s_add_u32 m0, s43, 2048
    s_nop 0
    buffer_load_dwordx4 v2, s[16:19], s48 offen  lds
    s_add_u32 s48, s47, 30720
    s_add_u32 m0, s43, 3072
    s_nop 0
    buffer_load_dwordx4 v3, s[16:19], s48 offen  lds
    s_lshl_b32 s49, s78, 1
    s_add_u32 s49, s49, 17
    s_sub_u32 s48, s49, 20
    s_cselect_b32 s49, s49, s48
    s_mul_i32 s49, s49, s42
    s_add_u32 m0, s44, 122880
    s_nop 0
    buffer_load_dwordx4 v4, s[24:27], s49 offen  lds
    s_add_u32 m0, s45, 122880
    s_nop 0
    buffer_load_dwordx4 v5, s[24:27], s49 offen  lds
    s_add_u32 m0, s46, 122880
    s_nop 0
    buffer_load_dwordx4 v6, s[24:27], s49 offen  lds
    s_waitcnt vmcnt(14)
    s_barrier
    s_cmp_lg_u32 s41, 0
    s_cbranch_scc1 LG_pi
    v_and_b32 v20, 1, v0
    v_lshlrev_b32 v20, 6, v20
    global_load_dword v21, v20, s[14:15] offset:128 sc1
LG_pi:
    s_add_u32 s47, s78, 9
    s_sub_u32 s48, s47, 10
    s_cselect_b32 s47, s47, s48
    s_lshl_b32 s47, s47, 7
    s_add_u32 s47, s47, s40
    s_add_u32 s48, s47, 40960
    s_add_u32 m0, s43, 4096
    s_nop 0
    buffer_load_dwordx4 v2, s[16:19], s48 offen  lds
    s_add_u32 s48, s47, 51200
    s_add_u32 m0, s43, 5120
    s_nop 0
    buffer_load_dwordx4 v3, s[16:19], s48 offen  lds
    s_add_u32 s48, s47, 61440
    s_add_u32 m0, s43, 6144
    s_nop 0
    buffer_load_dwordx4 v2, s[16:19], s48 offen  lds
    s_add_u32 s48, s47, 71680
    s_add_u32 m0, s43, 7168
    s_nop 0
    buffer_load_dwordx4 v3, s[16:19], s48 offen  lds
    s_lshl_b32 s49, s78, 1
    s_add_u32 s49, s49, 18
    s_sub_u32 s48, s49, 20
    s_cselect_b32 s49, s49, s48
    s_mul_i32 s49, s49, s42
    s_add_u32 m0, s44, 135168
    s_nop 0
    buffer_load_dwordx4 v4, s[24:27], s49 offen  lds
    s_add_u32 m0, s45, 135168
    s_nop 0
    buffer_load_dwordx4 v5, s[24:27], s49 offen  lds
    s_add_u32 m0, s46, 135168
    s_nop 0
    buffer_load_dwordx4 v6, s[24:27], s49 offen  lds
    s_waitcnt vmcnt(14)
    s_barrier
    s_lshl_b32 s49, s78, 1
    s_add_u32 s49, s49, 19
    s_sub_u32 s48, s49, 20
    s_cselect_b32 s49, s49, s48
    s_mul_i32 s49, s49, s42
    s_add_u32 m0, s44, 147456
    s_nop 0
    buffer_load_dwordx4 v4, s[24:27], s49 offen  lds
    s_add_u32 m0, s45, 147456
    s_nop 0
    buffer_load_dwordx4 v5, s[24:27], s49 offen  lds
    s_add_u32 m0, s46, 147456
    s_nop 0
    buffer_load_dwordx4 v6, s[24:27], s49 offen  lds
    s_cmp_lg_u32 s41, 0
    s_cbranch_scc1 LG_pc
    s_waitcnt vmcnt(10)
    s_mov_b32 s68, 100000
    s_branch LGG_chk
LGG_spin:
    global_load_dword v21, v20, s[14:15] offset:128 sc1
    s_waitcnt vmcnt(0)
LGG_chk:
    v_cmp_ne_u32 vcc, 1, v21
    s_cbranch_vccz LGG_out
    s_sub_u32 s68, s68, 1
    s_cbranch_scc1 LGG_out
    s_sleep 2
    s_branch LGG_spin
LGG_out:
LG_pc:
    s_waitcnt vmcnt(10)
    s_barrier
    v_lshrrev_b32 v16, 3, v0
    v_and_b32 v17, 7, v0
    v_lshlrev_b32 v17, 3, v17
    v_lshl_add_u32 v17, v16, 7, v17
    s_lshl_b32 s48, s32, 5
    s_lshl_b32 s49, s41, 3
    s_add_u32 s48, s48, s49
    s_lshl_b32 s48, s48, 7
    s_add_u32 s48, s48, 20447232
    buffer_load_dwordx2 v[18:19], v17, s[20:23], s48 offen sc1
    v_lshlrev_b32 v16, 3, v0
    v_lshlrev_b32 v17, 2, v0
    buffer_load_dword v40, v17, s[20:23], s53 offen offset:0 sc1
    buffer_load_dword v41, v17, s[20:23], s53 offen offset:768 sc1
    buffer_load_dword v42, v17, s[20:23], s53 offen offset:1536 sc1
    buffer_load_dword v43, v17, s[20:23], s53 offen offset:2304 sc1
    buffer_load_dword v44, v17, s[20:23], s53 offen offset:3072 sc1
    s_add_u32 s53, s53, 3840
    buffer_load_dword v45, v17, s[20:23], s53 offen offset:0 sc1
    buffer_load_dword v46, v17, s[20:23], s53 offen offset:768 sc1
    buffer_load_dword v47, v17, s[20:23], s53 offen offset:1536 sc1
    buffer_load_dword v48, v17, s[20:23], s53 offen offset:2304 sc1
    buffer_load_dword v49, v17, s[20:23], s53 offen offset:3072 sc1
    s_add_u32 s53, s53, 3840
    buffer_load_dword v50, v17, s[20:23], s53 offen offset:0 sc1
    buffer_load_dword v51, v17, s[20:23], s53 offen offset:768 sc1
    buffer_load_dword v52, v17, s[20:23], s53 offen offset:1536 sc1
    buffer_load_dword v53, v17, s[20:23], s53 offen offset:2304 sc1
    buffer_load_dword v54, v17, s[20:23], s53 offen offset:3072 sc1
    s_add_u32 s53, s53, 3840
    buffer_load_dword v55, v17, s[20:23], s53 offen offset:0 sc1
    s_waitcnt vmcnt(20)
    s_barrier
    s_waitcnt vmcnt(17)
    s_barrier
    s_waitcnt vmcnt(0)
    s_lshl_b32 s48, s41, 9
    s_add_u32 s48, s48, 159744
    v_add_u32 v16, s48, v16
    ds_write_b64 v16, v[18:19]
    v_add_f32 v40, v40, v48
    v_add_f32 v41, v41, v49
    v_add_f32 v42, v42, v50
    v_add_f32 v43, v43, v51
    v_add_f32 v44, v44, v52
    v_add_f32 v45, v45, v53
    v_add_f32 v46, v46, v54
    v_add_f32 v47, v47, v55
    v_add_f32 v40, v40, v44
    v_add_f32 v41, v41, v45
    v_add_f32 v42, v42, v46
    v_add_f32 v43, v43, v47
    v_add_f32 v40, v40, v42
    v_add_f32 v41, v41, v43
    v_add_f32 v40, v40, v41
    s_mul_i32 s48, s41, 192
    s_add_u32 s48, s48, 161792
    v_add_u32 v17, s48, v17
    s_mov_b32 exec_hi, 0xffff
    ds_write_b32 v17, v40
    s_mov_b64 exec, -1
    v_mov_b32 v16, 162816
    v_mov_b32 v18, 0
    v_mov_b32 v19, 0
    ds_write_b64 v16, v[18:19] offset:0
    ds_write_b64 v16, v[18:19] offset:8
    ds_write_b64 v16, v[18:19] offset:16
    ds_write_b64 v16, v[18:19] offset:24
    ds_write_b64 v16, v[18:19] offset:32
    ds_write_b64 v16, v[18:19] offset:40
    ds_write_b64 v16, v[18:19] offset:48
    ds_write_b64 v16, v[18:19] offset:56
    s_waitcnt lgkmcnt(0)
    s_barrier
    s_mov_b32 s57, 2146435072
    s_branch P2_aux
K1_l_qkv:
    v_cmp_gt_u32 vcc, 10, v13
    s_nop 1
    v_cndmask_b32 v7, v14, v7, vcc
    s_add_u32 s39, s39, 160
    s_mul_i32 s39, s39, s58
    s_add_u32 s50, s50, s39
    s_mul_i32 s57, s58, 320
    s_add_u32 s52, s52, s57
    s_mul_i32 s54, s35, 15
    s_mov_b32 s55, 15
    s_sub_u32 s57, s34, 1
    s_lshl_b32 s54, s54, s57
    s_lshl_b32 s55, s55, s57
    s_lshl_b32 s57, s41, 3
    s_add_u32 s54, s54, s57
    s_lshl_b32 s54, s54, 10
    s_add_u32 s54, s54, 20185088
    s_max_u32 s55, s55, s57
    s_sub_u32 s55, s55, s57
    s_cmp_ge_u32 s41, 2
    s_cbranch_scc1 K1_l_qkv2
    v_bfe_u32 v36, v0, 4, 1
    v_mul_u32_u24 v36, 1280, v36
    v_and_b32 v37, 15, v0
    v_lshl_add_u32 v36, v37, 4, v36
    s_mul_i32 s69, s66, 1280
    buffer_load_dwordx4 v[16:19], v36, s[16:19], s69 offen offset:0
    s_mul_i32 s48, s51, 0
    s_add_u32 s48, s48, s50
    buffer_load_dwordx4 v[80:83], v7, s[24:27], s48 offen
    s_mul_i32 s48, s51, 1
    s_add_u32 s48, s48, s50
    buffer_load_dwordx4 v[84:87], v7, s[24:27], s48 offen
    buffer_load_dwordx4 v[20:23], v36, s[16:19], s69 offen offset:256
    s_mul_i32 s48, s51, 32
    s_add_u32 s48, s48, s50
    buffer_load_dwordx4 v[88:91], v7, s[24:27], s48 offen
    s_mul_i32 s48, s51, 33
    s_add_u32 s48, s48, s50
    buffer_load_dwordx4 v[92:95], v7, s[24:27], s48 offen
    s_waitcnt vmcnt(9)
    s_barrier
    s_add_u32 s47, s78, 1
    s_sub_u32 s48, s47, 10
    s_cselect_b32 s47, s47, s48
    s_lshl_b32 s47, s47, 7
    s_add_u32 s47, s47, s40
    s_add_u32 s48, s47, 0
    s_add_u32 m0, s43, 8192
    s_nop 0
    buffer_load_dwordx4 v2, s[16:19], s48 offen  lds
    s_add_u32 s48, s47, 10240
    s_add_u32 m0, s43, 9216
    s_nop 0
    buffer_load_dwordx4 v3, s[16:19], s48 offen  lds
    s_add_u32 s48, s47, 20480
    s_add_u32 m0, s43, 10240
    s_nop 0
    buffer_load_dwordx4 v2, s[16:19], s48 offen  lds
    s_add_u32 s48, s47, 30720
    s_add_u32 m0, s43, 11264
    s_nop 0
    buffer_load_dwordx4 v3, s[16:19], s48 offen  lds
    s_add_u32 s47, s78, 1
    s_sub_u32 s48, s47, 10
    s_cselect_b32 s47, s47, s48
    s_lshl_b32 s47, s47, 7
    s_add_u32 s47, s47, s40
    s_add_u32 s48, s47, 40960
    s_add_u32 m0, s43, 12288
    s_nop 0
    buffer_load_dwordx4 v2, s[16:19], s48 offen  lds
    s_add_u32 s48, s47, 51200
    s_add_u32 m0, s43, 13312
    s_nop 0
    buffer_load_dwordx4 v3, s[16:19], s48 offen  lds
    s_add_u32 s48, s47, 61440
    s_add_u32 m0, s43, 14336
    s_nop 0
    buffer_load_dwordx4 v2, s[16:19], s48 offen  lds
    s_add_u32 s48, s47, 71680
    s_add_u32 m0, s43, 15360
    s_nop 0
    buffer_load_dwordx4 v3, s[16:19], s48 offen  lds
    s_lshl_b32 s49, s78, 1
    s_add_u32 s49, s49, 2
    s_sub_u32 s48, s49, 20
    s_cselect_b32 s49, s49, s48
    s_mul_i32 s49, s49, s42
    s_add_u32 m0, s44, 118784
    s_nop 0
    buffer_load_dwordx4 v4, s[24:27], s49 offen  lds
    s_add_u32 m0, s45, 118784
    s_nop 0
    buffer_load_dwordx4 v5, s[24:27], s49 offen  lds
    s_add_u32 m0, s46, 118784
    s_nop 0
    buffer_load_dwordx4 v6, s[24:27], s49 offen  lds
    s_lshl_b32 s49, s78, 1
    s_add_u32 s49, s49, 3
    s_sub_u32 s48, s49, 20
    s_cselect_b32 s49, s49, s48
    s_mul_i32 s49, s49, s42
    s_add_u32 m0, s44, 129024
    s_nop 0
    buffer_load_dwordx4 v4, s[24:27], s49 offen  lds
    s_add_u32 m0, s45, 129024
    s_nop 0
    buffer_load_dwordx4 v5, s[24:27], s49 offen  lds
    s_add_u32 m0, s46, 129024
    s_nop 0
    buffer_load_dwordx4 v6, s[24:27], s49 offen  lds
    s_add_u32 s47, s78, 2
    s_sub_u32 s48, s47, 10
    s_cselect_b32 s47, s47, s48
    s_lshl_b32 s47, s47, 7
    s_add_u32 s47, s47, s40
    s_add_u32 s48, s47, 0
    s_add_u32 m0, s43, 16384
    s_nop 0
    buffer_load_dwordx4 v2, s[16:19], s48 offen  lds
    s_add_u32 s48, s47, 10240
    s_add_u32 m0, s43, 17408
    s_nop 0
    buffer_load_dwordx4 v3, s[16:19], s48 offen  lds
    s_add_u32 s48, s47, 20480
    s_add_u32 m0, s43, 18432
    s_nop 0
    buffer_load_dwordx4 v2, s[16:19], s48 offen  lds
    s_add_u32 s48, s47, 30720
    s_add_u32 m0, s43, 19456
    s_nop 0
    buffer_load_dwordx4 v3, s[16:19], s48 offen  lds
    v_and_b32 v128, 15, v0
    v_mov_b32 v129, 0x3f80
    v_mov_b32 v130, 0x3f800000
    v_cmp_eq_u32 vcc, 0, v128
    s_nop 1
    v_cndmask_b32 v124, 0, v129, vcc
    v_cmp_eq_u32 vcc, 1, v128
    s_nop 1
    v_cndmask_b32 v124, v124, v130, vcc
    v_cmp_eq_u32 vcc, 2, v128
    s_nop 1
    v_cndmask_b32 v125, 0, v129, vcc
    v_cmp_eq_u32 vcc, 3, v128
    s_nop 1
    v_cndmask_b32 v125, v125, v130, vcc
    v_cmp_eq_u32 vcc, 4, v128
    s_nop 1
    v_cndmask_b32 v126, 0, v129, vcc
    v_cmp_eq_u32 vcc, 5, v128
    s_nop 1
    v_cndmask_b32 v126, v126, v130, vcc
    v_cmp_eq_u32 vcc, 6, v128
    s_nop 1
    v_cndmask_b32 v127, 0, v129, vcc
    v_cmp_eq_u32 vcc, 7, v128
    s_nop 1
    v_cndmask_b32 v127, v127, v130, vcc
    buffer_load_dwordx4 v[24:27], v36, s[16:19], s69 offen offset:512
    s_mul_i32 s48, s51, 64
    s_add_u32 s48, s48, s50
    buffer_load_dwordx4 v[96:99], v7, s[24:27], s48 offen
    s_mul_i32 s48, s51, 65
    s_add_u32 s48, s48, s50
    buffer_load_dwordx4 v[100:103], v7, s[24:27], s48 offen
    s_waitcnt vmcnt(27)
    s_barrier
    s_add_u32 s47, s78, 2
    s_sub_u32 s48, s47, 10
    s_cselect_b32 s47, s47, s48
    s_lshl_b32 s47, s47, 7
    s_add_u32 s47, s47, s40
    s_add_u32 s48, s47, 40960
    s_add_u32 m0, s43, 20480
    s_nop 0
    buffer_load_dwordx4 v2, s[16:19], s48 offen  lds
    s_add_u32 s48, s47, 51200
    s_add_u32 m0, s43, 21504
    s_nop 0
    buffer_load_dwordx4 v3, s[16:19], s48 offen  lds
    s_add_u32 s48, s47, 61440
    s_add_u32 m0, s43, 22528
    s_nop 0
    buffer_load_dwordx4 v2, s[16:19], s48 offen  lds
    s_add_u32 s48, s47, 71680
    s_add_u32 m0, s43, 23552
    s_nop 0
    buffer_load_dwordx4 v3, s[16:19], s48 offen  lds
    s_lshl_b32 s49, s78, 1
    s_add_u32 s49, s49, 4
    s_sub_u32 s48, s49, 20
    s_cselect_b32 s49, s49, s48
    s_mul_i32 s49, s49, s42
    s_add_u32 m0, s44, 139264
    s_nop 0
    buffer_load_dwordx4 v4, s[24:27], s49 offen  lds
    s_add_u32 m0, s45, 139264
    s_nop 0
    buffer_load_dwordx4 v5, s[24:27], s49 offen  lds
    s_add_u32 m0, s46, 139264
    s_nop 0
    buffer_load_dwordx4 v6, s[24:27], s49 offen  lds
    buffer_load_dwordx4 v[28:31], v36, s[16:19], s69 offen offset:768
    s_mul_i32 s48, s51, 96
    s_add_u32 s48, s48, s50
    buffer_load_dwordx4 v[104:107], v7, s[24:27], s48 offen
    s_mul_i32 s48, s51, 97
    s_add_u32 s48, s48, s50
    buffer_load_dwordx4 v[108:111], v7, s[24:27], s48 offen
    s_waitcnt vmcnt(20)
    s_barrier
    s_add_u32 s47, s78, 3
    s_sub_u32 s48, s47, 10
    s_cselect_b32 s47, s47, s48
    s_lshl_b32 s47, s47, 7
    s_add_u32 s47, s47, s40
    s_add_u32 s48, s47, 0
    s_add_u32 m0, s43, 0
    s_nop 0
    buffer_load_dwordx4 v2, s[16:19], s48 offen  lds
    s_add_u32 s48, s47, 10240
    s_add_u32 m0, s43, 1024
    s_nop 0
    buffer_load_dwordx4 v3, s[16:19], s48 offen  lds
    s_add_u32 s48, s47, 20480
    s_add_u32 m0, s43, 2048
    s_nop 0
    buffer_load_dwordx4 v2, s[16:19], s48 offen  lds
    s_add_u32 s48, s47, 30720
    s_add_u32 m0, s43, 3072
    s_nop 0
    buffer_load_dwordx4 v3, s[16:19], s48 offen  lds
    s_lshl_b32 s49, s78, 1
    s_add_u32 s49, s49, 5
    s_sub_u32 s48, s49, 20
    s_cselect_b32 s49, s49, s48
    s_mul_i32 s49, s49, s42
    s_add_u32 m0, s44, 98304
    s_nop 0
    buffer_load_dwordx4 v4, s[24:27], s49 offen  lds
    s_add_u32 m0, s45, 98304
    s_nop 0
    buffer_load_dwordx4 v5, s[24:27], s49 offen  lds
    s_add_u32 m0, s46, 98304
    s_nop 0
    buffer_load_dwordx4 v6, s[24:27], s49 offen  lds
    buffer_load_dwordx4 v[32:35], v36, s[16:19], s69 offen offset:1024
    s_mul_i32 s48, s51, 128
    s_add_u32 s48, s48, s50
    buffer_load_dwordx4 v[112:115], v7, s[24:27], s48 offen
    s_mul_i32 s48, s51, 129
    s_add_u32 s48, s48, s50
    buffer_load_dwordx4 v[116:119], v7, s[24:27], s48 offen
    s_waitcnt vmcnt(27)
    s_barrier
    s_add_u32 s47, s78, 3
    s_sub_u32 s48, s47, 10
    s_cselect_b32 s47, s47, s48
    s_lshl_b32 s47, s47, 7
    s_add_u32 s47, s47, s40
    s_add_u32 s48, s47, 40960
    s_add_u32 m0, s43, 4096
    s_nop 0
    buffer_load_dwordx4 v2, s[16:19], s48 offen  lds
    s_add_u32 s48, s47, 51200
    s_add_u32 m0, s43, 5120
    s_nop 0
    buffer_load_dwordx4 v3, s[16:19], s48 offen  lds
    s_add_u32 s48, s47, 61440
    s_add_u32 m0, s43, 6144
    s_nop 0
    buffer_load_dwordx4 v2, s[16:19], s48 offen  lds
    s_add_u32 s48, s47, 71680
    s_add_u32 m0, s43, 7168
    s_nop 0
    buffer_load_dwordx4 v3, s[16:19], s48 offen  lds
    s_lshl_b32 s49, s78, 1
    s_add_u32 s49, s49, 6
    s_sub_u32 s48, s49, 20
    s_cselect_b32 s49, s49, s48
    s_mul_i32 s49, s49, s42
    s_add_u32 m0, s44, 108544
    s_nop 0
    buffer_load_dwordx4 v4, s[24:27], s49 offen  lds
    s_add_u32 m0, s45, 108544
    s_nop 0
    buffer_load_dwordx4 v5, s[24:27], s49 offen  lds
    s_add_u32 m0, s46, 108544
    s_nop 0
    buffer_load_dwordx4 v6, s[24:27], s49 offen  lds
    s_waitcnt vmcnt(20)
    s_barrier
    s_add_u32 s47, s78, 4
    s_sub_u32 s48, s47, 10
    s_cselect_b32 s47, s47, s48
    s_lshl_b32 s47, s47, 7
    s_add_u32 s47, s47, s40
    s_add_u32 s48, s47, 0
    s_add_u32 m0, s43, 8192
    s_nop 0
    buffer_load_dwordx4 v2, s[16:19], s48 offen  lds
    s_add_u32 s48, s47, 10240
    s_add_u32 m0, s43, 9216
    s_nop 0
    buffer_load_dwordx4 v3, s[16:19], s48 offen  lds
    s_add_u32 s48, s47, 20480
    s_add_u32 m0, s43, 10240
    s_nop 0
    buffer_load_dwordx4 v2, s[16:19], s48 offen  lds
    s_add_u32 s48, s47, 30720
    s_add_u32 m0, s43, 11264
    s_nop 0
    buffer_load_dwordx4 v3, s[16:19], s48 offen  lds
    s_lshl_b32 s49, s78, 1
    s_add_u32 s49, s49, 7
    s_sub_u32 s48, s49, 20
    s_cselect_b32 s49, s49, s48
    s_mul_i32 s49, s49, s42
    s_add_u32 m0, s44, 118784
    s_nop 0
    buffer_load_dwordx4 v4, s[24:27], s49 offen  lds
    s_add_u32 m0, s45, 118784
    s_nop 0
    buffer_load_dwordx4 v5, s[24:27], s49 offen  lds
    s_add_u32 m0, s46, 118784
    s_nop 0
    buffer_load_dwordx4 v6, s[24:27], s49 offen  lds
    s_waitcnt vmcnt(14)
    s_setprio 3
    v_mfma_f32_16x16x32_bf16 v[120:123], v[124:127], v[80:83], 0
    v_mfma_f32_16x16x32_bf16 v[120:123], v[124:127], v[84:87], v[120:123]
    v_mfma_f32_16x16x32_bf16 v[120:123], v[124:127], v[88:91], v[120:123]
    v_mfma_f32_16x16x32_bf16 v[120:123], v[124:127], v[92:95], v[120:123]
    v_mfma_f32_16x16x32_bf16 v[120:123], v[124:127], v[96:99], v[120:123]
    v_mfma_f32_16x16x32_bf16 v[120:123], v[124:127], v[100:103], v[120:123]
    v_mfma_f32_16x16x32_bf16 v[120:123], v[124:127], v[104:107], v[120:123]
    v_mfma_f32_16x16x32_bf16 v[120:123], v[124:127], v[108:111], v[120:123]
    v_mfma_f32_16x16x32_bf16 v[120:123], v[124:127], v[112:115], v[120:123]
    v_mfma_f32_16x16x32_bf16 v[120:123], v[124:127], v[116:119], v[120:123]
    s_nop 0
    v_mov_b32 v40, 0x3f803f80
    v_dot2_f32_bf16 v36, v16, v40, 0
    v_dot2_f32_bf16 v37, v16, v16, 0
    v_dot2_f32_bf16 v41, v17, v40, 0
    v_dot2_f32_bf16 v42, v17, v17, 0
    v_dot2_f32_bf16 v36, v18, v40, v36
    v_dot2_f32_bf16 v37, v18, v18, v37
    v_dot2_f32_bf16 v41, v19, v40, v41
    v_dot2_f32_bf16 v42, v19, v19, v42
    v_dot2_f32_bf16 v36, v20, v40, v36
    v_dot2_f32_bf16 v37, v20, v20, v37
    v_dot2_f32_bf16 v41, v21, v40, v41
    v_dot2_f32_bf16 v42, v21, v21, v42
    v_dot2_f32_bf16 v36, v22, v40, v36
    v_dot2_f32_bf16 v37, v22, v22, v37
    v_dot2_f32_bf16 v41, v23, v40, v41
    v_dot2_f32_bf16 v42, v23, v23, v42
    v_dot2_f32_bf16 v36, v24, v40, v36
    v_dot2_f32_bf16 v37, v24, v24, v37
    v_dot2_f32_bf16 v41, v25, v40, v41
    v_dot2_f32_bf16 v42, v25, v25, v42
    v_dot2_f32_bf16 v36, v26, v40, v36
    v_dot2_f32_bf16 v37, v26, v26, v37
    v_dot2_f32_bf16 v41, v27, v40, v41
    v_dot2_f32_bf16 v42, v27, v27, v42
    v_dot2_f32_bf16 v36, v28, v40, v36
    v_dot2_f32_bf16 v37, v28, v28, v37
    v_dot2_f32_bf16 v41, v29, v40, v41
    v_dot2_f32_bf16 v42, v29, v29, v42
    v_dot2_f32_bf16 v36, v30, v40, v36
    v_dot2_f32_bf16 v37, v30, v30, v37
    v_dot2_f32_bf16 v41, v31, v40, v41
    v_dot2_f32_bf16 v42, v31, v31, v42
    v_dot2_f32_bf16 v36, v32, v40, v36
    v_dot2_f32_bf16 v37, v32, v32, v37
    v_dot2_f32_bf16 v41, v33, v40, v41
    v_dot2_f32_bf16 v42, v33, v33, v42
    v_dot2_f32_bf16 v36, v34, v40, v36
    v_dot2_f32_bf16 v37, v34, v34, v37
    v_dot2_f32_bf16 v41, v35, v40, v41
    v_dot2_f32_bf16 v42, v35, v35, v42
    s_setprio 0
    s_barrier
    s_add_u32 s47, s78, 4
    s_sub_u32 s48, s47, 10
    s_cselect_b32 s47, s47, s48
    s_lshl_b32 s47, s47, 7
    s_add_u32 s47, s47, s40
    s_add_u32 s48, s47, 40960
    s_add_u32 m0, s43, 12288
    s_nop 0
    buffer_load_dwordx4 v2, s[16:19], s48 offen  lds
    s_add_u32 s48, s47, 51200
    s_add_u32 m0, s43, 13312
    s_nop 0
    buffer_load_dwordx4 v3, s[16:19], s48 offen  lds
    s_add_u32 s48, s47, 61440
    s_add_u32 m0, s43, 14336
    s_nop 0
    buffer_load_dwordx4 v2, s[16:19], s48 offen  lds
    s_add_u32 s48, s47, 71680
    s_add_u32 m0, s43, 15360
    s_nop 0
    buffer_load_dwordx4 v3, s[16:19], s48 offen  lds
    s_lshl_b32 s49, s78, 1
    s_add_u32 s49, s49, 8
    s_sub_u32 s48, s49, 20
    s_cselect_b32 s49, s49, s48
    s_mul_i32 s49, s49, s42
    s_add_u32 m0, s44, 129024
    s_nop 0
    buffer_load_dwordx4 v4, s[24:27], s49 offen  lds
    s_add_u32 m0, s45, 129024
    s_nop 0
    buffer_load_dwordx4 v5, s[24:27], s49 offen  lds
    s_add_u32 m0, s46, 129024
    s_nop 0
    buffer_load_dwordx4 v6, s[24:27], s49 offen  lds
    s_setprio 3
    s_nop 2
    v_add_f32 v36, v36, v41
    v_add_f32 v37, v37, v42
    s_nop 0
    v_add_f32_dpp v36, v36, v36 row_ror:8 row_mask:0xf bank_mask:0xf
    v_add_f32_dpp v37, v37, v37 row_ror:8 row_mask:0xf bank_mask:0xf
    s_nop 0
    v_add_f32_dpp v36, v36, v36 row_ror:4 row_mask:0xf bank_mask:0xf
    v_add_f32_dpp v37, v37, v37 row_ror:4 row_mask:0xf bank_mask:0xf
    s_nop 0
    v_add_f32_dpp v36, v36, v36 row_ror:2 row_mask:0xf bank_mask:0xf
    v_add_f32_dpp v37, v37, v37 row_ror:2 row_mask:0xf bank_mask:0xf
    s_nop 0
    s_nop 0
    v_add_f32_dpp v36, v36, v36 row_ror:1 row_mask:0xf bank_mask:0xf
    v_add_f32_dpp v37, v37, v37 row_ror:1 row_mask:0xf bank_mask:0xf
    v_mul_f32 v36, 0x3acccccd, v36
    v_mul_f32 v37, 0x3acccccd, v37
    v_fma_f32 v37, -v36, v36, v37
    v_max_f32_e64 v37, 0, v37
    v_cvt_pk_bf16_f32 v36, v36, v36
    v_lshlrev_b32_e64 v36, 16, v36
    v_cvt_pk_bf16_f32 v37, v37, v37
    v_lshlrev_b32_e64 v37, 16, v37
    v_add_f32 v37, 0x3727c5ac, v37
    v_cvt_pk_bf16_f32 v37, v37, v37
    v_lshlrev_b32 v37, 16, v37
    v_sqrt_f32_e64 v37, v37
    s_nop 0
    v_cvt_pk_bf16_f32 v37, v37, v37
    v_lshlrev_b32 v37, 16, v37
    v_rcp_f32 v37, v37
    v_bfe_u32 v16, v0, 4, 1
    v_lshlrev_b32 v16, 3, v16
    s_lshl_b32 s67, s41, 4
    s_add_u32 s67, s67, 159744
    v_add_u32 v16, s67, v16
    ds_write_b64 v16, v[36:37]
    v_and_b32 v80, 15, v0
    v_lshlrev_b32 v80, 5, v80
    v_lshrrev_b32 v81, 4, v0
    v_lshl_add_u32 v80, v81, 4, v80
    s_mul_i32 s48, s41, 384
    s_add_u32 s48, s48, 159872
    v_add_u32 v80, s48, v80
    s_mov_b64 exec, 67044351
    ds_write_b128 v80, v[120:123]
    s_mov_b64 exec, -1
    s_waitcnt lgkmcnt(0)
    s_setprio 0
    s_waitcnt vmcnt(14)
    s_barrier
    s_add_u32 s47, s78, 5
    s_sub_u32 s48, s47, 10
    s_cselect_b32 s47, s47, s48
    s_lshl_b32 s47, s47, 7
    s_add_u32 s47, s47, s40
    s_add_u32 s48, s47, 0
    s_add_u32 m0, s43, 16384
    s_nop 0
    buffer_load_dwordx4 v2, s[16:19], s48 offen  lds
    s_add_u32 s48, s47, 10240
    s_add_u32 m0, s43, 17408
    s_nop 0
    buffer_load_dwordx4 v3, s[16:19], s48 offen  lds
    s_add_u32 s48, s47, 20480
    s_add_u32 m0, s43, 18432
    s_nop 0
    buffer_load_dwordx4 v2, s[16:19], s48 offen  lds
    s_add_u32 s48, s47, 30720
    s_add_u32 m0, s43, 19456
    s_nop 0
    buffer_load_dwordx4 v3, s[16:19], s48 offen  lds
    s_lshl_b32 s49, s78, 1
    s_add_u32 s49, s49, 9
    s_sub_u32 s48, s49, 20
    s_cselect_b32 s49, s49, s48
    s_mul_i32 s49, s49, s42
    s_add_u32 m0, s44, 139264
    s_nop 0
    buffer_load_dwordx4 v4, s[24:27], s49 offen  lds
    s_add_u32 m0, s45, 139264
    s_nop 0
    buffer_load_dwordx4 v5, s[24:27], s49 offen  lds
    s_add_u32 m0, s46, 139264
    s_nop 0
    buffer_load_dwordx4 v6, s[24:27], s49 offen  lds
    s_mul_i32 s30, s32, 30
    s_add_u32 s30, s30, s29
    s_lshl_b32 s30, s30, 2
    s_add_u32 s30, s30, s41
    s_waitcnt lgkmcnt(0)
    s_cmp_lt_u32 s30, 740
    s_mov_b32 s76, 2146435072
    s_cselect_b32 s76, 13631488, s76
    s_cselect_b32 s77, 0, 2146435072
    s_mul_i32 s74, s30, 6554
    s_lshr_b32 s74, s74, 16
    s_mul_i32 s75, s74, 10
    s_sub_u32 s75, s30, s75
    s_cmp_lt_u32 s74, 54
    s_cselect_b32 s4, s72, s70
    s_cselect_b32 s5, s73, s71
    s_mov_b32 s6, 819200
    s_cselect_b32 s6, 2211840, s6
    s_mov_b32 s7, 0x20000
    s_cselect_b32 s31, 4, 20
    s_lshl_b32 s36, s74, 5
    s_mov_b32 s38, 16
    s_cmp_lt_u32 s74, 54
    s_cbranch_scc1 LA_rl
    s_sub_u32 s33, s74, 54
    s_mul_i32 s36, s33, 205
    s_lshr_b32 s36, s36, 10
    s_mul_i32 s48, s36, 5
    s_sub_u32 s33, s33, s48
    s_mul_i32 s36, s36, 160
    s_lshl_b32 s48, s33, 3
    s_cmp_ge_u32 s33, 3
    s_cselect_b32 s47, 56, 0
    s_add_u32 s48, s48, s47
    s_add_u32 s36, s36, s48
    s_cmp_eq_u32 s33, 2
    s_cselect_b32 s38, 80, 4
LA_rl:
    v_lshrrev_b32_e64 v8, 5, v0
    v_mul_lo_u32 v8, v8, s38
    v_bfe_u32 v9, v0, 3, 2
    v_add_u32_e64 v8, v8, v9
    v_mul_u32_u24 v8, 1280, v8
    v_and_b32_e64 v9, 7, v0
    v_lshl_add_u32 v8, v9, 4, v8
    s_mul_i32 s36, s36, 1280
    s_lshl_b32 s47, s75, 7
    s_add_u32 s47, s47, s36
    s_add_u32 s47, s47, s77
    s_mul_i32 s31, s31, 1280
    buffer_load_dwordx4 v[140:143], v8, s[4:7], s47 offen
    s_add_u32 s47, s47, s31
    buffer_load_dwordx4 v[144:147], v8, s[4:7], s47 offen
    s_add_u32 s47, s47, s31
    buffer_load_dwordx4 v[148:151], v8, s[4:7], s47 offen
    s_add_u32 s47, s47, s31
    buffer_load_dwordx4 v[152:155], v8, s[4:7], s47 offen
    s_waitcnt vmcnt(18)
    s_barrier
    s_add_u32 s47, s78, 5
    s_sub_u32 s48, s47, 10
    s_cselect_b32 s47, s47, s48
    s_lshl_b32 s47, s47, 7
    s_add_u32 s47, s47, s40
    s_add_u32 s48, s47, 40960
    s_add_u32 m0, s43, 20480
    s_nop 0
    buffer_load_dwordx4 v2, s[16:19], s48 offen  lds
    s_add_u32 s48, s47, 51200
    s_add_u32 m0, s43, 21504
    s_nop 0
    buffer_load_dwordx4 v3, s[16:19], s48 offen  lds
    s_add_u32 s48, s47, 61440
    s_add_u32 m0, s43, 22528
    s_nop 0
    buffer_load_dwordx4 v2, s[16:19], s48 offen  lds
    s_add_u32 s48, s47, 71680
    s_add_u32 m0, s43, 23552
    s_nop 0
    buffer_load_dwordx4 v3, s[16:19], s48 offen  lds
    s_lshl_b32 s49, s78, 1
    s_add_u32 s49, s49, 10
    s_sub_u32 s48, s49, 20
    s_cselect_b32 s49, s49, s48
    s_mul_i32 s49, s49, s42
    s_add_u32 m0, s44, 98304
    s_nop 0
    buffer_load_dwordx4 v4, s[24:27], s49 offen  lds
    s_add_u32 m0, s45, 98304
    s_nop 0
    buffer_load_dwordx4 v5, s[24:27], s49 offen  lds
    s_add_u32 m0, s46, 98304
    s_nop 0
    buffer_load_dwordx4 v6, s[24:27], s49 offen  lds
    s_mul_i32 s31, s30, 3277
    s_lshr_b32 s31, s31, 16
    s_mul_i32 s31, s31, 54
    s_add_u32 s31, s31, s30
    s_add_u32 s31, s31, 54
    s_lshl_b32 s31, s31, 12
    s_add_u32 s31, s31, 3145728
    s_lshl_b32 s33, s30, 12
    s_add_u32 s33, s33, 18350080
    s_cmp_lt_u32 s30, 640
    s_cselect_b32 s31, s31, s33
    s_cmp_lt_u32 s30, 768
    s_cselect_b32 s31, s31, 2146435072
    v_lshlrev_b32 v176, 4, v0
    v_mov_b32 v172, -1
    v_mov_b32 v173, -1
    v_mov_b32 v174, -1
    v_mov_b32 v175, -1
    buffer_store_dwordx4 v[172:175], v176, s[20:23], s31 offen offset:0 sc1
    buffer_store_dwordx4 v[172:175], v176, s[20:23], s31 offen offset:1024 sc1
    buffer_store_dwordx4 v[172:175], v176, s[20:23], s31 offen offset:2048 sc1
    buffer_store_dwordx4 v[172:175], v176, s[20:23], s31 offen offset:3072 sc1
    s_waitcnt vmcnt(22)
    s_barrier
    s_add_u32 s47, s78, 6
    s_sub_u32 s48, s47, 10
    s_cselect_b32 s47, s47, s48
    s_lshl_b32 s47, s47, 7
    s_add_u32 s47, s47, s40
    s_add_u32 s48, s47, 0
    s_add_u32 m0, s43, 0
    s_nop 0
    buffer_load_dwordx4 v2, s[16:19], s48 offen  lds
    s_add_u32 s48, s47, 10240
    s_add_u32 m0, s43, 1024
    s_nop 0
    buffer_load_dwordx4 v3, s[16:19], s48 offen  lds
    s_add_u32 s48, s47, 20480
    s_add_u32 m0, s43, 2048
    s_nop 0
    buffer_load_dwordx4 v2, s[16:19], s48 offen  lds
    s_add_u32 s48, s47, 30720
    s_add_u32 m0, s43, 3072
    s_nop 0
    buffer_load_dwordx4 v3, s[16:19], s48 offen  lds
    s_lshl_b32 s49, s78, 1
    s_add_u32 s49, s49, 11
    s_sub_u32 s48, s49, 20
    s_cselect_b32 s49, s49, s48
    s_mul_i32 s49, s49, s42
    s_add_u32 m0, s44, 108544
    s_nop 0
    buffer_load_dwordx4 v4, s[24:27], s49 offen  lds
    s_add_u32 m0, s45, 108544
    s_nop 0
    buffer_load_dwordx4 v5, s[24:27], s49 offen  lds
    s_add_u32 m0, s46, 108544
    s_nop 0
    buffer_load_dwordx4 v6, s[24:27], s49 offen  lds
    s_add_u32 s47, s43, 4096
    v_lshlrev_b32 v10, 4, v0
    v_add_u32 v8, s47, v10
    v_lshrrev_b32 v9, 4, v0
    v_lshlrev_b32 v9, 10, v9
    v_bfe_u32 v11, v0, 2, 2
    v_lshl_add_u32 v9, v11, 7, v9
    v_and_b32_e64 v11, 3, v0
    v_lshl_add_u32 v9, v11, 3, v9
    v_add_u32 v9, s47, v9
    s_waitcnt vmcnt(18)
    ds_write_b128 v8, v[140:143] offset:0
    ds_write_b128 v8, v[144:147] offset:1024
    ds_write_b128 v8, v[148:151] offset:2048
    ds_write_b128 v8, v[152:155] offset:3072
    s_barrier
    s_lshl_b32 s49, s78, 1
    s_add_u32 s49, s49, 12
    s_sub_u32 s48, s49, 20
    s_cselect_b32 s49, s49, s48
    s_mul_i32 s49, s49, s42
    s_add_u32 m0, s44, 118784
    s_nop 0
    buffer_load_dwordx4 v4, s[24:27], s49 offen  lds
    s_add_u32 m0, s45, 118784
    s_nop 0
    buffer_load_dwordx4 v5, s[24:27], s49 offen  lds
    s_add_u32 m0, s46, 118784
    s_nop 0
    buffer_load_dwordx4 v6, s[24:27], s49 offen  lds
    s_waitcnt lgkmcnt(0)
    ds_read_b64_tr_b16 v[156:157], v9 offset:0
    ds_read_b64_tr_b16 v[158:159], v9 offset:512
    ds_read_b64_tr_b16 v[160:161], v9 offset:32
    ds_read_b64_tr_b16 v[162:163], v9 offset:544
    ds_read_b64_tr_b16 v[164:165], v9 offset:64
    ds_read_b64_tr_b16 v[166:167], v9 offset:576
    ds_read_b64_tr_b16 v[168:169], v9 offset:96
    ds_read_b64_tr_b16 v[170:171], v9 offset:608
    s_lshl_b32 s47, s75, 2
    s_add_u32 s47, s47, 0
    s_mul_i32 s48, s47, 205
    s_lshr_b32 s48, s48, 10
    s_mul_i32 s49, s48, 5
    s_sub_u32 s47, s47, s49
    s_mul_i32 s48, s48, 74
    s_add_u32 s48, s48, s74
    s_mul_i32 s48, s48, 5
    s_add_u32 s48, s48, s47
    s_lshl_b32 s48, s48, 10
    s_add_u32 s48, s48, s76
    s_waitcnt lgkmcnt(6)
    buffer_store_dwordx4 v[156:159], v10, s[20:23], s48 offen sc1
    s_lshl_b32 s47, s75, 2
    s_add_u32 s47, s47, 1
    s_mul_i32 s48, s47, 205
    s_lshr_b32 s48, s48, 10
    s_mul_i32 s49, s48, 5
    s_sub_u32 s47, s47, s49
    s_mul_i32 s48, s48, 74
    s_add_u32 s48, s48, s74
    s_mul_i32 s48, s48, 5
    s_add_u32 s48, s48, s47
    s_lshl_b32 s48, s48, 10
    s_add_u32 s48, s48, s76
    s_waitcnt lgkmcnt(4)
    buffer_store_dwordx4 v[160:163], v10, s[20:23], s48 offen sc1
    s_lshl_b32 s47, s75, 2
    s_add_u32 s47, s47, 2
    s_mul_i32 s48, s47, 205
    s_lshr_b32 s48, s48, 10
    s_mul_i32 s49, s48, 5
    s_sub_u32 s47, s47, s49
    s_mul_i32 s48, s48, 74
    s_add_u32 s48, s48, s74
    s_mul_i32 s48, s48, 5
    s_add_u32 s48, s48, s47
    s_lshl_b32 s48, s48, 10
    s_add_u32 s48, s48, s76
    s_waitcnt lgkmcnt(2)
    buffer_store_dwordx4 v[164:167], v10, s[20:23], s48 offen sc1
    s_lshl_b32 s47, s75, 2
    s_add_u32 s47, s47, 3
    s_mul_i32 s48, s47, 205
    s_lshr_b32 s48, s48, 10
    s_mul_i32 s49, s48, 5
    s_sub_u32 s47, s47, s49
    s_mul_i32 s48, s48, 74
    s_add_u32 s48, s48, s74
    s_mul_i32 s48, s48, 5
    s_add_u32 s48, s48, s47
    s_lshl_b32 s48, s48, 10
    s_add_u32 s48, s48, s76
    s_waitcnt lgkmcnt(0)
    buffer_store_dwordx4 v[168:171], v10, s[20:23], s48 offen sc1
    s_add_u32 s47, s78, 6
    s_sub_u32 s48, s47, 10
    s_cselect_b32 s47, s47, s48
    s_lshl_b32 s47, s47, 7
    s_add_u32 s47, s47, s40
    s_add_u32 s48, s47, 40960
    s_add_u32 m0, s43, 4096
    s_nop 0
    buffer_load_dwordx4 v2, s[16:19], s48 offen  lds
    s_add_u32 s48, s47, 51200
    s_add_u32 m0, s43, 5120
    s_nop 0
    buffer_load_dwordx4 v3, s[16:19], s48 offen  lds
    s_add_u32 s48, s47, 61440
    s_add_u32 m0, s43, 6144
    s_nop 0
    buffer_load_dwordx4 v2, s[16:19], s48 offen  lds
    s_add_u32 s48, s47, 71680
    s_add_u32 m0, s43, 7168
    s_nop 0
    buffer_load_dwordx4 v3, s[16:19], s48 offen  lds
    s_waitcnt vmcnt(22)
    s_barrier
    s_add_u32 s47, s78, 7
    s_sub_u32 s48, s47, 10
    s_cselect_b32 s47, s47, s48
    s_lshl_b32 s47, s47, 7
    s_add_u32 s47, s47, s40
    s_add_u32 s48, s47, 0
    s_add_u32 m0, s43, 8192
    s_nop 0
    buffer_load_dwordx4 v2, s[16:19], s48 offen  lds
    s_add_u32 s48, s47, 10240
    s_add_u32 m0, s43, 9216
    s_nop 0
    buffer_load_dwordx4 v3, s[16:19], s48 offen  lds
    s_add_u32 s48, s47, 20480
    s_add_u32 m0, s43, 10240
    s_nop 0
    buffer_load_dwordx4 v2, s[16:19], s48 offen  lds
    s_add_u32 s48, s47, 30720
    s_add_u32 m0, s43, 11264
    s_nop 0
    buffer_load_dwordx4 v3, s[16:19], s48 offen  lds
    s_lshl_b32 s49, s78, 1
    s_add_u32 s49, s49, 13
    s_sub_u32 s48, s49, 20
    s_cselect_b32 s49, s49, s48
    s_mul_i32 s49, s49, s42
    s_add_u32 m0, s44, 129024
    s_nop 0
    buffer_load_dwordx4 v4, s[24:27], s49 offen  lds
    s_add_u32 m0, s45, 129024
    s_nop 0
    buffer_load_dwordx4 v5, s[24:27], s49 offen  lds
    s_add_u32 m0, s46, 129024
    s_nop 0
    buffer_load_dwordx4 v6, s[24:27], s49 offen  lds
    s_waitcnt vmcnt(18)
    s_barrier
    s_add_u32 s47, s78, 7
    s_sub_u32 s48, s47, 10
    s_cselect_b32 s47, s47, s48
    s_lshl_b32 s47, s47, 7
    s_add_u32 s47, s47, s40
    s_add_u32 s48, s47, 40960
    s_add_u32 m0, s43, 12288
    s_nop 0
    buffer_load_dwordx4 v2, s[16:19], s48 offen  lds
    s_add_u32 s48, s47, 51200
    s_add_u32 m0, s43, 13312
    s_nop 0
    buffer_load_dwordx4 v3, s[16:19], s48 offen  lds
    s_add_u32 s48, s47, 61440
    s_add_u32 m0, s43, 14336
    s_nop 0
    buffer_load_dwordx4 v2, s[16:19], s48 offen  lds
    s_add_u32 s48, s47, 71680
    s_add_u32 m0, s43, 15360
    s_nop 0
    buffer_load_dwordx4 v3, s[16:19], s48 offen  lds
    s_lshl_b32 s49, s78, 1
    s_add_u32 s49, s49, 14
    s_sub_u32 s48, s49, 20
    s_cselect_b32 s49, s49, s48
    s_mul_i32 s49, s49, s42
    s_add_u32 m0, s44, 139264
    s_nop 0
    buffer_load_dwordx4 v4, s[24:27], s49 offen  lds
    s_add_u32 m0, s45, 139264
    s_nop 0
    buffer_load_dwordx4 v5, s[24:27], s49 offen  lds
    s_add_u32 m0, s46, 139264
    s_nop 0
    buffer_load_dwordx4 v6, s[24:27], s49 offen  lds
    s_waitcnt vmcnt(14)
    s_barrier
    s_cmp_lg_u32 s41, 0
    s_cbranch_scc1 LA_cs
    s_and_b32 s67, s2, 1
    s_lshl_b32 s67, s67, 6
    s_add_u32 s67, s67, 4
    v_mov_b32 v130, s67
    v_mov_b32 v131, 1
    s_mov_b64 exec, 1
    global_atomic_add v130, v131, s[14:15]
    s_mov_b64 exec, -1
LA_cs:
    s_add_u32 s47, s78, 8
    s_sub_u32 s48, s47, 10
    s_cselect_b32 s47, s47, s48
    s_lshl_b32 s47, s47, 7
    s_add_u32 s47, s47, s40
    s_add_u32 s48, s47, 0
    s_add_u32 m0, s43, 16384
    s_nop 0
    buffer_load_dwordx4 v2, s[16:19], s48 offen  lds
    s_add_u32 s48, s47, 10240
    s_add_u32 m0, s43, 17408
    s_nop 0
    buffer_load_dwordx4 v3, s[16:19], s48 offen  lds
    s_add_u32 s48, s47, 20480
    s_add_u32 m0, s43, 18432
    s_nop 0
    buffer_load_dwordx4 v2, s[16:19], s48 offen  lds
    s_add_u32 s48, s47, 30720
    s_add_u32 m0, s43, 19456
    s_nop 0
    buffer_load_dwordx4 v3, s[16:19], s48 offen  lds
    s_lshl_b32 s49, s78, 1
    s_add_u32 s49, s49, 15
    s_sub_u32 s48, s49, 20
    s_cselect_b32 s49, s49, s48
    s_mul_i32 s49, s49, s42
    s_add_u32 m0, s44, 98304
    s_nop 0
    buffer_load_dwordx4 v4, s[24:27], s49 offen  lds
    s_add_u32 m0, s45, 98304
    s_nop 0
    buffer_load_dwordx4 v5, s[24:27], s49 offen  lds
    s_add_u32 m0, s46, 98304
    s_nop 0
    buffer_load_dwordx4 v6, s[24:27], s49 offen  lds
    s_waitcnt vmcnt(14)
    s_barrier
    s_add_u32 s47, s78, 8
    s_sub_u32 s48, s47, 10
    s_cselect_b32 s47, s47, s48
    s_lshl_b32 s47, s47, 7
    s_add_u32 s47, s47, s40
    s_add_u32 s48, s47, 40960
    s_add_u32 m0, s43, 20480
    s_nop 0
    buffer_load_dwordx4 v2, s[16:19], s48 offen  lds
    s_add_u32 s48, s47, 51200
    s_add_u32 m0, s43, 21504
    s_nop 0
    buffer_load_dwordx4 v3, s[16:19], s48 offen  lds
    s_add_u32 s48, s47, 61440
    s_add_u32 m0, s43, 22528
    s_nop 0
    buffer_load_dwordx4 v2, s[16:19], s48 offen  lds
    s_add_u32 s48, s47, 71680
    s_add_u32 m0, s43, 23552
    s_nop 0
    buffer_load_dwordx4 v3, s[16:19], s48 offen  lds
    s_lshl_b32 s49, s78, 1
    s_add_u32 s49, s49, 16
    s_sub_u32 s48, s49, 20
    s_cselect_b32 s49, s49, s48
    s_mul_i32 s49, s49, s42
    s_add_u32 m0, s44, 108544
    s_nop 0
    buffer_load_dwordx4 v4, s[24:27], s49 offen  lds
    s_add_u32 m0, s45, 108544
    s_nop 0
    buffer_load_dwordx4 v5, s[24:27], s49 offen  lds
    s_add_u32 m0, s46, 108544
    s_nop 0
    buffer_load_dwordx4 v6, s[24:27], s49 offen  lds
    s_waitcnt vmcnt(14)
    s_barrier
    s_add_u32 s47, s78, 9
    s_sub_u32 s48, s47, 10
    s_cselect_b32 s47, s47, s48
    s_lshl_b32 s47, s47, 7
    s_add_u32 s47, s47, s40
    s_add_u32 s48, s47, 0
    s_add_u32 m0, s43, 0
    s_nop 0
    buffer_load_dwordx4 v2, s[16:19], s48 offen  lds
    s_add_u32 s48, s47, 10240
    s_add_u32 m0, s43, 1024
    s_nop 0
    buffer_load_dwordx4 v3, s[16:19], s48 offen  lds
    s_add_u32 s48, s47, 20480
    s_add_u32 m0, s43, 2048
    s_nop 0
    buffer_load_dwordx4 v2, s[16:19], s48 offen  lds
    s_add_u32 s48, s47, 30720
    s_add_u32 m0, s43, 3072
    s_nop 0
    buffer_load_dwordx4 v3, s[16:19], s48 offen  lds
    s_lshl_b32 s49, s78, 1
    s_add_u32 s49, s49, 17
    s_sub_u32 s48, s49, 20
    s_cselect_b32 s49, s49, s48
    s_mul_i32 s49, s49, s42
    s_add_u32 m0, s44, 118784
    s_nop 0
    buffer_load_dwordx4 v4, s[24:27], s49 offen  lds
    s_add_u32 m0, s45, 118784
    s_nop 0
    buffer_load_dwordx4 v5, s[24:27], s49 offen  lds
    s_add_u32 m0, s46, 118784
    s_nop 0
    buffer_load_dwordx4 v6, s[24:27], s49 offen  lds
    s_waitcnt vmcnt(14)
    s_barrier
    s_cmp_lg_u32 s41, 0
    s_cbranch_scc1 LA_pi
    v_and_b32 v20, 1, v0
    v_lshlrev_b32 v20, 6, v20
    global_load_dword v21, v20, s[14:15] offset:128 sc1
LA_pi:
    s_add_u32 s47, s78, 9
    s_sub_u32 s48, s47, 10
    s_cselect_b32 s47, s47, s48
    s_lshl_b32 s47, s47, 7
    s_add_u32 s47, s47, s40
    s_add_u32 s48, s47, 40960
    s_add_u32 m0, s43, 4096
    s_nop 0
    buffer_load_dwordx4 v2, s[16:19], s48 offen  lds
    s_add_u32 s48, s47, 51200
    s_add_u32 m0, s43, 5120
    s_nop 0
    buffer_load_dwordx4 v3, s[16:19], s48 offen  lds
    s_add_u32 s48, s47, 61440
    s_add_u32 m0, s43, 6144
    s_nop 0
    buffer_load_dwordx4 v2, s[16:19], s48 offen  lds
    s_add_u32 s48, s47, 71680
    s_add_u32 m0, s43, 7168
    s_nop 0
    buffer_load_dwordx4 v3, s[16:19], s48 offen  lds
    s_lshl_b32 s49, s78, 1
    s_add_u32 s49, s49, 18
    s_sub_u32 s48, s49, 20
    s_cselect_b32 s49, s49, s48
    s_mul_i32 s49, s49, s42
    s_add_u32 m0, s44, 129024
    s_nop 0
    buffer_load_dwordx4 v4, s[24:27], s49 offen  lds
    s_add_u32 m0, s45, 129024
    s_nop 0
    buffer_load_dwordx4 v5, s[24:27], s49 offen  lds
    s_add_u32 m0, s46, 129024
    s_nop 0
    buffer_load_dwordx4 v6, s[24:27], s49 offen  lds
    s_waitcnt vmcnt(14)
    s_barrier
    s_lshl_b32 s49, s78, 1
    s_add_u32 s49, s49, 19
    s_sub_u32 s48, s49, 20
    s_cselect_b32 s49, s49, s48
    s_mul_i32 s49, s49, s42
    s_add_u32 m0, s44, 139264
    s_nop 0
    buffer_load_dwordx4 v4, s[24:27], s49 offen  lds
    s_add_u32 m0, s45, 139264
    s_nop 0
    buffer_load_dwordx4 v5, s[24:27], s49 offen  lds
    s_add_u32 m0, s46, 139264
    s_nop 0
    buffer_load_dwordx4 v6, s[24:27], s49 offen  lds
    s_cmp_lg_u32 s41, 0
    s_cbranch_scc1 LA_pc
    s_waitcnt vmcnt(10)
    s_mov_b32 s68, 100000
    s_branch LAG_chk
LAG_spin:
    global_load_dword v21, v20, s[14:15] offset:128 sc1
    s_waitcnt vmcnt(0)
LAG_chk:
    v_cmp_ne_u32 vcc, 1, v21
    s_cbranch_vccz LAG_out
    s_sub_u32 s68, s68, 1
    s_cbranch_scc1 LAG_out
    s_sleep 2
    s_branch LAG_spin
LAG_out:
LA_pc:
    s_waitcnt vmcnt(10)
    s_barrier
    v_lshrrev_b32 v16, 3, v0
    v_and_b32 v17, 7, v0
    v_lshlrev_b32 v17, 3, v17
    v_lshl_add_u32 v17, v16, 7, v17
    s_lshl_b32 s48, s32, 5
    s_lshl_b32 s49, s41, 3
    s_add_u32 s48, s48, s49
    s_lshl_b32 s48, s48, 7
    s_add_u32 s48, s48, 20447232
    buffer_load_dwordx2 v[18:19], v17, s[20:23], s48 offen sc1
    v_lshlrev_b32 v16, 3, v0
    v_lshlrev_b32 v17, 2, v0
    buffer_load_dword v40, v17, s[20:23], s53 offen offset:0 sc1
    buffer_load_dword v41, v17, s[20:23], s53 offen offset:768 sc1
    buffer_load_dword v42, v17, s[20:23], s53 offen offset:1536 sc1
    buffer_load_dword v43, v17, s[20:23], s53 offen offset:2304 sc1
    buffer_load_dword v44, v17, s[20:23], s53 offen offset:3072 sc1
    s_add_u32 s53, s53, 3840
    buffer_load_dword v45, v17, s[20:23], s53 offen offset:0 sc1
    buffer_load_dword v46, v17, s[20:23], s53 offen offset:768 sc1
    buffer_load_dword v47, v17, s[20:23], s53 offen offset:1536 sc1
    buffer_load_dword v48, v17, s[20:23], s53 offen offset:2304 sc1
    buffer_load_dword v49, v17, s[20:23], s53 offen offset:3072 sc1
    s_add_u32 s53, s53, 3840
    buffer_load_dword v50, v17, s[20:23], s53 offen offset:0 sc1
    buffer_load_dword v51, v17, s[20:23], s53 offen offset:768 sc1
    buffer_load_dword v52, v17, s[20:23], s53 offen offset:1536 sc1
    buffer_load_dword v53, v17, s[20:23], s53 offen offset:2304 sc1
    buffer_load_dword v54, v17, s[20:23], s53 offen offset:3072 sc1
    s_add_u32 s53, s53, 3840
    buffer_load_dword v55, v17, s[20:23], s53 offen offset:0 sc1
    v_lshlrev_b32 v20, 4, v0
    s_add_u32 s48, s54, 0
    s_cmp_lt_u32 0, s55
    s_cselect_b32 s48, s48, 2146435072
    buffer_load_dwordx4 v[80:83], v20, s[20:23], s48 offen sc1
    s_add_u32 s48, s54, 1024
    s_cmp_lt_u32 1, s55
    s_cselect_b32 s48, s48, 2146435072
    buffer_load_dwordx4 v[84:87], v20, s[20:23], s48 offen sc1
    s_add_u32 s48, s54, 2048
    s_cmp_lt_u32 2, s55
    s_cselect_b32 s48, s48, 2146435072
    buffer_load_dwordx4 v[88:91], v20, s[20:23], s48 offen sc1
    s_add_u32 s48, s54, 3072
    s_cmp_lt_u32 3, s55
    s_cselect_b32 s48, s48, 2146435072
    buffer_load_dwordx4 v[92:95], v20, s[20:23], s48 offen sc1
    s_add_u32 s48, s54, 4096
    s_cmp_lt_u32 4, s55
    s_cselect_b32 s48, s48, 2146435072
    buffer_load_dwordx4 v[96:99], v20, s[20:23], s48 offen sc1
    s_add_u32 s48, s54, 5120
    s_cmp_lt_u32 5, s55
    s_cselect_b32 s48, s48, 2146435072
    buffer_load_dwordx4 v[100:103], v20, s[20:23], s48 offen sc1
    s_add_u32 s48, s54, 6144
    s_cmp_lt_u32 6, s55
    s_cselect_b32 s48, s48, 2146435072
    buffer_load_dwordx4 v[104:107], v20, s[20:23], s48 offen sc1
    s_add_u32 s48, s54, 7168
    s_cmp_lt_u32 7, s55
    s_cselect_b32 s48, s48, 2146435072
    buffer_load_dwordx4 v[108:111], v20, s[20:23], s48 offen sc1
    s_waitcnt vmcnt(28)
    s_barrier
    s_waitcnt vmcnt(25)
    s_barrier
    s_waitcnt vmcnt(8)
    s_lshl_b32 s48, s41, 9
    s_add_u32 s48, s48, 159744
    v_add_u32 v16, s48, v16
    ds_write_b64 v16, v[18:19]
    v_add_f32 v40, v40, v48
    v_add_f32 v41, v41, v49
    v_add_f32 v42, v42, v50
    v_add_f32 v43, v43, v51
    v_add_f32 v44, v44, v52
    v_add_f32 v45, v45, v53
    v_add_f32 v46, v46, v54
    v_add_f32 v47, v47, v55
    v_add_f32 v40, v40, v44
    v_add_f32 v41, v41, v45
    v_add_f32 v42, v42, v46
    v_add_f32 v43, v43, v47
    v_add_f32 v40, v40, v42
    v_add_f32 v41, v41, v43
    v_add_f32 v40, v40, v41
    s_mul_i32 s48, s41, 192
    s_add_u32 s48, s48, 161792
    v_add_u32 v17, s48, v17
    s_mov_b32 exec_hi, 0xffff
    ds_write_b32 v17, v40
    s_mov_b64 exec, -1
    s_waitcnt vmcnt(0)
    v_add_u32 v20, s43, v20
    ds_write_b128 v20, v[80:83] offset:8192
    ds_write_b128 v20, v[84:87] offset:9216
    ds_write_b128 v20, v[88:91] offset:10240
    ds_write_b128 v20, v[92:95] offset:11264
    ds_write_b128 v20, v[96:99] offset:12288
    ds_write_b128 v20, v[100:103] offset:13312
    ds_write_b128 v20, v[104:107] offset:14336
    ds_write_b128 v20, v[108:111] offset:15360
    v_mov_b32 v16, 162816
    v_mov_b32 v18, 0
    v_mov_b32 v19, 0
    ds_write_b64 v16, v[18:19] offset:0
    ds_write_b64 v16, v[18:19] offset:8
    ds_write_b64 v16, v[18:19] offset:16
    ds_write_b64 v16, v[18:19] offset:24
    ds_write_b64 v16, v[18:19] offset:32
    ds_write_b64 v16, v[18:19] offset:40
    ds_write_b64 v16, v[18:19] offset:48
    ds_write_b64 v16, v[18:19] offset:56
    s_waitcnt lgkmcnt(0)
    s_barrier
    s_mov_b32 s57, 2146435072
    s_cmp_eq_u32 s34, 1
    s_cbranch_scc1 P2_stream
    s_branch P2_aux
K1_l_qkv2:
    v_bfe_u32 v36, v0, 4, 1
    v_mul_u32_u24 v36, 1280, v36
    v_and_b32 v37, 15, v0
    v_lshl_add_u32 v36, v37, 4, v36
    s_mul_i32 s69, s66, 1280
    buffer_load_dwordx4 v[16:19], v36, s[16:19], s69 offen offset:0
    s_mul_i32 s48, s51, 0
    s_add_u32 s48, s48, s50
    buffer_load_dwordx4 v[80:83], v7, s[24:27], s48 offen
    s_mul_i32 s48, s51, 1
    s_add_u32 s48, s48, s50
    buffer_load_dwordx4 v[84:87], v7, s[24:27], s48 offen
    buffer_load_dwordx4 v[20:23], v36, s[16:19], s69 offen offset:256
    s_mul_i32 s48, s51, 32
    s_add_u32 s48, s48, s50
    buffer_load_dwordx4 v[88:91], v7, s[24:27], s48 offen
    s_mul_i32 s48, s51, 33
    s_add_u32 s48, s48, s50
    buffer_load_dwordx4 v[92:95], v7, s[24:27], s48 offen
    s_waitcnt vmcnt(9)
    s_barrier
    s_add_u32 s47, s78, 1
    s_sub_u32 s48, s47, 10
    s_cselect_b32 s47, s47, s48
    s_lshl_b32 s47, s47, 7
    s_add_u32 s47, s47, s40
    s_add_u32 s48, s47, 0
    s_add_u32 m0, s43, 8192
    s_nop 0
    buffer_load_dwordx4 v2, s[16:19], s48 offen  lds
    s_add_u32 s48, s47, 10240
    s_add_u32 m0, s43, 9216
    s_nop 0
    buffer_load_dwordx4 v3, s[16:19], s48 offen  lds
    s_add_u32 s48, s47, 20480
    s_add_u32 m0, s43, 10240
    s_nop 0
    buffer_load_dwordx4 v2, s[16:19], s48 offen  lds
    s_add_u32 s48, s47, 30720
    s_add_u32 m0, s43, 11264
    s_nop 0
    buffer_load_dwordx4 v3, s[16:19], s48 offen  lds
    s_add_u32 s47, s78, 1
    s_sub_u32 s48, s47, 10
    s_cselect_b32 s47, s47, s48
    s_lshl_b32 s47, s47, 7
    s_add_u32 s47, s47, s40
    s_add_u32 s48, s47, 40960
    s_add_u32 m0, s43, 12288
    s_nop 0
    buffer_load_dwordx4 v2, s[16:19], s48 offen  lds
    s_add_u32 s48, s47, 51200
    s_add_u32 m0, s43, 13312
    s_nop 0
    buffer_load_dwordx4 v3, s[16:19], s48 offen  lds
    s_add_u32 s48, s47, 61440
    s_add_u32 m0, s43, 14336
    s_nop 0
    buffer_load_dwordx4 v2, s[16:19], s48 offen  lds
    s_add_u32 s48, s47, 71680
    s_add_u32 m0, s43, 15360
    s_nop 0
    buffer_load_dwordx4 v3, s[16:19], s48 offen  lds
    s_lshl_b32 s49, s78, 1
    s_add_u32 s49, s49, 2
    s_sub_u32 s48, s49, 20
    s_cselect_b32 s49, s49, s48
    s_mul_i32 s49, s49, s42
    s_add_u32 m0, s44, 118784
    s_nop 0
    buffer_load_dwordx4 v4, s[24:27], s49 offen  lds
    s_add_u32 m0, s45, 118784
    s_nop 0
    buffer_load_dwordx4 v5, s[24:27], s49 offen  lds
    s_lshl_b32 s49, s78, 1
    s_add_u32 s49, s49, 3
    s_sub_u32 s48, s49, 20
    s_cselect_b32 s49, s49, s48
    s_mul_i32 s49, s49, s42
    s_add_u32 m0, s44, 129024
    s_nop 0
    buffer_load_dwordx4 v4, s[24:27], s49 offen  lds
    s_add_u32 m0, s45, 129024
    s_nop 0
    buffer_load_dwordx4 v5, s[24:27], s49 offen  lds
    s_add_u32 s47, s78, 2
    s_sub_u32 s48, s47, 10
    s_cselect_b32 s47, s47, s48
    s_lshl_b32 s47, s47, 7
    s_add_u32 s47, s47, s40
    s_add_u32 s48, s47, 0
    s_add_u32 m0, s43, 16384
    s_nop 0
    buffer_load_dwordx4 v2, s[16:19], s48 offen  lds
    s_add_u32 s48, s47, 10240
    s_add_u32 m0, s43, 17408
    s_nop 0
    buffer_load_dwordx4 v3, s[16:19], s48 offen  lds
    s_add_u32 s48, s47, 20480
    s_add_u32 m0, s43, 18432
    s_nop 0
    buffer_load_dwordx4 v2, s[16:19], s48 offen  lds
    s_add_u32 s48, s47, 30720
    s_add_u32 m0, s43, 19456
    s_nop 0
    buffer_load_dwordx4 v3, s[16:19], s48 offen  lds
    v_and_b32 v128, 15, v0
    v_mov_b32 v129, 0x3f80
    v_mov_b32 v130, 0x3f800000
    v_cmp_eq_u32 vcc, 0, v128
    s_nop 1
    v_cndmask_b32 v124, 0, v129, vcc
    v_cmp_eq_u32 vcc, 1, v128
    s_nop 1
    v_cndmask_b32 v124, v124, v130, vcc
    v_cmp_eq_u32 vcc, 2, v128
    s_nop 1
    v_cndmask_b32 v125, 0, v129, vcc
    v_cmp_eq_u32 vcc, 3, v128
    s_nop 1
    v_cndmask_b32 v125, v125, v130, vcc
    v_cmp_eq_u32 vcc, 4, v128
    s_nop 1
    v_cndmask_b32 v126, 0, v129, vcc
    v_cmp_eq_u32 vcc, 5, v128
    s_nop 1
    v_cndmask_b32 v126, v126, v130, vcc
    v_cmp_eq_u32 vcc, 6, v128
    s_nop 1
    v_cndmask_b32 v127, 0, v129, vcc
    v_cmp_eq_u32 vcc, 7, v128
    s_nop 1
    v_cndmask_b32 v127, v127, v130, vcc
    buffer_load_dwordx4 v[24:27], v36, s[16:19], s69 offen offset:512
    s_mul_i32 s48, s51, 64
    s_add_u32 s48, s48, s50
    buffer_load_dwordx4 v[96:99], v7, s[24:27], s48 offen
    s_mul_i32 s48, s51, 65
    s_add_u32 s48, s48, s50
    buffer_load_dwordx4 v[100:103], v7, s[24:27], s48 offen
    s_waitcnt vmcnt(25)
    s_barrier
    s_add_u32 s47, s78, 2
    s_sub_u32 s48, s47, 10
    s_cselect_b32 s47, s47, s48
    s_lshl_b32 s47, s47, 7
    s_add_u32 s47, s47, s40
    s_add_u32 s48, s47, 40960
    s_add_u32 m0, s43, 20480
    s_nop 0
    buffer_load_dwordx4 v2, s[16:19], s48 offen  lds
    s_add_u32 s48, s47, 51200
    s_add_u32 m0, s43, 21504
    s_nop 0
    buffer_load_dwordx4 v3, s[16:19], s48 offen  lds
    s_add_u32 s48, s47, 61440
    s_add_u32 m0, s43, 22528
    s_nop 0
    buffer_load_dwordx4 v2, s[16:19], s48 offen  lds
    s_add_u32 s48, s47, 71680
    s_add_u32 m0, s43, 23552
    s_nop 0
    buffer_load_dwordx4 v3, s[16:19], s48 offen  lds
    s_lshl_b32 s49, s78, 1
    s_add_u32 s49, s49, 4
    s_sub_u32 s48, s49, 20
    s_cselect_b32 s49, s49, s48
    s_mul_i32 s49, s49, s42
    s_add_u32 m0, s44, 139264
    s_nop 0
    buffer_load_dwordx4 v4, s[24:27], s49 offen  lds
    s_add_u32 m0, s45, 139264
    s_nop 0
    buffer_load_dwordx4 v5, s[24:27], s49 offen  lds
    buffer_load_dwordx4 v[28:31], v36, s[16:19], s69 offen offset:768
    s_mul_i32 s48, s51, 96
    s_add_u32 s48, s48, s50
    buffer_load_dwordx4 v[104:107], v7, s[24:27], s48 offen
    s_mul_i32 s48, s51, 97
    s_add_u32 s48, s48, s50
    buffer_load_dwordx4 v[108:111], v7, s[24:27], s48 offen
    s_waitcnt vmcnt(18)
    s_barrier
    s_add_u32 s47, s78, 3
    s_sub_u32 s48, s47, 10
    s_cselect_b32 s47, s47, s48
    s_lshl_b32 s47, s47, 7
    s_add_u32 s47, s47, s40
    s_add_u32 s48, s47, 0
    s_add_u32 m0, s43, 0
    s_nop 0
    buffer_load_dwordx4 v2, s[16:19], s48 offen  lds
    s_add_u32 s48, s47, 10240
    s_add_u32 m0, s43, 1024
    s_nop 0
    buffer_load_dwordx4 v3, s[16:19], s48 offen  lds
    s_add_u32 s48, s47, 20480
    s_add_u32 m0, s43, 2048
    s_nop 0
    buffer_load_dwordx4 v2, s[16:19], s48 offen  lds
    s_add_u32 s48, s47, 30720
    s_add_u32 m0, s43, 3072
    s_nop 0
    buffer_load_dwordx4 v3, s[16:19], s48 offen  lds
    s_lshl_b32 s49, s78, 1
    s_add_u32 s49, s49, 5
    s_sub_u32 s48, s49, 20
    s_cselect_b32 s49, s49, s48
    s_mul_i32 s49, s49, s42
    s_add_u32 m0, s44, 98304
    s_nop 0
    buffer_load_dwordx4 v4, s[24:27], s49 offen  lds
    s_add_u32 m0, s45, 98304
    s_nop 0
    buffer_load_dwordx4 v5, s[24:27], s49 offen  lds
    buffer_load_dwordx4 v[32:35], v36, s[16:19], s69 offen offset:1024
    s_mul_i32 s48, s51, 128
    s_add_u32 s48, s48, s50
    buffer_load_dwordx4 v[112:115], v7, s[24:27], s48 offen
    s_mul_i32 s48, s51, 129
    s_add_u32 s48, s48, s50
    buffer_load_dwordx4 v[116:119], v7, s[24:27], s48 offen
    s_waitcnt vmcnt(25)
    s_barrier
    s_add_u32 s47, s78, 3
    s_sub_u32 s48, s47, 10
    s_cselect_b32 s47, s47, s48
    s_lshl_b32 s47, s47, 7
    s_add_u32 s47, s47, s40
    s_add_u32 s48, s47, 40960
    s_add_u32 m0, s43, 4096
    s_nop 0
    buffer_load_dwordx4 v2, s[16:19], s48 offen  lds
    s_add_u32 s48, s47, 51200
    s_add_u32 m0, s43, 5120
    s_nop 0
    buffer_load_dwordx4 v3, s[16:19], s48 offen  lds
    s_add_u32 s48, s47, 61440
    s_add_u32 m0, s43, 6144
    s_nop 0
    buffer_load_dwordx4 v2, s[16:19], s48 offen  lds
    s_add_u32 s48, s47, 71680
    s_add_u32 m0, s43, 7168
    s_nop 0
    buffer_load_dwordx4 v3, s[16:19], s48 offen  lds
    s_lshl_b32 s49, s78, 1
    s_add_u32 s49, s49, 6
    s_sub_u32 s48, s49, 20
    s_cselect_b32 s49, s49, s48
    s_mul_i32 s49, s49, s42
    s_add_u32 m0, s44, 108544
    s_nop 0
    buffer_load_dwordx4 v4, s[24:27], s49 offen  lds
    s_add_u32 m0, s45, 108544
    s_nop 0
    buffer_load_dwordx4 v5, s[24:27], s49 offen  lds
    s_waitcnt vmcnt(18)
    s_barrier
    s_add_u32 s47, s78, 4
    s_sub_u32 s48, s47, 10
    s_cselect_b32 s47, s47, s48
    s_lshl_b32 s47, s47, 7
    s_add_u32 s47, s47, s40
    s_add_u32 s48, s47, 0
    s_add_u32 m0, s43, 8192
    s_nop 0
    buffer_load_dwordx4 v2, s[16:19], s48 offen  lds
    s_add_u32 s48, s47, 10240
    s_add_u32 m0, s43, 9216
    s_nop 0
    buffer_load_dwordx4 v3, s[16:19], s48 offen  lds
    s_add_u32 s48, s47, 20480
    s_add_u32 m0, s43, 10240
    s_nop 0
    buffer_load_dwordx4 v2, s[16:19], s48 offen  lds
    s_add_u32 s48, s47, 30720
    s_add_u32 m0, s43, 11264
    s_nop 0
    buffer_load_dwordx4 v3, s[16:19], s48 offen  lds
    s_lshl_b32 s49, s78, 1
    s_add_u32 s49, s49, 7
    s_sub_u32 s48, s49, 20
    s_cselect_b32 s49, s49, s48
    s_mul_i32 s49, s49, s42
    s_add_u32 m0, s44, 118784
    s_nop 0
    buffer_load_dwordx4 v4, s[24:27], s49 offen  lds
    s_add_u32 m0, s45, 118784
    s_nop 0
    buffer_load_dwordx4 v5, s[24:27], s49 offen  lds
    s_waitcnt vmcnt(12)
    s_setprio 3
    v_mfma_f32_16x16x32_bf16 v[120:123], v[124:127], v[80:83], 0
    v_mfma_f32_16x16x32_bf16 v[120:123], v[124:127], v[84:87], v[120:123]
    v_mfma_f32_16x16x32_bf16 v[120:123], v[124:127], v[88:91], v[120:123]
    v_mfma_f32_16x16x32_bf16 v[120:123], v[124:127], v[92:95], v[120:123]
    v_mfma_f32_16x16x32_bf16 v[120:123], v[124:127], v[96:99], v[120:123]
    v_mfma_f32_16x16x32_bf16 v[120:123], v[124:127], v[100:103], v[120:123]
    v_mfma_f32_16x16x32_bf16 v[120:123], v[124:127], v[104:107], v[120:123]
    v_mfma_f32_16x16x32_bf16 v[120:123], v[124:127], v[108:111], v[120:123]
    v_mfma_f32_16x16x32_bf16 v[120:123], v[124:127], v[112:115], v[120:123]
    v_mfma_f32_16x16x32_bf16 v[120:123], v[124:127], v[116:119], v[120:123]
    s_nop 0
    v_mov_b32 v40, 0x3f803f80
    v_dot2_f32_bf16 v36, v16, v40, 0
    v_dot2_f32_bf16 v37, v16, v16, 0
    v_dot2_f32_bf16 v41, v17, v40, 0
    v_dot2_f32_bf16 v42, v17, v17, 0
    v_dot2_f32_bf16 v36, v18, v40, v36
    v_dot2_f32_bf16 v37, v18, v18, v37
    v_dot2_f32_bf16 v41, v19, v40, v41
    v_dot2_f32_bf16 v42, v19, v19, v42
    v_dot2_f32_bf16 v36, v20, v40, v36
    v_dot2_f32_bf16 v37, v20, v20, v37
    v_dot2_f32_bf16 v41, v21, v40, v41
    v_dot2_f32_bf16 v42, v21, v21, v42
    v_dot2_f32_bf16 v36, v22, v40, v36
    v_dot2_f32_bf16 v37, v22, v22, v37
    v_dot2_f32_bf16 v41, v23, v40, v41
    v_dot2_f32_bf16 v42, v23, v23, v42
    v_dot2_f32_bf16 v36, v24, v40, v36
    v_dot2_f32_bf16 v37, v24, v24, v37
    v_dot2_f32_bf16 v41, v25, v40, v41
    v_dot2_f32_bf16 v42, v25, v25, v42
    v_dot2_f32_bf16 v36, v26, v40, v36
    v_dot2_f32_bf16 v37, v26, v26, v37
    v_dot2_f32_bf16 v41, v27, v40, v41
    v_dot2_f32_bf16 v42, v27, v27, v42
    v_dot2_f32_bf16 v36, v28, v40, v36
    v_dot2_f32_bf16 v37, v28, v28, v37
    v_dot2_f32_bf16 v41, v29, v40, v41
    v_dot2_f32_bf16 v42, v29, v29, v42
    v_dot2_f32_bf16 v36, v30, v40, v36
    v_dot2_f32_bf16 v37, v30, v30, v37
    v_dot2_f32_bf16 v41, v31, v40, v41
    v_dot2_f32_bf16 v42, v31, v31, v42
    v_dot2_f32_bf16 v36, v32, v40, v36
    v_dot2_f32_bf16 v37, v32, v32, v37
    v_dot2_f32_bf16 v41, v33, v40, v41
    v_dot2_f32_bf16 v42, v33, v33, v42
    v_dot2_f32_bf16 v36, v34, v40, v36
    v_dot2_f32_bf16 v37, v34, v34, v37
    v_dot2_f32_bf16 v41, v35, v40, v41
    v_dot2_f32_bf16 v42, v35, v35, v42
    s_setprio 0
    s_barrier
    s_add_u32 s47, s78, 4
    s_sub_u32 s48, s47, 10
    s_cselect_b32 s47, s47, s48
    s_lshl_b32 s47, s47, 7
    s_add_u32 s47, s47, s40
    s_add_u32 s48, s47, 40960
    s_add_u32 m0, s43, 12288
    s_nop 0
    buffer_load_dwordx4 v2, s[16:19], s48 offen  lds
    s_add_u32 s48, s47, 51200
    s_add_u32 m0, s43, 13312
    s_nop 0
    buffer_load_dwordx4 v3, s[16:19], s48 offen  lds
    s_add_u32 s48, s47, 61440
    s_add_u32 m0, s43, 14336
    s_nop 0
    buffer_load_dwordx4 v2, s[16:19], s48 offen  lds
    s_add_u32 s48, s47, 71680
    s_add_u32 m0, s43, 15360
    s_nop 0
    buffer_load_dwordx4 v3, s[16:19], s48 offen  lds
    s_lshl_b32 s49, s78, 1
    s_add_u32 s49, s49, 8
    s_sub_u32 s48, s49, 20
    s_cselect_b32 s49, s49, s48
    s_mul_i32 s49, s49, s42
    s_add_u32 m0, s44, 129024
    s_nop 0
    buffer_load_dwordx4 v4, s[24:27], s49 offen  lds
    s_add_u32 m0, s45, 129024
    s_nop 0
    buffer_load_dwordx4 v5, s[24:27], s49 offen  lds
    s_setprio 3
    s_nop 2
    v_add_f32 v36, v36, v41
    v_add_f32_e64 v37, v37, v42
    s_nop 0
    v_add_f32_dpp v36, v36, v36 row_ror:8 row_mask:0xf bank_mask:0xf
    v_add_f32_dpp v37, v37, v37 row_ror:8 row_mask:0xf bank_mask:0xf
    s_nop 0
    v_add_f32_dpp v36, v36, v36 row_ror:4 row_mask:0xf bank_mask:0xf
    v_add_f32_dpp v37, v37, v37 row_ror:4 row_mask:0xf bank_mask:0xf
    s_nop 0
    v_add_f32_dpp v36, v36, v36 row_ror:2 row_mask:0xf bank_mask:0xf
    v_add_f32_dpp v37, v37, v37 row_ror:2 row_mask:0xf bank_mask:0xf
    s_nop 0
    s_nop 0
    v_add_f32_dpp v36, v36, v36 row_ror:1 row_mask:0xf bank_mask:0xf
    v_add_f32_dpp v37, v37, v37 row_ror:1 row_mask:0xf bank_mask:0xf
    v_mul_f32 v36, 0x3acccccd, v36
    v_mul_f32 v37, 0x3acccccd, v37
    v_fma_f32 v37, -v36, v36, v37
    v_max_f32_e64 v37, 0, v37
    v_cvt_pk_bf16_f32 v36, v36, v36
    v_lshlrev_b32_e64 v36, 16, v36
    v_cvt_pk_bf16_f32 v37, v37, v37
    v_lshlrev_b32_e64 v37, 16, v37
    v_add_f32 v37, 0x3727c5ac, v37
    v_cvt_pk_bf16_f32 v37, v37, v37
    v_lshlrev_b32 v37, 16, v37
    v_sqrt_f32_e64 v37, v37
    s_nop 0
    v_cvt_pk_bf16_f32 v37, v37, v37
    v_lshlrev_b32 v37, 16, v37
    v_rcp_f32 v37, v37
    v_bfe_u32 v16, v0, 4, 1
    v_lshlrev_b32 v16, 3, v16
    s_lshl_b32 s67, s41, 4
    s_add_u32 s67, s67, 159744
    v_add_u32 v16, s67, v16
    ds_write_b64 v16, v[36:37]
    v_and_b32 v80, 15, v0
    v_lshlrev_b32 v80, 5, v80
    v_lshrrev_b32 v81, 4, v0
    v_lshl_add_u32 v80, v81, 4, v80
    s_mul_i32 s48, s41, 384
    s_add_u32 s48, s48, 159872
    v_add_u32 v80, s48, v80
    s_mov_b64 exec, 67044351
    ds_write_b128 v80, v[120:123]
    s_mov_b64 exec, -1
    s_waitcnt lgkmcnt(0)
    s_setprio 0
    s_waitcnt vmcnt(12)
    s_barrier
    s_add_u32 s47, s78, 5
    s_sub_u32 s48, s47, 10
    s_cselect_b32 s47, s47, s48
    s_lshl_b32 s47, s47, 7
    s_add_u32 s47, s47, s40
    s_add_u32 s48, s47, 0
    s_add_u32 m0, s43, 16384
    s_nop 0
    buffer_load_dwordx4 v2, s[16:19], s48 offen  lds
    s_add_u32 s48, s47, 10240
    s_add_u32 m0, s43, 17408
    s_nop 0
    buffer_load_dwordx4 v3, s[16:19], s48 offen  lds
    s_add_u32 s48, s47, 20480
    s_add_u32 m0, s43, 18432
    s_nop 0
    buffer_load_dwordx4 v2, s[16:19], s48 offen  lds
    s_add_u32 s48, s47, 30720
    s_add_u32 m0, s43, 19456
    s_nop 0
    buffer_load_dwordx4 v3, s[16:19], s48 offen  lds
    s_lshl_b32 s49, s78, 1
    s_add_u32 s49, s49, 9
    s_sub_u32 s48, s49, 20
    s_cselect_b32 s49, s49, s48
    s_mul_i32 s49, s49, s42
    s_add_u32 m0, s44, 139264
    s_nop 0
    buffer_load_dwordx4 v4, s[24:27], s49 offen  lds
    s_add_u32 m0, s45, 139264
    s_nop 0
    buffer_load_dwordx4 v5, s[24:27], s49 offen  lds
    s_mul_i32 s30, s32, 30
    s_add_u32 s30, s30, s29
    s_lshl_b32 s30, s30, 2
    s_add_u32 s30, s30, s41
    s_waitcnt lgkmcnt(0)
    s_cmp_lt_u32 s30, 740
    s_mov_b32 s76, 2146435072
    s_cselect_b32 s76, 13631488, s76
    s_cselect_b32 s77, 0, 2146435072
    s_mul_i32 s74, s30, 6554
    s_lshr_b32 s74, s74, 16
    s_mul_i32 s75, s74, 10
    s_sub_u32 s75, s30, s75
    s_cmp_lt_u32 s74, 54
    s_cselect_b32 s4, s72, s70
    s_cselect_b32 s5, s73, s71
    s_mov_b32 s6, 819200
    s_cselect_b32 s6, 2211840, s6
    s_mov_b32 s7, 0x20000
    s_cselect_b32 s31, 4, 20
    s_lshl_b32 s36, s74, 5
    s_mov_b32 s38, 16
    s_cmp_lt_u32 s74, 54
    s_cbranch_scc1 LB_rl
    s_sub_u32 s33, s74, 54
    s_mul_i32 s36, s33, 205
    s_lshr_b32 s36, s36, 10
    s_mul_i32 s48, s36, 5
    s_sub_u32 s33, s33, s48
    s_mul_i32 s36, s36, 160
    s_lshl_b32 s48, s33, 3
    s_cmp_ge_u32 s33, 3
    s_cselect_b32 s47, 56, 0
    s_add_u32 s48, s48, s47
    s_add_u32 s36, s36, s48
    s_cmp_eq_u32 s33, 2
    s_cselect_b32 s38, 80, 4
LB_rl:
    v_lshrrev_b32 v8, 5, v0
    v_mul_lo_u32 v8, v8, s38
    v_bfe_u32 v9, v0, 3, 2
    v_add_u32_e64 v8, v8, v9
    v_mul_u32_u24 v8, 1280, v8
    v_and_b32_e64 v9, 7, v0
    v_lshl_add_u32 v8, v9, 4, v8
    s_mul_i32 s36, s36, 1280
    s_lshl_b32 s47, s75, 7
    s_add_u32 s47, s47, s36
    s_add_u32 s47, s47, s77
    s_mul_i32 s31, s31, 1280
    buffer_load_dwordx4 v[140:143], v8, s[4:7], s47 offen
    s_add_u32 s47, s47, s31
    buffer_load_dwordx4 v[144:147], v8, s[4:7], s47 offen
    s_add_u32 s47, s47, s31
    buffer_load_dwordx4 v[148:151], v8, s[4:7], s47 offen
    s_add_u32 s47, s47, s31
    buffer_load_dwordx4 v[152:155], v8, s[4:7], s47 offen
    s_waitcnt vmcnt(16)
    s_barrier
    s_add_u32 s47, s78, 5
    s_sub_u32 s48, s47, 10
    s_cselect_b32 s47, s47, s48
    s_lshl_b32 s47, s47, 7
    s_add_u32 s47, s47, s40
    s_add_u32 s48, s47, 40960
    s_add_u32 m0, s43, 20480
    s_nop 0
    buffer_load_dwordx4 v2, s[16:19], s48 offen  lds
    s_add_u32 s48, s47, 51200
    s_add_u32 m0, s43, 21504
    s_nop 0
    buffer_load_dwordx4 v3, s[16:19], s48 offen  lds
    s_add_u32 s48, s47, 61440
    s_add_u32 m0, s43, 22528
    s_nop 0
    buffer_load_dwordx4 v2, s[16:19], s48 offen  lds
    s_add_u32 s48, s47, 71680
    s_add_u32 m0, s43, 23552
    s_nop 0
    buffer_load_dwordx4 v3, s[16:19], s48 offen  lds
    s_lshl_b32 s49, s78, 1
    s_add_u32 s49, s49, 10
    s_sub_u32 s48, s49, 20
    s_cselect_b32 s49, s49, s48
    s_mul_i32 s49, s49, s42
    s_add_u32 m0, s44, 98304
    s_nop 0
    buffer_load_dwordx4 v4, s[24:27], s49 offen  lds
    s_add_u32 m0, s45, 98304
    s_nop 0
    buffer_load_dwordx4 v5, s[24:27], s49 offen  lds
    s_mul_i32 s31, s30, 3277
    s_lshr_b32 s31, s31, 16
    s_mul_i32 s31, s31, 54
    s_add_u32 s31, s31, s30
    s_add_u32 s31, s31, 54
    s_lshl_b32 s31, s31, 12
    s_add_u32 s31, s31, 3145728
    s_lshl_b32 s33, s30, 12
    s_add_u32 s33, s33, 18350080
    s_cmp_lt_u32 s30, 640
    s_cselect_b32 s31, s31, s33
    s_cmp_lt_u32 s30, 768
    s_cselect_b32 s31, s31, 2146435072
    v_lshlrev_b32 v176, 4, v0
    v_mov_b32 v172, -1
    v_mov_b32 v173, -1
    v_mov_b32 v174, -1
    v_mov_b32 v175, -1
    buffer_store_dwordx4 v[172:175], v176, s[20:23], s31 offen offset:0 sc1
    buffer_store_dwordx4 v[172:175], v176, s[20:23], s31 offen offset:1024 sc1
    buffer_store_dwordx4 v[172:175], v176, s[20:23], s31 offen offset:2048 sc1
    buffer_store_dwordx4 v[172:175], v176, s[20:23], s31 offen offset:3072 sc1
    s_waitcnt vmcnt(20)
    s_barrier
    s_add_u32 s47, s78, 6
    s_sub_u32 s48, s47, 10
    s_cselect_b32 s47, s47, s48
    s_lshl_b32 s47, s47, 7
    s_add_u32 s47, s47, s40
    s_add_u32 s48, s47, 0
    s_add_u32 m0, s43, 0
    s_nop 0
    buffer_load_dwordx4 v2, s[16:19], s48 offen  lds
    s_add_u32 s48, s47, 10240
    s_add_u32 m0, s43, 1024
    s_nop 0
    buffer_load_dwordx4 v3, s[16:19], s48 offen  lds
    s_add_u32 s48, s47, 20480
    s_add_u32 m0, s43, 2048
    s_nop 0
    buffer_load_dwordx4 v2, s[16:19], s48 offen  lds
    s_add_u32 s48, s47, 30720
    s_add_u32 m0, s43, 3072
    s_nop 0
    buffer_load_dwordx4 v3, s[16:19], s48 offen  lds
    s_lshl_b32 s49, s78, 1
    s_add_u32 s49, s49, 11
    s_sub_u32 s48, s49, 20
    s_cselect_b32 s49, s49, s48
    s_mul_i32 s49, s49, s42
    s_add_u32 m0, s44, 108544
    s_nop 0
    buffer_load_dwordx4 v4, s[24:27], s49 offen  lds
    s_add_u32 m0, s45, 108544
    s_nop 0
    buffer_load_dwordx4 v5, s[24:27], s49 offen  lds
    s_add_u32 s47, s43, 4096
    v_lshlrev_b32 v10, 4, v0
    v_add_u32 v8, s47, v10
    v_lshrrev_b32 v9, 4, v0
    v_lshlrev_b32 v9, 10, v9
    v_bfe_u32 v11, v0, 2, 2
    v_lshl_add_u32 v9, v11, 7, v9
    v_and_b32_e64 v11, 3, v0
    v_lshl_add_u32 v9, v11, 3, v9
    v_add_u32 v9, s47, v9
    s_waitcnt vmcnt(16)
    ds_write_b128 v8, v[140:143] offset:0
    ds_write_b128 v8, v[144:147] offset:1024
    ds_write_b128 v8, v[148:151] offset:2048
    ds_write_b128 v8, v[152:155] offset:3072
    s_barrier
    s_lshl_b32 s49, s78, 1
    s_add_u32 s49, s49, 12
    s_sub_u32 s48, s49, 20
    s_cselect_b32 s49, s49, s48
    s_mul_i32 s49, s49, s42
    s_add_u32 m0, s44, 118784
    s_nop 0
    buffer_load_dwordx4 v4, s[24:27], s49 offen  lds
    s_add_u32 m0, s45, 118784
    s_nop 0
    buffer_load_dwordx4 v5, s[24:27], s49 offen  lds
    s_waitcnt lgkmcnt(0)
    ds_read_b64_tr_b16 v[156:157], v9 offset:0
    ds_read_b64_tr_b16 v[158:159], v9 offset:512
    ds_read_b64_tr_b16 v[160:161], v9 offset:32
    ds_read_b64_tr_b16 v[162:163], v9 offset:544
    ds_read_b64_tr_b16 v[164:165], v9 offset:64
    ds_read_b64_tr_b16 v[166:167], v9 offset:576
    ds_read_b64_tr_b16 v[168:169], v9 offset:96
    ds_read_b64_tr_b16 v[170:171], v9 offset:608
    s_lshl_b32 s47, s75, 2
    s_add_u32 s47, s47, 0
    s_mul_i32 s48, s47, 205
    s_lshr_b32 s48, s48, 10
    s_mul_i32 s49, s48, 5
    s_sub_u32 s47, s47, s49
    s_mul_i32 s48, s48, 74
    s_add_u32 s48, s48, s74
    s_mul_i32 s48, s48, 5
    s_add_u32 s48, s48, s47
    s_lshl_b32 s48, s48, 10
    s_add_u32 s48, s48, s76
    s_waitcnt lgkmcnt(6)
    buffer_store_dwordx4 v[156:159], v10, s[20:23], s48 offen sc1
    s_lshl_b32 s47, s75, 2
    s_add_u32 s47, s47, 1
    s_mul_i32 s48, s47, 205
    s_lshr_b32 s48, s48, 10
    s_mul_i32 s49, s48, 5
    s_sub_u32 s47, s47, s49
    s_mul_i32 s48, s48, 74
    s_add_u32 s48, s48, s74
    s_mul_i32 s48, s48, 5
    s_add_u32 s48, s48, s47
    s_lshl_b32 s48, s48, 10
    s_add_u32 s48, s48, s76
    s_waitcnt lgkmcnt(4)
    buffer_store_dwordx4 v[160:163], v10, s[20:23], s48 offen sc1
    s_lshl_b32 s47, s75, 2
    s_add_u32 s47, s47, 2
    s_mul_i32 s48, s47, 205
    s_lshr_b32 s48, s48, 10
    s_mul_i32 s49, s48, 5
    s_sub_u32 s47, s47, s49
    s_mul_i32 s48, s48, 74
    s_add_u32 s48, s48, s74
    s_mul_i32 s48, s48, 5
    s_add_u32 s48, s48, s47
    s_lshl_b32 s48, s48, 10
    s_add_u32 s48, s48, s76
    s_waitcnt lgkmcnt(2)
    buffer_store_dwordx4 v[164:167], v10, s[20:23], s48 offen sc1
    s_lshl_b32 s47, s75, 2
    s_add_u32 s47, s47, 3
    s_mul_i32 s48, s47, 205
    s_lshr_b32 s48, s48, 10
    s_mul_i32 s49, s48, 5
    s_sub_u32 s47, s47, s49
    s_mul_i32 s48, s48, 74
    s_add_u32 s48, s48, s74
    s_mul_i32 s48, s48, 5
    s_add_u32 s48, s48, s47
    s_lshl_b32 s48, s48, 10
    s_add_u32 s48, s48, s76
    s_waitcnt lgkmcnt(0)
    buffer_store_dwordx4 v[168:171], v10, s[20:23], s48 offen sc1
    s_add_u32 s47, s78, 6
    s_sub_u32 s48, s47, 10
    s_cselect_b32 s47, s47, s48
    s_lshl_b32 s47, s47, 7
    s_add_u32 s47, s47, s40
    s_add_u32 s48, s47, 40960
    s_add_u32 m0, s43, 4096
    s_nop 0
    buffer_load_dwordx4 v2, s[16:19], s48 offen  lds
    s_add_u32 s48, s47, 51200
    s_add_u32 m0, s43, 5120
    s_nop 0
    buffer_load_dwordx4 v3, s[16:19], s48 offen  lds
    s_add_u32 s48, s47, 61440
    s_add_u32 m0, s43, 6144
    s_nop 0
    buffer_load_dwordx4 v2, s[16:19], s48 offen  lds
    s_add_u32 s48, s47, 71680
    s_add_u32 m0, s43, 7168
    s_nop 0
    buffer_load_dwordx4 v3, s[16:19], s48 offen  lds
    s_waitcnt vmcnt(20)
    s_barrier
    s_add_u32 s47, s78, 7
    s_sub_u32 s48, s47, 10
    s_cselect_b32 s47, s47, s48
    s_lshl_b32 s47, s47, 7
    s_add_u32 s47, s47, s40
    s_add_u32 s48, s47, 0
    s_add_u32 m0, s43, 8192
    s_nop 0
    buffer_load_dwordx4 v2, s[16:19], s48 offen  lds
    s_add_u32 s48, s47, 10240
    s_add_u32 m0, s43, 9216
    s_nop 0
    buffer_load_dwordx4 v3, s[16:19], s48 offen  lds
    s_add_u32 s48, s47, 20480
    s_add_u32 m0, s43, 10240
    s_nop 0
    buffer_load_dwordx4 v2, s[16:19], s48 offen  lds
    s_add_u32 s48, s47, 30720
    s_add_u32 m0, s43, 11264
    s_nop 0
    buffer_load_dwordx4 v3, s[16:19], s48 offen  lds
    s_lshl_b32 s49, s78, 1
    s_add_u32 s49, s49, 13
    s_sub_u32 s48, s49, 20
    s_cselect_b32 s49, s49, s48
    s_mul_i32 s49, s49, s42
    s_add_u32 m0, s44, 129024
    s_nop 0
    buffer_load_dwordx4 v4, s[24:27], s49 offen  lds
    s_add_u32 m0, s45, 129024
    s_nop 0
    buffer_load_dwordx4 v5, s[24:27], s49 offen  lds
    s_waitcnt vmcnt(16)
    s_barrier
    s_add_u32 s47, s78, 7
    s_sub_u32 s48, s47, 10
    s_cselect_b32 s47, s47, s48
    s_lshl_b32 s47, s47, 7
    s_add_u32 s47, s47, s40
    s_add_u32 s48, s47, 40960
    s_add_u32 m0, s43, 12288
    s_nop 0
    buffer_load_dwordx4 v2, s[16:19], s48 offen  lds
    s_add_u32 s48, s47, 51200
    s_add_u32 m0, s43, 13312
    s_nop 0
    buffer_load_dwordx4 v3, s[16:19], s48 offen  lds
    s_add_u32 s48, s47, 61440
    s_add_u32 m0, s43, 14336
    s_nop 0
    buffer_load_dwordx4 v2, s[16:19], s48 offen  lds
    s_add_u32 s48, s47, 71680
    s_add_u32 m0, s43, 15360
    s_nop 0
    buffer_load_dwordx4 v3, s[16:19], s48 offen  lds
    s_lshl_b32 s49, s78, 1
    s_add_u32 s49, s49, 14
    s_sub_u32 s48, s49, 20
    s_cselect_b32 s49, s49, s48
    s_mul_i32 s49, s49, s42
    s_add_u32 m0, s44, 139264
    s_nop 0
    buffer_load_dwordx4 v4, s[24:27], s49 offen  lds
    s_add_u32 m0, s45, 139264
    s_nop 0
    buffer_load_dwordx4 v5, s[24:27], s49 offen  lds
    s_waitcnt vmcnt(12)
    s_barrier
    s_cmp_lg_u32 s41, 0
    s_cbranch_scc1 LB_cs
    s_and_b32 s67, s2, 1
    s_lshl_b32 s67, s67, 6
    s_add_u32 s67, s67, 4
    v_mov_b32 v130, s67
    v_mov_b32 v131, 1
    s_mov_b64 exec, 1
    global_atomic_add v130, v131, s[14:15]
    s_mov_b64 exec, -1
LB_cs:
    s_add_u32 s47, s78, 8
    s_sub_u32 s48, s47, 10
    s_cselect_b32 s47, s47, s48
    s_lshl_b32 s47, s47, 7
    s_add_u32 s47, s47, s40
    s_add_u32 s48, s47, 0
    s_add_u32 m0, s43, 16384
    s_nop 0
    buffer_load_dwordx4 v2, s[16:19], s48 offen  lds
    s_add_u32 s48, s47, 10240
    s_add_u32 m0, s43, 17408
    s_nop 0
    buffer_load_dwordx4 v3, s[16:19], s48 offen  lds
    s_add_u32 s48, s47, 20480
    s_add_u32 m0, s43, 18432
    s_nop 0
    buffer_load_dwordx4 v2, s[16:19], s48 offen  lds
    s_add_u32 s48, s47, 30720
    s_add_u32 m0, s43, 19456
    s_nop 0
    buffer_load_dwordx4 v3, s[16:19], s48 offen  lds
    s_lshl_b32 s49, s78, 1
    s_add_u32 s49, s49, 15
    s_sub_u32 s48, s49, 20
    s_cselect_b32 s49, s49, s48
    s_mul_i32 s49, s49, s42
    s_add_u32 m0, s44, 98304
    s_nop 0
    buffer_load_dwordx4 v4, s[24:27], s49 offen  lds
    s_add_u32 m0, s45, 98304
    s_nop 0
    buffer_load_dwordx4 v5, s[24:27], s49 offen  lds
    s_waitcnt vmcnt(12)
    s_barrier
    s_add_u32 s47, s78, 8
    s_sub_u32 s48, s47, 10
    s_cselect_b32 s47, s47, s48
    s_lshl_b32 s47, s47, 7
    s_add_u32 s47, s47, s40
    s_add_u32 s48, s47, 40960
    s_add_u32 m0, s43, 20480
    s_nop 0
    buffer_load_dwordx4 v2, s[16:19], s48 offen  lds
    s_add_u32 s48, s47, 51200
    s_add_u32 m0, s43, 21504
    s_nop 0
    buffer_load_dwordx4 v3, s[16:19], s48 offen  lds
    s_add_u32 s48, s47, 61440
    s_add_u32 m0, s43, 22528
    s_nop 0
    buffer_load_dwordx4 v2, s[16:19], s48 offen  lds
    s_add_u32 s48, s47, 71680
    s_add_u32 m0, s43, 23552
    s_nop 0
    buffer_load_dwordx4 v3, s[16:19], s48 offen  lds
    s_lshl_b32 s49, s78, 1
    s_add_u32 s49, s49, 16
    s_sub_u32 s48, s49, 20
    s_cselect_b32 s49, s49, s48
    s_mul_i32 s49, s49, s42
    s_add_u32 m0, s44, 108544
    s_nop 0
    buffer_load_dwordx4 v4, s[24:27], s49 offen  lds
    s_add_u32 m0, s45, 108544
    s_nop 0
    buffer_load_dwordx4 v5, s[24:27], s49 offen  lds
    s_waitcnt vmcnt(12)
    s_barrier
    s_add_u32 s47, s78, 9
    s_sub_u32 s48, s47, 10
    s_cselect_b32 s47, s47, s48
    s_lshl_b32 s47, s47, 7
    s_add_u32 s47, s47, s40
    s_add_u32 s48, s47, 0
    s_add_u32 m0, s43, 0
    s_nop 0
    buffer_load_dwordx4 v2, s[16:19], s48 offen  lds
    s_add_u32 s48, s47, 10240
    s_add_u32 m0, s43, 1024
    s_nop 0
    buffer_load_dwordx4 v3, s[16:19], s48 offen  lds
    s_add_u32 s48, s47, 20480
    s_add_u32 m0, s43, 2048
    s_nop 0
    buffer_load_dwordx4 v2, s[16:19], s48 offen  lds
    s_add_u32 s48, s47, 30720
    s_add_u32 m0, s43, 3072
    s_nop 0
    buffer_load_dwordx4 v3, s[16:19], s48 offen  lds
    s_lshl_b32 s49, s78, 1
    s_add_u32 s49, s49, 17
    s_sub_u32 s48, s49, 20
    s_cselect_b32 s49, s49, s48
    s_mul_i32 s49, s49, s42
    s_add_u32 m0, s44, 118784
    s_nop 0
    buffer_load_dwordx4 v4, s[24:27], s49 offen  lds
    s_add_u32 m0, s45, 118784
    s_nop 0
    buffer_load_dwordx4 v5, s[24:27], s49 offen  lds
    s_waitcnt vmcnt(12)
    s_barrier
    s_cmp_lg_u32 s41, 0
    s_cbranch_scc1 LB_pi
    v_and_b32 v20, 1, v0
    v_lshlrev_b32 v20, 6, v20
    global_load_dword v21, v20, s[14:15] offset:128 sc1
LB_pi:
    s_add_u32 s47, s78, 9
    s_sub_u32 s48, s47, 10
    s_cselect_b32 s47, s47, s48
    s_lshl_b32 s47, s47, 7
    s_add_u32 s47, s47, s40
    s_add_u32 s48, s47, 40960
    s_add_u32 m0, s43, 4096
    s_nop 0
    buffer_load_dwordx4 v2, s[16:19], s48 offen  lds
    s_add_u32 s48, s47, 51200
    s_add_u32 m0, s43, 5120
    s_nop 0
    buffer_load_dwordx4 v3, s[16:19], s48 offen  lds
    s_add_u32 s48, s47, 61440
    s_add_u32 m0, s43, 6144
    s_nop 0
    buffer_load_dwordx4 v2, s[16:19], s48 offen  lds
    s_add_u32 s48, s47, 71680
    s_add_u32 m0, s43, 7168
    s_nop 0
    buffer_load_dwordx4 v3, s[16:19], s48 offen  lds
    s_lshl_b32 s49, s78, 1
    s_add_u32 s49, s49, 18
    s_sub_u32 s48, s49, 20
    s_cselect_b32 s49, s49, s48
    s_mul_i32 s49, s49, s42
    s_add_u32 m0, s44, 129024
    s_nop 0
    buffer_load_dwordx4 v4, s[24:27], s49 offen  lds
    s_add_u32 m0, s45, 129024
    s_nop 0
    buffer_load_dwordx4 v5, s[24:27], s49 offen  lds
    s_waitcnt vmcnt(12)
    s_barrier
    s_lshl_b32 s49, s78, 1
    s_add_u32 s49, s49, 19
    s_sub_u32 s48, s49, 20
    s_cselect_b32 s49, s49, s48
    s_mul_i32 s49, s49, s42
    s_add_u32 m0, s44, 139264
    s_nop 0
    buffer_load_dwordx4 v4, s[24:27], s49 offen  lds
    s_add_u32 m0, s45, 139264
    s_nop 0
    buffer_load_dwordx4 v5, s[24:27], s49 offen  lds
    s_cmp_lg_u32 s41, 0
    s_cbranch_scc1 LB_pc
    s_waitcnt vmcnt(8)
    s_mov_b32 s68, 100000
    s_branch LBG_chk
LBG_spin:
    global_load_dword v21, v20, s[14:15] offset:128 sc1
    s_waitcnt vmcnt(0)
LBG_chk:
    v_cmp_ne_u32 vcc, 1, v21
    s_cbranch_vccz LBG_out
    s_sub_u32 s68, s68, 1
    s_cbranch_scc1 LBG_out
    s_sleep 2
    s_branch LBG_spin
LBG_out:
LB_pc:
    s_waitcnt vmcnt(8)
    s_barrier
    v_lshrrev_b32 v16, 3, v0
    v_and_b32 v17, 7, v0
    v_lshlrev_b32 v17, 3, v17
    v_lshl_add_u32 v17, v16, 7, v17
    s_lshl_b32 s48, s32, 5
    s_lshl_b32 s49, s41, 3
    s_add_u32 s48, s48, s49
    s_lshl_b32 s48, s48, 7
    s_add_u32 s48, s48, 20447232
    buffer_load_dwordx2 v[18:19], v17, s[20:23], s48 offen sc1
    v_lshlrev_b32 v16, 3, v0
    v_lshlrev_b32 v17, 2, v0
    buffer_load_dword v40, v17, s[20:23], s53 offen offset:0 sc1
    buffer_load_dword v41, v17, s[20:23], s53 offen offset:768 sc1
    buffer_load_dword v42, v17, s[20:23], s53 offen offset:1536 sc1
    buffer_load_dword v43, v17, s[20:23], s53 offen offset:2304 sc1
    buffer_load_dword v44, v17, s[20:23], s53 offen offset:3072 sc1
    s_add_u32 s53, s53, 3840
    buffer_load_dword v45, v17, s[20:23], s53 offen offset:0 sc1
    buffer_load_dword v46, v17, s[20:23], s53 offen offset:768 sc1
    buffer_load_dword v47, v17, s[20:23], s53 offen offset:1536 sc1
    buffer_load_dword v48, v17, s[20:23], s53 offen offset:2304 sc1
    buffer_load_dword v49, v17, s[20:23], s53 offen offset:3072 sc1
    s_add_u32 s53, s53, 3840
    buffer_load_dword v50, v17, s[20:23], s53 offen offset:0 sc1
    buffer_load_dword v51, v17, s[20:23], s53 offen offset:768 sc1
    buffer_load_dword v52, v17, s[20:23], s53 offen offset:1536 sc1
    buffer_load_dword v53, v17, s[20:23], s53 offen offset:2304 sc1
    buffer_load_dword v54, v17, s[20:23], s53 offen offset:3072 sc1
    s_add_u32 s53, s53, 3840
    buffer_load_dword v55, v17, s[20:23], s53 offen offset:0 sc1
    v_lshlrev_b32 v20, 4, v0
    s_add_u32 s48, s54, 0
    s_cmp_lt_u32 0, s55
    s_cselect_b32 s48, s48, 2146435072
    buffer_load_dwordx4 v[80:83], v20, s[20:23], s48 offen sc1
    s_add_u32 s48, s54, 1024
    s_cmp_lt_u32 1, s55
    s_cselect_b32 s48, s48, 2146435072
    buffer_load_dwordx4 v[84:87], v20, s[20:23], s48 offen sc1
    s_add_u32 s48, s54, 2048
    s_cmp_lt_u32 2, s55
    s_cselect_b32 s48, s48, 2146435072
    buffer_load_dwordx4 v[88:91], v20, s[20:23], s48 offen sc1
    s_add_u32 s48, s54, 3072
    s_cmp_lt_u32 3, s55
    s_cselect_b32 s48, s48, 2146435072
    buffer_load_dwordx4 v[92:95], v20, s[20:23], s48 offen sc1
    s_add_u32 s48, s54, 4096
    s_cmp_lt_u32 4, s55
    s_cselect_b32 s48, s48, 2146435072
    buffer_load_dwordx4 v[96:99], v20, s[20:23], s48 offen sc1
    s_add_u32 s48, s54, 5120
    s_cmp_lt_u32 5, s55
    s_cselect_b32 s48, s48, 2146435072
    buffer_load_dwordx4 v[100:103], v20, s[20:23], s48 offen sc1
    s_add_u32 s48, s54, 6144
    s_cmp_lt_u32 6, s55
    s_cselect_b32 s48, s48, 2146435072
    buffer_load_dwordx4 v[104:107], v20, s[20:23], s48 offen sc1
    s_add_u32 s48, s54, 7168
    s_cmp_lt_u32 7, s55
    s_cselect_b32 s48, s48, 2146435072
    buffer_load_dwordx4 v[108:111], v20, s[20:23], s48 offen sc1
    s_waitcnt vmcnt(27)
    s_barrier
    s_waitcnt vmcnt(25)
    s_barrier
    s_waitcnt vmcnt(8)
    s_lshl_b32 s48, s41, 9
    s_add_u32 s48, s48, 159744
    v_add_u32 v16, s48, v16
    ds_write_b64 v16, v[18:19]
    v_add_f32 v40, v40, v48
    v_add_f32 v41, v41, v49
    v_add_f32 v42, v42, v50
    v_add_f32 v43, v43, v51
    v_add_f32 v44, v44, v52
    v_add_f32 v45, v45, v53
    v_add_f32 v46, v46, v54
    v_add_f32 v47, v47, v55
    v_add_f32 v40, v40, v44
    v_add_f32 v41, v41, v45
    v_add_f32 v42, v42, v46
    v_add_f32 v43, v43, v47
    v_add_f32 v40, v40, v42
    v_add_f32 v41, v41, v43
    v_add_f32 v40, v40, v41
    s_mul_i32 s48, s41, 192
    s_add_u32 s48, s48, 161792
    v_add_u32 v17, s48, v17
    s_mov_b32 exec_hi, 0xffff
    ds_write_b32 v17, v40
    s_mov_b64 exec, -1
    s_waitcnt vmcnt(0)
    v_add_u32 v20, s43, v20
    ds_write_b128 v20, v[80:83] offset:8192
    ds_write_b128 v20, v[84:87] offset:9216
    ds_write_b128 v20, v[88:91] offset:10240
    ds_write_b128 v20, v[92:95] offset:11264
    ds_write_b128 v20, v[96:99] offset:12288
    ds_write_b128 v20, v[100:103] offset:13312
    ds_write_b128 v20, v[104:107] offset:14336
    ds_write_b128 v20, v[108:111] offset:15360
    v_mov_b32 v16, 162816
    v_mov_b32 v18, 0
    v_mov_b32 v19, 0
    ds_write_b64 v16, v[18:19] offset:0
    ds_write_b64 v16, v[18:19] offset:8
    ds_write_b64 v16, v[18:19] offset:16
    ds_write_b64 v16, v[18:19] offset:24
    ds_write_b64 v16, v[18:19] offset:32
    ds_write_b64 v16, v[18:19] offset:40
    ds_write_b64 v16, v[18:19] offset:48
    ds_write_b64 v16, v[18:19] offset:56
    s_waitcnt lgkmcnt(0)
    s_barrier
    s_mov_b32 s57, 2146435072
    s_cmp_eq_u32 s34, 1
    s_cbranch_scc1 P2_stream
    s_branch P2_aux
K1_spare:
    s_waitcnt lgkmcnt(0)
    s_mov_b32 s16, s4
    s_mov_b32 s17, s5
    s_mov_b32 s20, s14
    s_mov_b32 s21, s15
    s_mov_b32 s14, s12
    s_mov_b32 s15, s13
    s_load_dwordx2 s[60:61], s[0:1], 16
    s_load_dwordx2 s[62:63], s[0:1], 24
    s_load_dwordx2 s[64:65], s[0:1], 56
    s_lshl_b32 s58, s32, 1
    s_add_u32 s58, s58, s30
    s_sub_u32 s58, s58, 2
    s_lshl_b32 s66, s32, 8
    s_lshl_b32 s67, s28, 3
    s_add_u32 s66, s66, s67
    s_and_b32 s59, s3, 3
    s_lshl_b32 s67, s59, 1
    s_add_u32 s66, s66, s67
    s_getpc_b64 s[70:71]
K1_warm:
    s_add_u32 s70, s70, K1_start-K1_warm
    s_addc_u32 s71, s71, -1
    s_lshl_b32 s72, s3, 13
    v_lshlrev_b32 v100, 7, v0
    v_add_u32 v100, s72, v100
    v_min_u32 v100, K1_end-K1_start, v100
    global_load_dword v101, v100, s[70:71]
    v_add_u32 v100, 65536, v100
    v_min_u32 v100, K1_end-K1_start, v100
    global_load_dword v101, v100, s[70:71]
    v_bfe_u32 v60, v0, 4, 1
    v_mul_u32_u24 v60, 1280, v60
    v_and_b32_e64 v61, 15, v0
    v_lshl_add_u32 v60, v61, 4, v60
    s_mul_i32 s69, s66, 1280
    buffer_load_dwordx4 v[40:43], v60, s[16:19], s69 offen offset:0
    buffer_load_dwordx4 v[44:47], v60, s[16:19], s69 offen offset:256
    buffer_load_dwordx4 v[48:51], v60, s[16:19], s69 offen offset:512
    buffer_load_dwordx4 v[52:55], v60, s[16:19], s69 offen offset:768
    buffer_load_dwordx4 v[56:59], v60, s[16:19], s69 offen offset:1024
    s_waitcnt lgkmcnt(0)
    s_mov_b32 s24, s60
    s_mov_b32 s25, s61
    s_mov_b32 s26, 25600
    s_mov_b32 s27, 0x20000
    s_lshl_b32 s60, s58, 3
    s_add_u32 s60, s60, s3
    s_min_u32 s30, s60, 119
    s_mov_b32 s61, s30
    s_mul_i32 s31, s30, 4370
    s_lshr_b32 s31, s31, 16
    s_mul_i32 s32, s31, 15
    s_sub_u32 s32, s30, s32
    s_mul_i32 s33, s32, 86
    s_lshr_b32 s33, s33, 8
    s_mul_i32 s34, s33, 3
    s_sub_u32 s35, s32, s34
    s_lshl_b32 s33, s33, 2
    s_mul_i32 s39, s31, 1600
    s_add_u32 s39, s39, s33
    v_bfe_u32 v4, v0, 2, 2
    v_and_b32_e64 v5, 3, v0
    v_mul_u32_u24 v6, 400, v4
    v_add_u32 v6, v6, v5
    v_add_u32 v6, s39, v6
    v_lshrrev_b32 v7, 4, v0
    v_lshlrev_b32 v7, 2, v7
    s_lshl_b32 s35, s35, 5
    v_add_u32 v7, s35, v7
    v_mov_b32 v11, 0x7ffffff0
    v_add_u32_e64 v8, 0, v7
    v_mul_u32_u24 v9, 205, v8
    v_lshrrev_b32 v9, 12, v9
    v_mul_u32_u24 v10, 20, v9
    v_sub_u32 v10, v8, v10
    v_mul_u32_u24 v10, 20, v10
    v_add_u32 v10, v10, v6
    v_lshlrev_b32 v10, 1, v10
    v_cmp_eq_u32 vcc, v9, v4
    s_nop 1
    v_cndmask_b32 v10, v11, v10, vcc
    buffer_load_ushort v16, v10, s[24:27], 0 offen
    v_add_u32 v8, 1, v7
    v_mul_u32_u24 v9, 205, v8
    v_lshrrev_b32 v9, 12, v9
    v_mul_u32_u24 v10, 20, v9
    v_sub_u32 v10, v8, v10
    v_mul_u32_u24 v10, 20, v10
    v_add_u32 v10, v10, v6
    v_lshlrev_b32 v10, 1, v10
    v_cmp_eq_u32 vcc, v9, v4
    s_nop 1
    v_cndmask_b32 v10, v11, v10, vcc
    buffer_load_ushort v17, v10, s[24:27], 0 offen
    v_add_u32 v8, 2, v7
    v_mul_u32_u24 v9, 205, v8
    v_lshrrev_b32 v9, 12, v9
    v_mul_u32_u24 v10, 20, v9
    v_sub_u32 v10, v8, v10
    v_mul_u32_u24 v10, 20, v10
    v_add_u32 v10, v10, v6
    v_lshlrev_b32 v10, 1, v10
    v_cmp_eq_u32 vcc, v9, v4
    s_nop 1
    v_cndmask_b32 v10, v11, v10, vcc
    buffer_load_ushort v18, v10, s[24:27], 0 offen
    v_add_u32 v8, 3, v7
    v_mul_u32_u24 v9, 205, v8
    v_lshrrev_b32 v9, 12, v9
    v_mul_u32_u24 v10, 20, v9
    v_sub_u32 v10, v8, v10
    v_mul_u32_u24 v10, 20, v10
    v_add_u32 v10, v10, v6
    v_lshlrev_b32 v10, 1, v10
    v_cmp_eq_u32 vcc, v9, v4
    s_nop 1
    v_cndmask_b32 v10, v11, v10, vcc
    buffer_load_ushort v19, v10, s[24:27], 0 offen
    v_add_u32 v8, 16, v7
    v_mul_u32_u24 v9, 205, v8
    v_lshrrev_b32 v9, 12, v9
    v_mul_u32_u24 v10, 20, v9
    v_sub_u32 v10, v8, v10
    v_mul_u32_u24 v10, 20, v10
    v_add_u32 v10, v10, v6
    v_lshlrev_b32 v10, 1, v10
    v_cmp_eq_u32 vcc, v9, v4
    s_nop 1
    v_cndmask_b32 v10, v11, v10, vcc
    buffer_load_ushort v20, v10, s[24:27], 0 offen
    v_add_u32 v8, 17, v7
    v_mul_u32_u24 v9, 205, v8
    v_lshrrev_b32 v9, 12, v9
    v_mul_u32_u24 v10, 20, v9
    v_sub_u32 v10, v8, v10
    v_mul_u32_u24 v10, 20, v10
    v_add_u32 v10, v10, v6
    v_lshlrev_b32 v10, 1, v10
    v_cmp_eq_u32 vcc, v9, v4
    s_nop 1
    v_cndmask_b32 v10, v11, v10, vcc
    buffer_load_ushort v21, v10, s[24:27], 0 offen
    v_add_u32 v8, 18, v7
    v_mul_u32_u24 v9, 205, v8
    v_lshrrev_b32 v9, 12, v9
    v_mul_u32_u24 v10, 20, v9
    v_sub_u32 v10, v8, v10
    v_mul_u32_u24 v10, 20, v10
    v_add_u32 v10, v10, v6
    v_lshlrev_b32 v10, 1, v10
    v_cmp_eq_u32 vcc, v9, v4
    s_nop 1
    v_cndmask_b32 v10, v11, v10, vcc
    buffer_load_ushort v22, v10, s[24:27], 0 offen
    v_add_u32 v8, 19, v7
    v_mul_u32_u24 v9, 205, v8
    v_lshrrev_b32 v9, 12, v9
    v_mul_u32_u24 v10, 20, v9
    v_sub_u32 v10, v8, v10
    v_mul_u32_u24 v10, 20, v10
    v_add_u32 v10, v10, v6
    v_lshlrev_b32 v10, 1, v10
    v_cmp_eq_u32 vcc, v9, v4
    s_nop 1
    v_cndmask_b32 v10, v11, v10, vcc
    buffer_load_ushort v23, v10, s[24:27], 0 offen
    v_mov_b32 v28, 0
    v_mov_b32 v29, 0
    v_mov_b32 v30, 0
    v_mov_b32 v31, 0
    v_lshlrev_b32 v3, 4, v0
    s_lshl_b32 s30, s60, 10
    s_add_u32 s30, s30, 20045824
    s_cmp_lt_u32 s60, 18
    s_cselect_b32 s30, s30, 2146435072
    buffer_store_dwordx4 v[28:31], v3, s[20:23], s30 offen sc1
    v_mov_b32 v32, 162816
    ds_write_b128 v32, v[28:31]
    ds_write_b128 v32, v[28:31] offset:16
    ds_write_b128 v32, v[28:31] offset:32
    ds_write_b128 v32, v[28:31] offset:48
    s_waitcnt vmcnt(1)
    v_lshl_or_b32 v24, v17, 16, v16
    v_lshl_or_b32 v25, v19, 16, v18
    v_lshl_or_b32 v26, v21, 16, v20
    v_lshl_or_b32 v27, v23, 16, v22
    s_lshl_b32 s30, s61, 10
    s_add_u32 s30, s30, 20185088
    buffer_store_dwordx4 v[24:27], v3, s[20:23], s30 offen sc1
    v_mov_b32 v64, 0x3f803f80
    v_dot2_f32_bf16 v60, v40, v64, 0
    v_dot2_f32_bf16 v61, v40, v40, 0
    v_dot2_f32_bf16 v65, v41, v64, 0
    v_dot2_f32_bf16 v66, v41, v41, 0
    v_dot2_f32_bf16 v60, v42, v64, v60
    v_dot2_f32_bf16 v61, v42, v42, v61
    v_dot2_f32_bf16 v65, v43, v64, v65
    v_dot2_f32_bf16 v66, v43, v43, v66
    v_dot2_f32_bf16 v60, v44, v64, v60
    v_dot2_f32_bf16 v61, v44, v44, v61
    v_dot2_f32_bf16 v65, v45, v64, v65
    v_dot2_f32_bf16 v66, v45, v45, v66
    v_dot2_f32_bf16 v60, v46, v64, v60
    v_dot2_f32_bf16 v61, v46, v46, v61
    v_dot2_f32_bf16 v65, v47, v64, v65
    v_dot2_f32_bf16 v66, v47, v47, v66
    v_dot2_f32_bf16 v60, v48, v64, v60
    v_dot2_f32_bf16 v61, v48, v48, v61
    v_dot2_f32_bf16 v65, v49, v64, v65
    v_dot2_f32_bf16 v66, v49, v49, v66
    v_dot2_f32_bf16 v60, v50, v64, v60
    v_dot2_f32_bf16 v61, v50, v50, v61
    v_dot2_f32_bf16 v65, v51, v64, v65
    v_dot2_f32_bf16 v66, v51, v51, v66
    v_dot2_f32_bf16 v60, v52, v64, v60
    v_dot2_f32_bf16 v61, v52, v52, v61
    v_dot2_f32_bf16 v65, v53, v64, v65
    v_dot2_f32_bf16 v66, v53, v53, v66
    v_dot2_f32_bf16 v60, v54, v64, v60
    v_dot2_f32_bf16 v61, v54, v54, v61
    v_dot2_f32_bf16 v65, v55, v64, v65
    v_dot2_f32_bf16 v66, v55, v55, v66
    v_dot2_f32_bf16 v60, v56, v64, v60
    v_dot2_f32_bf16 v61, v56, v56, v61
    v_dot2_f32_bf16 v65, v57, v64, v65
    v_dot2_f32_bf16 v66, v57, v57, v66
    v_dot2_f32_bf16 v60, v58, v64, v60
    v_dot2_f32_bf16 v61, v58, v58, v61
    v_dot2_f32_bf16 v65, v59, v64, v65
    v_dot2_f32_bf16 v66, v59, v59, v66
    s_nop 2
    v_add_f32 v60, v60, v65
    v_add_f32 v61, v61, v66
    s_nop 0
    v_add_f32_dpp v60, v60, v60 row_ror:8 row_mask:0xf bank_mask:0xf
    v_add_f32_dpp v61, v61, v61 row_ror:8 row_mask:0xf bank_mask:0xf
    s_nop 0
    v_add_f32_dpp v60, v60, v60 row_ror:4 row_mask:0xf bank_mask:0xf
    v_add_f32_dpp v61, v61, v61 row_ror:4 row_mask:0xf bank_mask:0xf
    s_nop 0
    v_add_f32_dpp v60, v60, v60 row_ror:2 row_mask:0xf bank_mask:0xf
    v_add_f32_dpp v61, v61, v61 row_ror:2 row_mask:0xf bank_mask:0xf
    s_nop 0
    s_nop 0
    v_add_f32_dpp v60, v60, v60 row_ror:1 row_mask:0xf bank_mask:0xf
    v_add_f32_dpp v61, v61, v61 row_ror:1 row_mask:0xf bank_mask:0xf
    v_mul_f32 v60, 0x3acccccd, v60
    v_mul_f32 v61, 0x3acccccd, v61
    v_fma_f32 v61, -v60, v60, v61
    v_max_f32_e64 v61, 0, v61
    v_cvt_pk_bf16_f32 v60, v60, v60
    v_lshlrev_b32_e64 v60, 16, v60
    v_cvt_pk_bf16_f32 v61, v61, v61
    v_lshlrev_b32_e64 v61, 16, v61
    v_add_f32 v61, 0x3727c5ac, v61
    v_cvt_pk_bf16_f32 v61, v61, v61
    v_lshlrev_b32 v61, 16, v61
    v_sqrt_f32_e64 v61, v61
    s_nop 0
    v_cvt_pk_bf16_f32 v61, v61, v61
    v_lshlrev_b32 v61, 16, v61
    v_rcp_f32 v61, v61
    v_bfe_u32 v40, v0, 4, 1
    v_lshlrev_b32 v40, 3, v40
    s_lshl_b32 s67, s59, 4
    s_add_u32 s67, s67, 159744
    v_add_u32 v40, s67, v40
    ds_write_b64 v40, v[60:61]
    s_waitcnt lgkmcnt(0)
    s_barrier
    v_add_u32 v32, 159744, v3
    ds_read_b128 v[36:39], v32
    s_lshr_b32 s30, s66, 3
    s_lshl_b32 s30, s30, 7
    s_add_u32 s30, s30, 20447232
    s_mov_b64 exec, 0xff
    s_waitcnt lgkmcnt(0)
    buffer_store_dwordx4 v[36:39], v3, s[20:23], s30 offen sc1
    s_mov_b64 exec, -1
    s_waitcnt vmcnt(0)
    s_barrier
    s_cmp_lg_u32 s3, 0
    s_cbranch_scc1 SP_f
    s_and_b32 s67, s2, 1
    s_lshl_b32 s67, s67, 6
    s_add_u32 s67, s67, 0
    v_mov_b32 v32, s67
    v_mov_b32 v33, 1
    s_mov_b64 exec, 1
    global_atomic_add v32, v33, s[14:15]
    s_mov_b64 exec, -1
    s_cmp_eq_u32 s58, 0
    s_cbranch_scc1 SP_watch
SP_f:
    s_sleep 10
    s_sub_u32 s59, s60, 1
    s_mov_b32 s4, s62
    s_mov_b32 s5, s63
    s_mov_b32 s6, 819200
    s_mov_b32 s7, 0x20000
    s_mov_b32 s8, s64
    s_mov_b32 s9, s65
    s_mov_b32 s10, 2211840
    s_mov_b32 s11, 0x20000
    v_lshlrev_b32 v102, 7, v0
    s_lshl_b32 s30, s59, 13
    buffer_load_dword v103, v102, s[8:11], s30 offen
    s_add_u32 s30, s30, 1040384
    buffer_load_dword v103, v102, s[8:11], s30 offen
    s_add_u32 s30, s30, 1040384
    buffer_load_dword v103, v102, s[8:11], s30 offen
    s_add_u32 s30, s30, 1040384
    s_lshl_b32 s30, s59, 13
    buffer_load_dword v103, v102, s[4:7], s30 offen
    s_cmp_eq_u32 s58, 0
    s_cbranch_scc1 SP_w
    s_cmp_lg_u32 s3, 0
    s_cbranch_scc1 SP_w
    s_branch SP_fol
SP_watch:
    v_and_b32 v32, 1, v0
    v_lshlrev_b32 v32, 6, v32
    v_and_b32_e64 v33, 2, v0
    v_lshl_add_u32 v32, v33, 1, v32
    v_mov_b32_e64 v34, 1
    v_mov_b32 v35, 0x80
    s_mov_b32 s30, 120
    v_writelane_b32 v35, s30, 2
    v_writelane_b32 v35, s30, 3
    s_mov_b64 s[70:71], 15
    s_mov_b32 s68, 100000
SW_spin:
    s_mov_b64 exec, s[70:71]
    global_load_dword v33, v32, s[14:15] sc1
    s_waitcnt vmcnt(0)
    v_cmp_eq_u32 vcc, v35, v33
    s_nop 0
    s_andn2_b64 s[70:71], s[70:71], vcc
    s_and_b64 exec, exec, vcc
    s_cbranch_execz SW_none
    global_store_dword v32, v34, s[14:15] offset:128 sc1
SW_none:
    s_cmp_eq_u64 s[70:71], 0
    s_cbranch_scc1 SW_out
    s_sub_u32 s68, s68, 1
    s_cbranch_scc1 SW_out
    s_sleep 6
    s_branch SW_spin
SW_out:
    s_mov_b64 exec, -1
    s_branch SP_w
SP_fol:
    v_and_b32 v32, 1, v0
    v_lshlrev_b32 v32, 6, v32
    v_and_b32_e64 v33, 2, v0
    v_lshl_add_u32 v32, v33, 1, v32
    s_mov_b32 s68, 100000
SPG_spin:
    global_load_dword v33, v32, s[14:15] offset:128 sc1
    s_waitcnt vmcnt(0)
SPG_chk:
    v_cmp_ne_u32 vcc, 1, v33
    s_cbranch_vccz SPG_out
    s_sub_u32 s68, s68, 1
    s_cbranch_scc1 SPG_out
    s_sleep 8
    s_branch SPG_spin
SPG_out:
SP_w:
    s_barrier
    s_mov_b32 s34, 0
    s_mov_b32 s57, 2146435076
    s_cmp_lt_u32 s3, 4
    s_cbranch_scc1 P2_stream
    s_branch P2_aux
K1_compute:
    s_lshl_b32 s35, s30, 1
    s_add_u32 s35, s35, s31
    s_add_u32 s29, s35, 18
    s_add_u32 s36, s30, 26
    s_cmp_eq_u32 s31, 2
    s_cselect_b32 s34, 2, 1
    s_cselect_b32 s35, s30, s35
    s_cselect_b32 s29, s36, s29
    s_mul_i32 s36, s30, 5
    s_lshl_b32 s37, s30, 2
    s_add_u32 s37, s37, 2
    s_min_u32 s36, s36, s37
    s_add_u32 s36, s36, s31
    s_sub_u32 s36, s36, 3
    s_cmp_ge_u32 s31, 3
    s_cselect_b32 s34, 0, s34
    s_cselect_b32 s35, s36, s35
    s_cselect_b32 s29, s36, s29
    s_waitcnt lgkmcnt(0)
    s_mov_b32 s16, s4
    s_mov_b32 s17, s5
    s_mov_b32 s20, s14
    s_mov_b32 s21, s15
    s_mov_b32 s14, s12
    s_mov_b32 s15, s13
    s_mov_b32 s79, 0
    s_setprio 2
    v_mov_b32 v248, v0
    v_and_b32 v1, 15, v0
    v_lshrrev_b32 v2, 4, v0
    v_lshrrev_b32 v3, 1, v1
    s_mul_i32 s36, s3, 24576
    v_lshlrev_b32 v4, 7, v1
    v_add_u32 v4, s36, v4
    v_xor_b32 v5, v2, v3
    v_lshl_add_u32 v244, v5, 4, v4
    v_xor_b32 v245, 64, v244
    s_cmp_eq_u32 s34, 0
    s_mov_b32 s36, 320
    s_cselect_b32 s36, 192, s36
    v_lshlrev_b32_e64 v4, 3, v2
    v_bfe_u32 v5, v0, 2, 2
    v_add_u32_e64 v4, v4, v5
    v_mul_lo_u32 v4, v4, s36
    v_and_b32_e64 v5, 3, v0
    v_lshl_add_u32 v4, v5, 3, v4
    v_add_u32 v4, 98304, v4
    v_and_b32 v5, 1, v2
    v_lshlrev_b32 v5, 5, v5
    v_add_u32 v246, v4, v5
    v_sub_u32 v247, v4, v5
    s_lshl_b32 s37, s32, 2
    s_add_u32 s37, s37, s3
    s_lshl_b32 s52, s29, 4
    s_lshl_b32 s53, s32, 1
    s_add_u32 s52, s52, s53
    s_and_b32 s53, s3, 1
    s_add_u32 s52, s52, s53
    s_mul_i32 s52, s52, 768
    s_lshr_b32 s53, s3, 1
    s_mov_b32 s54, 384
    s_mul_i32 s53, s53, s54
    s_add_u32 s52, s52, s53
    s_add_u32 s52, s52, 20512768
    s_lshl_b32 s53, s32, 5
    s_add_u32 s53, s53, s28
    s_lshl_b32 s53, s53, 7
    s_add_u32 s53, s53, 20447232
    s_cmp_lg_u32 s3, 0
    s_cselect_b32 s53, 2146435072, s53
    v_lshlrev_b32 v250, 4, v0
    s_mul_i32 s55, s3, 384
    s_add_u32 s55, s55, 159872
    v_add_u32 v249, s55, v250
    v_mov_b32 v6, 0x7ffffff0
    v_cmp_gt_u32 vcc, s54, v250
    s_nop 1
    v_cndmask_b32 v250, v6, v250, vcc
    s_cmp_eq_u32 s34, 0
    s_cbranch_scc0 K1_c_qkv
    s_mul_i32 s50, s37, 74
    s_mul_i32 s51, s35, 3
    s_add_u32 s50, s50, s51
    s_lshl_b32 s50, s50, 12
    s_add_u32 s50, s50, 3145728
    s_barrier
    ds_read_b128 v[192:195], v244 offset:0
    ds_read_b64_tr_b16 v[224:225], v246 offset:0
    ds_read_b64_tr_b16 v[226:227], v246 offset:768
    ds_read_b128 v[196:199], v244 offset:2048
    ds_read_b128 v[200:203], v244 offset:4096
    ds_read_b128 v[204:207], v244 offset:6144
    ds_read_b64_tr_b16 v[228:229], v247 offset:32
    ds_read_b64_tr_b16 v[230:231], v247 offset:800
    ds_read_b64_tr_b16 v[232:233], v246 offset:64
    ds_read_b64_tr_b16 v[234:235], v246 offset:832
    ds_read_b64_tr_b16 v[236:237], v247 offset:96
    ds_read_b64_tr_b16 v[238:239], v247 offset:864
    s_waitcnt lgkmcnt(9)
    v_mfma_f32_16x16x32_bf16 v[0:3], v[224:227], v[192:195], 0
    ds_read_b64_tr_b16 v[240:241], v246 offset:128
    s_waitcnt lgkmcnt(9)
    v_mfma_f32_16x16x32_bf16 v[48:51], v[224:227], v[196:199], 0
    ds_read_b64_tr_b16 v[242:243], v246 offset:896
    s_waitcnt lgkmcnt(9)
    v_mfma_f32_16x16x32_bf16 v[96:99], v[224:227], v[200:203], 0
    s_waitcnt lgkmcnt(8)
    v_mfma_f32_16x16x32_bf16 v[144:147], v[224:227], v[204:207], 0
    s_waitcnt lgkmcnt(6)
    v_mfma_f32_16x16x32_bf16 v[4:7], v[228:231], v[192:195], 0
    ds_read_b64_tr_b16 v[224:225], v247 offset:160
    v_mfma_f32_16x16x32_bf16 v[52:55], v[228:231], v[196:199], 0
    ds_read_b64_tr_b16 v[226:227], v247 offset:928
    v_mfma_f32_16x16x32_bf16 v[100:103], v[228:231], v[200:203], 0
    v_mfma_f32_16x16x32_bf16 v[148:151], v[228:231], v[204:207], 0
    s_waitcnt lgkmcnt(6)
    v_mfma_f32_16x16x32_bf16 v[8:11], v[232:235], v[192:195], 0
    ds_read_b64_tr_b16 v[228:229], v246 offset:6144
    v_mfma_f32_16x16x32_bf16 v[56:59], v[232:235], v[196:199], 0
    ds_read_b64_tr_b16 v[230:231], v246 offset:6912
    v_mfma_f32_16x16x32_bf16 v[104:107], v[232:235], v[200:203], 0
    v_mfma_f32_16x16x32_bf16 v[152:155], v[232:235], v[204:207], 0
    s_waitcnt lgkmcnt(6)
    v_mfma_f32_16x16x32_bf16 v[12:15], v[236:239], v[192:195], 0
    ds_read_b64_tr_b16 v[232:233], v247 offset:6176
    v_mfma_f32_16x16x32_bf16 v[60:63], v[236:239], v[196:199], 0
    ds_read_b64_tr_b16 v[234:235], v247 offset:6944
    v_mfma_f32_16x16x32_bf16 v[108:111], v[236:239], v[200:203], 0
    v_mfma_f32_16x16x32_bf16 v[156:159], v[236:239], v[204:207], 0
    s_waitcnt lgkmcnt(6)
    v_mfma_f32_16x16x32_bf16 v[16:19], v[240:243], v[192:195], 0
    ds_read_b64_tr_b16 v[236:237], v246 offset:6208
    v_mfma_f32_16x16x32_bf16 v[64:67], v[240:243], v[196:199], 0
    ds_read_b64_tr_b16 v[238:239], v246 offset:6976
    v_mfma_f32_16x16x32_bf16 v[112:115], v[240:243], v[200:203], 0
    v_mfma_f32_16x16x32_bf16 v[160:163], v[240:243], v[204:207], 0
    s_waitcnt lgkmcnt(6)
    v_mfma_f32_16x16x32_bf16 v[20:23], v[224:227], v[192:195], 0
    ds_read_b64_tr_b16 v[240:241], v247 offset:6240
    v_mfma_f32_16x16x32_bf16 v[68:71], v[224:227], v[196:199], 0
    ds_read_b64_tr_b16 v[242:243], v247 offset:7008
    v_mfma_f32_16x16x32_bf16 v[116:119], v[224:227], v[200:203], 0
    v_mfma_f32_16x16x32_bf16 v[164:167], v[224:227], v[204:207], 0
    s_waitcnt lgkmcnt(6)
    v_mfma_f32_16x16x32_bf16 v[24:27], v[228:231], v[192:195], 0
    ds_read_b64_tr_b16 v[224:225], v246 offset:6272
    v_mfma_f32_16x16x32_bf16 v[72:75], v[228:231], v[196:199], 0
    ds_read_b64_tr_b16 v[226:227], v246 offset:7040
    v_mfma_f32_16x16x32_bf16 v[120:123], v[228:231], v[200:203], 0
    v_mfma_f32_16x16x32_bf16 v[168:171], v[228:231], v[204:207], 0
    s_waitcnt lgkmcnt(6)
    v_mfma_f32_16x16x32_bf16 v[28:31], v[232:235], v[192:195], 0
    ds_read_b64_tr_b16 v[228:229], v247 offset:6304
    v_mfma_f32_16x16x32_bf16 v[76:79], v[232:235], v[196:199], 0
    ds_read_b64_tr_b16 v[230:231], v247 offset:7072
    v_mfma_f32_16x16x32_bf16 v[124:127], v[232:235], v[200:203], 0
    v_mfma_f32_16x16x32_bf16 v[172:175], v[232:235], v[204:207], 0
    s_waitcnt lgkmcnt(6)
    v_mfma_f32_16x16x32_bf16 v[32:35], v[236:239], v[192:195], 0
    s_barrier
    ds_read_b64_tr_b16 v[232:233], v246 offset:12288
    v_mfma_f32_16x16x32_bf16 v[80:83], v[236:239], v[196:199], 0
    ds_read_b64_tr_b16 v[234:235], v246 offset:13056
    v_mfma_f32_16x16x32_bf16 v[128:131], v[236:239], v[200:203], 0
    ds_read_b128 v[208:211], v245 offset:0
    v_mfma_f32_16x16x32_bf16 v[176:179], v[236:239], v[204:207], 0
    s_waitcnt lgkmcnt(7)
    v_mfma_f32_16x16x32_bf16 v[36:39], v[240:243], v[192:195], 0
    ds_read_b64_tr_b16 v[236:237], v247 offset:12320
    v_mfma_f32_16x16x32_bf16 v[84:87], v[240:243], v[196:199], 0
    ds_read_b64_tr_b16 v[238:239], v247 offset:13088
    v_mfma_f32_16x16x32_bf16 v[132:135], v[240:243], v[200:203], 0
    ds_read_b128 v[212:215], v245 offset:2048
    v_mfma_f32_16x16x32_bf16 v[180:183], v[240:243], v[204:207], 0
    s_waitcnt lgkmcnt(8)
    v_mfma_f32_16x16x32_bf16 v[40:43], v[224:227], v[192:195], 0
    ds_read_b64_tr_b16 v[240:241], v246 offset:12352
    v_mfma_f32_16x16x32_bf16 v[88:91], v[224:227], v[196:199], 0
    ds_read_b64_tr_b16 v[242:243], v246 offset:13120
    v_mfma_f32_16x16x32_bf16 v[136:139], v[224:227], v[200:203], 0
    ds_read_b128 v[216:219], v245 offset:4096
    v_mfma_f32_16x16x32_bf16 v[184:187], v[224:227], v[204:207], 0
    s_waitcnt lgkmcnt(9)
    v_mfma_f32_16x16x32_bf16 v[44:47], v[228:231], v[192:195], 0
    ds_read_b64_tr_b16 v[224:225], v247 offset:12384
    v_mfma_f32_16x16x32_bf16 v[92:95], v[228:231], v[196:199], 0
    ds_read_b64_tr_b16 v[226:227], v247 offset:13152
    v_mfma_f32_16x16x32_bf16 v[140:143], v[228:231], v[200:203], 0
    ds_read_b128 v[220:223], v245 offset:6144
    v_mfma_f32_16x16x32_bf16 v[188:191], v[228:231], v[204:207], 0
    s_waitcnt lgkmcnt(9)
    v_mfma_f32_16x16x32_bf16 v[0:3], v[232:235], v[208:211], v[0:3]
    ds_read_b64_tr_b16 v[228:229], v246 offset:12416
    s_waitcnt lgkmcnt(7)
    v_mfma_f32_16x16x32_bf16 v[48:51], v[232:235], v[212:215], v[48:51]
    ds_read_b64_tr_b16 v[230:231], v246 offset:13184
    s_waitcnt lgkmcnt(5)
    v_mfma_f32_16x16x32_bf16 v[96:99], v[232:235], v[216:219], v[96:99]
    s_waitcnt lgkmcnt(2)
    v_mfma_f32_16x16x32_bf16 v[144:147], v[232:235], v[220:223], v[144:147]
    v_mfma_f32_16x16x32_bf16 v[4:7], v[236:239], v[208:211], v[4:7]
    ds_read_b64_tr_b16 v[232:233], v247 offset:12448
    v_mfma_f32_16x16x32_bf16 v[52:55], v[236:239], v[212:215], v[52:55]
    ds_read_b64_tr_b16 v[234:235], v247 offset:13216
    v_mfma_f32_16x16x32_bf16 v[100:103], v[236:239], v[216:219], v[100:103]
    v_mfma_f32_16x16x32_bf16 v[148:151], v[236:239], v[220:223], v[148:151]
    v_mfma_f32_16x16x32_bf16 v[8:11], v[240:243], v[208:211], v[8:11]
    ds_read_b64_tr_b16 v[236:237], v246 offset:18432
    v_mfma_f32_16x16x32_bf16 v[56:59], v[240:243], v[212:215], v[56:59]
    ds_read_b64_tr_b16 v[238:239], v246 offset:19200
    v_mfma_f32_16x16x32_bf16 v[104:107], v[240:243], v[216:219], v[104:107]
    v_mfma_f32_16x16x32_bf16 v[152:155], v[240:243], v[220:223], v[152:155]
    v_mfma_f32_16x16x32_bf16 v[12:15], v[224:227], v[208:211], v[12:15]
    ds_read_b64_tr_b16 v[240:241], v247 offset:18464
    v_mfma_f32_16x16x32_bf16 v[60:63], v[224:227], v[212:215], v[60:63]
    ds_read_b64_tr_b16 v[242:243], v247 offset:19232
    v_mfma_f32_16x16x32_bf16 v[108:111], v[224:227], v[216:219], v[108:111]
    v_mfma_f32_16x16x32_bf16 v[156:159], v[224:227], v[220:223], v[156:159]
    s_waitcnt lgkmcnt(6)
    v_mfma_f32_16x16x32_bf16 v[16:19], v[228:231], v[208:211], v[16:19]
    ds_read_b64_tr_b16 v[224:225], v246 offset:18496
    v_mfma_f32_16x16x32_bf16 v[64:67], v[228:231], v[212:215], v[64:67]
    ds_read_b64_tr_b16 v[226:227], v246 offset:19264
    v_mfma_f32_16x16x32_bf16 v[112:115], v[228:231], v[216:219], v[112:115]
    v_mfma_f32_16x16x32_bf16 v[160:163], v[228:231], v[220:223], v[160:163]
    s_waitcnt lgkmcnt(6)
    v_mfma_f32_16x16x32_bf16 v[20:23], v[232:235], v[208:211], v[20:23]
    ds_read_b64_tr_b16 v[228:229], v247 offset:18528
    v_mfma_f32_16x16x32_bf16 v[68:71], v[232:235], v[212:215], v[68:71]
    ds_read_b64_tr_b16 v[230:231], v247 offset:19296
    v_mfma_f32_16x16x32_bf16 v[116:119], v[232:235], v[216:219], v[116:119]
    v_mfma_f32_16x16x32_bf16 v[164:167], v[232:235], v[220:223], v[164:167]
    s_waitcnt lgkmcnt(6)
    v_mfma_f32_16x16x32_bf16 v[24:27], v[236:239], v[208:211], v[24:27]
    ds_read_b64_tr_b16 v[232:233], v246 offset:18560
    v_mfma_f32_16x16x32_bf16 v[72:75], v[236:239], v[212:215], v[72:75]
    ds_read_b64_tr_b16 v[234:235], v246 offset:19328
    v_mfma_f32_16x16x32_bf16 v[120:123], v[236:239], v[216:219], v[120:123]
    v_mfma_f32_16x16x32_bf16 v[168:171], v[236:239], v[220:223], v[168:171]
    s_waitcnt lgkmcnt(6)
    v_mfma_f32_16x16x32_bf16 v[28:31], v[240:243], v[208:211], v[28:31]
    ds_read_b64_tr_b16 v[236:237], v247 offset:18592
    v_mfma_f32_16x16x32_bf16 v[76:79], v[240:243], v[212:215], v[76:79]
    ds_read_b64_tr_b16 v[238:239], v247 offset:19360
    v_mfma_f32_16x16x32_bf16 v[124:127], v[240:243], v[216:219], v[124:127]
    v_mfma_f32_16x16x32_bf16 v[172:175], v[240:243], v[220:223], v[172:175]
    s_waitcnt lgkmcnt(6)
    v_mfma_f32_16x16x32_bf16 v[32:35], v[224:227], v[208:211], v[32:35]
    s_barrier
    ds_read_b64_tr_b16 v[240:241], v246 offset:24576
    v_mfma_f32_16x16x32_bf16 v[80:83], v[224:227], v[212:215], v[80:83]
    ds_read_b64_tr_b16 v[242:243], v246 offset:25344
    v_mfma_f32_16x16x32_bf16 v[128:131], v[224:227], v[216:219], v[128:131]
    ds_read_b128 v[192:195], v244 offset:8192
    v_mfma_f32_16x16x32_bf16 v[176:179], v[224:227], v[220:223], v[176:179]
    s_waitcnt lgkmcnt(7)
    v_mfma_f32_16x16x32_bf16 v[36:39], v[228:231], v[208:211], v[36:39]
    ds_read_b64_tr_b16 v[224:225], v247 offset:24608
    v_mfma_f32_16x16x32_bf16 v[84:87], v[228:231], v[212:215], v[84:87]
    ds_read_b64_tr_b16 v[226:227], v247 offset:25376
    v_mfma_f32_16x16x32_bf16 v[132:135], v[228:231], v[216:219], v[132:135]
    ds_read_b128 v[196:199], v244 offset:10240
    v_mfma_f32_16x16x32_bf16 v[180:183], v[228:231], v[220:223], v[180:183]
    s_waitcnt lgkmcnt(8)
    v_mfma_f32_16x16x32_bf16 v[40:43], v[232:235], v[208:211], v[40:43]
    ds_read_b64_tr_b16 v[228:229], v246 offset:24640
    v_mfma_f32_16x16x32_bf16 v[88:91], v[232:235], v[212:215], v[88:91]
    ds_read_b64_tr_b16 v[230:231], v246 offset:25408
    v_mfma_f32_16x16x32_bf16 v[136:139], v[232:235], v[216:219], v[136:139]
    ds_read_b128 v[200:203], v244 offset:12288
    v_mfma_f32_16x16x32_bf16 v[184:187], v[232:235], v[220:223], v[184:187]
    s_waitcnt lgkmcnt(9)
    v_mfma_f32_16x16x32_bf16 v[44:47], v[236:239], v[208:211], v[44:47]
    ds_read_b64_tr_b16 v[232:233], v247 offset:24672
    v_mfma_f32_16x16x32_bf16 v[92:95], v[236:239], v[212:215], v[92:95]
    ds_read_b64_tr_b16 v[234:235], v247 offset:25440
    v_mfma_f32_16x16x32_bf16 v[140:143], v[236:239], v[216:219], v[140:143]
    ds_read_b128 v[204:207], v244 offset:14336
    v_mfma_f32_16x16x32_bf16 v[188:191], v[236:239], v[220:223], v[188:191]
    s_waitcnt lgkmcnt(9)
    v_mfma_f32_16x16x32_bf16 v[0:3], v[240:243], v[192:195], v[0:3]
    ds_read_b64_tr_b16 v[236:237], v246 offset:24704
    s_waitcnt lgkmcnt(7)
    v_mfma_f32_16x16x32_bf16 v[48:51], v[240:243], v[196:199], v[48:51]
    ds_read_b64_tr_b16 v[238:239], v246 offset:25472
    s_waitcnt lgkmcnt(5)
    v_mfma_f32_16x16x32_bf16 v[96:99], v[240:243], v[200:203], v[96:99]
    s_waitcnt lgkmcnt(2)
    v_mfma_f32_16x16x32_bf16 v[144:147], v[240:243], v[204:207], v[144:147]
    v_mfma_f32_16x16x32_bf16 v[4:7], v[224:227], v[192:195], v[4:7]
    ds_read_b64_tr_b16 v[240:241], v247 offset:24736
    v_mfma_f32_16x16x32_bf16 v[52:55], v[224:227], v[196:199], v[52:55]
    ds_read_b64_tr_b16 v[242:243], v247 offset:25504
    v_mfma_f32_16x16x32_bf16 v[100:103], v[224:227], v[200:203], v[100:103]
    v_mfma_f32_16x16x32_bf16 v[148:151], v[224:227], v[204:207], v[148:151]
    v_mfma_f32_16x16x32_bf16 v[8:11], v[228:231], v[192:195], v[8:11]
    ds_read_b64_tr_b16 v[224:225], v246 offset:30720
    v_mfma_f32_16x16x32_bf16 v[56:59], v[228:231], v[196:199], v[56:59]
    ds_read_b64_tr_b16 v[226:227], v246 offset:31488
    v_mfma_f32_16x16x32_bf16 v[104:107], v[228:231], v[200:203], v[104:107]
    v_mfma_f32_16x16x32_bf16 v[152:155], v[228:231], v[204:207], v[152:155]
    v_mfma_f32_16x16x32_bf16 v[12:15], v[232:235], v[192:195], v[12:15]
    ds_read_b64_tr_b16 v[228:229], v247 offset:30752
    v_mfma_f32_16x16x32_bf16 v[60:63], v[232:235], v[196:199], v[60:63]
    ds_read_b64_tr_b16 v[230:231], v247 offset:31520
    v_mfma_f32_16x16x32_bf16 v[108:111], v[232:235], v[200:203], v[108:111]
    v_mfma_f32_16x16x32_bf16 v[156:159], v[232:235], v[204:207], v[156:159]
    s_waitcnt lgkmcnt(6)
    v_mfma_f32_16x16x32_bf16 v[16:19], v[236:239], v[192:195], v[16:19]
    ds_read_b64_tr_b16 v[232:233], v246 offset:30784
    v_mfma_f32_16x16x32_bf16 v[64:67], v[236:239], v[196:199], v[64:67]
    ds_read_b64_tr_b16 v[234:235], v246 offset:31552
    v_mfma_f32_16x16x32_bf16 v[112:115], v[236:239], v[200:203], v[112:115]
    v_mfma_f32_16x16x32_bf16 v[160:163], v[236:239], v[204:207], v[160:163]
    s_waitcnt lgkmcnt(6)
    v_mfma_f32_16x16x32_bf16 v[20:23], v[240:243], v[192:195], v[20:23]
    ds_read_b64_tr_b16 v[236:237], v247 offset:30816
    v_mfma_f32_16x16x32_bf16 v[68:71], v[240:243], v[196:199], v[68:71]
    ds_read_b64_tr_b16 v[238:239], v247 offset:31584
    v_mfma_f32_16x16x32_bf16 v[116:119], v[240:243], v[200:203], v[116:119]
    v_mfma_f32_16x16x32_bf16 v[164:167], v[240:243], v[204:207], v[164:167]
    s_waitcnt lgkmcnt(6)
    v_mfma_f32_16x16x32_bf16 v[24:27], v[224:227], v[192:195], v[24:27]
    ds_read_b64_tr_b16 v[240:241], v246 offset:30848
    v_mfma_f32_16x16x32_bf16 v[72:75], v[224:227], v[196:199], v[72:75]
    ds_read_b64_tr_b16 v[242:243], v246 offset:31616
    v_mfma_f32_16x16x32_bf16 v[120:123], v[224:227], v[200:203], v[120:123]
    v_mfma_f32_16x16x32_bf16 v[168:171], v[224:227], v[204:207], v[168:171]
    s_waitcnt lgkmcnt(6)
    v_mfma_f32_16x16x32_bf16 v[28:31], v[228:231], v[192:195], v[28:31]
    ds_read_b64_tr_b16 v[224:225], v247 offset:30880
    v_mfma_f32_16x16x32_bf16 v[76:79], v[228:231], v[196:199], v[76:79]
    ds_read_b64_tr_b16 v[226:227], v247 offset:31648
    v_mfma_f32_16x16x32_bf16 v[124:127], v[228:231], v[200:203], v[124:127]
    v_mfma_f32_16x16x32_bf16 v[172:175], v[228:231], v[204:207], v[172:175]
    s_waitcnt lgkmcnt(6)
    v_mfma_f32_16x16x32_bf16 v[32:35], v[232:235], v[192:195], v[32:35]
    s_barrier
    ds_read_b64_tr_b16 v[228:229], v246 offset:36864
    v_mfma_f32_16x16x32_bf16 v[80:83], v[232:235], v[196:199], v[80:83]
    ds_read_b64_tr_b16 v[230:231], v246 offset:37632
    v_mfma_f32_16x16x32_bf16 v[128:131], v[232:235], v[200:203], v[128:131]
    ds_read_b128 v[208:211], v245 offset:8192
    v_mfma_f32_16x16x32_bf16 v[176:179], v[232:235], v[204:207], v[176:179]
    s_waitcnt lgkmcnt(7)
    v_mfma_f32_16x16x32_bf16 v[36:39], v[236:239], v[192:195], v[36:39]
    ds_read_b64_tr_b16 v[232:233], v247 offset:36896
    v_mfma_f32_16x16x32_bf16 v[84:87], v[236:239], v[196:199], v[84:87]
    ds_read_b64_tr_b16 v[234:235], v247 offset:37664
    v_mfma_f32_16x16x32_bf16 v[132:135], v[236:239], v[200:203], v[132:135]
    ds_read_b128 v[212:215], v245 offset:10240
    v_mfma_f32_16x16x32_bf16 v[180:183], v[236:239], v[204:207], v[180:183]
    s_waitcnt lgkmcnt(8)
    v_mfma_f32_16x16x32_bf16 v[40:43], v[240:243], v[192:195], v[40:43]
    ds_read_b64_tr_b16 v[236:237], v246 offset:36928
    v_mfma_f32_16x16x32_bf16 v[88:91], v[240:243], v[196:199], v[88:91]
    ds_read_b64_tr_b16 v[238:239], v246 offset:37696
    v_mfma_f32_16x16x32_bf16 v[136:139], v[240:243], v[200:203], v[136:139]
    ds_read_b128 v[216:219], v245 offset:12288
    v_mfma_f32_16x16x32_bf16 v[184:187], v[240:243], v[204:207], v[184:187]
    s_waitcnt lgkmcnt(9)
    v_mfma_f32_16x16x32_bf16 v[44:47], v[224:227], v[192:195], v[44:47]
    ds_read_b64_tr_b16 v[240:241], v247 offset:36960
    v_mfma_f32_16x16x32_bf16 v[92:95], v[224:227], v[196:199], v[92:95]
    ds_read_b64_tr_b16 v[242:243], v247 offset:37728
    v_mfma_f32_16x16x32_bf16 v[140:143], v[224:227], v[200:203], v[140:143]
    ds_read_b128 v[220:223], v245 offset:14336
    v_mfma_f32_16x16x32_bf16 v[188:191], v[224:227], v[204:207], v[188:191]
    s_waitcnt lgkmcnt(9)
    v_mfma_f32_16x16x32_bf16 v[0:3], v[228:231], v[208:211], v[0:3]
    ds_read_b64_tr_b16 v[224:225], v246 offset:36992
    s_waitcnt lgkmcnt(7)
    v_mfma_f32_16x16x32_bf16 v[48:51], v[228:231], v[212:215], v[48:51]
    ds_read_b64_tr_b16 v[226:227], v246 offset:37760
    s_waitcnt lgkmcnt(5)
    v_mfma_f32_16x16x32_bf16 v[96:99], v[228:231], v[216:219], v[96:99]
    s_waitcnt lgkmcnt(2)
    v_mfma_f32_16x16x32_bf16 v[144:147], v[228:231], v[220:223], v[144:147]
    v_mfma_f32_16x16x32_bf16 v[4:7], v[232:235], v[208:211], v[4:7]
    ds_read_b64_tr_b16 v[228:229], v247 offset:37024
    v_mfma_f32_16x16x32_bf16 v[52:55], v[232:235], v[212:215], v[52:55]
    ds_read_b64_tr_b16 v[230:231], v247 offset:37792
    v_mfma_f32_16x16x32_bf16 v[100:103], v[232:235], v[216:219], v[100:103]
    v_mfma_f32_16x16x32_bf16 v[148:151], v[232:235], v[220:223], v[148:151]
    v_mfma_f32_16x16x32_bf16 v[8:11], v[236:239], v[208:211], v[8:11]
    ds_read_b64_tr_b16 v[232:233], v246 offset:43008
    v_mfma_f32_16x16x32_bf16 v[56:59], v[236:239], v[212:215], v[56:59]
    ds_read_b64_tr_b16 v[234:235], v246 offset:43776
    v_mfma_f32_16x16x32_bf16 v[104:107], v[236:239], v[216:219], v[104:107]
    v_mfma_f32_16x16x32_bf16 v[152:155], v[236:239], v[220:223], v[152:155]
    v_mfma_f32_16x16x32_bf16 v[12:15], v[240:243], v[208:211], v[12:15]
    ds_read_b64_tr_b16 v[236:237], v247 offset:43040
    v_mfma_f32_16x16x32_bf16 v[60:63], v[240:243], v[212:215], v[60:63]
    ds_read_b64_tr_b16 v[238:239], v247 offset:43808
    v_mfma_f32_16x16x32_bf16 v[108:111], v[240:243], v[216:219], v[108:111]
    v_mfma_f32_16x16x32_bf16 v[156:159], v[240:243], v[220:223], v[156:159]
    s_waitcnt lgkmcnt(6)
    v_mfma_f32_16x16x32_bf16 v[16:19], v[224:227], v[208:211], v[16:19]
    ds_read_b64_tr_b16 v[240:241], v246 offset:43072
    v_mfma_f32_16x16x32_bf16 v[64:67], v[224:227], v[212:215], v[64:67]
    ds_read_b64_tr_b16 v[242:243], v246 offset:43840
    v_mfma_f32_16x16x32_bf16 v[112:115], v[224:227], v[216:219], v[112:115]
    v_mfma_f32_16x16x32_bf16 v[160:163], v[224:227], v[220:223], v[160:163]
    s_waitcnt lgkmcnt(6)
    v_mfma_f32_16x16x32_bf16 v[20:23], v[228:231], v[208:211], v[20:23]
    ds_read_b64_tr_b16 v[224:225], v247 offset:43104
    v_mfma_f32_16x16x32_bf16 v[68:71], v[228:231], v[212:215], v[68:71]
    ds_read_b64_tr_b16 v[226:227], v247 offset:43872
    v_mfma_f32_16x16x32_bf16 v[116:119], v[228:231], v[216:219], v[116:119]
    v_mfma_f32_16x16x32_bf16 v[164:167], v[228:231], v[220:223], v[164:167]
    s_waitcnt lgkmcnt(6)
    v_mfma_f32_16x16x32_bf16 v[24:27], v[232:235], v[208:211], v[24:27]
    ds_read_b64_tr_b16 v[228:229], v246 offset:43136
    v_mfma_f32_16x16x32_bf16 v[72:75], v[232:235], v[212:215], v[72:75]
    ds_read_b64_tr_b16 v[230:231], v246 offset:43904
    v_mfma_f32_16x16x32_bf16 v[120:123], v[232:235], v[216:219], v[120:123]
    v_mfma_f32_16x16x32_bf16 v[168:171], v[232:235], v[220:223], v[168:171]
    s_waitcnt lgkmcnt(6)
    v_mfma_f32_16x16x32_bf16 v[28:31], v[236:239], v[208:211], v[28:31]
    ds_read_b64_tr_b16 v[232:233], v247 offset:43168
    v_mfma_f32_16x16x32_bf16 v[76:79], v[236:239], v[212:215], v[76:79]
    ds_read_b64_tr_b16 v[234:235], v247 offset:43936
    v_mfma_f32_16x16x32_bf16 v[124:127], v[236:239], v[216:219], v[124:127]
    v_mfma_f32_16x16x32_bf16 v[172:175], v[236:239], v[220:223], v[172:175]
    s_waitcnt lgkmcnt(6)
    v_mfma_f32_16x16x32_bf16 v[32:35], v[240:243], v[208:211], v[32:35]
    s_barrier
    ds_read_b64_tr_b16 v[236:237], v246 offset:49152
    v_mfma_f32_16x16x32_bf16 v[80:83], v[240:243], v[212:215], v[80:83]
    ds_read_b64_tr_b16 v[238:239], v246 offset:49920
    v_mfma_f32_16x16x32_bf16 v[128:131], v[240:243], v[216:219], v[128:131]
    ds_read_b128 v[192:195], v244 offset:16384
    v_mfma_f32_16x16x32_bf16 v[176:179], v[240:243], v[220:223], v[176:179]
    s_waitcnt lgkmcnt(7)
    v_mfma_f32_16x16x32_bf16 v[36:39], v[224:227], v[208:211], v[36:39]
    ds_read_b64_tr_b16 v[240:241], v247 offset:49184
    v_mfma_f32_16x16x32_bf16 v[84:87], v[224:227], v[212:215], v[84:87]
    ds_read_b64_tr_b16 v[242:243], v247 offset:49952
    v_mfma_f32_16x16x32_bf16 v[132:135], v[224:227], v[216:219], v[132:135]
    ds_read_b128 v[196:199], v244 offset:18432
    v_mfma_f32_16x16x32_bf16 v[180:183], v[224:227], v[220:223], v[180:183]
    s_waitcnt lgkmcnt(8)
    v_mfma_f32_16x16x32_bf16 v[40:43], v[228:231], v[208:211], v[40:43]
    ds_read_b64_tr_b16 v[224:225], v246 offset:49216
    v_mfma_f32_16x16x32_bf16 v[88:91], v[228:231], v[212:215], v[88:91]
    ds_read_b64_tr_b16 v[226:227], v246 offset:49984
    v_mfma_f32_16x16x32_bf16 v[136:139], v[228:231], v[216:219], v[136:139]
    ds_read_b128 v[200:203], v244 offset:20480
    v_mfma_f32_16x16x32_bf16 v[184:187], v[228:231], v[220:223], v[184:187]
    s_waitcnt lgkmcnt(9)
    v_mfma_f32_16x16x32_bf16 v[44:47], v[232:235], v[208:211], v[44:47]
    ds_read_b64_tr_b16 v[228:229], v247 offset:49248
    v_mfma_f32_16x16x32_bf16 v[92:95], v[232:235], v[212:215], v[92:95]
    ds_read_b64_tr_b16 v[230:231], v247 offset:50016
    v_mfma_f32_16x16x32_bf16 v[140:143], v[232:235], v[216:219], v[140:143]
    ds_read_b128 v[204:207], v244 offset:22528
    v_mfma_f32_16x16x32_bf16 v[188:191], v[232:235], v[220:223], v[188:191]
    s_waitcnt lgkmcnt(9)
    v_mfma_f32_16x16x32_bf16 v[0:3], v[236:239], v[192:195], v[0:3]
    ds_read_b64_tr_b16 v[232:233], v246 offset:49280
    s_waitcnt lgkmcnt(7)
    v_mfma_f32_16x16x32_bf16 v[48:51], v[236:239], v[196:199], v[48:51]
    ds_read_b64_tr_b16 v[234:235], v246 offset:50048
    s_waitcnt lgkmcnt(5)
    v_mfma_f32_16x16x32_bf16 v[96:99], v[236:239], v[200:203], v[96:99]
    s_waitcnt lgkmcnt(2)
    v_mfma_f32_16x16x32_bf16 v[144:147], v[236:239], v[204:207], v[144:147]
    v_mfma_f32_16x16x32_bf16 v[4:7], v[240:243], v[192:195], v[4:7]
    ds_read_b64_tr_b16 v[236:237], v247 offset:49312
    v_mfma_f32_16x16x32_bf16 v[52:55], v[240:243], v[196:199], v[52:55]
    ds_read_b64_tr_b16 v[238:239], v247 offset:50080
    v_mfma_f32_16x16x32_bf16 v[100:103], v[240:243], v[200:203], v[100:103]
    v_mfma_f32_16x16x32_bf16 v[148:151], v[240:243], v[204:207], v[148:151]
    v_mfma_f32_16x16x32_bf16 v[8:11], v[224:227], v[192:195], v[8:11]
    ds_read_b64_tr_b16 v[240:241], v246 offset:55296
    v_mfma_f32_16x16x32_bf16 v[56:59], v[224:227], v[196:199], v[56:59]
    ds_read_b64_tr_b16 v[242:243], v246 offset:56064
    v_mfma_f32_16x16x32_bf16 v[104:107], v[224:227], v[200:203], v[104:107]
    v_mfma_f32_16x16x32_bf16 v[152:155], v[224:227], v[204:207], v[152:155]
    v_mfma_f32_16x16x32_bf16 v[12:15], v[228:231], v[192:195], v[12:15]
    ds_read_b64_tr_b16 v[224:225], v247 offset:55328
    v_mfma_f32_16x16x32_bf16 v[60:63], v[228:231], v[196:199], v[60:63]
    ds_read_b64_tr_b16 v[226:227], v247 offset:56096
    v_mfma_f32_16x16x32_bf16 v[108:111], v[228:231], v[200:203], v[108:111]
    v_mfma_f32_16x16x32_bf16 v[156:159], v[228:231], v[204:207], v[156:159]
    s_waitcnt lgkmcnt(6)
    v_mfma_f32_16x16x32_bf16 v[16:19], v[232:235], v[192:195], v[16:19]
    ds_read_b64_tr_b16 v[228:229], v246 offset:55360
    v_mfma_f32_16x16x32_bf16 v[64:67], v[232:235], v[196:199], v[64:67]
    ds_read_b64_tr_b16 v[230:231], v246 offset:56128
    v_mfma_f32_16x16x32_bf16 v[112:115], v[232:235], v[200:203], v[112:115]
    v_mfma_f32_16x16x32_bf16 v[160:163], v[232:235], v[204:207], v[160:163]
    s_waitcnt lgkmcnt(6)
    v_mfma_f32_16x16x32_bf16 v[20:23], v[236:239], v[192:195], v[20:23]
    ds_read_b64_tr_b16 v[232:233], v247 offset:55392
    v_mfma_f32_16x16x32_bf16 v[68:71], v[236:239], v[196:199], v[68:71]
    ds_read_b64_tr_b16 v[234:235], v247 offset:56160
    v_mfma_f32_16x16x32_bf16 v[116:119], v[236:239], v[200:203], v[116:119]
    v_mfma_f32_16x16x32_bf16 v[164:167], v[236:239], v[204:207], v[164:167]
    s_waitcnt lgkmcnt(6)
    v_mfma_f32_16x16x32_bf16 v[24:27], v[240:243], v[192:195], v[24:27]
    ds_read_b64_tr_b16 v[236:237], v246 offset:55424
    v_mfma_f32_16x16x32_bf16 v[72:75], v[240:243], v[196:199], v[72:75]
    ds_read_b64_tr_b16 v[238:239], v246 offset:56192
    v_mfma_f32_16x16x32_bf16 v[120:123], v[240:243], v[200:203], v[120:123]
    v_mfma_f32_16x16x32_bf16 v[168:171], v[240:243], v[204:207], v[168:171]
    s_waitcnt lgkmcnt(6)
    v_mfma_f32_16x16x32_bf16 v[28:31], v[224:227], v[192:195], v[28:31]
    ds_read_b64_tr_b16 v[240:241], v247 offset:55456
    v_mfma_f32_16x16x32_bf16 v[76:79], v[224:227], v[196:199], v[76:79]
    ds_read_b64_tr_b16 v[242:243], v247 offset:56224
    v_mfma_f32_16x16x32_bf16 v[124:127], v[224:227], v[200:203], v[124:127]
    v_mfma_f32_16x16x32_bf16 v[172:175], v[224:227], v[204:207], v[172:175]
    s_waitcnt lgkmcnt(6)
    v_mfma_f32_16x16x32_bf16 v[32:35], v[228:231], v[192:195], v[32:35]
    s_barrier
    ds_read_b64_tr_b16 v[224:225], v246 offset:0
    v_mfma_f32_16x16x32_bf16 v[80:83], v[228:231], v[196:199], v[80:83]
    ds_read_b64_tr_b16 v[226:227], v246 offset:768
    v_mfma_f32_16x16x32_bf16 v[128:131], v[228:231], v[200:203], v[128:131]
    ds_read_b128 v[208:211], v245 offset:16384
    v_mfma_f32_16x16x32_bf16 v[176:179], v[228:231], v[204:207], v[176:179]
    s_waitcnt lgkmcnt(7)
    v_mfma_f32_16x16x32_bf16 v[36:39], v[232:235], v[192:195], v[36:39]
    ds_read_b64_tr_b16 v[228:229], v247 offset:32
    v_mfma_f32_16x16x32_bf16 v[84:87], v[232:235], v[196:199], v[84:87]
    ds_read_b64_tr_b16 v[230:231], v247 offset:800
    v_mfma_f32_16x16x32_bf16 v[132:135], v[232:235], v[200:203], v[132:135]
    ds_read_b128 v[212:215], v245 offset:18432
    v_mfma_f32_16x16x32_bf16 v[180:183], v[232:235], v[204:207], v[180:183]
    s_waitcnt lgkmcnt(8)
    v_mfma_f32_16x16x32_bf16 v[40:43], v[236:239], v[192:195], v[40:43]
    ds_read_b64_tr_b16 v[232:233], v246 offset:64
    v_mfma_f32_16x16x32_bf16 v[88:91], v[236:239], v[196:199], v[88:91]
    ds_read_b64_tr_b16 v[234:235], v246 offset:832
    v_mfma_f32_16x16x32_bf16 v[136:139], v[236:239], v[200:203], v[136:139]
    ds_read_b128 v[216:219], v245 offset:20480
    v_mfma_f32_16x16x32_bf16 v[184:187], v[236:239], v[204:207], v[184:187]
    s_waitcnt lgkmcnt(9)
    v_mfma_f32_16x16x32_bf16 v[44:47], v[240:243], v[192:195], v[44:47]
    ds_read_b64_tr_b16 v[236:237], v247 offset:96
    v_mfma_f32_16x16x32_bf16 v[92:95], v[240:243], v[196:199], v[92:95]
    ds_read_b64_tr_b16 v[238:239], v247 offset:864
    v_mfma_f32_16x16x32_bf16 v[140:143], v[240:243], v[200:203], v[140:143]
    ds_read_b128 v[220:223], v245 offset:22528
    v_mfma_f32_16x16x32_bf16 v[188:191], v[240:243], v[204:207], v[188:191]
    s_waitcnt lgkmcnt(9)
    v_mfma_f32_16x16x32_bf16 v[0:3], v[224:227], v[208:211], v[0:3]
    ds_read_b64_tr_b16 v[240:241], v246 offset:128
    s_waitcnt lgkmcnt(7)
    v_mfma_f32_16x16x32_bf16 v[48:51], v[224:227], v[212:215], v[48:51]
    ds_read_b64_tr_b16 v[242:243], v246 offset:896
    s_waitcnt lgkmcnt(5)
    v_mfma_f32_16x16x32_bf16 v[96:99], v[224:227], v[216:219], v[96:99]
    s_waitcnt lgkmcnt(2)
    v_mfma_f32_16x16x32_bf16 v[144:147], v[224:227], v[220:223], v[144:147]
    v_mfma_f32_16x16x32_bf16 v[4:7], v[228:231], v[208:211], v[4:7]
    ds_read_b64_tr_b16 v[224:225], v247 offset:160
    v_mfma_f32_16x16x32_bf16 v[52:55], v[228:231], v[212:215], v[52:55]
    ds_read_b64_tr_b16 v[226:227], v247 offset:928
    v_mfma_f32_16x16x32_bf16 v[100:103], v[228:231], v[216:219], v[100:103]
    v_mfma_f32_16x16x32_bf16 v[148:151], v[228:231], v[220:223], v[148:151]
    v_mfma_f32_16x16x32_bf16 v[8:11], v[232:235], v[208:211], v[8:11]
    ds_read_b64_tr_b16 v[228:229], v246 offset:6144
    v_mfma_f32_16x16x32_bf16 v[56:59], v[232:235], v[212:215], v[56:59]
    ds_read_b64_tr_b16 v[230:231], v246 offset:6912
    v_mfma_f32_16x16x32_bf16 v[104:107], v[232:235], v[216:219], v[104:107]
    v_mfma_f32_16x16x32_bf16 v[152:155], v[232:235], v[220:223], v[152:155]
    v_mfma_f32_16x16x32_bf16 v[12:15], v[236:239], v[208:211], v[12:15]
    ds_read_b64_tr_b16 v[232:233], v247 offset:6176
    v_mfma_f32_16x16x32_bf16 v[60:63], v[236:239], v[212:215], v[60:63]
    ds_read_b64_tr_b16 v[234:235], v247 offset:6944
    v_mfma_f32_16x16x32_bf16 v[108:111], v[236:239], v[216:219], v[108:111]
    v_mfma_f32_16x16x32_bf16 v[156:159], v[236:239], v[220:223], v[156:159]
    s_waitcnt lgkmcnt(6)
    v_mfma_f32_16x16x32_bf16 v[16:19], v[240:243], v[208:211], v[16:19]
    ds_read_b64_tr_b16 v[236:237], v246 offset:6208
    v_mfma_f32_16x16x32_bf16 v[64:67], v[240:243], v[212:215], v[64:67]
    ds_read_b64_tr_b16 v[238:239], v246 offset:6976
    v_mfma_f32_16x16x32_bf16 v[112:115], v[240:243], v[216:219], v[112:115]
    v_mfma_f32_16x16x32_bf16 v[160:163], v[240:243], v[220:223], v[160:163]
    s_waitcnt lgkmcnt(6)
    v_mfma_f32_16x16x32_bf16 v[20:23], v[224:227], v[208:211], v[20:23]
    ds_read_b64_tr_b16 v[240:241], v247 offset:6240
    v_mfma_f32_16x16x32_bf16 v[68:71], v[224:227], v[212:215], v[68:71]
    ds_read_b64_tr_b16 v[242:243], v247 offset:7008
    v_mfma_f32_16x16x32_bf16 v[116:119], v[224:227], v[216:219], v[116:119]
    v_mfma_f32_16x16x32_bf16 v[164:167], v[224:227], v[220:223], v[164:167]
    s_waitcnt lgkmcnt(6)
    v_mfma_f32_16x16x32_bf16 v[24:27], v[228:231], v[208:211], v[24:27]
    ds_read_b64_tr_b16 v[224:225], v246 offset:6272
    v_mfma_f32_16x16x32_bf16 v[72:75], v[228:231], v[212:215], v[72:75]
    ds_read_b64_tr_b16 v[226:227], v246 offset:7040
    v_mfma_f32_16x16x32_bf16 v[120:123], v[228:231], v[216:219], v[120:123]
    v_mfma_f32_16x16x32_bf16 v[168:171], v[228:231], v[220:223], v[168:171]
    s_waitcnt lgkmcnt(6)
    v_mfma_f32_16x16x32_bf16 v[28:31], v[232:235], v[208:211], v[28:31]
    ds_read_b64_tr_b16 v[228:229], v247 offset:6304
    v_mfma_f32_16x16x32_bf16 v[76:79], v[232:235], v[212:215], v[76:79]
    ds_read_b64_tr_b16 v[230:231], v247 offset:7072
    v_mfma_f32_16x16x32_bf16 v[124:127], v[232:235], v[216:219], v[124:127]
    v_mfma_f32_16x16x32_bf16 v[172:175], v[232:235], v[220:223], v[172:175]
    s_waitcnt lgkmcnt(6)
    v_mfma_f32_16x16x32_bf16 v[32:35], v[236:239], v[208:211], v[32:35]
    s_barrier
    ds_read_b64_tr_b16 v[232:233], v246 offset:12288
    v_mfma_f32_16x16x32_bf16 v[80:83], v[236:239], v[212:215], v[80:83]
    ds_read_b64_tr_b16 v[234:235], v246 offset:13056
    v_mfma_f32_16x16x32_bf16 v[128:131], v[236:239], v[216:219], v[128:131]
    ds_read_b128 v[192:195], v244 offset:0
    v_mfma_f32_16x16x32_bf16 v[176:179], v[236:239], v[220:223], v[176:179]
    ds_read_b128 v[252:255], v249
    s_waitcnt lgkmcnt(8)
    v_mfma_f32_16x16x32_bf16 v[36:39], v[240:243], v[208:211], v[36:39]
    ds_read_b64_tr_b16 v[236:237], v247 offset:12320
    v_mfma_f32_16x16x32_bf16 v[84:87], v[240:243], v[212:215], v[84:87]
    ds_read_b64_tr_b16 v[238:239], v247 offset:13088
    v_mfma_f32_16x16x32_bf16 v[132:135], v[240:243], v[216:219], v[132:135]
    ds_read_b128 v[196:199], v244 offset:2048
    v_mfma_f32_16x16x32_bf16 v[180:183], v[240:243], v[220:223], v[180:183]
    s_waitcnt lgkmcnt(9)
    v_mfma_f32_16x16x32_bf16 v[40:43], v[224:227], v[208:211], v[40:43]
    ds_read_b64_tr_b16 v[240:241], v246 offset:12352
    v_mfma_f32_16x16x32_bf16 v[88:91], v[224:227], v[212:215], v[88:91]
    ds_read_b64_tr_b16 v[242:243], v246 offset:13120
    v_mfma_f32_16x16x32_bf16 v[136:139], v[224:227], v[216:219], v[136:139]
    ds_read_b128 v[200:203], v244 offset:4096
    v_mfma_f32_16x16x32_bf16 v[184:187], v[224:227], v[220:223], v[184:187]
    s_waitcnt lgkmcnt(10)
    v_mfma_f32_16x16x32_bf16 v[44:47], v[228:231], v[208:211], v[44:47]
    ds_read_b64_tr_b16 v[224:225], v247 offset:12384
    v_mfma_f32_16x16x32_bf16 v[92:95], v[228:231], v[212:215], v[92:95]
    ds_read_b64_tr_b16 v[226:227], v247 offset:13152
    v_mfma_f32_16x16x32_bf16 v[140:143], v[228:231], v[216:219], v[140:143]
    ds_read_b128 v[204:207], v244 offset:6144
    v_mfma_f32_16x16x32_bf16 v[188:191], v[228:231], v[220:223], v[188:191]
    s_waitcnt lgkmcnt(9)
    buffer_store_dwordx4 v[252:255], v250, s[20:23], s52 offen sc1
    v_lshlrev_b32 v250, 4, v248
    v_add_u32 v249, 159744, v250
    v_mfma_f32_16x16x32_bf16 v[0:3], v[232:235], v[192:195], v[0:3]
    ds_read_b64_tr_b16 v[228:229], v246 offset:12416
    s_waitcnt lgkmcnt(7)
    v_mfma_f32_16x16x32_bf16 v[48:51], v[232:235], v[196:199], v[48:51]
    ds_read_b64_tr_b16 v[230:231], v246 offset:13184
    s_waitcnt lgkmcnt(5)
    v_mfma_f32_16x16x32_bf16 v[96:99], v[232:235], v[200:203], v[96:99]
    s_waitcnt lgkmcnt(2)
    v_mfma_f32_16x16x32_bf16 v[144:147], v[232:235], v[204:207], v[144:147]
    ds_read_b128 v[252:255], v249
    v_mfma_f32_16x16x32_bf16 v[4:7], v[236:239], v[192:195], v[4:7]
    ds_read_b64_tr_b16 v[232:233], v247 offset:12448
    v_mfma_f32_16x16x32_bf16 v[52:55], v[236:239], v[196:199], v[52:55]
    ds_read_b64_tr_b16 v[234:235], v247 offset:13216
    v_mfma_f32_16x16x32_bf16 v[100:103], v[236:239], v[200:203], v[100:103]
    v_mfma_f32_16x16x32_bf16 v[148:151], v[236:239], v[204:207], v[148:151]
    v_mfma_f32_16x16x32_bf16 v[8:11], v[240:243], v[192:195], v[8:11]
    ds_read_b64_tr_b16 v[236:237], v246 offset:18432
    v_mfma_f32_16x16x32_bf16 v[56:59], v[240:243], v[196:199], v[56:59]
    ds_read_b64_tr_b16 v[238:239], v246 offset:19200
    v_mfma_f32_16x16x32_bf16 v[104:107], v[240:243], v[200:203], v[104:107]
    v_mfma_f32_16x16x32_bf16 v[152:155], v[240:243], v[204:207], v[152:155]
    v_mfma_f32_16x16x32_bf16 v[12:15], v[224:227], v[192:195], v[12:15]
    ds_read_b64_tr_b16 v[240:241], v247 offset:18464
    v_mfma_f32_16x16x32_bf16 v[60:63], v[224:227], v[196:199], v[60:63]
    ds_read_b64_tr_b16 v[242:243], v247 offset:19232
    v_mfma_f32_16x16x32_bf16 v[108:111], v[224:227], v[200:203], v[108:111]
    v_mfma_f32_16x16x32_bf16 v[156:159], v[224:227], v[204:207], v[156:159]
    s_waitcnt lgkmcnt(6)
    s_mov_b64 exec, 0xff
    buffer_store_dwordx4 v[252:255], v250, s[20:23], s53 offen sc1
    s_mov_b64 exec, -1
    v_mfma_f32_16x16x32_bf16 v[16:19], v[228:231], v[192:195], v[16:19]
    ds_read_b64_tr_b16 v[224:225], v246 offset:18496
    v_mfma_f32_16x16x32_bf16 v[64:67], v[228:231], v[196:199], v[64:67]
    ds_read_b64_tr_b16 v[226:227], v246 offset:19264
    v_mfma_f32_16x16x32_bf16 v[112:115], v[228:231], v[200:203], v[112:115]
    v_mfma_f32_16x16x32_bf16 v[160:163], v[228:231], v[204:207], v[160:163]
    s_waitcnt lgkmcnt(6)
    v_mfma_f32_16x16x32_bf16 v[20:23], v[232:235], v[192:195], v[20:23]
    ds_read_b64_tr_b16 v[228:229], v247 offset:18528
    v_mfma_f32_16x16x32_bf16 v[68:71], v[232:235], v[196:199], v[68:71]
    ds_read_b64_tr_b16 v[230:231], v247 offset:19296
    v_mfma_f32_16x16x32_bf16 v[116:119], v[232:235], v[200:203], v[116:119]
    v_mfma_f32_16x16x32_bf16 v[164:167], v[232:235], v[204:207], v[164:167]
    s_waitcnt lgkmcnt(6)
    v_mfma_f32_16x16x32_bf16 v[24:27], v[236:239], v[192:195], v[24:27]
    ds_read_b64_tr_b16 v[232:233], v246 offset:18560
    v_mfma_f32_16x16x32_bf16 v[72:75], v[236:239], v[196:199], v[72:75]
    ds_read_b64_tr_b16 v[234:235], v246 offset:19328
    v_mfma_f32_16x16x32_bf16 v[120:123], v[236:239], v[200:203], v[120:123]
    v_mfma_f32_16x16x32_bf16 v[168:171], v[236:239], v[204:207], v[168:171]
    s_waitcnt lgkmcnt(6)
    v_mfma_f32_16x16x32_bf16 v[28:31], v[240:243], v[192:195], v[28:31]
    ds_read_b64_tr_b16 v[236:237], v247 offset:18592
    v_mfma_f32_16x16x32_bf16 v[76:79], v[240:243], v[196:199], v[76:79]
    ds_read_b64_tr_b16 v[238:239], v247 offset:19360
    v_mfma_f32_16x16x32_bf16 v[124:127], v[240:243], v[200:203], v[124:127]
    v_mfma_f32_16x16x32_bf16 v[172:175], v[240:243], v[204:207], v[172:175]
    s_waitcnt lgkmcnt(6)
    v_mfma_f32_16x16x32_bf16 v[32:35], v[224:227], v[192:195], v[32:35]
    s_barrier
    ds_read_b64_tr_b16 v[240:241], v246 offset:24576
    v_mfma_f32_16x16x32_bf16 v[80:83], v[224:227], v[196:199], v[80:83]
    ds_read_b64_tr_b16 v[242:243], v246 offset:25344
    v_mfma_f32_16x16x32_bf16 v[128:131], v[224:227], v[200:203], v[128:131]
    ds_read_b128 v[208:211], v245 offset:0
    v_mfma_f32_16x16x32_bf16 v[176:179], v[224:227], v[204:207], v[176:179]
    s_waitcnt lgkmcnt(7)
    v_mfma_f32_16x16x32_bf16 v[36:39], v[228:231], v[192:195], v[36:39]
    ds_read_b64_tr_b16 v[224:225], v247 offset:24608
    v_mfma_f32_16x16x32_bf16 v[84:87], v[228:231], v[196:199], v[84:87]
    ds_read_b64_tr_b16 v[226:227], v247 offset:25376
    v_mfma_f32_16x16x32_bf16 v[132:135], v[228:231], v[200:203], v[132:135]
    ds_read_b128 v[212:215], v245 offset:2048
    v_mfma_f32_16x16x32_bf16 v[180:183], v[228:231], v[204:207], v[180:183]
    s_waitcnt lgkmcnt(8)
    v_mfma_f32_16x16x32_bf16 v[40:43], v[232:235], v[192:195], v[40:43]
    ds_read_b64_tr_b16 v[228:229], v246 offset:24640
    v_mfma_f32_16x16x32_bf16 v[88:91], v[232:235], v[196:199], v[88:91]
    ds_read_b64_tr_b16 v[230:231], v246 offset:25408
    v_mfma_f32_16x16x32_bf16 v[136:139], v[232:235], v[200:203], v[136:139]
    ds_read_b128 v[216:219], v245 offset:4096
    v_mfma_f32_16x16x32_bf16 v[184:187], v[232:235], v[204:207], v[184:187]
    s_waitcnt lgkmcnt(9)
    v_mfma_f32_16x16x32_bf16 v[44:47], v[236:239], v[192:195], v[44:47]
    ds_read_b64_tr_b16 v[232:233], v247 offset:24672
    v_mfma_f32_16x16x32_bf16 v[92:95], v[236:239], v[196:199], v[92:95]
    ds_read_b64_tr_b16 v[234:235], v247 offset:25440
    v_mfma_f32_16x16x32_bf16 v[140:143], v[236:239], v[200:203], v[140:143]
    ds_read_b128 v[220:223], v245 offset:6144
    v_mfma_f32_16x16x32_bf16 v[188:191], v[236:239], v[204:207], v[188:191]
    s_waitcnt lgkmcnt(9)
    v_mfma_f32_16x16x32_bf16 v[0:3], v[240:243], v[208:211], v[0:3]
    ds_read_b64_tr_b16 v[236:237], v246 offset:24704
    s_waitcnt lgkmcnt(7)
    v_mfma_f32_16x16x32_bf16 v[48:51], v[240:243], v[212:215], v[48:51]
    ds_read_b64_tr_b16 v[238:239], v246 offset:25472
    s_waitcnt lgkmcnt(5)
    v_mfma_f32_16x16x32_bf16 v[96:99], v[240:243], v[216:219], v[96:99]
    s_waitcnt lgkmcnt(2)
    v_mfma_f32_16x16x32_bf16 v[144:147], v[240:243], v[220:223], v[144:147]
    v_mfma_f32_16x16x32_bf16 v[4:7], v[224:227], v[208:211], v[4:7]
    ds_read_b64_tr_b16 v[240:241], v247 offset:24736
    v_mfma_f32_16x16x32_bf16 v[52:55], v[224:227], v[212:215], v[52:55]
    ds_read_b64_tr_b16 v[242:243], v247 offset:25504
    v_mfma_f32_16x16x32_bf16 v[100:103], v[224:227], v[216:219], v[100:103]
    v_mfma_f32_16x16x32_bf16 v[148:151], v[224:227], v[220:223], v[148:151]
    v_mfma_f32_16x16x32_bf16 v[8:11], v[228:231], v[208:211], v[8:11]
    ds_read_b64_tr_b16 v[224:225], v246 offset:30720
    v_mfma_f32_16x16x32_bf16 v[56:59], v[228:231], v[212:215], v[56:59]
    ds_read_b64_tr_b16 v[226:227], v246 offset:31488
    v_mfma_f32_16x16x32_bf16 v[104:107], v[228:231], v[216:219], v[104:107]
    v_mfma_f32_16x16x32_bf16 v[152:155], v[228:231], v[220:223], v[152:155]
    v_mfma_f32_16x16x32_bf16 v[12:15], v[232:235], v[208:211], v[12:15]
    ds_read_b64_tr_b16 v[228:229], v247 offset:30752
    v_mfma_f32_16x16x32_bf16 v[60:63], v[232:235], v[212:215], v[60:63]
    ds_read_b64_tr_b16 v[230:231], v247 offset:31520
    v_mfma_f32_16x16x32_bf16 v[108:111], v[232:235], v[216:219], v[108:111]
    v_mfma_f32_16x16x32_bf16 v[156:159], v[232:235], v[220:223], v[156:159]
    s_waitcnt lgkmcnt(6)
    v_mfma_f32_16x16x32_bf16 v[16:19], v[236:239], v[208:211], v[16:19]
    ds_read_b64_tr_b16 v[232:233], v246 offset:30784
    v_mfma_f32_16x16x32_bf16 v[64:67], v[236:239], v[212:215], v[64:67]
    ds_read_b64_tr_b16 v[234:235], v246 offset:31552
    v_mfma_f32_16x16x32_bf16 v[112:115], v[236:239], v[216:219], v[112:115]
    v_mfma_f32_16x16x32_bf16 v[160:163], v[236:239], v[220:223], v[160:163]
    s_waitcnt lgkmcnt(6)
    v_mfma_f32_16x16x32_bf16 v[20:23], v[240:243], v[208:211], v[20:23]
    ds_read_b64_tr_b16 v[236:237], v247 offset:30816
    v_mfma_f32_16x16x32_bf16 v[68:71], v[240:243], v[212:215], v[68:71]
    ds_read_b64_tr_b16 v[238:239], v247 offset:31584
    v_mfma_f32_16x16x32_bf16 v[116:119], v[240:243], v[216:219], v[116:119]
    v_mfma_f32_16x16x32_bf16 v[164:167], v[240:243], v[220:223], v[164:167]
    s_waitcnt lgkmcnt(6)
    v_mfma_f32_16x16x32_bf16 v[24:27], v[224:227], v[208:211], v[24:27]
    ds_read_b64_tr_b16 v[240:241], v246 offset:30848
    v_mfma_f32_16x16x32_bf16 v[72:75], v[224:227], v[212:215], v[72:75]
    ds_read_b64_tr_b16 v[242:243], v246 offset:31616
    v_mfma_f32_16x16x32_bf16 v[120:123], v[224:227], v[216:219], v[120:123]
    v_mfma_f32_16x16x32_bf16 v[168:171], v[224:227], v[220:223], v[168:171]
    s_waitcnt lgkmcnt(6)
    v_mfma_f32_16x16x32_bf16 v[28:31], v[228:231], v[208:211], v[28:31]
    ds_read_b64_tr_b16 v[224:225], v247 offset:30880
    v_mfma_f32_16x16x32_bf16 v[76:79], v[228:231], v[212:215], v[76:79]
    ds_read_b64_tr_b16 v[226:227], v247 offset:31648
    v_mfma_f32_16x16x32_bf16 v[124:127], v[228:231], v[216:219], v[124:127]
    v_mfma_f32_16x16x32_bf16 v[172:175], v[228:231], v[220:223], v[172:175]
    s_waitcnt lgkmcnt(6)
    v_mfma_f32_16x16x32_bf16 v[32:35], v[232:235], v[208:211], v[32:35]
    s_waitcnt vmcnt(0)
    s_barrier
    ds_read_b64_tr_b16 v[228:229], v246 offset:36864
    v_mfma_f32_16x16x32_bf16 v[80:83], v[232:235], v[212:215], v[80:83]
    ds_read_b64_tr_b16 v[230:231], v246 offset:37632
    v_mfma_f32_16x16x32_bf16 v[128:131], v[232:235], v[216:219], v[128:131]
    ds_read_b128 v[192:195], v244 offset:8192
    v_mfma_f32_16x16x32_bf16 v[176:179], v[232:235], v[220:223], v[176:179]
    s_cmp_lg_u32 s3, 0
    s_cbranch_scc1 SG10
    s_and_b32 s67, s2, 1
    s_lshl_b32 s67, s67, 6
    s_add_u32 s67, s67, 0
    v_mov_b32 v252, s67
    v_mov_b32 v253, 1
    s_mov_b64 exec, 1
    global_atomic_add v252, v253, s[14:15]
    s_mov_b64 exec, -1
SG10:
    s_waitcnt lgkmcnt(7)
    v_mfma_f32_16x16x32_bf16 v[36:39], v[236:239], v[208:211], v[36:39]
    ds_read_b64_tr_b16 v[232:233], v247 offset:36896
    v_mfma_f32_16x16x32_bf16 v[84:87], v[236:239], v[212:215], v[84:87]
    ds_read_b64_tr_b16 v[234:235], v247 offset:37664
    v_mfma_f32_16x16x32_bf16 v[132:135], v[236:239], v[216:219], v[132:135]
    ds_read_b128 v[196:199], v244 offset:10240
    v_mfma_f32_16x16x32_bf16 v[180:183], v[236:239], v[220:223], v[180:183]
    s_waitcnt lgkmcnt(8)
    v_mfma_f32_16x16x32_bf16 v[40:43], v[240:243], v[208:211], v[40:43]
    ds_read_b64_tr_b16 v[236:237], v246 offset:36928
    v_mfma_f32_16x16x32_bf16 v[88:91], v[240:243], v[212:215], v[88:91]
    ds_read_b64_tr_b16 v[238:239], v246 offset:37696
    v_mfma_f32_16x16x32_bf16 v[136:139], v[240:243], v[216:219], v[136:139]
    ds_read_b128 v[200:203], v244 offset:12288
    v_mfma_f32_16x16x32_bf16 v[184:187], v[240:243], v[220:223], v[184:187]
    s_waitcnt lgkmcnt(9)
    v_mfma_f32_16x16x32_bf16 v[44:47], v[224:227], v[208:211], v[44:47]
    ds_read_b64_tr_b16 v[240:241], v247 offset:36960
    v_mfma_f32_16x16x32_bf16 v[92:95], v[224:227], v[212:215], v[92:95]
    ds_read_b64_tr_b16 v[242:243], v247 offset:37728
    v_mfma_f32_16x16x32_bf16 v[140:143], v[224:227], v[216:219], v[140:143]
    ds_read_b128 v[204:207], v244 offset:14336
    v_mfma_f32_16x16x32_bf16 v[188:191], v[224:227], v[220:223], v[188:191]
    s_waitcnt lgkmcnt(9)
    v_mfma_f32_16x16x32_bf16 v[0:3], v[228:231], v[192:195], v[0:3]
    ds_read_b64_tr_b16 v[224:225], v246 offset:36992
    s_waitcnt lgkmcnt(7)
    v_mfma_f32_16x16x32_bf16 v[48:51], v[228:231], v[196:199], v[48:51]
    ds_read_b64_tr_b16 v[226:227], v246 offset:37760
    s_waitcnt lgkmcnt(5)
    v_mfma_f32_16x16x32_bf16 v[96:99], v[228:231], v[200:203], v[96:99]
    s_waitcnt lgkmcnt(2)
    v_mfma_f32_16x16x32_bf16 v[144:147], v[228:231], v[204:207], v[144:147]
    v_mfma_f32_16x16x32_bf16 v[4:7], v[232:235], v[192:195], v[4:7]
    ds_read_b64_tr_b16 v[228:229], v247 offset:37024
    v_mfma_f32_16x16x32_bf16 v[52:55], v[232:235], v[196:199], v[52:55]
    ds_read_b64_tr_b16 v[230:231], v247 offset:37792
    v_mfma_f32_16x16x32_bf16 v[100:103], v[232:235], v[200:203], v[100:103]
    v_mfma_f32_16x16x32_bf16 v[148:151], v[232:235], v[204:207], v[148:151]
    v_mfma_f32_16x16x32_bf16 v[8:11], v[236:239], v[192:195], v[8:11]
    ds_read_b64_tr_b16 v[232:233], v246 offset:43008
    v_mfma_f32_16x16x32_bf16 v[56:59], v[236:239], v[196:199], v[56:59]
    ds_read_b64_tr_b16 v[234:235], v246 offset:43776
    v_mfma_f32_16x16x32_bf16 v[104:107], v[236:239], v[200:203], v[104:107]
    v_mfma_f32_16x16x32_bf16 v[152:155], v[236:239], v[204:207], v[152:155]
    v_mfma_f32_16x16x32_bf16 v[12:15], v[240:243], v[192:195], v[12:15]
    ds_read_b64_tr_b16 v[236:237], v247 offset:43040
    v_mfma_f32_16x16x32_bf16 v[60:63], v[240:243], v[196:199], v[60:63]
    ds_read_b64_tr_b16 v[238:239], v247 offset:43808
    v_mfma_f32_16x16x32_bf16 v[108:111], v[240:243], v[200:203], v[108:111]
    v_mfma_f32_16x16x32_bf16 v[156:159], v[240:243], v[204:207], v[156:159]
    s_waitcnt lgkmcnt(6)
    v_mfma_f32_16x16x32_bf16 v[16:19], v[224:227], v[192:195], v[16:19]
    ds_read_b64_tr_b16 v[240:241], v246 offset:43072
    v_mfma_f32_16x16x32_bf16 v[64:67], v[224:227], v[196:199], v[64:67]
    ds_read_b64_tr_b16 v[242:243], v246 offset:43840
    v_mfma_f32_16x16x32_bf16 v[112:115], v[224:227], v[200:203], v[112:115]
    v_mfma_f32_16x16x32_bf16 v[160:163], v[224:227], v[204:207], v[160:163]
    s_waitcnt lgkmcnt(6)
    v_mfma_f32_16x16x32_bf16 v[20:23], v[228:231], v[192:195], v[20:23]
    ds_read_b64_tr_b16 v[224:225], v247 offset:43104
    v_mfma_f32_16x16x32_bf16 v[68:71], v[228:231], v[196:199], v[68:71]
    ds_read_b64_tr_b16 v[226:227], v247 offset:43872
    v_mfma_f32_16x16x32_bf16 v[116:119], v[228:231], v[200:203], v[116:119]
    v_mfma_f32_16x16x32_bf16 v[164:167], v[228:231], v[204:207], v[164:167]
    s_waitcnt lgkmcnt(6)
    v_mfma_f32_16x16x32_bf16 v[24:27], v[232:235], v[192:195], v[24:27]
    ds_read_b64_tr_b16 v[228:229], v246 offset:43136
    v_mfma_f32_16x16x32_bf16 v[72:75], v[232:235], v[196:199], v[72:75]
    ds_read_b64_tr_b16 v[230:231], v246 offset:43904
    v_mfma_f32_16x16x32_bf16 v[120:123], v[232:235], v[200:203], v[120:123]
    v_mfma_f32_16x16x32_bf16 v[168:171], v[232:235], v[204:207], v[168:171]
    s_waitcnt lgkmcnt(6)
    v_mfma_f32_16x16x32_bf16 v[28:31], v[236:239], v[192:195], v[28:31]
    ds_read_b64_tr_b16 v[232:233], v247 offset:43168
    v_mfma_f32_16x16x32_bf16 v[76:79], v[236:239], v[196:199], v[76:79]
    ds_read_b64_tr_b16 v[234:235], v247 offset:43936
    v_mfma_f32_16x16x32_bf16 v[124:127], v[236:239], v[200:203], v[124:127]
    v_mfma_f32_16x16x32_bf16 v[172:175], v[236:239], v[204:207], v[172:175]
    s_waitcnt lgkmcnt(6)
    v_mfma_f32_16x16x32_bf16 v[32:35], v[240:243], v[192:195], v[32:35]
    s_barrier
    ds_read_b64_tr_b16 v[236:237], v246 offset:49152
    v_mfma_f32_16x16x32_bf16 v[80:83], v[240:243], v[196:199], v[80:83]
    ds_read_b64_tr_b16 v[238:239], v246 offset:49920
    v_mfma_f32_16x16x32_bf16 v[128:131], v[240:243], v[200:203], v[128:131]
    ds_read_b128 v[208:211], v245 offset:8192
    v_mfma_f32_16x16x32_bf16 v[176:179], v[240:243], v[204:207], v[176:179]
    s_waitcnt lgkmcnt(7)
    v_mfma_f32_16x16x32_bf16 v[36:39], v[224:227], v[192:195], v[36:39]
    ds_read_b64_tr_b16 v[240:241], v247 offset:49184
    v_mfma_f32_16x16x32_bf16 v[84:87], v[224:227], v[196:199], v[84:87]
    ds_read_b64_tr_b16 v[242:243], v247 offset:49952
    v_mfma_f32_16x16x32_bf16 v[132:135], v[224:227], v[200:203], v[132:135]
    ds_read_b128 v[212:215], v245 offset:10240
    v_mfma_f32_16x16x32_bf16 v[180:183], v[224:227], v[204:207], v[180:183]
    s_waitcnt lgkmcnt(8)
    v_mfma_f32_16x16x32_bf16 v[40:43], v[228:231], v[192:195], v[40:43]
    ds_read_b64_tr_b16 v[224:225], v246 offset:49216
    v_mfma_f32_16x16x32_bf16 v[88:91], v[228:231], v[196:199], v[88:91]
    ds_read_b64_tr_b16 v[226:227], v246 offset:49984
    v_mfma_f32_16x16x32_bf16 v[136:139], v[228:231], v[200:203], v[136:139]
    ds_read_b128 v[216:219], v245 offset:12288
    v_mfma_f32_16x16x32_bf16 v[184:187], v[228:231], v[204:207], v[184:187]
    s_waitcnt lgkmcnt(9)
    v_mfma_f32_16x16x32_bf16 v[44:47], v[232:235], v[192:195], v[44:47]
    ds_read_b64_tr_b16 v[228:229], v247 offset:49248
    v_mfma_f32_16x16x32_bf16 v[92:95], v[232:235], v[196:199], v[92:95]
    ds_read_b64_tr_b16 v[230:231], v247 offset:50016
    v_mfma_f32_16x16x32_bf16 v[140:143], v[232:235], v[200:203], v[140:143]
    ds_read_b128 v[220:223], v245 offset:14336
    v_mfma_f32_16x16x32_bf16 v[188:191], v[232:235], v[204:207], v[188:191]
    s_waitcnt lgkmcnt(9)
    v_mfma_f32_16x16x32_bf16 v[0:3], v[236:239], v[208:211], v[0:3]
    ds_read_b64_tr_b16 v[232:233], v246 offset:49280
    s_waitcnt lgkmcnt(7)
    v_mfma_f32_16x16x32_bf16 v[48:51], v[236:239], v[212:215], v[48:51]
    ds_read_b64_tr_b16 v[234:235], v246 offset:50048
    s_waitcnt lgkmcnt(5)
    v_mfma_f32_16x16x32_bf16 v[96:99], v[236:239], v[216:219], v[96:99]
    s_waitcnt lgkmcnt(2)
    v_mfma_f32_16x16x32_bf16 v[144:147], v[236:239], v[220:223], v[144:147]
    v_mfma_f32_16x16x32_bf16 v[4:7], v[240:243], v[208:211], v[4:7]
    ds_read_b64_tr_b16 v[236:237], v247 offset:49312
    v_mfma_f32_16x16x32_bf16 v[52:55], v[240:243], v[212:215], v[52:55]
    ds_read_b64_tr_b16 v[238:239], v247 offset:50080
    v_mfma_f32_16x16x32_bf16 v[100:103], v[240:243], v[216:219], v[100:103]
    v_mfma_f32_16x16x32_bf16 v[148:151], v[240:243], v[220:223], v[148:151]
    v_mfma_f32_16x16x32_bf16 v[8:11], v[224:227], v[208:211], v[8:11]
    ds_read_b64_tr_b16 v[240:241], v246 offset:55296
    v_mfma_f32_16x16x32_bf16 v[56:59], v[224:227], v[212:215], v[56:59]
    ds_read_b64_tr_b16 v[242:243], v246 offset:56064
    v_mfma_f32_16x16x32_bf16 v[104:107], v[224:227], v[216:219], v[104:107]
    v_mfma_f32_16x16x32_bf16 v[152:155], v[224:227], v[220:223], v[152:155]
    v_mfma_f32_16x16x32_bf16 v[12:15], v[228:231], v[208:211], v[12:15]
    ds_read_b64_tr_b16 v[224:225], v247 offset:55328
    v_mfma_f32_16x16x32_bf16 v[60:63], v[228:231], v[212:215], v[60:63]
    ds_read_b64_tr_b16 v[226:227], v247 offset:56096
    v_mfma_f32_16x16x32_bf16 v[108:111], v[228:231], v[216:219], v[108:111]
    v_mfma_f32_16x16x32_bf16 v[156:159], v[228:231], v[220:223], v[156:159]
    s_waitcnt lgkmcnt(6)
    v_mfma_f32_16x16x32_bf16 v[16:19], v[232:235], v[208:211], v[16:19]
    ds_read_b64_tr_b16 v[228:229], v246 offset:55360
    v_mfma_f32_16x16x32_bf16 v[64:67], v[232:235], v[212:215], v[64:67]
    ds_read_b64_tr_b16 v[230:231], v246 offset:56128
    v_mfma_f32_16x16x32_bf16 v[112:115], v[232:235], v[216:219], v[112:115]
    v_mfma_f32_16x16x32_bf16 v[160:163], v[232:235], v[220:223], v[160:163]
    s_waitcnt lgkmcnt(6)
    v_mfma_f32_16x16x32_bf16 v[20:23], v[236:239], v[208:211], v[20:23]
    ds_read_b64_tr_b16 v[232:233], v247 offset:55392
    v_mfma_f32_16x16x32_bf16 v[68:71], v[236:239], v[212:215], v[68:71]
    ds_read_b64_tr_b16 v[234:235], v247 offset:56160
    v_mfma_f32_16x16x32_bf16 v[116:119], v[236:239], v[216:219], v[116:119]
    v_mfma_f32_16x16x32_bf16 v[164:167], v[236:239], v[220:223], v[164:167]
    s_waitcnt lgkmcnt(6)
    v_mfma_f32_16x16x32_bf16 v[24:27], v[240:243], v[208:211], v[24:27]
    ds_read_b64_tr_b16 v[236:237], v246 offset:55424
    v_mfma_f32_16x16x32_bf16 v[72:75], v[240:243], v[212:215], v[72:75]
    ds_read_b64_tr_b16 v[238:239], v246 offset:56192
    v_mfma_f32_16x16x32_bf16 v[120:123], v[240:243], v[216:219], v[120:123]
    v_mfma_f32_16x16x32_bf16 v[168:171], v[240:243], v[220:223], v[168:171]
    s_waitcnt lgkmcnt(6)
    v_mfma_f32_16x16x32_bf16 v[28:31], v[224:227], v[208:211], v[28:31]
    ds_read_b64_tr_b16 v[240:241], v247 offset:55456
    v_mfma_f32_16x16x32_bf16 v[76:79], v[224:227], v[212:215], v[76:79]
    ds_read_b64_tr_b16 v[242:243], v247 offset:56224
    v_mfma_f32_16x16x32_bf16 v[124:127], v[224:227], v[216:219], v[124:127]
    v_mfma_f32_16x16x32_bf16 v[172:175], v[224:227], v[220:223], v[172:175]
    s_waitcnt lgkmcnt(6)
    v_mfma_f32_16x16x32_bf16 v[32:35], v[228:231], v[208:211], v[32:35]
    s_barrier
    ds_read_b64_tr_b16 v[224:225], v246 offset:0
    v_mfma_f32_16x16x32_bf16 v[80:83], v[228:231], v[212:215], v[80:83]
    ds_read_b64_tr_b16 v[226:227], v246 offset:768
    v_mfma_f32_16x16x32_bf16 v[128:131], v[228:231], v[216:219], v[128:131]
    ds_read_b128 v[192:195], v244 offset:16384
    v_mfma_f32_16x16x32_bf16 v[176:179], v[228:231], v[220:223], v[176:179]
    s_waitcnt lgkmcnt(7)
    v_mfma_f32_16x16x32_bf16 v[36:39], v[232:235], v[208:211], v[36:39]
    ds_read_b64_tr_b16 v[228:229], v247 offset:32
    v_mfma_f32_16x16x32_bf16 v[84:87], v[232:235], v[212:215], v[84:87]
    ds_read_b64_tr_b16 v[230:231], v247 offset:800
    v_mfma_f32_16x16x32_bf16 v[132:135], v[232:235], v[216:219], v[132:135]
    ds_read_b128 v[196:199], v244 offset:18432
    v_mfma_f32_16x16x32_bf16 v[180:183], v[232:235], v[220:223], v[180:183]
    s_waitcnt lgkmcnt(8)
    v_mfma_f32_16x16x32_bf16 v[40:43], v[236:239], v[208:211], v[40:43]
    ds_read_b64_tr_b16 v[232:233], v246 offset:64
    v_mfma_f32_16x16x32_bf16 v[88:91], v[236:239], v[212:215], v[88:91]
    ds_read_b64_tr_b16 v[234:235], v246 offset:832
    v_mfma_f32_16x16x32_bf16 v[136:139], v[236:239], v[216:219], v[136:139]
    ds_read_b128 v[200:203], v244 offset:20480
    v_mfma_f32_16x16x32_bf16 v[184:187], v[236:239], v[220:223], v[184:187]
    s_waitcnt lgkmcnt(9)
    v_mfma_f32_16x16x32_bf16 v[44:47], v[240:243], v[208:211], v[44:47]
    ds_read_b64_tr_b16 v[236:237], v247 offset:96
    v_mfma_f32_16x16x32_bf16 v[92:95], v[240:243], v[212:215], v[92:95]
    ds_read_b64_tr_b16 v[238:239], v247 offset:864
    v_mfma_f32_16x16x32_bf16 v[140:143], v[240:243], v[216:219], v[140:143]
    ds_read_b128 v[204:207], v244 offset:22528
    v_mfma_f32_16x16x32_bf16 v[188:191], v[240:243], v[220:223], v[188:191]
    s_waitcnt lgkmcnt(9)
    v_mfma_f32_16x16x32_bf16 v[0:3], v[224:227], v[192:195], v[0:3]
    ds_read_b64_tr_b16 v[240:241], v246 offset:128
    s_waitcnt lgkmcnt(7)
    v_mfma_f32_16x16x32_bf16 v[48:51], v[224:227], v[196:199], v[48:51]
    ds_read_b64_tr_b16 v[242:243], v246 offset:896
    s_waitcnt lgkmcnt(5)
    v_mfma_f32_16x16x32_bf16 v[96:99], v[224:227], v[200:203], v[96:99]
    s_waitcnt lgkmcnt(2)
    v_mfma_f32_16x16x32_bf16 v[144:147], v[224:227], v[204:207], v[144:147]
    v_mfma_f32_16x16x32_bf16 v[4:7], v[228:231], v[192:195], v[4:7]
    ds_read_b64_tr_b16 v[224:225], v247 offset:160
    v_mfma_f32_16x16x32_bf16 v[52:55], v[228:231], v[196:199], v[52:55]
    ds_read_b64_tr_b16 v[226:227], v247 offset:928
    v_mfma_f32_16x16x32_bf16 v[100:103], v[228:231], v[200:203], v[100:103]
    v_mfma_f32_16x16x32_bf16 v[148:151], v[228:231], v[204:207], v[148:151]
    v_mfma_f32_16x16x32_bf16 v[8:11], v[232:235], v[192:195], v[8:11]
    ds_read_b64_tr_b16 v[228:229], v246 offset:6144
    v_mfma_f32_16x16x32_bf16 v[56:59], v[232:235], v[196:199], v[56:59]
    ds_read_b64_tr_b16 v[230:231], v246 offset:6912
    v_mfma_f32_16x16x32_bf16 v[104:107], v[232:235], v[200:203], v[104:107]
    v_mfma_f32_16x16x32_bf16 v[152:155], v[232:235], v[204:207], v[152:155]
    v_mfma_f32_16x16x32_bf16 v[12:15], v[236:239], v[192:195], v[12:15]
    ds_read_b64_tr_b16 v[232:233], v247 offset:6176
    v_mfma_f32_16x16x32_bf16 v[60:63], v[236:239], v[196:199], v[60:63]
    ds_read_b64_tr_b16 v[234:235], v247 offset:6944
    v_mfma_f32_16x16x32_bf16 v[108:111], v[236:239], v[200:203], v[108:111]
    v_mfma_f32_16x16x32_bf16 v[156:159], v[236:239], v[204:207], v[156:159]
    s_waitcnt lgkmcnt(6)
    v_mfma_f32_16x16x32_bf16 v[16:19], v[240:243], v[192:195], v[16:19]
    ds_read_b64_tr_b16 v[236:237], v246 offset:6208
    v_mfma_f32_16x16x32_bf16 v[64:67], v[240:243], v[196:199], v[64:67]
    ds_read_b64_tr_b16 v[238:239], v246 offset:6976
    v_mfma_f32_16x16x32_bf16 v[112:115], v[240:243], v[200:203], v[112:115]
    v_mfma_f32_16x16x32_bf16 v[160:163], v[240:243], v[204:207], v[160:163]
    s_waitcnt lgkmcnt(6)
    v_mfma_f32_16x16x32_bf16 v[20:23], v[224:227], v[192:195], v[20:23]
    ds_read_b64_tr_b16 v[240:241], v247 offset:6240
    v_mfma_f32_16x16x32_bf16 v[68:71], v[224:227], v[196:199], v[68:71]
    ds_read_b64_tr_b16 v[242:243], v247 offset:7008
    v_mfma_f32_16x16x32_bf16 v[116:119], v[224:227], v[200:203], v[116:119]
    v_mfma_f32_16x16x32_bf16 v[164:167], v[224:227], v[204:207], v[164:167]
    s_waitcnt lgkmcnt(6)
    v_mfma_f32_16x16x32_bf16 v[24:27], v[228:231], v[192:195], v[24:27]
    ds_read_b64_tr_b16 v[224:225], v246 offset:6272
    v_mfma_f32_16x16x32_bf16 v[72:75], v[228:231], v[196:199], v[72:75]
    ds_read_b64_tr_b16 v[226:227], v246 offset:7040
    v_mfma_f32_16x16x32_bf16 v[120:123], v[228:231], v[200:203], v[120:123]
    v_mfma_f32_16x16x32_bf16 v[168:171], v[228:231], v[204:207], v[168:171]
    s_waitcnt lgkmcnt(6)
    v_mfma_f32_16x16x32_bf16 v[28:31], v[232:235], v[192:195], v[28:31]
    ds_read_b64_tr_b16 v[228:229], v247 offset:6304
    v_mfma_f32_16x16x32_bf16 v[76:79], v[232:235], v[196:199], v[76:79]
    ds_read_b64_tr_b16 v[230:231], v247 offset:7072
    v_mfma_f32_16x16x32_bf16 v[124:127], v[232:235], v[200:203], v[124:127]
    v_mfma_f32_16x16x32_bf16 v[172:175], v[232:235], v[204:207], v[172:175]
    s_waitcnt lgkmcnt(6)
    v_mfma_f32_16x16x32_bf16 v[32:35], v[236:239], v[192:195], v[32:35]
    s_barrier
    ds_read_b64_tr_b16 v[232:233], v246 offset:12288
    v_mfma_f32_16x16x32_bf16 v[80:83], v[236:239], v[196:199], v[80:83]
    ds_read_b64_tr_b16 v[234:235], v246 offset:13056
    v_mfma_f32_16x16x32_bf16 v[128:131], v[236:239], v[200:203], v[128:131]
    ds_read_b128 v[208:211], v245 offset:16384
    v_mfma_f32_16x16x32_bf16 v[176:179], v[236:239], v[204:207], v[176:179]
    s_waitcnt lgkmcnt(7)
    v_mfma_f32_16x16x32_bf16 v[36:39], v[240:243], v[192:195], v[36:39]
    ds_read_b64_tr_b16 v[236:237], v247 offset:12320
    v_mfma_f32_16x16x32_bf16 v[84:87], v[240:243], v[196:199], v[84:87]
    ds_read_b64_tr_b16 v[238:239], v247 offset:13088
    v_mfma_f32_16x16x32_bf16 v[132:135], v[240:243], v[200:203], v[132:135]
    ds_read_b128 v[212:215], v245 offset:18432
    v_mfma_f32_16x16x32_bf16 v[180:183], v[240:243], v[204:207], v[180:183]
    s_waitcnt lgkmcnt(8)
    v_mfma_f32_16x16x32_bf16 v[40:43], v[224:227], v[192:195], v[40:43]
    ds_read_b64_tr_b16 v[240:241], v246 offset:12352
    v_mfma_f32_16x16x32_bf16 v[88:91], v[224:227], v[196:199], v[88:91]
    ds_read_b64_tr_b16 v[242:243], v246 offset:13120
    v_mfma_f32_16x16x32_bf16 v[136:139], v[224:227], v[200:203], v[136:139]
    ds_read_b128 v[216:219], v245 offset:20480
    v_mfma_f32_16x16x32_bf16 v[184:187], v[224:227], v[204:207], v[184:187]
    s_waitcnt lgkmcnt(9)
    v_mfma_f32_16x16x32_bf16 v[44:47], v[228:231], v[192:195], v[44:47]
    ds_read_b64_tr_b16 v[224:225], v247 offset:12384
    v_mfma_f32_16x16x32_bf16 v[92:95], v[228:231], v[196:199], v[92:95]
    ds_read_b64_tr_b16 v[226:227], v247 offset:13152
    v_mfma_f32_16x16x32_bf16 v[140:143], v[228:231], v[200:203], v[140:143]
    ds_read_b128 v[220:223], v245 offset:22528
    v_mfma_f32_16x16x32_bf16 v[188:191], v[228:231], v[204:207], v[188:191]
    s_waitcnt lgkmcnt(9)
    v_mfma_f32_16x16x32_bf16 v[0:3], v[232:235], v[208:211], v[0:3]
    ds_read_b64_tr_b16 v[228:229], v246 offset:12416
    s_waitcnt lgkmcnt(7)
    v_mfma_f32_16x16x32_bf16 v[48:51], v[232:235], v[212:215], v[48:51]
    ds_read_b64_tr_b16 v[230:231], v246 offset:13184
    s_waitcnt lgkmcnt(5)
    v_mfma_f32_16x16x32_bf16 v[96:99], v[232:235], v[216:219], v[96:99]
    s_waitcnt lgkmcnt(2)
    v_mfma_f32_16x16x32_bf16 v[144:147], v[232:235], v[220:223], v[144:147]
    v_mfma_f32_16x16x32_bf16 v[4:7], v[236:239], v[208:211], v[4:7]
    ds_read_b64_tr_b16 v[232:233], v247 offset:12448
    v_mfma_f32_16x16x32_bf16 v[52:55], v[236:239], v[212:215], v[52:55]
    ds_read_b64_tr_b16 v[234:235], v247 offset:13216
    v_mfma_f32_16x16x32_bf16 v[100:103], v[236:239], v[216:219], v[100:103]
    v_mfma_f32_16x16x32_bf16 v[148:151], v[236:239], v[220:223], v[148:151]
    v_mfma_f32_16x16x32_bf16 v[8:11], v[240:243], v[208:211], v[8:11]
    ds_read_b64_tr_b16 v[236:237], v246 offset:18432
    v_mfma_f32_16x16x32_bf16 v[56:59], v[240:243], v[212:215], v[56:59]
    ds_read_b64_tr_b16 v[238:239], v246 offset:19200
    v_mfma_f32_16x16x32_bf16 v[104:107], v[240:243], v[216:219], v[104:107]
    v_mfma_f32_16x16x32_bf16 v[152:155], v[240:243], v[220:223], v[152:155]
    v_mfma_f32_16x16x32_bf16 v[12:15], v[224:227], v[208:211], v[12:15]
    ds_read_b64_tr_b16 v[240:241], v247 offset:18464
    v_mfma_f32_16x16x32_bf16 v[60:63], v[224:227], v[212:215], v[60:63]
    ds_read_b64_tr_b16 v[242:243], v247 offset:19232
    v_mfma_f32_16x16x32_bf16 v[108:111], v[224:227], v[216:219], v[108:111]
    v_mfma_f32_16x16x32_bf16 v[156:159], v[224:227], v[220:223], v[156:159]
    s_waitcnt lgkmcnt(6)
    v_mfma_f32_16x16x32_bf16 v[16:19], v[228:231], v[208:211], v[16:19]
    ds_read_b64_tr_b16 v[224:225], v246 offset:18496
    v_mfma_f32_16x16x32_bf16 v[64:67], v[228:231], v[212:215], v[64:67]
    ds_read_b64_tr_b16 v[226:227], v246 offset:19264
    v_mfma_f32_16x16x32_bf16 v[112:115], v[228:231], v[216:219], v[112:115]
    v_mfma_f32_16x16x32_bf16 v[160:163], v[228:231], v[220:223], v[160:163]
    s_waitcnt lgkmcnt(6)
    v_mfma_f32_16x16x32_bf16 v[20:23], v[232:235], v[208:211], v[20:23]
    ds_read_b64_tr_b16 v[228:229], v247 offset:18528
    v_mfma_f32_16x16x32_bf16 v[68:71], v[232:235], v[212:215], v[68:71]
    ds_read_b64_tr_b16 v[230:231], v247 offset:19296
    v_mfma_f32_16x16x32_bf16 v[116:119], v[232:235], v[216:219], v[116:119]
    v_mfma_f32_16x16x32_bf16 v[164:167], v[232:235], v[220:223], v[164:167]
    s_waitcnt lgkmcnt(6)
    v_mfma_f32_16x16x32_bf16 v[24:27], v[236:239], v[208:211], v[24:27]
    ds_read_b64_tr_b16 v[232:233], v246 offset:18560
    v_mfma_f32_16x16x32_bf16 v[72:75], v[236:239], v[212:215], v[72:75]
    ds_read_b64_tr_b16 v[234:235], v246 offset:19328
    v_mfma_f32_16x16x32_bf16 v[120:123], v[236:239], v[216:219], v[120:123]
    v_mfma_f32_16x16x32_bf16 v[168:171], v[236:239], v[220:223], v[168:171]
    s_waitcnt lgkmcnt(6)
    v_mfma_f32_16x16x32_bf16 v[28:31], v[240:243], v[208:211], v[28:31]
    ds_read_b64_tr_b16 v[236:237], v247 offset:18592
    v_mfma_f32_16x16x32_bf16 v[76:79], v[240:243], v[212:215], v[76:79]
    ds_read_b64_tr_b16 v[238:239], v247 offset:19360
    v_mfma_f32_16x16x32_bf16 v[124:127], v[240:243], v[216:219], v[124:127]
    v_mfma_f32_16x16x32_bf16 v[172:175], v[240:243], v[220:223], v[172:175]
    s_waitcnt lgkmcnt(6)
    v_mfma_f32_16x16x32_bf16 v[32:35], v[224:227], v[208:211], v[32:35]
    s_barrier
    ds_read_b64_tr_b16 v[240:241], v246 offset:24576
    v_mfma_f32_16x16x32_bf16 v[80:83], v[224:227], v[212:215], v[80:83]
    ds_read_b64_tr_b16 v[242:243], v246 offset:25344
    v_mfma_f32_16x16x32_bf16 v[128:131], v[224:227], v[216:219], v[128:131]
    ds_read_b128 v[192:195], v244 offset:0
    v_mfma_f32_16x16x32_bf16 v[176:179], v[224:227], v[220:223], v[176:179]
    s_waitcnt lgkmcnt(7)
    v_mfma_f32_16x16x32_bf16 v[36:39], v[228:231], v[208:211], v[36:39]
    ds_read_b64_tr_b16 v[224:225], v247 offset:24608
    v_mfma_f32_16x16x32_bf16 v[84:87], v[228:231], v[212:215], v[84:87]
    ds_read_b64_tr_b16 v[226:227], v247 offset:25376
    v_mfma_f32_16x16x32_bf16 v[132:135], v[228:231], v[216:219], v[132:135]
    ds_read_b128 v[196:199], v244 offset:2048
    v_mfma_f32_16x16x32_bf16 v[180:183], v[228:231], v[220:223], v[180:183]
    s_waitcnt lgkmcnt(8)
    v_mfma_f32_16x16x32_bf16 v[40:43], v[232:235], v[208:211], v[40:43]
    ds_read_b64_tr_b16 v[228:229], v246 offset:24640
    v_mfma_f32_16x16x32_bf16 v[88:91], v[232:235], v[212:215], v[88:91]
    ds_read_b64_tr_b16 v[230:231], v246 offset:25408
    v_mfma_f32_16x16x32_bf16 v[136:139], v[232:235], v[216:219], v[136:139]
    ds_read_b128 v[200:203], v244 offset:4096
    v_mfma_f32_16x16x32_bf16 v[184:187], v[232:235], v[220:223], v[184:187]
    s_waitcnt lgkmcnt(9)
    v_mfma_f32_16x16x32_bf16 v[44:47], v[236:239], v[208:211], v[44:47]
    ds_read_b64_tr_b16 v[232:233], v247 offset:24672
    v_mfma_f32_16x16x32_bf16 v[92:95], v[236:239], v[212:215], v[92:95]
    ds_read_b64_tr_b16 v[234:235], v247 offset:25440
    v_mfma_f32_16x16x32_bf16 v[140:143], v[236:239], v[216:219], v[140:143]
    ds_read_b128 v[204:207], v244 offset:6144
    v_mfma_f32_16x16x32_bf16 v[188:191], v[236:239], v[220:223], v[188:191]
    s_waitcnt lgkmcnt(9)
    v_mfma_f32_16x16x32_bf16 v[0:3], v[240:243], v[192:195], v[0:3]
    ds_read_b64_tr_b16 v[236:237], v246 offset:24704
    s_waitcnt lgkmcnt(7)
    v_mfma_f32_16x16x32_bf16 v[48:51], v[240:243], v[196:199], v[48:51]
    ds_read_b64_tr_b16 v[238:239], v246 offset:25472
    s_waitcnt lgkmcnt(5)
    v_mfma_f32_16x16x32_bf16 v[96:99], v[240:243], v[200:203], v[96:99]
    s_waitcnt lgkmcnt(2)
    v_mfma_f32_16x16x32_bf16 v[144:147], v[240:243], v[204:207], v[144:147]
    v_mfma_f32_16x16x32_bf16 v[4:7], v[224:227], v[192:195], v[4:7]
    ds_read_b64_tr_b16 v[240:241], v247 offset:24736
    v_mfma_f32_16x16x32_bf16 v[52:55], v[224:227], v[196:199], v[52:55]
    ds_read_b64_tr_b16 v[242:243], v247 offset:25504
    v_mfma_f32_16x16x32_bf16 v[100:103], v[224:227], v[200:203], v[100:103]
    v_mfma_f32_16x16x32_bf16 v[148:151], v[224:227], v[204:207], v[148:151]
    v_mfma_f32_16x16x32_bf16 v[8:11], v[228:231], v[192:195], v[8:11]
    ds_read_b64_tr_b16 v[224:225], v246 offset:30720
    v_mfma_f32_16x16x32_bf16 v[56:59], v[228:231], v[196:199], v[56:59]
    ds_read_b64_tr_b16 v[226:227], v246 offset:31488
    v_mfma_f32_16x16x32_bf16 v[104:107], v[228:231], v[200:203], v[104:107]
    v_mfma_f32_16x16x32_bf16 v[152:155], v[228:231], v[204:207], v[152:155]
    v_mfma_f32_16x16x32_bf16 v[12:15], v[232:235], v[192:195], v[12:15]
    ds_read_b64_tr_b16 v[228:229], v247 offset:30752
    v_mfma_f32_16x16x32_bf16 v[60:63], v[232:235], v[196:199], v[60:63]
    ds_read_b64_tr_b16 v[230:231], v247 offset:31520
    v_mfma_f32_16x16x32_bf16 v[108:111], v[232:235], v[200:203], v[108:111]
    v_mfma_f32_16x16x32_bf16 v[156:159], v[232:235], v[204:207], v[156:159]
    s_waitcnt lgkmcnt(6)
    v_mfma_f32_16x16x32_bf16 v[16:19], v[236:239], v[192:195], v[16:19]
    ds_read_b64_tr_b16 v[232:233], v246 offset:30784
    v_mfma_f32_16x16x32_bf16 v[64:67], v[236:239], v[196:199], v[64:67]
    ds_read_b64_tr_b16 v[234:235], v246 offset:31552
    v_mfma_f32_16x16x32_bf16 v[112:115], v[236:239], v[200:203], v[112:115]
    v_mfma_f32_16x16x32_bf16 v[160:163], v[236:239], v[204:207], v[160:163]
    s_waitcnt lgkmcnt(6)
    v_mfma_f32_16x16x32_bf16 v[20:23], v[240:243], v[192:195], v[20:23]
    ds_read_b64_tr_b16 v[236:237], v247 offset:30816
    v_mfma_f32_16x16x32_bf16 v[68:71], v[240:243], v[196:199], v[68:71]
    ds_read_b64_tr_b16 v[238:239], v247 offset:31584
    v_mfma_f32_16x16x32_bf16 v[116:119], v[240:243], v[200:203], v[116:119]
    v_mfma_f32_16x16x32_bf16 v[164:167], v[240:243], v[204:207], v[164:167]
    s_waitcnt lgkmcnt(6)
    v_mfma_f32_16x16x32_bf16 v[24:27], v[224:227], v[192:195], v[24:27]
    ds_read_b64_tr_b16 v[240:241], v246 offset:30848
    v_mfma_f32_16x16x32_bf16 v[72:75], v[224:227], v[196:199], v[72:75]
    ds_read_b64_tr_b16 v[242:243], v246 offset:31616
    v_mfma_f32_16x16x32_bf16 v[120:123], v[224:227], v[200:203], v[120:123]
    v_mfma_f32_16x16x32_bf16 v[168:171], v[224:227], v[204:207], v[168:171]
    s_waitcnt lgkmcnt(6)
    v_mfma_f32_16x16x32_bf16 v[28:31], v[228:231], v[192:195], v[28:31]
    ds_read_b64_tr_b16 v[224:225], v247 offset:30880
    v_mfma_f32_16x16x32_bf16 v[76:79], v[228:231], v[196:199], v[76:79]
    ds_read_b64_tr_b16 v[226:227], v247 offset:31648
    v_mfma_f32_16x16x32_bf16 v[124:127], v[228:231], v[200:203], v[124:127]
    v_mfma_f32_16x16x32_bf16 v[172:175], v[228:231], v[204:207], v[172:175]
    s_waitcnt lgkmcnt(6)
    v_mfma_f32_16x16x32_bf16 v[32:35], v[232:235], v[192:195], v[32:35]
    s_barrier
    ds_read_b64_tr_b16 v[228:229], v246 offset:36864
    v_mfma_f32_16x16x32_bf16 v[80:83], v[232:235], v[196:199], v[80:83]
    ds_read_b64_tr_b16 v[230:231], v246 offset:37632
    v_mfma_f32_16x16x32_bf16 v[128:131], v[232:235], v[200:203], v[128:131]
    ds_read_b128 v[208:211], v245 offset:0
    v_mfma_f32_16x16x32_bf16 v[176:179], v[232:235], v[204:207], v[176:179]
    s_waitcnt lgkmcnt(7)
    v_mfma_f32_16x16x32_bf16 v[36:39], v[236:239], v[192:195], v[36:39]
    ds_read_b64_tr_b16 v[232:233], v247 offset:36896
    v_mfma_f32_16x16x32_bf16 v[84:87], v[236:239], v[196:199], v[84:87]
    ds_read_b64_tr_b16 v[234:235], v247 offset:37664
    v_mfma_f32_16x16x32_bf16 v[132:135], v[236:239], v[200:203], v[132:135]
    ds_read_b128 v[212:215], v245 offset:2048
    v_mfma_f32_16x16x32_bf16 v[180:183], v[236:239], v[204:207], v[180:183]
    s_waitcnt lgkmcnt(8)
    v_mfma_f32_16x16x32_bf16 v[40:43], v[240:243], v[192:195], v[40:43]
    ds_read_b64_tr_b16 v[236:237], v246 offset:36928
    v_mfma_f32_16x16x32_bf16 v[88:91], v[240:243], v[196:199], v[88:91]
    ds_read_b64_tr_b16 v[238:239], v246 offset:37696
    v_mfma_f32_16x16x32_bf16 v[136:139], v[240:243], v[200:203], v[136:139]
    ds_read_b128 v[216:219], v245 offset:4096
    v_mfma_f32_16x16x32_bf16 v[184:187], v[240:243], v[204:207], v[184:187]
    s_waitcnt lgkmcnt(9)
    v_mfma_f32_16x16x32_bf16 v[44:47], v[224:227], v[192:195], v[44:47]
    ds_read_b64_tr_b16 v[240:241], v247 offset:36960
    v_mfma_f32_16x16x32_bf16 v[92:95], v[224:227], v[196:199], v[92:95]
    ds_read_b64_tr_b16 v[242:243], v247 offset:37728
    v_mfma_f32_16x16x32_bf16 v[140:143], v[224:227], v[200:203], v[140:143]
    ds_read_b128 v[220:223], v245 offset:6144
    v_mfma_f32_16x16x32_bf16 v[188:191], v[224:227], v[204:207], v[188:191]
    s_waitcnt lgkmcnt(9)
    v_mfma_f32_16x16x32_bf16 v[0:3], v[228:231], v[208:211], v[0:3]
    ds_read_b64_tr_b16 v[224:225], v246 offset:36992
    s_waitcnt lgkmcnt(7)
    v_mfma_f32_16x16x32_bf16 v[48:51], v[228:231], v[212:215], v[48:51]
    ds_read_b64_tr_b16 v[226:227], v246 offset:37760
    s_waitcnt lgkmcnt(5)
    v_mfma_f32_16x16x32_bf16 v[96:99], v[228:231], v[216:219], v[96:99]
    s_waitcnt lgkmcnt(2)
    v_mfma_f32_16x16x32_bf16 v[144:147], v[228:231], v[220:223], v[144:147]
    v_mfma_f32_16x16x32_bf16 v[4:7], v[232:235], v[208:211], v[4:7]
    ds_read_b64_tr_b16 v[228:229], v247 offset:37024
    v_mfma_f32_16x16x32_bf16 v[52:55], v[232:235], v[212:215], v[52:55]
    ds_read_b64_tr_b16 v[230:231], v247 offset:37792
    v_mfma_f32_16x16x32_bf16 v[100:103], v[232:235], v[216:219], v[100:103]
    v_mfma_f32_16x16x32_bf16 v[148:151], v[232:235], v[220:223], v[148:151]
    v_mfma_f32_16x16x32_bf16 v[8:11], v[236:239], v[208:211], v[8:11]
    ds_read_b64_tr_b16 v[232:233], v246 offset:43008
    v_mfma_f32_16x16x32_bf16 v[56:59], v[236:239], v[212:215], v[56:59]
    ds_read_b64_tr_b16 v[234:235], v246 offset:43776
    v_mfma_f32_16x16x32_bf16 v[104:107], v[236:239], v[216:219], v[104:107]
    v_mfma_f32_16x16x32_bf16 v[152:155], v[236:239], v[220:223], v[152:155]
    v_mfma_f32_16x16x32_bf16 v[12:15], v[240:243], v[208:211], v[12:15]
    ds_read_b64_tr_b16 v[236:237], v247 offset:43040
    v_mfma_f32_16x16x32_bf16 v[60:63], v[240:243], v[212:215], v[60:63]
    ds_read_b64_tr_b16 v[238:239], v247 offset:43808
    v_mfma_f32_16x16x32_bf16 v[108:111], v[240:243], v[216:219], v[108:111]
    v_mfma_f32_16x16x32_bf16 v[156:159], v[240:243], v[220:223], v[156:159]
    s_waitcnt lgkmcnt(6)
    v_mfma_f32_16x16x32_bf16 v[16:19], v[224:227], v[208:211], v[16:19]
    ds_read_b64_tr_b16 v[240:241], v246 offset:43072
    v_mfma_f32_16x16x32_bf16 v[64:67], v[224:227], v[212:215], v[64:67]
    ds_read_b64_tr_b16 v[242:243], v246 offset:43840
    v_mfma_f32_16x16x32_bf16 v[112:115], v[224:227], v[216:219], v[112:115]
    v_mfma_f32_16x16x32_bf16 v[160:163], v[224:227], v[220:223], v[160:163]
    s_waitcnt lgkmcnt(6)
    v_mfma_f32_16x16x32_bf16 v[20:23], v[228:231], v[208:211], v[20:23]
    ds_read_b64_tr_b16 v[224:225], v247 offset:43104
    v_mfma_f32_16x16x32_bf16 v[68:71], v[228:231], v[212:215], v[68:71]
    ds_read_b64_tr_b16 v[226:227], v247 offset:43872
    v_mfma_f32_16x16x32_bf16 v[116:119], v[228:231], v[216:219], v[116:119]
    v_mfma_f32_16x16x32_bf16 v[164:167], v[228:231], v[220:223], v[164:167]
    s_waitcnt lgkmcnt(6)
    v_mfma_f32_16x16x32_bf16 v[24:27], v[232:235], v[208:211], v[24:27]
    ds_read_b64_tr_b16 v[228:229], v246 offset:43136
    v_mfma_f32_16x16x32_bf16 v[72:75], v[232:235], v[212:215], v[72:75]
    ds_read_b64_tr_b16 v[230:231], v246 offset:43904
    v_mfma_f32_16x16x32_bf16 v[120:123], v[232:235], v[216:219], v[120:123]
    v_mfma_f32_16x16x32_bf16 v[168:171], v[232:235], v[220:223], v[168:171]
    s_waitcnt lgkmcnt(6)
    v_mfma_f32_16x16x32_bf16 v[28:31], v[236:239], v[208:211], v[28:31]
    ds_read_b64_tr_b16 v[232:233], v247 offset:43168
    v_mfma_f32_16x16x32_bf16 v[76:79], v[236:239], v[212:215], v[76:79]
    ds_read_b64_tr_b16 v[234:235], v247 offset:43936
    v_mfma_f32_16x16x32_bf16 v[124:127], v[236:239], v[216:219], v[124:127]
    v_mfma_f32_16x16x32_bf16 v[172:175], v[236:239], v[220:223], v[172:175]
    s_waitcnt lgkmcnt(6)
    v_mfma_f32_16x16x32_bf16 v[32:35], v[240:243], v[208:211], v[32:35]
    s_barrier
    ds_read_b64_tr_b16 v[236:237], v246 offset:49152
    v_mfma_f32_16x16x32_bf16 v[80:83], v[240:243], v[212:215], v[80:83]
    ds_read_b64_tr_b16 v[238:239], v246 offset:49920
    v_mfma_f32_16x16x32_bf16 v[128:131], v[240:243], v[216:219], v[128:131]
    ds_read_b128 v[192:195], v244 offset:8192
    v_mfma_f32_16x16x32_bf16 v[176:179], v[240:243], v[220:223], v[176:179]
    s_waitcnt lgkmcnt(7)
    v_mfma_f32_16x16x32_bf16 v[36:39], v[224:227], v[208:211], v[36:39]
    ds_read_b64_tr_b16 v[240:241], v247 offset:49184
    v_mfma_f32_16x16x32_bf16 v[84:87], v[224:227], v[212:215], v[84:87]
    ds_read_b64_tr_b16 v[242:243], v247 offset:49952
    v_mfma_f32_16x16x32_bf16 v[132:135], v[224:227], v[216:219], v[132:135]
    ds_read_b128 v[196:199], v244 offset:10240
    v_mfma_f32_16x16x32_bf16 v[180:183], v[224:227], v[220:223], v[180:183]
    s_waitcnt lgkmcnt(8)
    v_mfma_f32_16x16x32_bf16 v[40:43], v[228:231], v[208:211], v[40:43]
    ds_read_b64_tr_b16 v[224:225], v246 offset:49216
    v_mfma_f32_16x16x32_bf16 v[88:91], v[228:231], v[212:215], v[88:91]
    ds_read_b64_tr_b16 v[226:227], v246 offset:49984
    v_mfma_f32_16x16x32_bf16 v[136:139], v[228:231], v[216:219], v[136:139]
    ds_read_b128 v[200:203], v244 offset:12288
    v_mfma_f32_16x16x32_bf16 v[184:187], v[228:231], v[220:223], v[184:187]
    s_waitcnt lgkmcnt(9)
    v_mfma_f32_16x16x32_bf16 v[44:47], v[232:235], v[208:211], v[44:47]
    ds_read_b64_tr_b16 v[228:229], v247 offset:49248
    v_mfma_f32_16x16x32_bf16 v[92:95], v[232:235], v[212:215], v[92:95]
    ds_read_b64_tr_b16 v[230:231], v247 offset:50016
    v_mfma_f32_16x16x32_bf16 v[140:143], v[232:235], v[216:219], v[140:143]
    ds_read_b128 v[204:207], v244 offset:14336
    v_mfma_f32_16x16x32_bf16 v[188:191], v[232:235], v[220:223], v[188:191]
    s_waitcnt lgkmcnt(9)
    v_mfma_f32_16x16x32_bf16 v[0:3], v[236:239], v[192:195], v[0:3]
    ds_read_b64_tr_b16 v[232:233], v246 offset:49280
    s_waitcnt lgkmcnt(7)
    v_mfma_f32_16x16x32_bf16 v[48:51], v[236:239], v[196:199], v[48:51]
    ds_read_b64_tr_b16 v[234:235], v246 offset:50048
    s_waitcnt lgkmcnt(5)
    v_mfma_f32_16x16x32_bf16 v[96:99], v[236:239], v[200:203], v[96:99]
    s_waitcnt lgkmcnt(2)
    v_mfma_f32_16x16x32_bf16 v[144:147], v[236:239], v[204:207], v[144:147]
    v_mfma_f32_16x16x32_bf16 v[4:7], v[240:243], v[192:195], v[4:7]
    ds_read_b64_tr_b16 v[236:237], v247 offset:49312
    v_mfma_f32_16x16x32_bf16 v[52:55], v[240:243], v[196:199], v[52:55]
    ds_read_b64_tr_b16 v[238:239], v247 offset:50080
    v_mfma_f32_16x16x32_bf16 v[100:103], v[240:243], v[200:203], v[100:103]
    v_mfma_f32_16x16x32_bf16 v[148:151], v[240:243], v[204:207], v[148:151]
    v_mfma_f32_16x16x32_bf16 v[8:11], v[224:227], v[192:195], v[8:11]
    ds_read_b64_tr_b16 v[240:241], v246 offset:55296
    v_mfma_f32_16x16x32_bf16 v[56:59], v[224:227], v[196:199], v[56:59]
    ds_read_b64_tr_b16 v[242:243], v246 offset:56064
    v_mfma_f32_16x16x32_bf16 v[104:107], v[224:227], v[200:203], v[104:107]
    v_mfma_f32_16x16x32_bf16 v[152:155], v[224:227], v[204:207], v[152:155]
    v_mfma_f32_16x16x32_bf16 v[12:15], v[228:231], v[192:195], v[12:15]
    ds_read_b64_tr_b16 v[224:225], v247 offset:55328
    v_mfma_f32_16x16x32_bf16 v[60:63], v[228:231], v[196:199], v[60:63]
    ds_read_b64_tr_b16 v[226:227], v247 offset:56096
    v_mfma_f32_16x16x32_bf16 v[108:111], v[228:231], v[200:203], v[108:111]
    v_mfma_f32_16x16x32_bf16 v[156:159], v[228:231], v[204:207], v[156:159]
    s_waitcnt lgkmcnt(6)
    v_mfma_f32_16x16x32_bf16 v[16:19], v[232:235], v[192:195], v[16:19]
    ds_read_b64_tr_b16 v[228:229], v246 offset:55360
    v_mfma_f32_16x16x32_bf16 v[64:67], v[232:235], v[196:199], v[64:67]
    ds_read_b64_tr_b16 v[230:231], v246 offset:56128
    v_mfma_f32_16x16x32_bf16 v[112:115], v[232:235], v[200:203], v[112:115]
    v_mfma_f32_16x16x32_bf16 v[160:163], v[232:235], v[204:207], v[160:163]
    s_waitcnt lgkmcnt(6)
    v_mfma_f32_16x16x32_bf16 v[20:23], v[236:239], v[192:195], v[20:23]
    ds_read_b64_tr_b16 v[232:233], v247 offset:55392
    v_mfma_f32_16x16x32_bf16 v[68:71], v[236:239], v[196:199], v[68:71]
    ds_read_b64_tr_b16 v[234:235], v247 offset:56160
    v_mfma_f32_16x16x32_bf16 v[116:119], v[236:239], v[200:203], v[116:119]
    v_mfma_f32_16x16x32_bf16 v[164:167], v[236:239], v[204:207], v[164:167]
    s_waitcnt lgkmcnt(6)
    v_mfma_f32_16x16x32_bf16 v[24:27], v[240:243], v[192:195], v[24:27]
    ds_read_b64_tr_b16 v[236:237], v246 offset:55424
    v_mfma_f32_16x16x32_bf16 v[72:75], v[240:243], v[196:199], v[72:75]
    ds_read_b64_tr_b16 v[238:239], v246 offset:56192
    v_mfma_f32_16x16x32_bf16 v[120:123], v[240:243], v[200:203], v[120:123]
    v_mfma_f32_16x16x32_bf16 v[168:171], v[240:243], v[204:207], v[168:171]
    s_waitcnt lgkmcnt(6)
    v_mfma_f32_16x16x32_bf16 v[28:31], v[224:227], v[192:195], v[28:31]
    ds_read_b64_tr_b16 v[240:241], v247 offset:55456
    v_mfma_f32_16x16x32_bf16 v[76:79], v[224:227], v[196:199], v[76:79]
    ds_read_b64_tr_b16 v[242:243], v247 offset:56224
    v_mfma_f32_16x16x32_bf16 v[124:127], v[224:227], v[200:203], v[124:127]
    v_mfma_f32_16x16x32_bf16 v[172:175], v[224:227], v[204:207], v[172:175]
    s_waitcnt lgkmcnt(6)
    v_mfma_f32_16x16x32_bf16 v[32:35], v[228:231], v[192:195], v[32:35]
    s_barrier
    ds_read_b64_tr_b16 v[224:225], v246 offset:0
    v_mfma_f32_16x16x32_bf16 v[80:83], v[228:231], v[196:199], v[80:83]
    ds_read_b64_tr_b16 v[226:227], v246 offset:768
    v_mfma_f32_16x16x32_bf16 v[128:131], v[228:231], v[200:203], v[128:131]
    ds_read_b128 v[208:211], v245 offset:8192
    v_mfma_f32_16x16x32_bf16 v[176:179], v[228:231], v[204:207], v[176:179]
    s_waitcnt lgkmcnt(7)
    v_mfma_f32_16x16x32_bf16 v[36:39], v[232:235], v[192:195], v[36:39]
    ds_read_b64_tr_b16 v[228:229], v247 offset:32
    v_mfma_f32_16x16x32_bf16 v[84:87], v[232:235], v[196:199], v[84:87]
    ds_read_b64_tr_b16 v[230:231], v247 offset:800
    v_mfma_f32_16x16x32_bf16 v[132:135], v[232:235], v[200:203], v[132:135]
    ds_read_b128 v[212:215], v245 offset:10240
    v_mfma_f32_16x16x32_bf16 v[180:183], v[232:235], v[204:207], v[180:183]
    s_waitcnt lgkmcnt(8)
    v_mfma_f32_16x16x32_bf16 v[40:43], v[236:239], v[192:195], v[40:43]
    ds_read_b64_tr_b16 v[232:233], v246 offset:64
    v_mfma_f32_16x16x32_bf16 v[88:91], v[236:239], v[196:199], v[88:91]
    ds_read_b64_tr_b16 v[234:235], v246 offset:832
    v_mfma_f32_16x16x32_bf16 v[136:139], v[236:239], v[200:203], v[136:139]
    ds_read_b128 v[216:219], v245 offset:12288
    v_mfma_f32_16x16x32_bf16 v[184:187], v[236:239], v[204:207], v[184:187]
    s_waitcnt lgkmcnt(9)
    v_mfma_f32_16x16x32_bf16 v[44:47], v[240:243], v[192:195], v[44:47]
    ds_read_b64_tr_b16 v[236:237], v247 offset:96
    v_mfma_f32_16x16x32_bf16 v[92:95], v[240:243], v[196:199], v[92:95]
    ds_read_b64_tr_b16 v[238:239], v247 offset:864
    v_mfma_f32_16x16x32_bf16 v[140:143], v[240:243], v[200:203], v[140:143]
    ds_read_b128 v[220:223], v245 offset:14336
    v_mfma_f32_16x16x32_bf16 v[188:191], v[240:243], v[204:207], v[188:191]
    s_waitcnt lgkmcnt(9)
    v_mfma_f32_16x16x32_bf16 v[0:3], v[224:227], v[208:211], v[0:3]
    ds_read_b64_tr_b16 v[240:241], v246 offset:128
    s_waitcnt lgkmcnt(7)
    v_mfma_f32_16x16x32_bf16 v[48:51], v[224:227], v[212:215], v[48:51]
    ds_read_b64_tr_b16 v[242:243], v246 offset:896
    s_waitcnt lgkmcnt(5)
    v_mfma_f32_16x16x32_bf16 v[96:99], v[224:227], v[216:219], v[96:99]
    s_waitcnt lgkmcnt(2)
    v_mfma_f32_16x16x32_bf16 v[144:147], v[224:227], v[220:223], v[144:147]
    v_mfma_f32_16x16x32_bf16 v[4:7], v[228:231], v[208:211], v[4:7]
    ds_read_b64_tr_b16 v[224:225], v247 offset:160
    v_mfma_f32_16x16x32_bf16 v[52:55], v[228:231], v[212:215], v[52:55]
    ds_read_b64_tr_b16 v[226:227], v247 offset:928
    v_mfma_f32_16x16x32_bf16 v[100:103], v[228:231], v[216:219], v[100:103]
    v_mfma_f32_16x16x32_bf16 v[148:151], v[228:231], v[220:223], v[148:151]
    v_mfma_f32_16x16x32_bf16 v[8:11], v[232:235], v[208:211], v[8:11]
    ds_read_b64_tr_b16 v[228:229], v246 offset:6144
    v_mfma_f32_16x16x32_bf16 v[56:59], v[232:235], v[212:215], v[56:59]
    ds_read_b64_tr_b16 v[230:231], v246 offset:6912
    v_mfma_f32_16x16x32_bf16 v[104:107], v[232:235], v[216:219], v[104:107]
    v_mfma_f32_16x16x32_bf16 v[152:155], v[232:235], v[220:223], v[152:155]
    v_mfma_f32_16x16x32_bf16 v[12:15], v[236:239], v[208:211], v[12:15]
    ds_read_b64_tr_b16 v[232:233], v247 offset:6176
    v_mfma_f32_16x16x32_bf16 v[60:63], v[236:239], v[212:215], v[60:63]
    ds_read_b64_tr_b16 v[234:235], v247 offset:6944
    v_mfma_f32_16x16x32_bf16 v[108:111], v[236:239], v[216:219], v[108:111]
    v_mfma_f32_16x16x32_bf16 v[156:159], v[236:239], v[220:223], v[156:159]
    s_waitcnt lgkmcnt(6)
    v_mfma_f32_16x16x32_bf16 v[16:19], v[240:243], v[208:211], v[16:19]
    ds_read_b64_tr_b16 v[236:237], v246 offset:6208
    v_mfma_f32_16x16x32_bf16 v[64:67], v[240:243], v[212:215], v[64:67]
    ds_read_b64_tr_b16 v[238:239], v246 offset:6976
    v_mfma_f32_16x16x32_bf16 v[112:115], v[240:243], v[216:219], v[112:115]
    v_mfma_f32_16x16x32_bf16 v[160:163], v[240:243], v[220:223], v[160:163]
    s_waitcnt lgkmcnt(6)
    v_mfma_f32_16x16x32_bf16 v[20:23], v[224:227], v[208:211], v[20:23]
    ds_read_b64_tr_b16 v[240:241], v247 offset:6240
    v_mfma_f32_16x16x32_bf16 v[68:71], v[224:227], v[212:215], v[68:71]
    ds_read_b64_tr_b16 v[242:243], v247 offset:7008
    v_mfma_f32_16x16x32_bf16 v[116:119], v[224:227], v[216:219], v[116:119]
    v_mfma_f32_16x16x32_bf16 v[164:167], v[224:227], v[220:223], v[164:167]
    s_waitcnt lgkmcnt(6)
    v_mfma_f32_16x16x32_bf16 v[24:27], v[228:231], v[208:211], v[24:27]
    ds_read_b64_tr_b16 v[224:225], v246 offset:6272
    v_mfma_f32_16x16x32_bf16 v[72:75], v[228:231], v[212:215], v[72:75]
    ds_read_b64_tr_b16 v[226:227], v246 offset:7040
    v_mfma_f32_16x16x32_bf16 v[120:123], v[228:231], v[216:219], v[120:123]
    v_mfma_f32_16x16x32_bf16 v[168:171], v[228:231], v[220:223], v[168:171]
    s_waitcnt lgkmcnt(6)
    v_mfma_f32_16x16x32_bf16 v[28:31], v[232:235], v[208:211], v[28:31]
    ds_read_b64_tr_b16 v[228:229], v247 offset:6304
    v_mfma_f32_16x16x32_bf16 v[76:79], v[232:235], v[212:215], v[76:79]
    ds_read_b64_tr_b16 v[230:231], v247 offset:7072
    v_mfma_f32_16x16x32_bf16 v[124:127], v[232:235], v[216:219], v[124:127]
    v_mfma_f32_16x16x32_bf16 v[172:175], v[232:235], v[220:223], v[172:175]
    s_waitcnt lgkmcnt(6)
    v_mfma_f32_16x16x32_bf16 v[32:35], v[236:239], v[208:211], v[32:35]
    s_barrier
    ds_read_b64_tr_b16 v[232:233], v246 offset:12288
    v_mfma_f32_16x16x32_bf16 v[80:83], v[236:239], v[212:215], v[80:83]
    ds_read_b64_tr_b16 v[234:235], v246 offset:13056
    v_mfma_f32_16x16x32_bf16 v[128:131], v[236:239], v[216:219], v[128:131]
    ds_read_b128 v[192:195], v244 offset:16384
    v_mfma_f32_16x16x32_bf16 v[176:179], v[236:239], v[220:223], v[176:179]
    s_waitcnt lgkmcnt(7)
    v_mfma_f32_16x16x32_bf16 v[36:39], v[240:243], v[208:211], v[36:39]
    ds_read_b64_tr_b16 v[236:237], v247 offset:12320
    v_mfma_f32_16x16x32_bf16 v[84:87], v[240:243], v[212:215], v[84:87]
    ds_read_b64_tr_b16 v[238:239], v247 offset:13088
    v_mfma_f32_16x16x32_bf16 v[132:135], v[240:243], v[216:219], v[132:135]
    ds_read_b128 v[196:199], v244 offset:18432
    v_mfma_f32_16x16x32_bf16 v[180:183], v[240:243], v[220:223], v[180:183]
    s_waitcnt lgkmcnt(8)
    v_mfma_f32_16x16x32_bf16 v[40:43], v[224:227], v[208:211], v[40:43]
    ds_read_b64_tr_b16 v[240:241], v246 offset:12352
    v_mfma_f32_16x16x32_bf16 v[88:91], v[224:227], v[212:215], v[88:91]
    ds_read_b64_tr_b16 v[242:243], v246 offset:13120
    v_mfma_f32_16x16x32_bf16 v[136:139], v[224:227], v[216:219], v[136:139]
    ds_read_b128 v[200:203], v244 offset:20480
    v_mfma_f32_16x16x32_bf16 v[184:187], v[224:227], v[220:223], v[184:187]
    s_waitcnt lgkmcnt(9)
    v_mfma_f32_16x16x32_bf16 v[44:47], v[228:231], v[208:211], v[44:47]
    ds_read_b64_tr_b16 v[224:225], v247 offset:12384
    v_mfma_f32_16x16x32_bf16 v[92:95], v[228:231], v[212:215], v[92:95]
    ds_read_b64_tr_b16 v[226:227], v247 offset:13152
    v_mfma_f32_16x16x32_bf16 v[140:143], v[228:231], v[216:219], v[140:143]
    ds_read_b128 v[204:207], v244 offset:22528
    v_mfma_f32_16x16x32_bf16 v[188:191], v[228:231], v[220:223], v[188:191]
    s_waitcnt lgkmcnt(9)
    v_mfma_f32_16x16x32_bf16 v[0:3], v[232:235], v[192:195], v[0:3]
    ds_read_b64_tr_b16 v[228:229], v246 offset:12416
    s_waitcnt lgkmcnt(7)
    v_mfma_f32_16x16x32_bf16 v[48:51], v[232:235], v[196:199], v[48:51]
    ds_read_b64_tr_b16 v[230:231], v246 offset:13184
    s_waitcnt lgkmcnt(5)
    v_mfma_f32_16x16x32_bf16 v[96:99], v[232:235], v[200:203], v[96:99]
    s_waitcnt lgkmcnt(2)
    v_mfma_f32_16x16x32_bf16 v[144:147], v[232:235], v[204:207], v[144:147]
    v_mfma_f32_16x16x32_bf16 v[4:7], v[236:239], v[192:195], v[4:7]
    ds_read_b64_tr_b16 v[232:233], v247 offset:12448
    v_mfma_f32_16x16x32_bf16 v[52:55], v[236:239], v[196:199], v[52:55]
    ds_read_b64_tr_b16 v[234:235], v247 offset:13216
    v_mfma_f32_16x16x32_bf16 v[100:103], v[236:239], v[200:203], v[100:103]
    v_mfma_f32_16x16x32_bf16 v[148:151], v[236:239], v[204:207], v[148:151]
    v_mfma_f32_16x16x32_bf16 v[8:11], v[240:243], v[192:195], v[8:11]
    ds_read_b64_tr_b16 v[236:237], v246 offset:18432
    v_mfma_f32_16x16x32_bf16 v[56:59], v[240:243], v[196:199], v[56:59]
    ds_read_b64_tr_b16 v[238:239], v246 offset:19200
    v_mfma_f32_16x16x32_bf16 v[104:107], v[240:243], v[200:203], v[104:107]
    v_mfma_f32_16x16x32_bf16 v[152:155], v[240:243], v[204:207], v[152:155]
    v_mfma_f32_16x16x32_bf16 v[12:15], v[224:227], v[192:195], v[12:15]
    ds_read_b64_tr_b16 v[240:241], v247 offset:18464
    v_mfma_f32_16x16x32_bf16 v[60:63], v[224:227], v[196:199], v[60:63]
    ds_read_b64_tr_b16 v[242:243], v247 offset:19232
    v_mfma_f32_16x16x32_bf16 v[108:111], v[224:227], v[200:203], v[108:111]
    v_mfma_f32_16x16x32_bf16 v[156:159], v[224:227], v[204:207], v[156:159]
    s_waitcnt lgkmcnt(6)
    v_mfma_f32_16x16x32_bf16 v[16:19], v[228:231], v[192:195], v[16:19]
    ds_read_b64_tr_b16 v[224:225], v246 offset:18496
    v_mfma_f32_16x16x32_bf16 v[64:67], v[228:231], v[196:199], v[64:67]
    ds_read_b64_tr_b16 v[226:227], v246 offset:19264
    v_mfma_f32_16x16x32_bf16 v[112:115], v[228:231], v[200:203], v[112:115]
    v_mfma_f32_16x16x32_bf16 v[160:163], v[228:231], v[204:207], v[160:163]
    s_waitcnt lgkmcnt(6)
    v_mfma_f32_16x16x32_bf16 v[20:23], v[232:235], v[192:195], v[20:23]
    ds_read_b64_tr_b16 v[228:229], v247 offset:18528
    v_mfma_f32_16x16x32_bf16 v[68:71], v[232:235], v[196:199], v[68:71]
    ds_read_b64_tr_b16 v[230:231], v247 offset:19296
    v_mfma_f32_16x16x32_bf16 v[116:119], v[232:235], v[200:203], v[116:119]
    v_mfma_f32_16x16x32_bf16 v[164:167], v[232:235], v[204:207], v[164:167]
    s_waitcnt lgkmcnt(6)
    v_mfma_f32_16x16x32_bf16 v[24:27], v[236:239], v[192:195], v[24:27]
    ds_read_b64_tr_b16 v[232:233], v246 offset:18560
    v_mfma_f32_16x16x32_bf16 v[72:75], v[236:239], v[196:199], v[72:75]
    ds_read_b64_tr_b16 v[234:235], v246 offset:19328
    v_mfma_f32_16x16x32_bf16 v[120:123], v[236:239], v[200:203], v[120:123]
    v_mfma_f32_16x16x32_bf16 v[168:171], v[236:239], v[204:207], v[168:171]
    s_waitcnt lgkmcnt(6)
    v_mfma_f32_16x16x32_bf16 v[28:31], v[240:243], v[192:195], v[28:31]
    ds_read_b64_tr_b16 v[236:237], v247 offset:18592
    v_mfma_f32_16x16x32_bf16 v[76:79], v[240:243], v[196:199], v[76:79]
    ds_read_b64_tr_b16 v[238:239], v247 offset:19360
    v_mfma_f32_16x16x32_bf16 v[124:127], v[240:243], v[200:203], v[124:127]
    v_mfma_f32_16x16x32_bf16 v[172:175], v[240:243], v[204:207], v[172:175]
    s_waitcnt lgkmcnt(6)
    v_mfma_f32_16x16x32_bf16 v[32:35], v[224:227], v[192:195], v[32:35]
    s_barrier
    ds_read_b64_tr_b16 v[240:241], v246 offset:24576
    v_mfma_f32_16x16x32_bf16 v[80:83], v[224:227], v[196:199], v[80:83]
    ds_read_b64_tr_b16 v[242:243], v246 offset:25344
    v_mfma_f32_16x16x32_bf16 v[128:131], v[224:227], v[200:203], v[128:131]
    ds_read_b128 v[208:211], v245 offset:16384
    v_mfma_f32_16x16x32_bf16 v[176:179], v[224:227], v[204:207], v[176:179]
    s_waitcnt lgkmcnt(7)
    v_mfma_f32_16x16x32_bf16 v[36:39], v[228:231], v[192:195], v[36:39]
    ds_read_b64_tr_b16 v[224:225], v247 offset:24608
    v_mfma_f32_16x16x32_bf16 v[84:87], v[228:231], v[196:199], v[84:87]
    ds_read_b64_tr_b16 v[226:227], v247 offset:25376
    v_mfma_f32_16x16x32_bf16 v[132:135], v[228:231], v[200:203], v[132:135]
    ds_read_b128 v[212:215], v245 offset:18432
    v_mfma_f32_16x16x32_bf16 v[180:183], v[228:231], v[204:207], v[180:183]
    s_waitcnt lgkmcnt(8)
    v_mfma_f32_16x16x32_bf16 v[40:43], v[232:235], v[192:195], v[40:43]
    ds_read_b64_tr_b16 v[228:229], v246 offset:24640
    v_mfma_f32_16x16x32_bf16 v[88:91], v[232:235], v[196:199], v[88:91]
    ds_read_b64_tr_b16 v[230:231], v246 offset:25408
    v_mfma_f32_16x16x32_bf16 v[136:139], v[232:235], v[200:203], v[136:139]
    ds_read_b128 v[216:219], v245 offset:20480
    v_mfma_f32_16x16x32_bf16 v[184:187], v[232:235], v[204:207], v[184:187]
    s_waitcnt lgkmcnt(9)
    v_mfma_f32_16x16x32_bf16 v[44:47], v[236:239], v[192:195], v[44:47]
    ds_read_b64_tr_b16 v[232:233], v247 offset:24672
    v_mfma_f32_16x16x32_bf16 v[92:95], v[236:239], v[196:199], v[92:95]
    ds_read_b64_tr_b16 v[234:235], v247 offset:25440
    v_mfma_f32_16x16x32_bf16 v[140:143], v[236:239], v[200:203], v[140:143]
    ds_read_b128 v[220:223], v245 offset:22528
    v_mfma_f32_16x16x32_bf16 v[188:191], v[236:239], v[204:207], v[188:191]
    s_waitcnt lgkmcnt(9)
    v_mfma_f32_16x16x32_bf16 v[0:3], v[240:243], v[208:211], v[0:3]
    ds_read_b64_tr_b16 v[236:237], v246 offset:24704
    s_waitcnt lgkmcnt(7)
    v_mfma_f32_16x16x32_bf16 v[48:51], v[240:243], v[212:215], v[48:51]
    ds_read_b64_tr_b16 v[238:239], v246 offset:25472
    s_waitcnt lgkmcnt(5)
    v_mfma_f32_16x16x32_bf16 v[96:99], v[240:243], v[216:219], v[96:99]
    s_waitcnt lgkmcnt(2)
    v_mfma_f32_16x16x32_bf16 v[144:147], v[240:243], v[220:223], v[144:147]
    v_mfma_f32_16x16x32_bf16 v[4:7], v[224:227], v[208:211], v[4:7]
    ds_read_b64_tr_b16 v[240:241], v247 offset:24736
    v_mfma_f32_16x16x32_bf16 v[52:55], v[224:227], v[212:215], v[52:55]
    ds_read_b64_tr_b16 v[242:243], v247 offset:25504
    v_mfma_f32_16x16x32_bf16 v[100:103], v[224:227], v[216:219], v[100:103]
    v_mfma_f32_16x16x32_bf16 v[148:151], v[224:227], v[220:223], v[148:151]
    v_mfma_f32_16x16x32_bf16 v[8:11], v[228:231], v[208:211], v[8:11]
    ds_read_b64_tr_b16 v[224:225], v246 offset:30720
    v_mfma_f32_16x16x32_bf16 v[56:59], v[228:231], v[212:215], v[56:59]
    ds_read_b64_tr_b16 v[226:227], v246 offset:31488
    v_mfma_f32_16x16x32_bf16 v[104:107], v[228:231], v[216:219], v[104:107]
    v_mfma_f32_16x16x32_bf16 v[152:155], v[228:231], v[220:223], v[152:155]
    v_mfma_f32_16x16x32_bf16 v[12:15], v[232:235], v[208:211], v[12:15]
    ds_read_b64_tr_b16 v[228:229], v247 offset:30752
    v_mfma_f32_16x16x32_bf16 v[60:63], v[232:235], v[212:215], v[60:63]
    ds_read_b64_tr_b16 v[230:231], v247 offset:31520
    v_mfma_f32_16x16x32_bf16 v[108:111], v[232:235], v[216:219], v[108:111]
    v_mfma_f32_16x16x32_bf16 v[156:159], v[232:235], v[220:223], v[156:159]
    s_waitcnt lgkmcnt(6)
    v_mfma_f32_16x16x32_bf16 v[16:19], v[236:239], v[208:211], v[16:19]
    ds_read_b64_tr_b16 v[232:233], v246 offset:30784
    v_mfma_f32_16x16x32_bf16 v[64:67], v[236:239], v[212:215], v[64:67]
    ds_read_b64_tr_b16 v[234:235], v246 offset:31552
    v_mfma_f32_16x16x32_bf16 v[112:115], v[236:239], v[216:219], v[112:115]
    v_mfma_f32_16x16x32_bf16 v[160:163], v[236:239], v[220:223], v[160:163]
    s_waitcnt lgkmcnt(6)
    v_mfma_f32_16x16x32_bf16 v[20:23], v[240:243], v[208:211], v[20:23]
    ds_read_b64_tr_b16 v[236:237], v247 offset:30816
    v_mfma_f32_16x16x32_bf16 v[68:71], v[240:243], v[212:215], v[68:71]
    ds_read_b64_tr_b16 v[238:239], v247 offset:31584
    v_mfma_f32_16x16x32_bf16 v[116:119], v[240:243], v[216:219], v[116:119]
    v_mfma_f32_16x16x32_bf16 v[164:167], v[240:243], v[220:223], v[164:167]
    s_waitcnt lgkmcnt(6)
    v_mfma_f32_16x16x32_bf16 v[24:27], v[224:227], v[208:211], v[24:27]
    ds_read_b64_tr_b16 v[240:241], v246 offset:30848
    v_mfma_f32_16x16x32_bf16 v[72:75], v[224:227], v[212:215], v[72:75]
    ds_read_b64_tr_b16 v[242:243], v246 offset:31616
    v_mfma_f32_16x16x32_bf16 v[120:123], v[224:227], v[216:219], v[120:123]
    v_mfma_f32_16x16x32_bf16 v[168:171], v[224:227], v[220:223], v[168:171]
    s_waitcnt lgkmcnt(6)
    v_mfma_f32_16x16x32_bf16 v[28:31], v[228:231], v[208:211], v[28:31]
    ds_read_b64_tr_b16 v[224:225], v247 offset:30880
    v_mfma_f32_16x16x32_bf16 v[76:79], v[228:231], v[212:215], v[76:79]
    ds_read_b64_tr_b16 v[226:227], v247 offset:31648
    v_mfma_f32_16x16x32_bf16 v[124:127], v[228:231], v[216:219], v[124:127]
    v_mfma_f32_16x16x32_bf16 v[172:175], v[228:231], v[220:223], v[172:175]
    s_waitcnt lgkmcnt(6)
    v_mfma_f32_16x16x32_bf16 v[32:35], v[232:235], v[208:211], v[32:35]
    s_barrier
    ds_read_b64_tr_b16 v[228:229], v246 offset:36864
    v_mfma_f32_16x16x32_bf16 v[80:83], v[232:235], v[212:215], v[80:83]
    ds_read_b64_tr_b16 v[230:231], v246 offset:37632
    v_mfma_f32_16x16x32_bf16 v[128:131], v[232:235], v[216:219], v[128:131]
    ds_read_b128 v[192:195], v244 offset:0
    v_mfma_f32_16x16x32_bf16 v[176:179], v[232:235], v[220:223], v[176:179]
    s_waitcnt lgkmcnt(7)
    v_mfma_f32_16x16x32_bf16 v[36:39], v[236:239], v[208:211], v[36:39]
    ds_read_b64_tr_b16 v[232:233], v247 offset:36896
    v_mfma_f32_16x16x32_bf16 v[84:87], v[236:239], v[212:215], v[84:87]
    ds_read_b64_tr_b16 v[234:235], v247 offset:37664
    v_mfma_f32_16x16x32_bf16 v[132:135], v[236:239], v[216:219], v[132:135]
    ds_read_b128 v[196:199], v244 offset:2048
    v_mfma_f32_16x16x32_bf16 v[180:183], v[236:239], v[220:223], v[180:183]
    s_waitcnt lgkmcnt(8)
    v_mfma_f32_16x16x32_bf16 v[40:43], v[240:243], v[208:211], v[40:43]
    ds_read_b64_tr_b16 v[236:237], v246 offset:36928
    v_mfma_f32_16x16x32_bf16 v[88:91], v[240:243], v[212:215], v[88:91]
    ds_read_b64_tr_b16 v[238:239], v246 offset:37696
    v_mfma_f32_16x16x32_bf16 v[136:139], v[240:243], v[216:219], v[136:139]
    ds_read_b128 v[200:203], v244 offset:4096
    v_mfma_f32_16x16x32_bf16 v[184:187], v[240:243], v[220:223], v[184:187]
    s_waitcnt lgkmcnt(9)
    v_mfma_f32_16x16x32_bf16 v[44:47], v[224:227], v[208:211], v[44:47]
    ds_read_b64_tr_b16 v[240:241], v247 offset:36960
    v_mfma_f32_16x16x32_bf16 v[92:95], v[224:227], v[212:215], v[92:95]
    ds_read_b64_tr_b16 v[242:243], v247 offset:37728
    v_mfma_f32_16x16x32_bf16 v[140:143], v[224:227], v[216:219], v[140:143]
    ds_read_b128 v[204:207], v244 offset:6144
    v_mfma_f32_16x16x32_bf16 v[188:191], v[224:227], v[220:223], v[188:191]
    s_waitcnt lgkmcnt(9)
    v_mfma_f32_16x16x32_bf16 v[0:3], v[228:231], v[192:195], v[0:3]
    ds_read_b64_tr_b16 v[224:225], v246 offset:36992
    s_waitcnt lgkmcnt(7)
    v_mfma_f32_16x16x32_bf16 v[48:51], v[228:231], v[196:199], v[48:51]
    ds_read_b64_tr_b16 v[226:227], v246 offset:37760
    s_waitcnt lgkmcnt(5)
    v_mfma_f32_16x16x32_bf16 v[96:99], v[228:231], v[200:203], v[96:99]
    s_waitcnt lgkmcnt(2)
    v_mfma_f32_16x16x32_bf16 v[144:147], v[228:231], v[204:207], v[144:147]
    v_mfma_f32_16x16x32_bf16 v[4:7], v[232:235], v[192:195], v[4:7]
    ds_read_b64_tr_b16 v[228:229], v247 offset:37024
    v_mfma_f32_16x16x32_bf16 v[52:55], v[232:235], v[196:199], v[52:55]
    ds_read_b64_tr_b16 v[230:231], v247 offset:37792
    v_mfma_f32_16x16x32_bf16 v[100:103], v[232:235], v[200:203], v[100:103]
    v_mfma_f32_16x16x32_bf16 v[148:151], v[232:235], v[204:207], v[148:151]
    v_mfma_f32_16x16x32_bf16 v[8:11], v[236:239], v[192:195], v[8:11]
    ds_read_b64_tr_b16 v[232:233], v246 offset:43008
    v_mfma_f32_16x16x32_bf16 v[56:59], v[236:239], v[196:199], v[56:59]
    ds_read_b64_tr_b16 v[234:235], v246 offset:43776
    v_mfma_f32_16x16x32_bf16 v[104:107], v[236:239], v[200:203], v[104:107]
    v_mfma_f32_16x16x32_bf16 v[152:155], v[236:239], v[204:207], v[152:155]
    v_mfma_f32_16x16x32_bf16 v[12:15], v[240:243], v[192:195], v[12:15]
    ds_read_b64_tr_b16 v[236:237], v247 offset:43040
    v_mfma_f32_16x16x32_bf16 v[60:63], v[240:243], v[196:199], v[60:63]
    ds_read_b64_tr_b16 v[238:239], v247 offset:43808
    v_mfma_f32_16x16x32_bf16 v[108:111], v[240:243], v[200:203], v[108:111]
    v_mfma_f32_16x16x32_bf16 v[156:159], v[240:243], v[204:207], v[156:159]
    s_waitcnt lgkmcnt(6)
    v_mfma_f32_16x16x32_bf16 v[16:19], v[224:227], v[192:195], v[16:19]
    ds_read_b64_tr_b16 v[240:241], v246 offset:43072
    v_mfma_f32_16x16x32_bf16 v[64:67], v[224:227], v[196:199], v[64:67]
    ds_read_b64_tr_b16 v[242:243], v246 offset:43840
    v_mfma_f32_16x16x32_bf16 v[112:115], v[224:227], v[200:203], v[112:115]
    v_mfma_f32_16x16x32_bf16 v[160:163], v[224:227], v[204:207], v[160:163]
    s_waitcnt lgkmcnt(6)
    v_mfma_f32_16x16x32_bf16 v[20:23], v[228:231], v[192:195], v[20:23]
    ds_read_b64_tr_b16 v[224:225], v247 offset:43104
    v_mfma_f32_16x16x32_bf16 v[68:71], v[228:231], v[196:199], v[68:71]
    ds_read_b64_tr_b16 v[226:227], v247 offset:43872
    v_mfma_f32_16x16x32_bf16 v[116:119], v[228:231], v[200:203], v[116:119]
    v_mfma_f32_16x16x32_bf16 v[164:167], v[228:231], v[204:207], v[164:167]
    s_waitcnt lgkmcnt(6)
    v_mfma_f32_16x16x32_bf16 v[24:27], v[232:235], v[192:195], v[24:27]
    ds_read_b64_tr_b16 v[228:229], v246 offset:43136
    v_mfma_f32_16x16x32_bf16 v[72:75], v[232:235], v[196:199], v[72:75]
    ds_read_b64_tr_b16 v[230:231], v246 offset:43904
    v_mfma_f32_16x16x32_bf16 v[120:123], v[232:235], v[200:203], v[120:123]
    v_mfma_f32_16x16x32_bf16 v[168:171], v[232:235], v[204:207], v[168:171]
    s_waitcnt lgkmcnt(6)
    v_mfma_f32_16x16x32_bf16 v[28:31], v[236:239], v[192:195], v[28:31]
    ds_read_b64_tr_b16 v[232:233], v247 offset:43168
    v_mfma_f32_16x16x32_bf16 v[76:79], v[236:239], v[196:199], v[76:79]
    ds_read_b64_tr_b16 v[234:235], v247 offset:43936
    v_mfma_f32_16x16x32_bf16 v[124:127], v[236:239], v[200:203], v[124:127]
    v_mfma_f32_16x16x32_bf16 v[172:175], v[236:239], v[204:207], v[172:175]
    s_waitcnt lgkmcnt(6)
    v_mfma_f32_16x16x32_bf16 v[32:35], v[240:243], v[192:195], v[32:35]
    s_barrier
    ds_read_b64_tr_b16 v[236:237], v246 offset:49152
    v_mfma_f32_16x16x32_bf16 v[80:83], v[240:243], v[196:199], v[80:83]
    ds_read_b64_tr_b16 v[238:239], v246 offset:49920
    v_mfma_f32_16x16x32_bf16 v[128:131], v[240:243], v[200:203], v[128:131]
    ds_read_b128 v[208:211], v245 offset:0
    v_mfma_f32_16x16x32_bf16 v[176:179], v[240:243], v[204:207], v[176:179]
    s_waitcnt lgkmcnt(7)
    v_mfma_f32_16x16x32_bf16 v[36:39], v[224:227], v[192:195], v[36:39]
    ds_read_b64_tr_b16 v[240:241], v247 offset:49184
    v_mfma_f32_16x16x32_bf16 v[84:87], v[224:227], v[196:199], v[84:87]
    ds_read_b64_tr_b16 v[242:243], v247 offset:49952
    v_mfma_f32_16x16x32_bf16 v[132:135], v[224:227], v[200:203], v[132:135]
    ds_read_b128 v[212:215], v245 offset:2048
    v_mfma_f32_16x16x32_bf16 v[180:183], v[224:227], v[204:207], v[180:183]
    s_waitcnt lgkmcnt(8)
    v_mfma_f32_16x16x32_bf16 v[40:43], v[228:231], v[192:195], v[40:43]
    ds_read_b64_tr_b16 v[224:225], v246 offset:49216
    v_mfma_f32_16x16x32_bf16 v[88:91], v[228:231], v[196:199], v[88:91]
    ds_read_b64_tr_b16 v[226:227], v246 offset:49984
    v_mfma_f32_16x16x32_bf16 v[136:139], v[228:231], v[200:203], v[136:139]
    ds_read_b128 v[216:219], v245 offset:4096
    v_mfma_f32_16x16x32_bf16 v[184:187], v[228:231], v[204:207], v[184:187]
    s_waitcnt lgkmcnt(9)
    v_mfma_f32_16x16x32_bf16 v[44:47], v[232:235], v[192:195], v[44:47]
    ds_read_b64_tr_b16 v[228:229], v247 offset:49248
    v_mfma_f32_16x16x32_bf16 v[92:95], v[232:235], v[196:199], v[92:95]
    ds_read_b64_tr_b16 v[230:231], v247 offset:50016
    v_mfma_f32_16x16x32_bf16 v[140:143], v[232:235], v[200:203], v[140:143]
    ds_read_b128 v[220:223], v245 offset:6144
    v_mfma_f32_16x16x32_bf16 v[188:191], v[232:235], v[204:207], v[188:191]
    s_waitcnt lgkmcnt(9)
    v_mfma_f32_16x16x32_bf16 v[0:3], v[236:239], v[208:211], v[0:3]
    ds_read_b64_tr_b16 v[232:233], v246 offset:49280
    s_waitcnt lgkmcnt(7)
    v_mfma_f32_16x16x32_bf16 v[48:51], v[236:239], v[212:215], v[48:51]
    ds_read_b64_tr_b16 v[234:235], v246 offset:50048
    s_waitcnt lgkmcnt(5)
    v_mfma_f32_16x16x32_bf16 v[96:99], v[236:239], v[216:219], v[96:99]
    s_waitcnt lgkmcnt(2)
    v_mfma_f32_16x16x32_bf16 v[144:147], v[236:239], v[220:223], v[144:147]
    v_mfma_f32_16x16x32_bf16 v[4:7], v[240:243], v[208:211], v[4:7]
    ds_read_b64_tr_b16 v[236:237], v247 offset:49312
    v_mfma_f32_16x16x32_bf16 v[52:55], v[240:243], v[212:215], v[52:55]
    ds_read_b64_tr_b16 v[238:239], v247 offset:50080
    v_mfma_f32_16x16x32_bf16 v[100:103], v[240:243], v[216:219], v[100:103]
    v_mfma_f32_16x16x32_bf16 v[148:151], v[240:243], v[220:223], v[148:151]
    v_mfma_f32_16x16x32_bf16 v[8:11], v[224:227], v[208:211], v[8:11]
    ds_read_b64_tr_b16 v[240:241], v246 offset:55296
    v_mfma_f32_16x16x32_bf16 v[56:59], v[224:227], v[212:215], v[56:59]
    ds_read_b64_tr_b16 v[242:243], v246 offset:56064
    v_mfma_f32_16x16x32_bf16 v[104:107], v[224:227], v[216:219], v[104:107]
    v_mfma_f32_16x16x32_bf16 v[152:155], v[224:227], v[220:223], v[152:155]
    v_mfma_f32_16x16x32_bf16 v[12:15], v[228:231], v[208:211], v[12:15]
    ds_read_b64_tr_b16 v[224:225], v247 offset:55328
    v_mfma_f32_16x16x32_bf16 v[60:63], v[228:231], v[212:215], v[60:63]
    ds_read_b64_tr_b16 v[226:227], v247 offset:56096
    v_mfma_f32_16x16x32_bf16 v[108:111], v[228:231], v[216:219], v[108:111]
    v_mfma_f32_16x16x32_bf16 v[156:159], v[228:231], v[220:223], v[156:159]
    s_waitcnt lgkmcnt(6)
    v_mfma_f32_16x16x32_bf16 v[16:19], v[232:235], v[208:211], v[16:19]
    ds_read_b64_tr_b16 v[228:229], v246 offset:55360
    v_mfma_f32_16x16x32_bf16 v[64:67], v[232:235], v[212:215], v[64:67]
    ds_read_b64_tr_b16 v[230:231], v246 offset:56128
    v_mfma_f32_16x16x32_bf16 v[112:115], v[232:235], v[216:219], v[112:115]
    v_mfma_f32_16x16x32_bf16 v[160:163], v[232:235], v[220:223], v[160:163]
    s_waitcnt lgkmcnt(6)
    v_mfma_f32_16x16x32_bf16 v[20:23], v[236:239], v[208:211], v[20:23]
    ds_read_b64_tr_b16 v[232:233], v247 offset:55392
    v_mfma_f32_16x16x32_bf16 v[68:71], v[236:239], v[212:215], v[68:71]
    ds_read_b64_tr_b16 v[234:235], v247 offset:56160
    v_mfma_f32_16x16x32_bf16 v[116:119], v[236:239], v[216:219], v[116:119]
    v_mfma_f32_16x16x32_bf16 v[164:167], v[236:239], v[220:223], v[164:167]
    s_waitcnt lgkmcnt(6)
    v_mfma_f32_16x16x32_bf16 v[24:27], v[240:243], v[208:211], v[24:27]
    ds_read_b64_tr_b16 v[236:237], v246 offset:55424
    v_mfma_f32_16x16x32_bf16 v[72:75], v[240:243], v[212:215], v[72:75]
    ds_read_b64_tr_b16 v[238:239], v246 offset:56192
    v_mfma_f32_16x16x32_bf16 v[120:123], v[240:243], v[216:219], v[120:123]
    v_mfma_f32_16x16x32_bf16 v[168:171], v[240:243], v[220:223], v[168:171]
    s_waitcnt lgkmcnt(6)
    v_mfma_f32_16x16x32_bf16 v[28:31], v[224:227], v[208:211], v[28:31]
    ds_read_b64_tr_b16 v[240:241], v247 offset:55456
    v_mfma_f32_16x16x32_bf16 v[76:79], v[224:227], v[212:215], v[76:79]
    ds_read_b64_tr_b16 v[242:243], v247 offset:56224
    v_mfma_f32_16x16x32_bf16 v[124:127], v[224:227], v[216:219], v[124:127]
    v_mfma_f32_16x16x32_bf16 v[172:175], v[224:227], v[220:223], v[172:175]
    s_waitcnt lgkmcnt(6)
    v_mfma_f32_16x16x32_bf16 v[32:35], v[228:231], v[208:211], v[32:35]
    v_mfma_f32_16x16x32_bf16 v[80:83], v[228:231], v[212:215], v[80:83]
    v_mfma_f32_16x16x32_bf16 v[128:131], v[228:231], v[216:219], v[128:131]
    v_mfma_f32_16x16x32_bf16 v[176:179], v[228:231], v[220:223], v[176:179]
    s_waitcnt lgkmcnt(4)
    v_mfma_f32_16x16x32_bf16 v[36:39], v[232:235], v[208:211], v[36:39]
    v_mfma_f32_16x16x32_bf16 v[84:87], v[232:235], v[212:215], v[84:87]
    v_mfma_f32_16x16x32_bf16 v[132:135], v[232:235], v[216:219], v[132:135]
    v_mfma_f32_16x16x32_bf16 v[180:183], v[232:235], v[220:223], v[180:183]
    s_waitcnt lgkmcnt(2)
    v_mfma_f32_16x16x32_bf16 v[40:43], v[236:239], v[208:211], v[40:43]
    v_mfma_f32_16x16x32_bf16 v[88:91], v[236:239], v[212:215], v[88:91]
    v_mfma_f32_16x16x32_bf16 v[136:139], v[236:239], v[216:219], v[136:139]
    v_mfma_f32_16x16x32_bf16 v[184:187], v[236:239], v[220:223], v[184:187]
    s_waitcnt lgkmcnt(0)
    v_mfma_f32_16x16x32_bf16 v[44:47], v[240:243], v[208:211], v[44:47]
    v_mfma_f32_16x16x32_bf16 v[92:95], v[240:243], v[212:215], v[92:95]
    v_mfma_f32_16x16x32_bf16 v[140:143], v[240:243], v[216:219], v[140:143]
    v_mfma_f32_16x16x32_bf16 v[188:191], v[240:243], v[220:223], v[188:191]
K1_compute_end:
    v_lshrrev_b32 v249, 4, v248
    v_lshlrev_b32_e64 v249, 4, v249
    v_add_u32 v249, 161792, v249
    v_and_b32 v250, 15, v248
    v_lshlrev_b32 v250, 3, v250
    s_lshl_b32 s51, s3, 9
    s_add_u32 s51, s51, 159744
    v_add_u32 v250, s51, v250
    s_waitcnt vmcnt(0)
    s_barrier
    ds_read_b64 v[240:241], v250 offset:0
    ds_read_b64 v[242:243], v250 offset:128
    ds_read_b64 v[244:245], v250 offset:256
    ds_read_b64 v[246:247], v250 offset:384
    ds_read_b128 v[192:195], v249 offset:0
    ds_read_b128 v[196:199], v249 offset:64
    ds_read_b128 v[200:203], v249 offset:128
    ds_read_b128 v[204:207], v249 offset:192
    ds_read_b128 v[208:211], v249 offset:256
    ds_read_b128 v[212:215], v249 offset:320
    ds_read_b128 v[216:219], v249 offset:384
    ds_read_b128 v[220:223], v249 offset:448
    ds_read_b128 v[224:227], v249 offset:512
    ds_read_b128 v[228:231], v249 offset:576
    ds_read_b128 v[232:235], v249 offset:640
    ds_read_b128 v[236:239], v249 offset:704
    v_lshlrev_b32 v249, 4, v248
    s_waitcnt lgkmcnt(0)
    v_mul_f32_e64 v252, v241, v241
    v_mul_f32 v241, 3216550459, v241
    v_rcp_f32 v252, v252
    v_mul_f32 v253, v243, v243
    v_mul_f32 v243, 3216550459, v243
    v_rcp_f32 v253, v253
    v_mul_f32 v254, v245, v245
    v_mul_f32 v245, 3216550459, v245
    v_rcp_f32 v254, v254
    v_mul_f32 v255, v247, v247
    v_mul_f32 v247, 3216550459, v247
    v_rcp_f32 v255, v255
    s_add_u32 s51, s50, 0
    v_pk_fma_f32 v[0:1], v[192:193], v[240:241], v[0:1] op_sel_hi:[1,0,1] neg_lo:[1,0,0] neg_hi:[1,0,0]
    v_pk_fma_f32 v[2:3], v[194:195], v[240:241], v[2:3] op_sel_hi:[1,0,1] neg_lo:[1,0,0] neg_hi:[1,0,0]
    v_pk_fma_f32 v[24:25], v[216:217], v[240:241], v[24:25] op_sel_hi:[1,0,1] neg_lo:[1,0,0] neg_hi:[1,0,0]
    v_pk_fma_f32 v[26:27], v[218:219], v[240:241], v[26:27] op_sel_hi:[1,0,1] neg_lo:[1,0,0] neg_hi:[1,0,0]
    v_pk_fma_f32 v[4:5], v[196:197], v[240:241], v[4:5] op_sel_hi:[1,0,1] neg_lo:[1,0,0] neg_hi:[1,0,0]
    v_pk_fma_f32 v[6:7], v[198:199], v[240:241], v[6:7] op_sel_hi:[1,0,1] neg_lo:[1,0,0] neg_hi:[1,0,0]
    v_pk_fma_f32 v[28:29], v[220:221], v[240:241], v[28:29] op_sel_hi:[1,0,1] neg_lo:[1,0,0] neg_hi:[1,0,0]
    v_pk_fma_f32 v[30:31], v[222:223], v[240:241], v[30:31] op_sel_hi:[1,0,1] neg_lo:[1,0,0] neg_hi:[1,0,0]
    v_pk_fma_f32 v[48:49], v[192:193], v[242:243], v[48:49] op_sel_hi:[1,0,1] neg_lo:[1,0,0] neg_hi:[1,0,0]
    v_pk_fma_f32 v[50:51], v[194:195], v[242:243], v[50:51] op_sel_hi:[1,0,1] neg_lo:[1,0,0] neg_hi:[1,0,0]
    v_pk_fma_f32 v[72:73], v[216:217], v[242:243], v[72:73] op_sel_hi:[1,0,1] neg_lo:[1,0,0] neg_hi:[1,0,0]
    v_pk_fma_f32 v[74:75], v[218:219], v[242:243], v[74:75] op_sel_hi:[1,0,1] neg_lo:[1,0,0] neg_hi:[1,0,0]
    v_pk_fma_f32 v[52:53], v[196:197], v[242:243], v[52:53] op_sel_hi:[1,0,1] neg_lo:[1,0,0] neg_hi:[1,0,0]
    v_pk_fma_f32 v[54:55], v[198:199], v[242:243], v[54:55] op_sel_hi:[1,0,1] neg_lo:[1,0,0] neg_hi:[1,0,0]
    v_pk_fma_f32 v[76:77], v[220:221], v[242:243], v[76:77] op_sel_hi:[1,0,1] neg_lo:[1,0,0] neg_hi:[1,0,0]
    v_pk_fma_f32 v[78:79], v[222:223], v[242:243], v[78:79] op_sel_hi:[1,0,1] neg_lo:[1,0,0] neg_hi:[1,0,0]
    v_pk_mul_f32 v[24:25], v[0:1], v[24:25]
    v_pk_mul_f32 v[26:27], v[2:3], v[26:27]
    v_pk_mul_f32 v[28:29], v[4:5], v[28:29]
    v_pk_mul_f32 v[30:31], v[6:7], v[30:31]
    v_pk_mul_f32 v[0:1], v[0:1], v[240:241] op_sel:[0,1] op_sel_hi:[1,1]
    v_pk_mul_f32 v[2:3], v[2:3], v[240:241] op_sel:[0,1] op_sel_hi:[1,1]
    v_pk_mul_f32 v[4:5], v[4:5], v[240:241] op_sel:[0,1] op_sel_hi:[1,1]
    v_pk_mul_f32 v[6:7], v[6:7], v[240:241] op_sel:[0,1] op_sel_hi:[1,1]
    v_pk_mul_f32 v[72:73], v[48:49], v[72:73]
    v_pk_mul_f32 v[74:75], v[50:51], v[74:75]
    v_pk_mul_f32 v[76:77], v[52:53], v[76:77]
    v_pk_mul_f32 v[78:79], v[54:55], v[78:79]
    v_pk_mul_f32 v[48:49], v[48:49], v[242:243] op_sel:[0,1] op_sel_hi:[1,1]
    v_pk_mul_f32 v[50:51], v[50:51], v[242:243] op_sel:[0,1] op_sel_hi:[1,1]
    v_pk_mul_f32 v[52:53], v[52:53], v[242:243] op_sel:[0,1] op_sel_hi:[1,1]
    v_pk_mul_f32 v[54:55], v[54:55], v[242:243] op_sel:[0,1] op_sel_hi:[1,1]
    v_exp_f32 v0, v0
    v_exp_f32 v1, v1
    v_exp_f32 v2, v2
    v_exp_f32 v3, v3
    v_exp_f32 v4, v4
    v_exp_f32 v5, v5
    v_exp_f32 v6, v6
    v_exp_f32 v7, v7
    v_exp_f32 v48, v48
    v_exp_f32 v49, v49
    v_exp_f32 v50, v50
    v_exp_f32 v51, v51
    v_exp_f32 v52, v52
    v_exp_f32 v53, v53
    v_exp_f32 v54, v54
    v_exp_f32 v55, v55
    v_pk_fma_f32 v[0:1], v[0:1], v[252:253], v[252:253] op_sel:[0,0,0] op_sel_hi:[1,0,0]
    v_pk_fma_f32 v[2:3], v[2:3], v[252:253], v[252:253] op_sel:[0,0,0] op_sel_hi:[1,0,0]
    v_pk_fma_f32 v[4:5], v[4:5], v[252:253], v[252:253] op_sel:[0,0,0] op_sel_hi:[1,0,0]
    v_pk_fma_f32 v[6:7], v[6:7], v[252:253], v[252:253] op_sel:[0,0,0] op_sel_hi:[1,0,0]
    v_pk_fma_f32 v[48:49], v[48:49], v[252:253], v[252:253] op_sel:[0,1,1] op_sel_hi:[1,1,1]
    v_pk_fma_f32 v[50:51], v[50:51], v[252:253], v[252:253] op_sel:[0,1,1] op_sel_hi:[1,1,1]
    v_pk_fma_f32 v[52:53], v[52:53], v[252:253], v[252:253] op_sel:[0,1,1] op_sel_hi:[1,1,1]
    v_pk_fma_f32 v[54:55], v[54:55], v[252:253], v[252:253] op_sel:[0,1,1] op_sel_hi:[1,1,1]
    v_rcp_f32 v0, v0
    v_rcp_f32 v1, v1
    v_rcp_f32 v2, v2
    v_rcp_f32 v3, v3
    v_rcp_f32 v4, v4
    v_rcp_f32 v5, v5
    v_rcp_f32 v6, v6
    v_rcp_f32 v7, v7
    v_rcp_f32 v48, v48
    v_rcp_f32 v49, v49
    v_rcp_f32 v50, v50
    v_rcp_f32 v51, v51
    v_rcp_f32 v52, v52
    v_rcp_f32 v53, v53
    v_rcp_f32 v54, v54
    v_rcp_f32 v55, v55
    v_pk_mul_f32 v[24:25], v[24:25], v[0:1]
    v_pk_mul_f32 v[26:27], v[26:27], v[2:3]
    v_pk_mul_f32 v[28:29], v[28:29], v[4:5]
    v_pk_mul_f32 v[30:31], v[30:31], v[6:7]
    v_pk_mul_f32 v[72:73], v[72:73], v[48:49]
    v_pk_mul_f32 v[74:75], v[74:75], v[50:51]
    v_pk_mul_f32 v[76:77], v[76:77], v[52:53]
    v_pk_mul_f32 v[78:79], v[78:79], v[54:55]
    v_cvt_pk_bf16_f32 v0, v24, v25
    v_cvt_pk_bf16_f32 v1, v26, v27
    v_cvt_pk_bf16_f32 v2, v28, v29
    v_cvt_pk_bf16_f32 v3, v30, v31
    buffer_store_dwordx4 v[0:3], v249, s[20:23], s51 offen offset:0 sc1
    v_cvt_pk_bf16_f32 v48, v72, v73
    v_cvt_pk_bf16_f32 v49, v74, v75
    v_cvt_pk_bf16_f32 v50, v76, v77
    v_cvt_pk_bf16_f32 v51, v78, v79
    buffer_store_dwordx4 v[48:51], v249, s[20:23], s51 offen offset:1024 sc1
    v_pk_fma_f32 v[96:97], v[192:193], v[244:245], v[96:97] op_sel_hi:[1,0,1] neg_lo:[1,0,0] neg_hi:[1,0,0]
    v_pk_fma_f32 v[98:99], v[194:195], v[244:245], v[98:99] op_sel_hi:[1,0,1] neg_lo:[1,0,0] neg_hi:[1,0,0]
    v_pk_fma_f32 v[120:121], v[216:217], v[244:245], v[120:121] op_sel_hi:[1,0,1] neg_lo:[1,0,0] neg_hi:[1,0,0]
    v_pk_fma_f32 v[122:123], v[218:219], v[244:245], v[122:123] op_sel_hi:[1,0,1] neg_lo:[1,0,0] neg_hi:[1,0,0]
    v_pk_fma_f32 v[100:101], v[196:197], v[244:245], v[100:101] op_sel_hi:[1,0,1] neg_lo:[1,0,0] neg_hi:[1,0,0]
    v_pk_fma_f32 v[102:103], v[198:199], v[244:245], v[102:103] op_sel_hi:[1,0,1] neg_lo:[1,0,0] neg_hi:[1,0,0]
    v_pk_fma_f32 v[124:125], v[220:221], v[244:245], v[124:125] op_sel_hi:[1,0,1] neg_lo:[1,0,0] neg_hi:[1,0,0]
    v_pk_fma_f32 v[126:127], v[222:223], v[244:245], v[126:127] op_sel_hi:[1,0,1] neg_lo:[1,0,0] neg_hi:[1,0,0]
    v_pk_fma_f32 v[144:145], v[192:193], v[246:247], v[144:145] op_sel_hi:[1,0,1] neg_lo:[1,0,0] neg_hi:[1,0,0]
    v_pk_fma_f32 v[146:147], v[194:195], v[246:247], v[146:147] op_sel_hi:[1,0,1] neg_lo:[1,0,0] neg_hi:[1,0,0]
    v_pk_fma_f32 v[168:169], v[216:217], v[246:247], v[168:169] op_sel_hi:[1,0,1] neg_lo:[1,0,0] neg_hi:[1,0,0]
    v_pk_fma_f32 v[170:171], v[218:219], v[246:247], v[170:171] op_sel_hi:[1,0,1] neg_lo:[1,0,0] neg_hi:[1,0,0]
    v_pk_fma_f32 v[148:149], v[196:197], v[246:247], v[148:149] op_sel_hi:[1,0,1] neg_lo:[1,0,0] neg_hi:[1,0,0]
    v_pk_fma_f32 v[150:151], v[198:199], v[246:247], v[150:151] op_sel_hi:[1,0,1] neg_lo:[1,0,0] neg_hi:[1,0,0]
    v_pk_fma_f32 v[172:173], v[220:221], v[246:247], v[172:173] op_sel_hi:[1,0,1] neg_lo:[1,0,0] neg_hi:[1,0,0]
    v_pk_fma_f32 v[174:175], v[222:223], v[246:247], v[174:175] op_sel_hi:[1,0,1] neg_lo:[1,0,0] neg_hi:[1,0,0]
    v_pk_mul_f32 v[120:121], v[96:97], v[120:121]
    v_pk_mul_f32 v[122:123], v[98:99], v[122:123]
    v_pk_mul_f32 v[124:125], v[100:101], v[124:125]
    v_pk_mul_f32 v[126:127], v[102:103], v[126:127]
    v_pk_mul_f32 v[96:97], v[96:97], v[244:245] op_sel:[0,1] op_sel_hi:[1,1]
    v_pk_mul_f32 v[98:99], v[98:99], v[244:245] op_sel:[0,1] op_sel_hi:[1,1]
    v_pk_mul_f32 v[100:101], v[100:101], v[244:245] op_sel:[0,1] op_sel_hi:[1,1]
    v_pk_mul_f32 v[102:103], v[102:103], v[244:245] op_sel:[0,1] op_sel_hi:[1,1]
    v_pk_mul_f32 v[168:169], v[144:145], v[168:169]
    v_pk_mul_f32 v[170:171], v[146:147], v[170:171]
    v_pk_mul_f32 v[172:173], v[148:149], v[172:173]
    v_pk_mul_f32 v[174:175], v[150:151], v[174:175]
    v_pk_mul_f32 v[144:145], v[144:145], v[246:247] op_sel:[0,1] op_sel_hi:[1,1]
    v_pk_mul_f32 v[146:147], v[146:147], v[246:247] op_sel:[0,1] op_sel_hi:[1,1]
    v_pk_mul_f32 v[148:149], v[148:149], v[246:247] op_sel:[0,1] op_sel_hi:[1,1]
    v_pk_mul_f32 v[150:151], v[150:151], v[246:247] op_sel:[0,1] op_sel_hi:[1,1]
    v_exp_f32 v96, v96
    v_exp_f32 v97, v97
    v_exp_f32 v98, v98
    v_exp_f32 v99, v99
    v_exp_f32 v100, v100
    v_exp_f32 v101, v101
    v_exp_f32 v102, v102
    v_exp_f32 v103, v103
    v_exp_f32 v144, v144
    v_exp_f32 v145, v145
    v_exp_f32 v146, v146
    v_exp_f32 v147, v147
    v_exp_f32 v148, v148
    v_exp_f32 v149, v149
    v_exp_f32 v150, v150
    v_exp_f32 v151, v151
    v_pk_fma_f32 v[96:97], v[96:97], v[254:255], v[254:255] op_sel:[0,0,0] op_sel_hi:[1,0,0]
    v_pk_fma_f32 v[98:99], v[98:99], v[254:255], v[254:255] op_sel:[0,0,0] op_sel_hi:[1,0,0]
    v_pk_fma_f32 v[100:101], v[100:101], v[254:255], v[254:255] op_sel:[0,0,0] op_sel_hi:[1,0,0]
    v_pk_fma_f32 v[102:103], v[102:103], v[254:255], v[254:255] op_sel:[0,0,0] op_sel_hi:[1,0,0]
    v_pk_fma_f32 v[144:145], v[144:145], v[254:255], v[254:255] op_sel:[0,1,1] op_sel_hi:[1,1,1]
    v_pk_fma_f32 v[146:147], v[146:147], v[254:255], v[254:255] op_sel:[0,1,1] op_sel_hi:[1,1,1]
    v_pk_fma_f32 v[148:149], v[148:149], v[254:255], v[254:255] op_sel:[0,1,1] op_sel_hi:[1,1,1]
    v_pk_fma_f32 v[150:151], v[150:151], v[254:255], v[254:255] op_sel:[0,1,1] op_sel_hi:[1,1,1]
    v_rcp_f32 v96, v96
    v_rcp_f32 v97, v97
    v_rcp_f32 v98, v98
    v_rcp_f32 v99, v99
    v_rcp_f32 v100, v100
    v_rcp_f32 v101, v101
    v_rcp_f32 v102, v102
    v_rcp_f32 v103, v103
    v_rcp_f32 v144, v144
    v_rcp_f32 v145, v145
    v_rcp_f32 v146, v146
    v_rcp_f32 v147, v147
    v_rcp_f32 v148, v148
    v_rcp_f32 v149, v149
    v_rcp_f32 v150, v150
    v_rcp_f32 v151, v151
    v_pk_mul_f32 v[120:121], v[120:121], v[96:97]
    v_pk_mul_f32 v[122:123], v[122:123], v[98:99]
    v_pk_mul_f32 v[124:125], v[124:125], v[100:101]
    v_pk_mul_f32 v[126:127], v[126:127], v[102:103]
    v_pk_mul_f32 v[168:169], v[168:169], v[144:145]
    v_pk_mul_f32 v[170:171], v[170:171], v[146:147]
    v_pk_mul_f32 v[172:173], v[172:173], v[148:149]
    v_pk_mul_f32 v[174:175], v[174:175], v[150:151]
    v_cvt_pk_bf16_f32 v96, v120, v121
    v_cvt_pk_bf16_f32 v97, v122, v123
    v_cvt_pk_bf16_f32 v98, v124, v125
    v_cvt_pk_bf16_f32 v99, v126, v127
    buffer_store_dwordx4 v[96:99], v249, s[20:23], s51 offen offset:2048 sc1
    v_cvt_pk_bf16_f32 v144, v168, v169
    v_cvt_pk_bf16_f32 v145, v170, v171
    v_cvt_pk_bf16_f32 v146, v172, v173
    v_cvt_pk_bf16_f32 v147, v174, v175
    buffer_store_dwordx4 v[144:147], v249, s[20:23], s51 offen offset:3072 sc1
    s_add_u32 s51, s50, 4096
    v_pk_fma_f32 v[8:9], v[200:201], v[240:241], v[8:9] op_sel_hi:[1,0,1] neg_lo:[1,0,0] neg_hi:[1,0,0]
    v_pk_fma_f32 v[10:11], v[202:203], v[240:241], v[10:11] op_sel_hi:[1,0,1] neg_lo:[1,0,0] neg_hi:[1,0,0]
    v_pk_fma_f32 v[32:33], v[224:225], v[240:241], v[32:33] op_sel_hi:[1,0,1] neg_lo:[1,0,0] neg_hi:[1,0,0]
    v_pk_fma_f32 v[34:35], v[226:227], v[240:241], v[34:35] op_sel_hi:[1,0,1] neg_lo:[1,0,0] neg_hi:[1,0,0]
    v_pk_fma_f32 v[12:13], v[204:205], v[240:241], v[12:13] op_sel_hi:[1,0,1] neg_lo:[1,0,0] neg_hi:[1,0,0]
    v_pk_fma_f32 v[14:15], v[206:207], v[240:241], v[14:15] op_sel_hi:[1,0,1] neg_lo:[1,0,0] neg_hi:[1,0,0]
    v_pk_fma_f32 v[36:37], v[228:229], v[240:241], v[36:37] op_sel_hi:[1,0,1] neg_lo:[1,0,0] neg_hi:[1,0,0]
    v_pk_fma_f32 v[38:39], v[230:231], v[240:241], v[38:39] op_sel_hi:[1,0,1] neg_lo:[1,0,0] neg_hi:[1,0,0]
    v_pk_fma_f32 v[56:57], v[200:201], v[242:243], v[56:57] op_sel_hi:[1,0,1] neg_lo:[1,0,0] neg_hi:[1,0,0]
    v_pk_fma_f32 v[58:59], v[202:203], v[242:243], v[58:59] op_sel_hi:[1,0,1] neg_lo:[1,0,0] neg_hi:[1,0,0]
    v_pk_fma_f32 v[80:81], v[224:225], v[242:243], v[80:81] op_sel_hi:[1,0,1] neg_lo:[1,0,0] neg_hi:[1,0,0]
    v_pk_fma_f32 v[82:83], v[226:227], v[242:243], v[82:83] op_sel_hi:[1,0,1] neg_lo:[1,0,0] neg_hi:[1,0,0]
    v_pk_fma_f32 v[60:61], v[204:205], v[242:243], v[60:61] op_sel_hi:[1,0,1] neg_lo:[1,0,0] neg_hi:[1,0,0]
    v_pk_fma_f32 v[62:63], v[206:207], v[242:243], v[62:63] op_sel_hi:[1,0,1] neg_lo:[1,0,0] neg_hi:[1,0,0]
    v_pk_fma_f32 v[84:85], v[228:229], v[242:243], v[84:85] op_sel_hi:[1,0,1] neg_lo:[1,0,0] neg_hi:[1,0,0]
    v_pk_fma_f32 v[86:87], v[230:231], v[242:243], v[86:87] op_sel_hi:[1,0,1] neg_lo:[1,0,0] neg_hi:[1,0,0]
    v_pk_mul_f32 v[32:33], v[8:9], v[32:33]
    v_pk_mul_f32 v[34:35], v[10:11], v[34:35]
    v_pk_mul_f32 v[36:37], v[12:13], v[36:37]
    v_pk_mul_f32 v[38:39], v[14:15], v[38:39]
    v_pk_mul_f32 v[8:9], v[8:9], v[240:241] op_sel:[0,1] op_sel_hi:[1,1]
    v_pk_mul_f32 v[10:11], v[10:11], v[240:241] op_sel:[0,1] op_sel_hi:[1,1]
    v_pk_mul_f32 v[12:13], v[12:13], v[240:241] op_sel:[0,1] op_sel_hi:[1,1]
    v_pk_mul_f32 v[14:15], v[14:15], v[240:241] op_sel:[0,1] op_sel_hi:[1,1]
    v_pk_mul_f32 v[80:81], v[56:57], v[80:81]
    v_pk_mul_f32 v[82:83], v[58:59], v[82:83]
    v_pk_mul_f32 v[84:85], v[60:61], v[84:85]
    v_pk_mul_f32 v[86:87], v[62:63], v[86:87]
    v_pk_mul_f32 v[56:57], v[56:57], v[242:243] op_sel:[0,1] op_sel_hi:[1,1]
    v_pk_mul_f32 v[58:59], v[58:59], v[242:243] op_sel:[0,1] op_sel_hi:[1,1]
    v_pk_mul_f32 v[60:61], v[60:61], v[242:243] op_sel:[0,1] op_sel_hi:[1,1]
    v_pk_mul_f32 v[62:63], v[62:63], v[242:243] op_sel:[0,1] op_sel_hi:[1,1]
    v_exp_f32 v8, v8
    v_exp_f32 v9, v9
    v_exp_f32 v10, v10
    v_exp_f32 v11, v11
    v_exp_f32 v12, v12
    v_exp_f32 v13, v13
    v_exp_f32 v14, v14
    v_exp_f32 v15, v15
    v_exp_f32 v56, v56
    v_exp_f32 v57, v57
    v_exp_f32 v58, v58
    v_exp_f32 v59, v59
    v_exp_f32 v60, v60
    v_exp_f32 v61, v61
    v_exp_f32 v62, v62
    v_exp_f32 v63, v63
    v_pk_fma_f32 v[8:9], v[8:9], v[252:253], v[252:253] op_sel:[0,0,0] op_sel_hi:[1,0,0]
    v_pk_fma_f32 v[10:11], v[10:11], v[252:253], v[252:253] op_sel:[0,0,0] op_sel_hi:[1,0,0]
    v_pk_fma_f32 v[12:13], v[12:13], v[252:253], v[252:253] op_sel:[0,0,0] op_sel_hi:[1,0,0]
    v_pk_fma_f32 v[14:15], v[14:15], v[252:253], v[252:253] op_sel:[0,0,0] op_sel_hi:[1,0,0]
    v_pk_fma_f32 v[56:57], v[56:57], v[252:253], v[252:253] op_sel:[0,1,1] op_sel_hi:[1,1,1]
    v_pk_fma_f32 v[58:59], v[58:59], v[252:253], v[252:253] op_sel:[0,1,1] op_sel_hi:[1,1,1]
    v_pk_fma_f32 v[60:61], v[60:61], v[252:253], v[252:253] op_sel:[0,1,1] op_sel_hi:[1,1,1]
    v_pk_fma_f32 v[62:63], v[62:63], v[252:253], v[252:253] op_sel:[0,1,1] op_sel_hi:[1,1,1]
    v_rcp_f32 v8, v8
    v_rcp_f32 v9, v9
    v_rcp_f32 v10, v10
    v_rcp_f32 v11, v11
    v_rcp_f32 v12, v12
    v_rcp_f32 v13, v13
    v_rcp_f32 v14, v14
    v_rcp_f32 v15, v15
    v_rcp_f32 v56, v56
    v_rcp_f32 v57, v57
    v_rcp_f32 v58, v58
    v_rcp_f32 v59, v59
    v_rcp_f32 v60, v60
    v_rcp_f32 v61, v61
    v_rcp_f32 v62, v62
    v_rcp_f32 v63, v63
    v_pk_mul_f32 v[32:33], v[32:33], v[8:9]
    v_pk_mul_f32 v[34:35], v[34:35], v[10:11]
    v_pk_mul_f32 v[36:37], v[36:37], v[12:13]
    v_pk_mul_f32 v[38:39], v[38:39], v[14:15]
    v_pk_mul_f32 v[80:81], v[80:81], v[56:57]
    v_pk_mul_f32 v[82:83], v[82:83], v[58:59]
    v_pk_mul_f32 v[84:85], v[84:85], v[60:61]
    v_pk_mul_f32 v[86:87], v[86:87], v[62:63]
    v_cvt_pk_bf16_f32 v8, v32, v33
    v_cvt_pk_bf16_f32 v9, v34, v35
    v_cvt_pk_bf16_f32 v10, v36, v37
    v_cvt_pk_bf16_f32 v11, v38, v39
    buffer_store_dwordx4 v[8:11], v249, s[20:23], s51 offen offset:0 sc1
    v_cvt_pk_bf16_f32 v56, v80, v81
    v_cvt_pk_bf16_f32 v57, v82, v83
    v_cvt_pk_bf16_f32 v58, v84, v85
    v_cvt_pk_bf16_f32 v59, v86, v87
    buffer_store_dwordx4 v[56:59], v249, s[20:23], s51 offen offset:1024 sc1
    v_pk_fma_f32 v[104:105], v[200:201], v[244:245], v[104:105] op_sel_hi:[1,0,1] neg_lo:[1,0,0] neg_hi:[1,0,0]
    v_pk_fma_f32 v[106:107], v[202:203], v[244:245], v[106:107] op_sel_hi:[1,0,1] neg_lo:[1,0,0] neg_hi:[1,0,0]
    v_pk_fma_f32 v[128:129], v[224:225], v[244:245], v[128:129] op_sel_hi:[1,0,1] neg_lo:[1,0,0] neg_hi:[1,0,0]
    v_pk_fma_f32 v[130:131], v[226:227], v[244:245], v[130:131] op_sel_hi:[1,0,1] neg_lo:[1,0,0] neg_hi:[1,0,0]
    v_pk_fma_f32 v[108:109], v[204:205], v[244:245], v[108:109] op_sel_hi:[1,0,1] neg_lo:[1,0,0] neg_hi:[1,0,0]
    v_pk_fma_f32 v[110:111], v[206:207], v[244:245], v[110:111] op_sel_hi:[1,0,1] neg_lo:[1,0,0] neg_hi:[1,0,0]
    v_pk_fma_f32 v[132:133], v[228:229], v[244:245], v[132:133] op_sel_hi:[1,0,1] neg_lo:[1,0,0] neg_hi:[1,0,0]
    v_pk_fma_f32 v[134:135], v[230:231], v[244:245], v[134:135] op_sel_hi:[1,0,1] neg_lo:[1,0,0] neg_hi:[1,0,0]
    v_pk_fma_f32 v[152:153], v[200:201], v[246:247], v[152:153] op_sel_hi:[1,0,1] neg_lo:[1,0,0] neg_hi:[1,0,0]
    v_pk_fma_f32 v[154:155], v[202:203], v[246:247], v[154:155] op_sel_hi:[1,0,1] neg_lo:[1,0,0] neg_hi:[1,0,0]
    v_pk_fma_f32 v[176:177], v[224:225], v[246:247], v[176:177] op_sel_hi:[1,0,1] neg_lo:[1,0,0] neg_hi:[1,0,0]
    v_pk_fma_f32 v[178:179], v[226:227], v[246:247], v[178:179] op_sel_hi:[1,0,1] neg_lo:[1,0,0] neg_hi:[1,0,0]
    v_pk_fma_f32 v[156:157], v[204:205], v[246:247], v[156:157] op_sel_hi:[1,0,1] neg_lo:[1,0,0] neg_hi:[1,0,0]
    v_pk_fma_f32 v[158:159], v[206:207], v[246:247], v[158:159] op_sel_hi:[1,0,1] neg_lo:[1,0,0] neg_hi:[1,0,0]
    v_pk_fma_f32 v[180:181], v[228:229], v[246:247], v[180:181] op_sel_hi:[1,0,1] neg_lo:[1,0,0] neg_hi:[1,0,0]
    v_pk_fma_f32 v[182:183], v[230:231], v[246:247], v[182:183] op_sel_hi:[1,0,1] neg_lo:[1,0,0] neg_hi:[1,0,0]
    v_pk_mul_f32 v[128:129], v[104:105], v[128:129]
    v_pk_mul_f32 v[130:131], v[106:107], v[130:131]
    v_pk_mul_f32 v[132:133], v[108:109], v[132:133]
    v_pk_mul_f32 v[134:135], v[110:111], v[134:135]
    v_pk_mul_f32 v[104:105], v[104:105], v[244:245] op_sel:[0,1] op_sel_hi:[1,1]
    v_pk_mul_f32 v[106:107], v[106:107], v[244:245] op_sel:[0,1] op_sel_hi:[1,1]
    v_pk_mul_f32 v[108:109], v[108:109], v[244:245] op_sel:[0,1] op_sel_hi:[1,1]
    v_pk_mul_f32 v[110:111], v[110:111], v[244:245] op_sel:[0,1] op_sel_hi:[1,1]
    v_pk_mul_f32 v[176:177], v[152:153], v[176:177]
    v_pk_mul_f32 v[178:179], v[154:155], v[178:179]
    v_pk_mul_f32 v[180:181], v[156:157], v[180:181]
    v_pk_mul_f32 v[182:183], v[158:159], v[182:183]
    v_pk_mul_f32 v[152:153], v[152:153], v[246:247] op_sel:[0,1] op_sel_hi:[1,1]
    v_pk_mul_f32 v[154:155], v[154:155], v[246:247] op_sel:[0,1] op_sel_hi:[1,1]
    v_pk_mul_f32 v[156:157], v[156:157], v[246:247] op_sel:[0,1] op_sel_hi:[1,1]
    v_pk_mul_f32 v[158:159], v[158:159], v[246:247] op_sel:[0,1] op_sel_hi:[1,1]
    v_exp_f32 v104, v104
    v_exp_f32 v105, v105
    v_exp_f32 v106, v106
    v_exp_f32 v107, v107
    v_exp_f32 v108, v108
    v_exp_f32 v109, v109
    v_exp_f32 v110, v110
    v_exp_f32 v111, v111
    v_exp_f32 v152, v152
    v_exp_f32 v153, v153
    v_exp_f32 v154, v154
    v_exp_f32 v155, v155
    v_exp_f32 v156, v156
    v_exp_f32 v157, v157
    v_exp_f32 v158, v158
    v_exp_f32 v159, v159
    v_pk_fma_f32 v[104:105], v[104:105], v[254:255], v[254:255] op_sel:[0,0,0] op_sel_hi:[1,0,0]
    v_pk_fma_f32 v[106:107], v[106:107], v[254:255], v[254:255] op_sel:[0,0,0] op_sel_hi:[1,0,0]
    v_pk_fma_f32 v[108:109], v[108:109], v[254:255], v[254:255] op_sel:[0,0,0] op_sel_hi:[1,0,0]
    v_pk_fma_f32 v[110:111], v[110:111], v[254:255], v[254:255] op_sel:[0,0,0] op_sel_hi:[1,0,0]
    v_pk_fma_f32 v[152:153], v[152:153], v[254:255], v[254:255] op_sel:[0,1,1] op_sel_hi:[1,1,1]
    v_pk_fma_f32 v[154:155], v[154:155], v[254:255], v[254:255] op_sel:[0,1,1] op_sel_hi:[1,1,1]
    v_pk_fma_f32 v[156:157], v[156:157], v[254:255], v[254:255] op_sel:[0,1,1] op_sel_hi:[1,1,1]
    v_pk_fma_f32 v[158:159], v[158:159], v[254:255], v[254:255] op_sel:[0,1,1] op_sel_hi:[1,1,1]
    v_rcp_f32 v104, v104
    v_rcp_f32 v105, v105
    v_rcp_f32 v106, v106
    v_rcp_f32 v107, v107
    v_rcp_f32 v108, v108
    v_rcp_f32 v109, v109
    v_rcp_f32 v110, v110
    v_rcp_f32 v111, v111
    v_rcp_f32 v152, v152
    v_rcp_f32 v153, v153
    v_rcp_f32 v154, v154
    v_rcp_f32 v155, v155
    v_rcp_f32 v156, v156
    v_rcp_f32 v157, v157
    v_rcp_f32 v158, v158
    v_rcp_f32 v159, v159
    v_pk_mul_f32 v[128:129], v[128:129], v[104:105]
    v_pk_mul_f32 v[130:131], v[130:131], v[106:107]
    v_pk_mul_f32 v[132:133], v[132:133], v[108:109]
    v_pk_mul_f32 v[134:135], v[134:135], v[110:111]
    v_pk_mul_f32 v[176:177], v[176:177], v[152:153]
    v_pk_mul_f32 v[178:179], v[178:179], v[154:155]
    v_pk_mul_f32 v[180:181], v[180:181], v[156:157]
    v_pk_mul_f32 v[182:183], v[182:183], v[158:159]
    v_cvt_pk_bf16_f32 v104, v128, v129
    v_cvt_pk_bf16_f32 v105, v130, v131
    v_cvt_pk_bf16_f32 v106, v132, v133
    v_cvt_pk_bf16_f32 v107, v134, v135
    buffer_store_dwordx4 v[104:107], v249, s[20:23], s51 offen offset:2048 sc1
    v_cvt_pk_bf16_f32 v152, v176, v177
    v_cvt_pk_bf16_f32 v153, v178, v179
    v_cvt_pk_bf16_f32 v154, v180, v181
    v_cvt_pk_bf16_f32 v155, v182, v183
    buffer_store_dwordx4 v[152:155], v249, s[20:23], s51 offen offset:3072 sc1
    s_add_u32 s51, s50, 8192
    v_pk_fma_f32 v[16:17], v[208:209], v[240:241], v[16:17] op_sel_hi:[1,0,1] neg_lo:[1,0,0] neg_hi:[1,0,0]
    v_pk_fma_f32 v[18:19], v[210:211], v[240:241], v[18:19] op_sel_hi:[1,0,1] neg_lo:[1,0,0] neg_hi:[1,0,0]
    v_pk_fma_f32 v[40:41], v[232:233], v[240:241], v[40:41] op_sel_hi:[1,0,1] neg_lo:[1,0,0] neg_hi:[1,0,0]
    v_pk_fma_f32 v[42:43], v[234:235], v[240:241], v[42:43] op_sel_hi:[1,0,1] neg_lo:[1,0,0] neg_hi:[1,0,0]
    v_pk_fma_f32 v[20:21], v[212:213], v[240:241], v[20:21] op_sel_hi:[1,0,1] neg_lo:[1,0,0] neg_hi:[1,0,0]
    v_pk_fma_f32 v[22:23], v[214:215], v[240:241], v[22:23] op_sel_hi:[1,0,1] neg_lo:[1,0,0] neg_hi:[1,0,0]
    v_pk_fma_f32 v[44:45], v[236:237], v[240:241], v[44:45] op_sel_hi:[1,0,1] neg_lo:[1,0,0] neg_hi:[1,0,0]
    v_pk_fma_f32 v[46:47], v[238:239], v[240:241], v[46:47] op_sel_hi:[1,0,1] neg_lo:[1,0,0] neg_hi:[1,0,0]
    v_pk_fma_f32 v[64:65], v[208:209], v[242:243], v[64:65] op_sel_hi:[1,0,1] neg_lo:[1,0,0] neg_hi:[1,0,0]
    v_pk_fma_f32 v[66:67], v[210:211], v[242:243], v[66:67] op_sel_hi:[1,0,1] neg_lo:[1,0,0] neg_hi:[1,0,0]
    v_pk_fma_f32 v[88:89], v[232:233], v[242:243], v[88:89] op_sel_hi:[1,0,1] neg_lo:[1,0,0] neg_hi:[1,0,0]
    v_pk_fma_f32 v[90:91], v[234:235], v[242:243], v[90:91] op_sel_hi:[1,0,1] neg_lo:[1,0,0] neg_hi:[1,0,0]
    v_pk_fma_f32 v[68:69], v[212:213], v[242:243], v[68:69] op_sel_hi:[1,0,1] neg_lo:[1,0,0] neg_hi:[1,0,0]
    v_pk_fma_f32 v[70:71], v[214:215], v[242:243], v[70:71] op_sel_hi:[1,0,1] neg_lo:[1,0,0] neg_hi:[1,0,0]
    v_pk_fma_f32 v[92:93], v[236:237], v[242:243], v[92:93] op_sel_hi:[1,0,1] neg_lo:[1,0,0] neg_hi:[1,0,0]
    v_pk_fma_f32 v[94:95], v[238:239], v[242:243], v[94:95] op_sel_hi:[1,0,1] neg_lo:[1,0,0] neg_hi:[1,0,0]
    v_pk_mul_f32 v[40:41], v[16:17], v[40:41]
    v_pk_mul_f32 v[42:43], v[18:19], v[42:43]
    v_pk_mul_f32 v[44:45], v[20:21], v[44:45]
    v_pk_mul_f32 v[46:47], v[22:23], v[46:47]
    v_pk_mul_f32 v[16:17], v[16:17], v[240:241] op_sel:[0,1] op_sel_hi:[1,1]
    v_pk_mul_f32 v[18:19], v[18:19], v[240:241] op_sel:[0,1] op_sel_hi:[1,1]
    v_pk_mul_f32 v[20:21], v[20:21], v[240:241] op_sel:[0,1] op_sel_hi:[1,1]
    v_pk_mul_f32 v[22:23], v[22:23], v[240:241] op_sel:[0,1] op_sel_hi:[1,1]
    v_pk_mul_f32 v[88:89], v[64:65], v[88:89]
    v_pk_mul_f32 v[90:91], v[66:67], v[90:91]
    v_pk_mul_f32 v[92:93], v[68:69], v[92:93]
    v_pk_mul_f32 v[94:95], v[70:71], v[94:95]
    v_pk_mul_f32 v[64:65], v[64:65], v[242:243] op_sel:[0,1] op_sel_hi:[1,1]
    v_pk_mul_f32 v[66:67], v[66:67], v[242:243] op_sel:[0,1] op_sel_hi:[1,1]
    v_pk_mul_f32 v[68:69], v[68:69], v[242:243] op_sel:[0,1] op_sel_hi:[1,1]
    v_pk_mul_f32 v[70:71], v[70:71], v[242:243] op_sel:[0,1] op_sel_hi:[1,1]
    v_exp_f32 v16, v16
    v_exp_f32 v17, v17
    v_exp_f32 v18, v18
    v_exp_f32 v19, v19
    v_exp_f32 v20, v20
    v_exp_f32 v21, v21
    v_exp_f32 v22, v22
    v_exp_f32 v23, v23
    v_exp_f32 v64, v64
    v_exp_f32 v65, v65
    v_exp_f32 v66, v66
    v_exp_f32 v67, v67
    v_exp_f32 v68, v68
    v_exp_f32 v69, v69
    v_exp_f32 v70, v70
    v_exp_f32 v71, v71
    v_pk_fma_f32 v[16:17], v[16:17], v[252:253], v[252:253] op_sel:[0,0,0] op_sel_hi:[1,0,0]
    v_pk_fma_f32 v[18:19], v[18:19], v[252:253], v[252:253] op_sel:[0,0,0] op_sel_hi:[1,0,0]
    v_pk_fma_f32 v[20:21], v[20:21], v[252:253], v[252:253] op_sel:[0,0,0] op_sel_hi:[1,0,0]
    v_pk_fma_f32 v[22:23], v[22:23], v[252:253], v[252:253] op_sel:[0,0,0] op_sel_hi:[1,0,0]
    v_pk_fma_f32 v[64:65], v[64:65], v[252:253], v[252:253] op_sel:[0,1,1] op_sel_hi:[1,1,1]
    v_pk_fma_f32 v[66:67], v[66:67], v[252:253], v[252:253] op_sel:[0,1,1] op_sel_hi:[1,1,1]
    v_pk_fma_f32 v[68:69], v[68:69], v[252:253], v[252:253] op_sel:[0,1,1] op_sel_hi:[1,1,1]
    v_pk_fma_f32 v[70:71], v[70:71], v[252:253], v[252:253] op_sel:[0,1,1] op_sel_hi:[1,1,1]
    v_rcp_f32 v16, v16
    v_rcp_f32 v17, v17
    v_rcp_f32 v18, v18
    v_rcp_f32 v19, v19
    v_rcp_f32 v20, v20
    v_rcp_f32 v21, v21
    v_rcp_f32 v22, v22
    v_rcp_f32 v23, v23
    v_rcp_f32 v64, v64
    v_rcp_f32 v65, v65
    v_rcp_f32 v66, v66
    v_rcp_f32 v67, v67
    v_rcp_f32 v68, v68
    v_rcp_f32 v69, v69
    v_rcp_f32 v70, v70
    v_rcp_f32 v71, v71
    v_pk_mul_f32 v[40:41], v[40:41], v[16:17]
    v_pk_mul_f32 v[42:43], v[42:43], v[18:19]
    v_pk_mul_f32 v[44:45], v[44:45], v[20:21]
    v_pk_mul_f32 v[46:47], v[46:47], v[22:23]
    v_pk_mul_f32 v[88:89], v[88:89], v[64:65]
    v_pk_mul_f32 v[90:91], v[90:91], v[66:67]
    v_pk_mul_f32 v[92:93], v[92:93], v[68:69]
    v_pk_mul_f32 v[94:95], v[94:95], v[70:71]
    v_cvt_pk_bf16_f32 v16, v40, v41
    v_cvt_pk_bf16_f32 v17, v42, v43
    v_cvt_pk_bf16_f32 v18, v44, v45
    v_cvt_pk_bf16_f32 v19, v46, v47
    buffer_store_dwordx4 v[16:19], v249, s[20:23], s51 offen offset:0 sc1
    v_cvt_pk_bf16_f32 v64, v88, v89
    v_cvt_pk_bf16_f32 v65, v90, v91
    v_cvt_pk_bf16_f32 v66, v92, v93
    v_cvt_pk_bf16_f32 v67, v94, v95
    buffer_store_dwordx4 v[64:67], v249, s[20:23], s51 offen offset:1024 sc1
    v_pk_fma_f32 v[112:113], v[208:209], v[244:245], v[112:113] op_sel_hi:[1,0,1] neg_lo:[1,0,0] neg_hi:[1,0,0]
    v_pk_fma_f32 v[114:115], v[210:211], v[244:245], v[114:115] op_sel_hi:[1,0,1] neg_lo:[1,0,0] neg_hi:[1,0,0]
    v_pk_fma_f32 v[136:137], v[232:233], v[244:245], v[136:137] op_sel_hi:[1,0,1] neg_lo:[1,0,0] neg_hi:[1,0,0]
    v_pk_fma_f32 v[138:139], v[234:235], v[244:245], v[138:139] op_sel_hi:[1,0,1] neg_lo:[1,0,0] neg_hi:[1,0,0]
    v_pk_fma_f32 v[116:117], v[212:213], v[244:245], v[116:117] op_sel_hi:[1,0,1] neg_lo:[1,0,0] neg_hi:[1,0,0]
    v_pk_fma_f32 v[118:119], v[214:215], v[244:245], v[118:119] op_sel_hi:[1,0,1] neg_lo:[1,0,0] neg_hi:[1,0,0]
    v_pk_fma_f32 v[140:141], v[236:237], v[244:245], v[140:141] op_sel_hi:[1,0,1] neg_lo:[1,0,0] neg_hi:[1,0,0]
    v_pk_fma_f32 v[142:143], v[238:239], v[244:245], v[142:143] op_sel_hi:[1,0,1] neg_lo:[1,0,0] neg_hi:[1,0,0]
    v_pk_fma_f32 v[160:161], v[208:209], v[246:247], v[160:161] op_sel_hi:[1,0,1] neg_lo:[1,0,0] neg_hi:[1,0,0]
    v_pk_fma_f32 v[162:163], v[210:211], v[246:247], v[162:163] op_sel_hi:[1,0,1] neg_lo:[1,0,0] neg_hi:[1,0,0]
    v_pk_fma_f32 v[184:185], v[232:233], v[246:247], v[184:185] op_sel_hi:[1,0,1] neg_lo:[1,0,0] neg_hi:[1,0,0]
    v_pk_fma_f32 v[186:187], v[234:235], v[246:247], v[186:187] op_sel_hi:[1,0,1] neg_lo:[1,0,0] neg_hi:[1,0,0]
    v_pk_fma_f32 v[164:165], v[212:213], v[246:247], v[164:165] op_sel_hi:[1,0,1] neg_lo:[1,0,0] neg_hi:[1,0,0]
    v_pk_fma_f32 v[166:167], v[214:215], v[246:247], v[166:167] op_sel_hi:[1,0,1] neg_lo:[1,0,0] neg_hi:[1,0,0]
    v_pk_fma_f32 v[188:189], v[236:237], v[246:247], v[188:189] op_sel_hi:[1,0,1] neg_lo:[1,0,0] neg_hi:[1,0,0]
    v_pk_fma_f32 v[190:191], v[238:239], v[246:247], v[190:191] op_sel_hi:[1,0,1] neg_lo:[1,0,0] neg_hi:[1,0,0]
    v_pk_mul_f32 v[136:137], v[112:113], v[136:137]
    v_pk_mul_f32 v[138:139], v[114:115], v[138:139]
    v_pk_mul_f32 v[140:141], v[116:117], v[140:141]
    v_pk_mul_f32 v[142:143], v[118:119], v[142:143]
    v_pk_mul_f32 v[112:113], v[112:113], v[244:245] op_sel:[0,1] op_sel_hi:[1,1]
    v_pk_mul_f32 v[114:115], v[114:115], v[244:245] op_sel:[0,1] op_sel_hi:[1,1]
    v_pk_mul_f32 v[116:117], v[116:117], v[244:245] op_sel:[0,1] op_sel_hi:[1,1]
    v_pk_mul_f32 v[118:119], v[118:119], v[244:245] op_sel:[0,1] op_sel_hi:[1,1]
    v_pk_mul_f32 v[184:185], v[160:161], v[184:185]
    v_pk_mul_f32 v[186:187], v[162:163], v[186:187]
    v_pk_mul_f32 v[188:189], v[164:165], v[188:189]
    v_pk_mul_f32 v[190:191], v[166:167], v[190:191]
    v_pk_mul_f32 v[160:161], v[160:161], v[246:247] op_sel:[0,1] op_sel_hi:[1,1]
    v_pk_mul_f32 v[162:163], v[162:163], v[246:247] op_sel:[0,1] op_sel_hi:[1,1]
    v_pk_mul_f32 v[164:165], v[164:165], v[246:247] op_sel:[0,1] op_sel_hi:[1,1]
    v_pk_mul_f32 v[166:167], v[166:167], v[246:247] op_sel:[0,1] op_sel_hi:[1,1]
    v_exp_f32 v112, v112
    v_exp_f32 v113, v113
    v_exp_f32 v114, v114
    v_exp_f32 v115, v115
    v_exp_f32 v116, v116
    v_exp_f32 v117, v117
    v_exp_f32 v118, v118
    v_exp_f32 v119, v119
    v_exp_f32 v160, v160
    v_exp_f32 v161, v161
    v_exp_f32 v162, v162
    v_exp_f32 v163, v163
    v_exp_f32 v164, v164
    v_exp_f32 v165, v165
    v_exp_f32 v166, v166
    v_exp_f32 v167, v167
    v_pk_fma_f32 v[112:113], v[112:113], v[254:255], v[254:255] op_sel:[0,0,0] op_sel_hi:[1,0,0]
    v_pk_fma_f32 v[114:115], v[114:115], v[254:255], v[254:255] op_sel:[0,0,0] op_sel_hi:[1,0,0]
    v_pk_fma_f32 v[116:117], v[116:117], v[254:255], v[254:255] op_sel:[0,0,0] op_sel_hi:[1,0,0]
    v_pk_fma_f32 v[118:119], v[118:119], v[254:255], v[254:255] op_sel:[0,0,0] op_sel_hi:[1,0,0]
    v_pk_fma_f32 v[160:161], v[160:161], v[254:255], v[254:255] op_sel:[0,1,1] op_sel_hi:[1,1,1]
    v_pk_fma_f32 v[162:163], v[162:163], v[254:255], v[254:255] op_sel:[0,1,1] op_sel_hi:[1,1,1]
    v_pk_fma_f32 v[164:165], v[164:165], v[254:255], v[254:255] op_sel:[0,1,1] op_sel_hi:[1,1,1]
    v_pk_fma_f32 v[166:167], v[166:167], v[254:255], v[254:255] op_sel:[0,1,1] op_sel_hi:[1,1,1]
    v_rcp_f32 v112, v112
    v_rcp_f32 v113, v113
    v_rcp_f32 v114, v114
    v_rcp_f32 v115, v115
    v_rcp_f32 v116, v116
    v_rcp_f32 v117, v117
    v_rcp_f32 v118, v118
    v_rcp_f32 v119, v119
    v_rcp_f32 v160, v160
    v_rcp_f32 v161, v161
    v_rcp_f32 v162, v162
    v_rcp_f32 v163, v163
    v_rcp_f32 v164, v164
    v_rcp_f32 v165, v165
    v_rcp_f32 v166, v166
    v_rcp_f32 v167, v167
    v_pk_mul_f32 v[136:137], v[136:137], v[112:113]
    v_pk_mul_f32 v[138:139], v[138:139], v[114:115]
    v_pk_mul_f32 v[140:141], v[140:141], v[116:117]
    v_pk_mul_f32 v[142:143], v[142:143], v[118:119]
    v_pk_mul_f32 v[184:185], v[184:185], v[160:161]
    v_pk_mul_f32 v[186:187], v[186:187], v[162:163]
    v_pk_mul_f32 v[188:189], v[188:189], v[164:165]
    v_pk_mul_f32 v[190:191], v[190:191], v[166:167]
    v_cvt_pk_bf16_f32 v112, v136, v137
    v_cvt_pk_bf16_f32 v113, v138, v139
    v_cvt_pk_bf16_f32 v114, v140, v141
    v_cvt_pk_bf16_f32 v115, v142, v143
    buffer_store_dwordx4 v[112:115], v249, s[20:23], s51 offen offset:2048 sc1
    v_cvt_pk_bf16_f32 v160, v184, v185
    v_cvt_pk_bf16_f32 v161, v186, v187
    v_cvt_pk_bf16_f32 v162, v188, v189
    v_cvt_pk_bf16_f32 v163, v190, v191
    buffer_store_dwordx4 v[160:163], v249, s[20:23], s51 offen offset:3072 sc1
    s_lshl_b32 s57, s37, 7
    s_add_u32 s57, s57, 20045824
    s_mov_b32 s56, 17
    v_mov_b32 v0, v248
    s_branch P2_stream
K1_c_qkv:
    s_lshl_b32 s57, s35, 3
    s_add_u32 s57, s57, s32
    s_lshl_b32 s57, s57, 2
    s_add_u32 s57, s57, s3
    s_lshl_b32 s57, s57, 11
    s_add_u32 s57, s57, 20971520
    s_barrier
    ds_read_b128 v[192:195], v244 offset:0
    ds_read_b64_tr_b16 v[224:225], v246 offset:0
    ds_read_b64_tr_b16 v[226:227], v246 offset:1280
    ds_read_b128 v[196:199], v244 offset:2048
    ds_read_b128 v[200:203], v244 offset:4096
    ds_read_b128 v[204:207], v244 offset:6144
    ds_read_b64_tr_b16 v[228:229], v247 offset:32
    ds_read_b64_tr_b16 v[230:231], v247 offset:1312
    ds_read_b64_tr_b16 v[232:233], v246 offset:64
    ds_read_b64_tr_b16 v[234:235], v246 offset:1344
    ds_read_b64_tr_b16 v[236:237], v247 offset:96
    ds_read_b64_tr_b16 v[238:239], v247 offset:1376
    s_waitcnt lgkmcnt(9)
    v_mfma_f32_16x16x32_bf16 v[0:3], v[224:227], v[192:195], 0
    ds_read_b64_tr_b16 v[240:241], v246 offset:128
    s_waitcnt lgkmcnt(9)
    v_mfma_f32_16x16x32_bf16 v[48:51], v[224:227], v[196:199], 0
    ds_read_b64_tr_b16 v[242:243], v246 offset:1408
    s_waitcnt lgkmcnt(9)
    v_mfma_f32_16x16x32_bf16 v[96:99], v[224:227], v[200:203], 0
    s_waitcnt lgkmcnt(8)
    v_mfma_f32_16x16x32_bf16 v[144:147], v[224:227], v[204:207], 0
    s_waitcnt lgkmcnt(6)
    v_mfma_f32_16x16x32_bf16 v[4:7], v[228:231], v[192:195], 0
    ds_read_b64_tr_b16 v[224:225], v247 offset:160
    v_mfma_f32_16x16x32_bf16 v[52:55], v[228:231], v[196:199], 0
    ds_read_b64_tr_b16 v[226:227], v247 offset:1440
    v_mfma_f32_16x16x32_bf16 v[100:103], v[228:231], v[200:203], 0
    v_mfma_f32_16x16x32_bf16 v[148:151], v[228:231], v[204:207], 0
    s_waitcnt lgkmcnt(6)
    v_mfma_f32_16x16x32_bf16 v[8:11], v[232:235], v[192:195], 0
    ds_read_b64_tr_b16 v[228:229], v246 offset:192
    v_mfma_f32_16x16x32_bf16 v[56:59], v[232:235], v[196:199], 0
    ds_read_b64_tr_b16 v[230:231], v246 offset:1472
    v_mfma_f32_16x16x32_bf16 v[104:107], v[232:235], v[200:203], 0
    v_mfma_f32_16x16x32_bf16 v[152:155], v[232:235], v[204:207], 0
    s_waitcnt lgkmcnt(6)
    v_mfma_f32_16x16x32_bf16 v[12:15], v[236:239], v[192:195], 0
    ds_read_b64_tr_b16 v[232:233], v247 offset:224
    v_mfma_f32_16x16x32_bf16 v[60:63], v[236:239], v[196:199], 0
    ds_read_b64_tr_b16 v[234:235], v247 offset:1504
    v_mfma_f32_16x16x32_bf16 v[108:111], v[236:239], v[200:203], 0
    v_mfma_f32_16x16x32_bf16 v[156:159], v[236:239], v[204:207], 0
    s_waitcnt lgkmcnt(6)
    v_mfma_f32_16x16x32_bf16 v[16:19], v[240:243], v[192:195], 0
    ds_read_b64_tr_b16 v[236:237], v246 offset:256
    v_mfma_f32_16x16x32_bf16 v[64:67], v[240:243], v[196:199], 0
    ds_read_b64_tr_b16 v[238:239], v246 offset:1536
    v_mfma_f32_16x16x32_bf16 v[112:115], v[240:243], v[200:203], 0
    v_mfma_f32_16x16x32_bf16 v[160:163], v[240:243], v[204:207], 0
    s_waitcnt lgkmcnt(6)
    v_mfma_f32_16x16x32_bf16 v[20:23], v[224:227], v[192:195], 0
    ds_read_b64_tr_b16 v[240:241], v247 offset:288
    v_mfma_f32_16x16x32_bf16 v[68:71], v[224:227], v[196:199], 0
    ds_read_b64_tr_b16 v[242:243], v247 offset:1568
    v_mfma_f32_16x16x32_bf16 v[116:119], v[224:227], v[200:203], 0
    v_mfma_f32_16x16x32_bf16 v[164:167], v[224:227], v[204:207], 0
    s_waitcnt lgkmcnt(6)
    v_mfma_f32_16x16x32_bf16 v[24:27], v[228:231], v[192:195], 0
    s_barrier
    ds_read_b64_tr_b16 v[224:225], v246 offset:10240
    v_mfma_f32_16x16x32_bf16 v[72:75], v[228:231], v[196:199], 0
    ds_read_b64_tr_b16 v[226:227], v246 offset:11520
    v_mfma_f32_16x16x32_bf16 v[120:123], v[228:231], v[200:203], 0
    ds_read_b128 v[208:211], v245 offset:0
    v_mfma_f32_16x16x32_bf16 v[168:171], v[228:231], v[204:207], 0
    s_waitcnt lgkmcnt(7)
    v_mfma_f32_16x16x32_bf16 v[28:31], v[232:235], v[192:195], 0
    ds_read_b64_tr_b16 v[228:229], v247 offset:10272
    v_mfma_f32_16x16x32_bf16 v[76:79], v[232:235], v[196:199], 0
    ds_read_b64_tr_b16 v[230:231], v247 offset:11552
    v_mfma_f32_16x16x32_bf16 v[124:127], v[232:235], v[200:203], 0
    ds_read_b128 v[212:215], v245 offset:2048
    v_mfma_f32_16x16x32_bf16 v[172:175], v[232:235], v[204:207], 0
    s_waitcnt lgkmcnt(8)
    v_mfma_f32_16x16x32_bf16 v[32:35], v[236:239], v[192:195], 0
    ds_read_b64_tr_b16 v[232:233], v246 offset:10304
    v_mfma_f32_16x16x32_bf16 v[80:83], v[236:239], v[196:199], 0
    ds_read_b64_tr_b16 v[234:235], v246 offset:11584
    v_mfma_f32_16x16x32_bf16 v[128:131], v[236:239], v[200:203], 0
    ds_read_b128 v[216:219], v245 offset:4096
    v_mfma_f32_16x16x32_bf16 v[176:179], v[236:239], v[204:207], 0
    s_waitcnt lgkmcnt(9)
    v_mfma_f32_16x16x32_bf16 v[36:39], v[240:243], v[192:195], 0
    ds_read_b64_tr_b16 v[236:237], v247 offset:10336
    v_mfma_f32_16x16x32_bf16 v[84:87], v[240:243], v[196:199], 0
    ds_read_b64_tr_b16 v[238:239], v247 offset:11616
    v_mfma_f32_16x16x32_bf16 v[132:135], v[240:243], v[200:203], 0
    ds_read_b128 v[220:223], v245 offset:6144
    v_mfma_f32_16x16x32_bf16 v[180:183], v[240:243], v[204:207], 0
    s_waitcnt lgkmcnt(9)
    v_mfma_f32_16x16x32_bf16 v[0:3], v[224:227], v[208:211], v[0:3]
    ds_read_b64_tr_b16 v[240:241], v246 offset:10368
    s_waitcnt lgkmcnt(7)
    v_mfma_f32_16x16x32_bf16 v[48:51], v[224:227], v[212:215], v[48:51]
    ds_read_b64_tr_b16 v[242:243], v246 offset:11648
    s_waitcnt lgkmcnt(5)
    v_mfma_f32_16x16x32_bf16 v[96:99], v[224:227], v[216:219], v[96:99]
    s_waitcnt lgkmcnt(2)
    v_mfma_f32_16x16x32_bf16 v[144:147], v[224:227], v[220:223], v[144:147]
    v_mfma_f32_16x16x32_bf16 v[4:7], v[228:231], v[208:211], v[4:7]
    ds_read_b64_tr_b16 v[224:225], v247 offset:10400
    v_mfma_f32_16x16x32_bf16 v[52:55], v[228:231], v[212:215], v[52:55]
    ds_read_b64_tr_b16 v[226:227], v247 offset:11680
    v_mfma_f32_16x16x32_bf16 v[100:103], v[228:231], v[216:219], v[100:103]
    v_mfma_f32_16x16x32_bf16 v[148:151], v[228:231], v[220:223], v[148:151]
    v_mfma_f32_16x16x32_bf16 v[8:11], v[232:235], v[208:211], v[8:11]
    ds_read_b64_tr_b16 v[228:229], v246 offset:10432
    v_mfma_f32_16x16x32_bf16 v[56:59], v[232:235], v[212:215], v[56:59]
    ds_read_b64_tr_b16 v[230:231], v246 offset:11712
    v_mfma_f32_16x16x32_bf16 v[104:107], v[232:235], v[216:219], v[104:107]
    v_mfma_f32_16x16x32_bf16 v[152:155], v[232:235], v[220:223], v[152:155]
    v_mfma_f32_16x16x32_bf16 v[12:15], v[236:239], v[208:211], v[12:15]
    ds_read_b64_tr_b16 v[232:233], v247 offset:10464
    v_mfma_f32_16x16x32_bf16 v[60:63], v[236:239], v[212:215], v[60:63]
    ds_read_b64_tr_b16 v[234:235], v247 offset:11744
    v_mfma_f32_16x16x32_bf16 v[108:111], v[236:239], v[216:219], v[108:111]
    v_mfma_f32_16x16x32_bf16 v[156:159], v[236:239], v[220:223], v[156:159]
    s_waitcnt lgkmcnt(6)
    v_mfma_f32_16x16x32_bf16 v[16:19], v[240:243], v[208:211], v[16:19]
    ds_read_b64_tr_b16 v[236:237], v246 offset:10496
    v_mfma_f32_16x16x32_bf16 v[64:67], v[240:243], v[212:215], v[64:67]
    ds_read_b64_tr_b16 v[238:239], v246 offset:11776
    v_mfma_f32_16x16x32_bf16 v[112:115], v[240:243], v[216:219], v[112:115]
    v_mfma_f32_16x16x32_bf16 v[160:163], v[240:243], v[220:223], v[160:163]
    s_waitcnt lgkmcnt(6)
    v_mfma_f32_16x16x32_bf16 v[20:23], v[224:227], v[208:211], v[20:23]
    ds_read_b64_tr_b16 v[240:241], v247 offset:10528
    v_mfma_f32_16x16x32_bf16 v[68:71], v[224:227], v[212:215], v[68:71]
    ds_read_b64_tr_b16 v[242:243], v247 offset:11808
    v_mfma_f32_16x16x32_bf16 v[116:119], v[224:227], v[216:219], v[116:119]
    v_mfma_f32_16x16x32_bf16 v[164:167], v[224:227], v[220:223], v[164:167]
    s_waitcnt lgkmcnt(6)
    v_mfma_f32_16x16x32_bf16 v[24:27], v[228:231], v[208:211], v[24:27]
    s_barrier
    ds_read_b64_tr_b16 v[224:225], v246 offset:20480
    v_mfma_f32_16x16x32_bf16 v[72:75], v[228:231], v[212:215], v[72:75]
    ds_read_b64_tr_b16 v[226:227], v246 offset:21760
    v_mfma_f32_16x16x32_bf16 v[120:123], v[228:231], v[216:219], v[120:123]
    ds_read_b128 v[192:195], v244 offset:8192
    v_mfma_f32_16x16x32_bf16 v[168:171], v[228:231], v[220:223], v[168:171]
    s_waitcnt lgkmcnt(7)
    v_mfma_f32_16x16x32_bf16 v[28:31], v[232:235], v[208:211], v[28:31]
    ds_read_b64_tr_b16 v[228:229], v247 offset:20512
    v_mfma_f32_16x16x32_bf16 v[76:79], v[232:235], v[212:215], v[76:79]
    ds_read_b64_tr_b16 v[230:231], v247 offset:21792
    v_mfma_f32_16x16x32_bf16 v[124:127], v[232:235], v[216:219], v[124:127]
    ds_read_b128 v[196:199], v244 offset:10240
    v_mfma_f32_16x16x32_bf16 v[172:175], v[232:235], v[220:223], v[172:175]
    s_waitcnt lgkmcnt(8)
    v_mfma_f32_16x16x32_bf16 v[32:35], v[236:239], v[208:211], v[32:35]
    ds_read_b64_tr_b16 v[232:233], v246 offset:20544
    v_mfma_f32_16x16x32_bf16 v[80:83], v[236:239], v[212:215], v[80:83]
    ds_read_b64_tr_b16 v[234:235], v246 offset:21824
    v_mfma_f32_16x16x32_bf16 v[128:131], v[236:239], v[216:219], v[128:131]
    ds_read_b128 v[200:203], v244 offset:12288
    v_mfma_f32_16x16x32_bf16 v[176:179], v[236:239], v[220:223], v[176:179]
    s_waitcnt lgkmcnt(9)
    v_mfma_f32_16x16x32_bf16 v[36:39], v[240:243], v[208:211], v[36:39]
    ds_read_b64_tr_b16 v[236:237], v247 offset:20576
    v_mfma_f32_16x16x32_bf16 v[84:87], v[240:243], v[212:215], v[84:87]
    ds_read_b64_tr_b16 v[238:239], v247 offset:21856
    v_mfma_f32_16x16x32_bf16 v[132:135], v[240:243], v[216:219], v[132:135]
    ds_read_b128 v[204:207], v244 offset:14336
    v_mfma_f32_16x16x32_bf16 v[180:183], v[240:243], v[220:223], v[180:183]
    s_waitcnt lgkmcnt(9)
    v_mfma_f32_16x16x32_bf16 v[0:3], v[224:227], v[192:195], v[0:3]
    ds_read_b64_tr_b16 v[240:241], v246 offset:20608
    s_waitcnt lgkmcnt(7)
    v_mfma_f32_16x16x32_bf16 v[48:51], v[224:227], v[196:199], v[48:51]
    ds_read_b64_tr_b16 v[242:243], v246 offset:21888
    s_waitcnt lgkmcnt(5)
    v_mfma_f32_16x16x32_bf16 v[96:99], v[224:227], v[200:203], v[96:99]
    s_waitcnt lgkmcnt(2)
    v_mfma_f32_16x16x32_bf16 v[144:147], v[224:227], v[204:207], v[144:147]
    v_mfma_f32_16x16x32_bf16 v[4:7], v[228:231], v[192:195], v[4:7]
    ds_read_b64_tr_b16 v[224:225], v247 offset:20640
    v_mfma_f32_16x16x32_bf16 v[52:55], v[228:231], v[196:199], v[52:55]
    ds_read_b64_tr_b16 v[226:227], v247 offset:21920
    v_mfma_f32_16x16x32_bf16 v[100:103], v[228:231], v[200:203], v[100:103]
    v_mfma_f32_16x16x32_bf16 v[148:151], v[228:231], v[204:207], v[148:151]
    v_mfma_f32_16x16x32_bf16 v[8:11], v[232:235], v[192:195], v[8:11]
    ds_read_b64_tr_b16 v[228:229], v246 offset:20672
    v_mfma_f32_16x16x32_bf16 v[56:59], v[232:235], v[196:199], v[56:59]
    ds_read_b64_tr_b16 v[230:231], v246 offset:21952
    v_mfma_f32_16x16x32_bf16 v[104:107], v[232:235], v[200:203], v[104:107]
    v_mfma_f32_16x16x32_bf16 v[152:155], v[232:235], v[204:207], v[152:155]
    v_mfma_f32_16x16x32_bf16 v[12:15], v[236:239], v[192:195], v[12:15]
    ds_read_b64_tr_b16 v[232:233], v247 offset:20704
    v_mfma_f32_16x16x32_bf16 v[60:63], v[236:239], v[196:199], v[60:63]
    ds_read_b64_tr_b16 v[234:235], v247 offset:21984
    v_mfma_f32_16x16x32_bf16 v[108:111], v[236:239], v[200:203], v[108:111]
    v_mfma_f32_16x16x32_bf16 v[156:159], v[236:239], v[204:207], v[156:159]
    s_waitcnt lgkmcnt(6)
    v_mfma_f32_16x16x32_bf16 v[16:19], v[240:243], v[192:195], v[16:19]
    ds_read_b64_tr_b16 v[236:237], v246 offset:20736
    v_mfma_f32_16x16x32_bf16 v[64:67], v[240:243], v[196:199], v[64:67]
    ds_read_b64_tr_b16 v[238:239], v246 offset:22016
    v_mfma_f32_16x16x32_bf16 v[112:115], v[240:243], v[200:203], v[112:115]
    v_mfma_f32_16x16x32_bf16 v[160:163], v[240:243], v[204:207], v[160:163]
    s_waitcnt lgkmcnt(6)
    v_mfma_f32_16x16x32_bf16 v[20:23], v[224:227], v[192:195], v[20:23]
    ds_read_b64_tr_b16 v[240:241], v247 offset:20768
    v_mfma_f32_16x16x32_bf16 v[68:71], v[224:227], v[196:199], v[68:71]
    ds_read_b64_tr_b16 v[242:243], v247 offset:22048
    v_mfma_f32_16x16x32_bf16 v[116:119], v[224:227], v[200:203], v[116:119]
    v_mfma_f32_16x16x32_bf16 v[164:167], v[224:227], v[204:207], v[164:167]
    s_waitcnt lgkmcnt(6)
    v_mfma_f32_16x16x32_bf16 v[24:27], v[228:231], v[192:195], v[24:27]
    s_barrier
    ds_read_b64_tr_b16 v[224:225], v246 offset:30720
    v_mfma_f32_16x16x32_bf16 v[72:75], v[228:231], v[196:199], v[72:75]
    ds_read_b64_tr_b16 v[226:227], v246 offset:32000
    v_mfma_f32_16x16x32_bf16 v[120:123], v[228:231], v[200:203], v[120:123]
    ds_read_b128 v[208:211], v245 offset:8192
    v_mfma_f32_16x16x32_bf16 v[168:171], v[228:231], v[204:207], v[168:171]
    s_waitcnt lgkmcnt(7)
    v_mfma_f32_16x16x32_bf16 v[28:31], v[232:235], v[192:195], v[28:31]
    ds_read_b64_tr_b16 v[228:229], v247 offset:30752
    v_mfma_f32_16x16x32_bf16 v[76:79], v[232:235], v[196:199], v[76:79]
    ds_read_b64_tr_b16 v[230:231], v247 offset:32032
    v_mfma_f32_16x16x32_bf16 v[124:127], v[232:235], v[200:203], v[124:127]
    ds_read_b128 v[212:215], v245 offset:10240
    v_mfma_f32_16x16x32_bf16 v[172:175], v[232:235], v[204:207], v[172:175]
    s_waitcnt lgkmcnt(8)
    v_mfma_f32_16x16x32_bf16 v[32:35], v[236:239], v[192:195], v[32:35]
    ds_read_b64_tr_b16 v[232:233], v246 offset:30784
    v_mfma_f32_16x16x32_bf16 v[80:83], v[236:239], v[196:199], v[80:83]
    ds_read_b64_tr_b16 v[234:235], v246 offset:32064
    v_mfma_f32_16x16x32_bf16 v[128:131], v[236:239], v[200:203], v[128:131]
    ds_read_b128 v[216:219], v245 offset:12288
    v_mfma_f32_16x16x32_bf16 v[176:179], v[236:239], v[204:207], v[176:179]
    s_waitcnt lgkmcnt(9)
    v_mfma_f32_16x16x32_bf16 v[36:39], v[240:243], v[192:195], v[36:39]
    ds_read_b64_tr_b16 v[236:237], v247 offset:30816
    v_mfma_f32_16x16x32_bf16 v[84:87], v[240:243], v[196:199], v[84:87]
    ds_read_b64_tr_b16 v[238:239], v247 offset:32096
    v_mfma_f32_16x16x32_bf16 v[132:135], v[240:243], v[200:203], v[132:135]
    ds_read_b128 v[220:223], v245 offset:14336
    v_mfma_f32_16x16x32_bf16 v[180:183], v[240:243], v[204:207], v[180:183]
    s_waitcnt lgkmcnt(9)
    v_mfma_f32_16x16x32_bf16 v[0:3], v[224:227], v[208:211], v[0:3]
    ds_read_b64_tr_b16 v[240:241], v246 offset:30848
    s_waitcnt lgkmcnt(7)
    v_mfma_f32_16x16x32_bf16 v[48:51], v[224:227], v[212:215], v[48:51]
    ds_read_b64_tr_b16 v[242:243], v246 offset:32128
    s_waitcnt lgkmcnt(5)
    v_mfma_f32_16x16x32_bf16 v[96:99], v[224:227], v[216:219], v[96:99]
    s_waitcnt lgkmcnt(2)
    v_mfma_f32_16x16x32_bf16 v[144:147], v[224:227], v[220:223], v[144:147]
    v_mfma_f32_16x16x32_bf16 v[4:7], v[228:231], v[208:211], v[4:7]
    ds_read_b64_tr_b16 v[224:225], v247 offset:30880
    v_mfma_f32_16x16x32_bf16 v[52:55], v[228:231], v[212:215], v[52:55]
    ds_read_b64_tr_b16 v[226:227], v247 offset:32160
    v_mfma_f32_16x16x32_bf16 v[100:103], v[228:231], v[216:219], v[100:103]
    v_mfma_f32_16x16x32_bf16 v[148:151], v[228:231], v[220:223], v[148:151]
    v_mfma_f32_16x16x32_bf16 v[8:11], v[232:235], v[208:211], v[8:11]
    ds_read_b64_tr_b16 v[228:229], v246 offset:30912
    v_mfma_f32_16x16x32_bf16 v[56:59], v[232:235], v[212:215], v[56:59]
    ds_read_b64_tr_b16 v[230:231], v246 offset:32192
    v_mfma_f32_16x16x32_bf16 v[104:107], v[232:235], v[216:219], v[104:107]
    v_mfma_f32_16x16x32_bf16 v[152:155], v[232:235], v[220:223], v[152:155]
    v_mfma_f32_16x16x32_bf16 v[12:15], v[236:239], v[208:211], v[12:15]
    ds_read_b64_tr_b16 v[232:233], v247 offset:30944
    v_mfma_f32_16x16x32_bf16 v[60:63], v[236:239], v[212:215], v[60:63]
    ds_read_b64_tr_b16 v[234:235], v247 offset:32224
    v_mfma_f32_16x16x32_bf16 v[108:111], v[236:239], v[216:219], v[108:111]
    v_mfma_f32_16x16x32_bf16 v[156:159], v[236:239], v[220:223], v[156:159]
    s_waitcnt lgkmcnt(6)
    v_mfma_f32_16x16x32_bf16 v[16:19], v[240:243], v[208:211], v[16:19]
    ds_read_b64_tr_b16 v[236:237], v246 offset:30976
    v_mfma_f32_16x16x32_bf16 v[64:67], v[240:243], v[212:215], v[64:67]
    ds_read_b64_tr_b16 v[238:239], v246 offset:32256
    v_mfma_f32_16x16x32_bf16 v[112:115], v[240:243], v[216:219], v[112:115]
    v_mfma_f32_16x16x32_bf16 v[160:163], v[240:243], v[220:223], v[160:163]
    s_waitcnt lgkmcnt(6)
    v_mfma_f32_16x16x32_bf16 v[20:23], v[224:227], v[208:211], v[20:23]
    ds_read_b64_tr_b16 v[240:241], v247 offset:31008
    v_mfma_f32_16x16x32_bf16 v[68:71], v[224:227], v[212:215], v[68:71]
    ds_read_b64_tr_b16 v[242:243], v247 offset:32288
    v_mfma_f32_16x16x32_bf16 v[116:119], v[224:227], v[216:219], v[116:119]
    v_mfma_f32_16x16x32_bf16 v[164:167], v[224:227], v[220:223], v[164:167]
    s_waitcnt lgkmcnt(6)
    v_mfma_f32_16x16x32_bf16 v[24:27], v[228:231], v[208:211], v[24:27]
    s_barrier
    ds_read_b64_tr_b16 v[224:225], v246 offset:40960
    v_mfma_f32_16x16x32_bf16 v[72:75], v[228:231], v[212:215], v[72:75]
    ds_read_b64_tr_b16 v[226:227], v246 offset:42240
    v_mfma_f32_16x16x32_bf16 v[120:123], v[228:231], v[216:219], v[120:123]
    ds_read_b128 v[192:195], v244 offset:16384
    v_mfma_f32_16x16x32_bf16 v[168:171], v[228:231], v[220:223], v[168:171]
    s_waitcnt lgkmcnt(7)
    v_mfma_f32_16x16x32_bf16 v[28:31], v[232:235], v[208:211], v[28:31]
    ds_read_b64_tr_b16 v[228:229], v247 offset:40992
    v_mfma_f32_16x16x32_bf16 v[76:79], v[232:235], v[212:215], v[76:79]
    ds_read_b64_tr_b16 v[230:231], v247 offset:42272
    v_mfma_f32_16x16x32_bf16 v[124:127], v[232:235], v[216:219], v[124:127]
    ds_read_b128 v[196:199], v244 offset:18432
    v_mfma_f32_16x16x32_bf16 v[172:175], v[232:235], v[220:223], v[172:175]
    s_waitcnt lgkmcnt(8)
    v_mfma_f32_16x16x32_bf16 v[32:35], v[236:239], v[208:211], v[32:35]
    ds_read_b64_tr_b16 v[232:233], v246 offset:41024
    v_mfma_f32_16x16x32_bf16 v[80:83], v[236:239], v[212:215], v[80:83]
    ds_read_b64_tr_b16 v[234:235], v246 offset:42304
    v_mfma_f32_16x16x32_bf16 v[128:131], v[236:239], v[216:219], v[128:131]
    ds_read_b128 v[200:203], v244 offset:20480
    v_mfma_f32_16x16x32_bf16 v[176:179], v[236:239], v[220:223], v[176:179]
    s_waitcnt lgkmcnt(9)
    v_mfma_f32_16x16x32_bf16 v[36:39], v[240:243], v[208:211], v[36:39]
    ds_read_b64_tr_b16 v[236:237], v247 offset:41056
    v_mfma_f32_16x16x32_bf16 v[84:87], v[240:243], v[212:215], v[84:87]
    ds_read_b64_tr_b16 v[238:239], v247 offset:42336
    v_mfma_f32_16x16x32_bf16 v[132:135], v[240:243], v[216:219], v[132:135]
    ds_read_b128 v[204:207], v244 offset:22528
    v_mfma_f32_16x16x32_bf16 v[180:183], v[240:243], v[220:223], v[180:183]
    s_waitcnt lgkmcnt(9)
    v_mfma_f32_16x16x32_bf16 v[0:3], v[224:227], v[192:195], v[0:3]
    ds_read_b64_tr_b16 v[240:241], v246 offset:41088
    s_waitcnt lgkmcnt(7)
    v_mfma_f32_16x16x32_bf16 v[48:51], v[224:227], v[196:199], v[48:51]
    ds_read_b64_tr_b16 v[242:243], v246 offset:42368
    s_waitcnt lgkmcnt(5)
    v_mfma_f32_16x16x32_bf16 v[96:99], v[224:227], v[200:203], v[96:99]
    s_waitcnt lgkmcnt(2)
    v_mfma_f32_16x16x32_bf16 v[144:147], v[224:227], v[204:207], v[144:147]
    v_mfma_f32_16x16x32_bf16 v[4:7], v[228:231], v[192:195], v[4:7]
    ds_read_b64_tr_b16 v[224:225], v247 offset:41120
    v_mfma_f32_16x16x32_bf16 v[52:55], v[228:231], v[196:199], v[52:55]
    ds_read_b64_tr_b16 v[226:227], v247 offset:42400
    v_mfma_f32_16x16x32_bf16 v[100:103], v[228:231], v[200:203], v[100:103]
    v_mfma_f32_16x16x32_bf16 v[148:151], v[228:231], v[204:207], v[148:151]
    v_mfma_f32_16x16x32_bf16 v[8:11], v[232:235], v[192:195], v[8:11]
    ds_read_b64_tr_b16 v[228:229], v246 offset:41152
    v_mfma_f32_16x16x32_bf16 v[56:59], v[232:235], v[196:199], v[56:59]
    ds_read_b64_tr_b16 v[230:231], v246 offset:42432
    v_mfma_f32_16x16x32_bf16 v[104:107], v[232:235], v[200:203], v[104:107]
    v_mfma_f32_16x16x32_bf16 v[152:155], v[232:235], v[204:207], v[152:155]
    v_mfma_f32_16x16x32_bf16 v[12:15], v[236:239], v[192:195], v[12:15]
    ds_read_b64_tr_b16 v[232:233], v247 offset:41184
    v_mfma_f32_16x16x32_bf16 v[60:63], v[236:239], v[196:199], v[60:63]
    ds_read_b64_tr_b16 v[234:235], v247 offset:42464
    v_mfma_f32_16x16x32_bf16 v[108:111], v[236:239], v[200:203], v[108:111]
    v_mfma_f32_16x16x32_bf16 v[156:159], v[236:239], v[204:207], v[156:159]
    s_waitcnt lgkmcnt(6)
    v_mfma_f32_16x16x32_bf16 v[16:19], v[240:243], v[192:195], v[16:19]
    ds_read_b64_tr_b16 v[236:237], v246 offset:41216
    v_mfma_f32_16x16x32_bf16 v[64:67], v[240:243], v[196:199], v[64:67]
    ds_read_b64_tr_b16 v[238:239], v246 offset:42496
    v_mfma_f32_16x16x32_bf16 v[112:115], v[240:243], v[200:203], v[112:115]
    v_mfma_f32_16x16x32_bf16 v[160:163], v[240:243], v[204:207], v[160:163]
    s_waitcnt lgkmcnt(6)
    v_mfma_f32_16x16x32_bf16 v[20:23], v[224:227], v[192:195], v[20:23]
    ds_read_b64_tr_b16 v[240:241], v247 offset:41248
    v_mfma_f32_16x16x32_bf16 v[68:71], v[224:227], v[196:199], v[68:71]
    ds_read_b64_tr_b16 v[242:243], v247 offset:42528
    v_mfma_f32_16x16x32_bf16 v[116:119], v[224:227], v[200:203], v[116:119]
    v_mfma_f32_16x16x32_bf16 v[164:167], v[224:227], v[204:207], v[164:167]
    s_waitcnt lgkmcnt(6)
    v_mfma_f32_16x16x32_bf16 v[24:27], v[228:231], v[192:195], v[24:27]
    s_barrier
    ds_read_b64_tr_b16 v[224:225], v246 offset:0
    v_mfma_f32_16x16x32_bf16 v[72:75], v[228:231], v[196:199], v[72:75]
    ds_read_b64_tr_b16 v[226:227], v246 offset:1280
    v_mfma_f32_16x16x32_bf16 v[120:123], v[228:231], v[200:203], v[120:123]
    ds_read_b128 v[208:211], v245 offset:16384
    v_mfma_f32_16x16x32_bf16 v[168:171], v[228:231], v[204:207], v[168:171]
    s_waitcnt lgkmcnt(7)
    v_mfma_f32_16x16x32_bf16 v[28:31], v[232:235], v[192:195], v[28:31]
    ds_read_b64_tr_b16 v[228:229], v247 offset:32
    v_mfma_f32_16x16x32_bf16 v[76:79], v[232:235], v[196:199], v[76:79]
    ds_read_b64_tr_b16 v[230:231], v247 offset:1312
    v_mfma_f32_16x16x32_bf16 v[124:127], v[232:235], v[200:203], v[124:127]
    ds_read_b128 v[212:215], v245 offset:18432
    v_mfma_f32_16x16x32_bf16 v[172:175], v[232:235], v[204:207], v[172:175]
    s_waitcnt lgkmcnt(8)
    v_mfma_f32_16x16x32_bf16 v[32:35], v[236:239], v[192:195], v[32:35]
    ds_read_b64_tr_b16 v[232:233], v246 offset:64
    v_mfma_f32_16x16x32_bf16 v[80:83], v[236:239], v[196:199], v[80:83]
    ds_read_b64_tr_b16 v[234:235], v246 offset:1344
    v_mfma_f32_16x16x32_bf16 v[128:131], v[236:239], v[200:203], v[128:131]
    ds_read_b128 v[216:219], v245 offset:20480
    v_mfma_f32_16x16x32_bf16 v[176:179], v[236:239], v[204:207], v[176:179]
    s_waitcnt lgkmcnt(9)
    v_mfma_f32_16x16x32_bf16 v[36:39], v[240:243], v[192:195], v[36:39]
    ds_read_b64_tr_b16 v[236:237], v247 offset:96
    v_mfma_f32_16x16x32_bf16 v[84:87], v[240:243], v[196:199], v[84:87]
    ds_read_b64_tr_b16 v[238:239], v247 offset:1376
    v_mfma_f32_16x16x32_bf16 v[132:135], v[240:243], v[200:203], v[132:135]
    ds_read_b128 v[220:223], v245 offset:22528
    v_mfma_f32_16x16x32_bf16 v[180:183], v[240:243], v[204:207], v[180:183]
    s_waitcnt lgkmcnt(9)
    v_mfma_f32_16x16x32_bf16 v[0:3], v[224:227], v[208:211], v[0:3]
    ds_read_b64_tr_b16 v[240:241], v246 offset:128
    s_waitcnt lgkmcnt(7)
    v_mfma_f32_16x16x32_bf16 v[48:51], v[224:227], v[212:215], v[48:51]
    ds_read_b64_tr_b16 v[242:243], v246 offset:1408
    s_waitcnt lgkmcnt(5)
    v_mfma_f32_16x16x32_bf16 v[96:99], v[224:227], v[216:219], v[96:99]
    s_waitcnt lgkmcnt(2)
    v_mfma_f32_16x16x32_bf16 v[144:147], v[224:227], v[220:223], v[144:147]
    v_mfma_f32_16x16x32_bf16 v[4:7], v[228:231], v[208:211], v[4:7]
    ds_read_b64_tr_b16 v[224:225], v247 offset:160
    v_mfma_f32_16x16x32_bf16 v[52:55], v[228:231], v[212:215], v[52:55]
    ds_read_b64_tr_b16 v[226:227], v247 offset:1440
    v_mfma_f32_16x16x32_bf16 v[100:103], v[228:231], v[216:219], v[100:103]
    v_mfma_f32_16x16x32_bf16 v[148:151], v[228:231], v[220:223], v[148:151]
    v_mfma_f32_16x16x32_bf16 v[8:11], v[232:235], v[208:211], v[8:11]
    ds_read_b64_tr_b16 v[228:229], v246 offset:192
    v_mfma_f32_16x16x32_bf16 v[56:59], v[232:235], v[212:215], v[56:59]
    ds_read_b64_tr_b16 v[230:231], v246 offset:1472
    v_mfma_f32_16x16x32_bf16 v[104:107], v[232:235], v[216:219], v[104:107]
    v_mfma_f32_16x16x32_bf16 v[152:155], v[232:235], v[220:223], v[152:155]
    v_mfma_f32_16x16x32_bf16 v[12:15], v[236:239], v[208:211], v[12:15]
    ds_read_b64_tr_b16 v[232:233], v247 offset:224
    v_mfma_f32_16x16x32_bf16 v[60:63], v[236:239], v[212:215], v[60:63]
    ds_read_b64_tr_b16 v[234:235], v247 offset:1504
    v_mfma_f32_16x16x32_bf16 v[108:111], v[236:239], v[216:219], v[108:111]
    v_mfma_f32_16x16x32_bf16 v[156:159], v[236:239], v[220:223], v[156:159]
    s_waitcnt lgkmcnt(6)
    v_mfma_f32_16x16x32_bf16 v[16:19], v[240:243], v[208:211], v[16:19]
    ds_read_b64_tr_b16 v[236:237], v246 offset:256
    v_mfma_f32_16x16x32_bf16 v[64:67], v[240:243], v[212:215], v[64:67]
    ds_read_b64_tr_b16 v[238:239], v246 offset:1536
    v_mfma_f32_16x16x32_bf16 v[112:115], v[240:243], v[216:219], v[112:115]
    v_mfma_f32_16x16x32_bf16 v[160:163], v[240:243], v[220:223], v[160:163]
    s_waitcnt lgkmcnt(6)
    v_mfma_f32_16x16x32_bf16 v[20:23], v[224:227], v[208:211], v[20:23]
    ds_read_b64_tr_b16 v[240:241], v247 offset:288
    v_mfma_f32_16x16x32_bf16 v[68:71], v[224:227], v[212:215], v[68:71]
    ds_read_b64_tr_b16 v[242:243], v247 offset:1568
    v_mfma_f32_16x16x32_bf16 v[116:119], v[224:227], v[216:219], v[116:119]
    v_mfma_f32_16x16x32_bf16 v[164:167], v[224:227], v[220:223], v[164:167]
    s_waitcnt lgkmcnt(6)
    v_mfma_f32_16x16x32_bf16 v[24:27], v[228:231], v[208:211], v[24:27]
    s_barrier
    ds_read_b64_tr_b16 v[224:225], v246 offset:10240
    v_mfma_f32_16x16x32_bf16 v[72:75], v[228:231], v[212:215], v[72:75]
    ds_read_b64_tr_b16 v[226:227], v246 offset:11520
    v_mfma_f32_16x16x32_bf16 v[120:123], v[228:231], v[216:219], v[120:123]
    ds_read_b128 v[192:195], v244 offset:0
    v_mfma_f32_16x16x32_bf16 v[168:171], v[228:231], v[220:223], v[168:171]
    ds_read_b128 v[252:255], v249
    s_waitcnt lgkmcnt(8)
    v_mfma_f32_16x16x32_bf16 v[28:31], v[232:235], v[208:211], v[28:31]
    ds_read_b64_tr_b16 v[228:229], v247 offset:10272
    v_mfma_f32_16x16x32_bf16 v[76:79], v[232:235], v[212:215], v[76:79]
    ds_read_b64_tr_b16 v[230:231], v247 offset:11552
    v_mfma_f32_16x16x32_bf16 v[124:127], v[232:235], v[216:219], v[124:127]
    ds_read_b128 v[196:199], v244 offset:2048
    v_mfma_f32_16x16x32_bf16 v[172:175], v[232:235], v[220:223], v[172:175]
    s_waitcnt lgkmcnt(9)
    v_mfma_f32_16x16x32_bf16 v[32:35], v[236:239], v[208:211], v[32:35]
    ds_read_b64_tr_b16 v[232:233], v246 offset:10304
    v_mfma_f32_16x16x32_bf16 v[80:83], v[236:239], v[212:215], v[80:83]
    ds_read_b64_tr_b16 v[234:235], v246 offset:11584
    v_mfma_f32_16x16x32_bf16 v[128:131], v[236:239], v[216:219], v[128:131]
    ds_read_b128 v[200:203], v244 offset:4096
    v_mfma_f32_16x16x32_bf16 v[176:179], v[236:239], v[220:223], v[176:179]
    s_waitcnt lgkmcnt(10)
    v_mfma_f32_16x16x32_bf16 v[36:39], v[240:243], v[208:211], v[36:39]
    ds_read_b64_tr_b16 v[236:237], v247 offset:10336
    v_mfma_f32_16x16x32_bf16 v[84:87], v[240:243], v[212:215], v[84:87]
    ds_read_b64_tr_b16 v[238:239], v247 offset:11616
    v_mfma_f32_16x16x32_bf16 v[132:135], v[240:243], v[216:219], v[132:135]
    ds_read_b128 v[204:207], v244 offset:6144
    v_mfma_f32_16x16x32_bf16 v[180:183], v[240:243], v[220:223], v[180:183]
    s_waitcnt lgkmcnt(9)
    buffer_store_dwordx4 v[252:255], v250, s[20:23], s52 offen sc1
    v_lshlrev_b32_e64 v250, 4, v248
    v_add_u32 v249, 159744, v250
    v_mfma_f32_16x16x32_bf16 v[0:3], v[224:227], v[192:195], v[0:3]
    ds_read_b64_tr_b16 v[240:241], v246 offset:10368
    s_waitcnt lgkmcnt(7)
    v_mfma_f32_16x16x32_bf16 v[48:51], v[224:227], v[196:199], v[48:51]
    ds_read_b64_tr_b16 v[242:243], v246 offset:11648
    s_waitcnt lgkmcnt(5)
    v_mfma_f32_16x16x32_bf16 v[96:99], v[224:227], v[200:203], v[96:99]
    s_waitcnt lgkmcnt(2)
    v_mfma_f32_16x16x32_bf16 v[144:147], v[224:227], v[204:207], v[144:147]
    ds_read_b128 v[252:255], v249
    v_mfma_f32_16x16x32_bf16 v[4:7], v[228:231], v[192:195], v[4:7]
    ds_read_b64_tr_b16 v[224:225], v247 offset:10400
    v_mfma_f32_16x16x32_bf16 v[52:55], v[228:231], v[196:199], v[52:55]
    ds_read_b64_tr_b16 v[226:227], v247 offset:11680
    v_mfma_f32_16x16x32_bf16 v[100:103], v[228:231], v[200:203], v[100:103]
    v_mfma_f32_16x16x32_bf16 v[148:151], v[228:231], v[204:207], v[148:151]
    v_mfma_f32_16x16x32_bf16 v[8:11], v[232:235], v[192:195], v[8:11]
    ds_read_b64_tr_b16 v[228:229], v246 offset:10432
    v_mfma_f32_16x16x32_bf16 v[56:59], v[232:235], v[196:199], v[56:59]
    ds_read_b64_tr_b16 v[230:231], v246 offset:11712
    v_mfma_f32_16x16x32_bf16 v[104:107], v[232:235], v[200:203], v[104:107]
    v_mfma_f32_16x16x32_bf16 v[152:155], v[232:235], v[204:207], v[152:155]
    v_mfma_f32_16x16x32_bf16 v[12:15], v[236:239], v[192:195], v[12:15]
    ds_read_b64_tr_b16 v[232:233], v247 offset:10464
    v_mfma_f32_16x16x32_bf16 v[60:63], v[236:239], v[196:199], v[60:63]
    ds_read_b64_tr_b16 v[234:235], v247 offset:11744
    v_mfma_f32_16x16x32_bf16 v[108:111], v[236:239], v[200:203], v[108:111]
    v_mfma_f32_16x16x32_bf16 v[156:159], v[236:239], v[204:207], v[156:159]
    s_waitcnt lgkmcnt(6)
    s_mov_b64 exec, 0xff
    buffer_store_dwordx4 v[252:255], v250, s[20:23], s53 offen sc1
    s_mov_b64 exec, -1
    v_mfma_f32_16x16x32_bf16 v[16:19], v[240:243], v[192:195], v[16:19]
    ds_read_b64_tr_b16 v[236:237], v246 offset:10496
    v_mfma_f32_16x16x32_bf16 v[64:67], v[240:243], v[196:199], v[64:67]
    ds_read_b64_tr_b16 v[238:239], v246 offset:11776
    v_mfma_f32_16x16x32_bf16 v[112:115], v[240:243], v[200:203], v[112:115]
    v_mfma_f32_16x16x32_bf16 v[160:163], v[240:243], v[204:207], v[160:163]
    s_waitcnt lgkmcnt(6)
    v_mfma_f32_16x16x32_bf16 v[20:23], v[224:227], v[192:195], v[20:23]
    ds_read_b64_tr_b16 v[240:241], v247 offset:10528
    v_mfma_f32_16x16x32_bf16 v[68:71], v[224:227], v[196:199], v[68:71]
    ds_read_b64_tr_b16 v[242:243], v247 offset:11808
    v_mfma_f32_16x16x32_bf16 v[116:119], v[224:227], v[200:203], v[116:119]
    v_mfma_f32_16x16x32_bf16 v[164:167], v[224:227], v[204:207], v[164:167]
    s_waitcnt lgkmcnt(6)
    v_mfma_f32_16x16x32_bf16 v[24:27], v[228:231], v[192:195], v[24:27]
    s_barrier
    ds_read_b64_tr_b16 v[224:225], v246 offset:20480
    v_mfma_f32_16x16x32_bf16 v[72:75], v[228:231], v[196:199], v[72:75]
    ds_read_b64_tr_b16 v[226:227], v246 offset:21760
    v_mfma_f32_16x16x32_bf16 v[120:123], v[228:231], v[200:203], v[120:123]
    ds_read_b128 v[208:211], v245 offset:0
    v_mfma_f32_16x16x32_bf16 v[168:171], v[228:231], v[204:207], v[168:171]
    s_waitcnt lgkmcnt(7)
    v_mfma_f32_16x16x32_bf16 v[28:31], v[232:235], v[192:195], v[28:31]
    ds_read_b64_tr_b16 v[228:229], v247 offset:20512
    v_mfma_f32_16x16x32_bf16 v[76:79], v[232:235], v[196:199], v[76:79]
    ds_read_b64_tr_b16 v[230:231], v247 offset:21792
    v_mfma_f32_16x16x32_bf16 v[124:127], v[232:235], v[200:203], v[124:127]
    ds_read_b128 v[212:215], v245 offset:2048
    v_mfma_f32_16x16x32_bf16 v[172:175], v[232:235], v[204:207], v[172:175]
    s_waitcnt lgkmcnt(8)
    v_mfma_f32_16x16x32_bf16 v[32:35], v[236:239], v[192:195], v[32:35]
    ds_read_b64_tr_b16 v[232:233], v246 offset:20544
    v_mfma_f32_16x16x32_bf16 v[80:83], v[236:239], v[196:199], v[80:83]
    ds_read_b64_tr_b16 v[234:235], v246 offset:21824
    v_mfma_f32_16x16x32_bf16 v[128:131], v[236:239], v[200:203], v[128:131]
    ds_read_b128 v[216:219], v245 offset:4096
    v_mfma_f32_16x16x32_bf16 v[176:179], v[236:239], v[204:207], v[176:179]
    s_waitcnt lgkmcnt(9)
    v_mfma_f32_16x16x32_bf16 v[36:39], v[240:243], v[192:195], v[36:39]
    ds_read_b64_tr_b16 v[236:237], v247 offset:20576
    v_mfma_f32_16x16x32_bf16 v[84:87], v[240:243], v[196:199], v[84:87]
    ds_read_b64_tr_b16 v[238:239], v247 offset:21856
    v_mfma_f32_16x16x32_bf16 v[132:135], v[240:243], v[200:203], v[132:135]
    ds_read_b128 v[220:223], v245 offset:6144
    v_mfma_f32_16x16x32_bf16 v[180:183], v[240:243], v[204:207], v[180:183]
    s_waitcnt lgkmcnt(9)
    v_mfma_f32_16x16x32_bf16 v[0:3], v[224:227], v[208:211], v[0:3]
    ds_read_b64_tr_b16 v[240:241], v246 offset:20608
    s_waitcnt lgkmcnt(7)
    v_mfma_f32_16x16x32_bf16 v[48:51], v[224:227], v[212:215], v[48:51]
    ds_read_b64_tr_b16 v[242:243], v246 offset:21888
    s_waitcnt lgkmcnt(5)
    v_mfma_f32_16x16x32_bf16 v[96:99], v[224:227], v[216:219], v[96:99]
    s_waitcnt lgkmcnt(2)
    v_mfma_f32_16x16x32_bf16 v[144:147], v[224:227], v[220:223], v[144:147]
    v_mfma_f32_16x16x32_bf16 v[4:7], v[228:231], v[208:211], v[4:7]
    ds_read_b64_tr_b16 v[224:225], v247 offset:20640
    v_mfma_f32_16x16x32_bf16 v[52:55], v[228:231], v[212:215], v[52:55]
    ds_read_b64_tr_b16 v[226:227], v247 offset:21920
    v_mfma_f32_16x16x32_bf16 v[100:103], v[228:231], v[216:219], v[100:103]
    v_mfma_f32_16x16x32_bf16 v[148:151], v[228:231], v[220:223], v[148:151]
    v_mfma_f32_16x16x32_bf16 v[8:11], v[232:235], v[208:211], v[8:11]
    ds_read_b64_tr_b16 v[228:229], v246 offset:20672
    v_mfma_f32_16x16x32_bf16 v[56:59], v[232:235], v[212:215], v[56:59]
    ds_read_b64_tr_b16 v[230:231], v246 offset:21952
    v_mfma_f32_16x16x32_bf16 v[104:107], v[232:235], v[216:219], v[104:107]
    v_mfma_f32_16x16x32_bf16 v[152:155], v[232:235], v[220:223], v[152:155]
    v_mfma_f32_16x16x32_bf16 v[12:15], v[236:239], v[208:211], v[12:15]
    ds_read_b64_tr_b16 v[232:233], v247 offset:20704
    v_mfma_f32_16x16x32_bf16 v[60:63], v[236:239], v[212:215], v[60:63]
    ds_read_b64_tr_b16 v[234:235], v247 offset:21984
    v_mfma_f32_16x16x32_bf16 v[108:111], v[236:239], v[216:219], v[108:111]
    v_mfma_f32_16x16x32_bf16 v[156:159], v[236:239], v[220:223], v[156:159]
    s_waitcnt lgkmcnt(6)
    v_mfma_f32_16x16x32_bf16 v[16:19], v[240:243], v[208:211], v[16:19]
    ds_read_b64_tr_b16 v[236:237], v246 offset:20736
    v_mfma_f32_16x16x32_bf16 v[64:67], v[240:243], v[212:215], v[64:67]
    ds_read_b64_tr_b16 v[238:239], v246 offset:22016
    v_mfma_f32_16x16x32_bf16 v[112:115], v[240:243], v[216:219], v[112:115]
    v_mfma_f32_16x16x32_bf16 v[160:163], v[240:243], v[220:223], v[160:163]
    s_waitcnt lgkmcnt(6)
    v_mfma_f32_16x16x32_bf16 v[20:23], v[224:227], v[208:211], v[20:23]
    ds_read_b64_tr_b16 v[240:241], v247 offset:20768
    v_mfma_f32_16x16x32_bf16 v[68:71], v[224:227], v[212:215], v[68:71]
    ds_read_b64_tr_b16 v[242:243], v247 offset:22048
    v_mfma_f32_16x16x32_bf16 v[116:119], v[224:227], v[216:219], v[116:119]
    v_mfma_f32_16x16x32_bf16 v[164:167], v[224:227], v[220:223], v[164:167]
    s_waitcnt lgkmcnt(6)
    v_mfma_f32_16x16x32_bf16 v[24:27], v[228:231], v[208:211], v[24:27]
    s_waitcnt vmcnt(0)
    s_barrier
    ds_read_b64_tr_b16 v[224:225], v246 offset:30720
    v_mfma_f32_16x16x32_bf16 v[72:75], v[228:231], v[212:215], v[72:75]
    ds_read_b64_tr_b16 v[226:227], v246 offset:32000
    v_mfma_f32_16x16x32_bf16 v[120:123], v[228:231], v[216:219], v[120:123]
    ds_read_b128 v[192:195], v244 offset:8192
    v_mfma_f32_16x16x32_bf16 v[168:171], v[228:231], v[220:223], v[168:171]
    s_cmp_lg_u32 s3, 0
    s_cbranch_scc1 SG00
    s_and_b32 s67, s2, 1
    s_lshl_b32 s67, s67, 6
    s_add_u32 s67, s67, 0
    v_mov_b32 v252, s67
    v_mov_b32 v253, 1
    s_mov_b64 exec, 1
    global_atomic_add v252, v253, s[14:15]
    s_mov_b64 exec, -1
SG00:
    s_waitcnt lgkmcnt(7)
    v_mfma_f32_16x16x32_bf16 v[28:31], v[232:235], v[208:211], v[28:31]
    ds_read_b64_tr_b16 v[228:229], v247 offset:30752
    v_mfma_f32_16x16x32_bf16 v[76:79], v[232:235], v[212:215], v[76:79]
    ds_read_b64_tr_b16 v[230:231], v247 offset:32032
    v_mfma_f32_16x16x32_bf16 v[124:127], v[232:235], v[216:219], v[124:127]
    ds_read_b128 v[196:199], v244 offset:10240
    v_mfma_f32_16x16x32_bf16 v[172:175], v[232:235], v[220:223], v[172:175]
    s_waitcnt lgkmcnt(8)
    v_mfma_f32_16x16x32_bf16 v[32:35], v[236:239], v[208:211], v[32:35]
    ds_read_b64_tr_b16 v[232:233], v246 offset:30784
    v_mfma_f32_16x16x32_bf16 v[80:83], v[236:239], v[212:215], v[80:83]
    ds_read_b64_tr_b16 v[234:235], v246 offset:32064
    v_mfma_f32_16x16x32_bf16 v[128:131], v[236:239], v[216:219], v[128:131]
    ds_read_b128 v[200:203], v244 offset:12288
    v_mfma_f32_16x16x32_bf16 v[176:179], v[236:239], v[220:223], v[176:179]
    s_waitcnt lgkmcnt(9)
    v_mfma_f32_16x16x32_bf16 v[36:39], v[240:243], v[208:211], v[36:39]
    ds_read_b64_tr_b16 v[236:237], v247 offset:30816
    v_mfma_f32_16x16x32_bf16 v[84:87], v[240:243], v[212:215], v[84:87]
    ds_read_b64_tr_b16 v[238:239], v247 offset:32096
    v_mfma_f32_16x16x32_bf16 v[132:135], v[240:243], v[216:219], v[132:135]
    ds_read_b128 v[204:207], v244 offset:14336
    v_mfma_f32_16x16x32_bf16 v[180:183], v[240:243], v[220:223], v[180:183]
    s_waitcnt lgkmcnt(9)
    v_mfma_f32_16x16x32_bf16 v[0:3], v[224:227], v[192:195], v[0:3]
    ds_read_b64_tr_b16 v[240:241], v246 offset:30848
    s_waitcnt lgkmcnt(7)
    v_mfma_f32_16x16x32_bf16 v[48:51], v[224:227], v[196:199], v[48:51]
    ds_read_b64_tr_b16 v[242:243], v246 offset:32128
    s_waitcnt lgkmcnt(5)
    v_mfma_f32_16x16x32_bf16 v[96:99], v[224:227], v[200:203], v[96:99]
    s_waitcnt lgkmcnt(2)
    v_mfma_f32_16x16x32_bf16 v[144:147], v[224:227], v[204:207], v[144:147]
    v_mfma_f32_16x16x32_bf16 v[4:7], v[228:231], v[192:195], v[4:7]
    ds_read_b64_tr_b16 v[224:225], v247 offset:30880
    v_mfma_f32_16x16x32_bf16 v[52:55], v[228:231], v[196:199], v[52:55]
    ds_read_b64_tr_b16 v[226:227], v247 offset:32160
    v_mfma_f32_16x16x32_bf16 v[100:103], v[228:231], v[200:203], v[100:103]
    v_mfma_f32_16x16x32_bf16 v[148:151], v[228:231], v[204:207], v[148:151]
    v_mfma_f32_16x16x32_bf16 v[8:11], v[232:235], v[192:195], v[8:11]
    ds_read_b64_tr_b16 v[228:229], v246 offset:30912
    v_mfma_f32_16x16x32_bf16 v[56:59], v[232:235], v[196:199], v[56:59]
    ds_read_b64_tr_b16 v[230:231], v246 offset:32192
    v_mfma_f32_16x16x32_bf16 v[104:107], v[232:235], v[200:203], v[104:107]
    v_mfma_f32_16x16x32_bf16 v[152:155], v[232:235], v[204:207], v[152:155]
    v_mfma_f32_16x16x32_bf16 v[12:15], v[236:239], v[192:195], v[12:15]
    ds_read_b64_tr_b16 v[232:233], v247 offset:30944
    v_mfma_f32_16x16x32_bf16 v[60:63], v[236:239], v[196:199], v[60:63]
    ds_read_b64_tr_b16 v[234:235], v247 offset:32224
    v_mfma_f32_16x16x32_bf16 v[108:111], v[236:239], v[200:203], v[108:111]
    v_mfma_f32_16x16x32_bf16 v[156:159], v[236:239], v[204:207], v[156:159]
    s_waitcnt lgkmcnt(6)
    v_mfma_f32_16x16x32_bf16 v[16:19], v[240:243], v[192:195], v[16:19]
    ds_read_b64_tr_b16 v[236:237], v246 offset:30976
    v_mfma_f32_16x16x32_bf16 v[64:67], v[240:243], v[196:199], v[64:67]
    ds_read_b64_tr_b16 v[238:239], v246 offset:32256
    v_mfma_f32_16x16x32_bf16 v[112:115], v[240:243], v[200:203], v[112:115]
    v_mfma_f32_16x16x32_bf16 v[160:163], v[240:243], v[204:207], v[160:163]
    s_waitcnt lgkmcnt(6)
    v_mfma_f32_16x16x32_bf16 v[20:23], v[224:227], v[192:195], v[20:23]
    ds_read_b64_tr_b16 v[240:241], v247 offset:31008
    v_mfma_f32_16x16x32_bf16 v[68:71], v[224:227], v[196:199], v[68:71]
    ds_read_b64_tr_b16 v[242:243], v247 offset:32288
    v_mfma_f32_16x16x32_bf16 v[116:119], v[224:227], v[200:203], v[116:119]
    v_mfma_f32_16x16x32_bf16 v[164:167], v[224:227], v[204:207], v[164:167]
    s_waitcnt lgkmcnt(6)
    v_mfma_f32_16x16x32_bf16 v[24:27], v[228:231], v[192:195], v[24:27]
    s_barrier
    ds_read_b64_tr_b16 v[224:225], v246 offset:40960
    v_mfma_f32_16x16x32_bf16 v[72:75], v[228:231], v[196:199], v[72:75]
    ds_read_b64_tr_b16 v[226:227], v246 offset:42240
    v_mfma_f32_16x16x32_bf16 v[120:123], v[228:231], v[200:203], v[120:123]
    ds_read_b128 v[208:211], v245 offset:8192
    v_mfma_f32_16x16x32_bf16 v[168:171], v[228:231], v[204:207], v[168:171]
    s_waitcnt lgkmcnt(7)
    v_mfma_f32_16x16x32_bf16 v[28:31], v[232:235], v[192:195], v[28:31]
    ds_read_b64_tr_b16 v[228:229], v247 offset:40992
    v_mfma_f32_16x16x32_bf16 v[76:79], v[232:235], v[196:199], v[76:79]
    ds_read_b64_tr_b16 v[230:231], v247 offset:42272
    v_mfma_f32_16x16x32_bf16 v[124:127], v[232:235], v[200:203], v[124:127]
    ds_read_b128 v[212:215], v245 offset:10240
    v_mfma_f32_16x16x32_bf16 v[172:175], v[232:235], v[204:207], v[172:175]
    s_waitcnt lgkmcnt(8)
    v_mfma_f32_16x16x32_bf16 v[32:35], v[236:239], v[192:195], v[32:35]
    ds_read_b64_tr_b16 v[232:233], v246 offset:41024
    v_mfma_f32_16x16x32_bf16 v[80:83], v[236:239], v[196:199], v[80:83]
    ds_read_b64_tr_b16 v[234:235], v246 offset:42304
    v_mfma_f32_16x16x32_bf16 v[128:131], v[236:239], v[200:203], v[128:131]
    ds_read_b128 v[216:219], v245 offset:12288
    v_mfma_f32_16x16x32_bf16 v[176:179], v[236:239], v[204:207], v[176:179]
    s_waitcnt lgkmcnt(9)
    v_mfma_f32_16x16x32_bf16 v[36:39], v[240:243], v[192:195], v[36:39]
    ds_read_b64_tr_b16 v[236:237], v247 offset:41056
    v_mfma_f32_16x16x32_bf16 v[84:87], v[240:243], v[196:199], v[84:87]
    ds_read_b64_tr_b16 v[238:239], v247 offset:42336
    v_mfma_f32_16x16x32_bf16 v[132:135], v[240:243], v[200:203], v[132:135]
    ds_read_b128 v[220:223], v245 offset:14336
    v_mfma_f32_16x16x32_bf16 v[180:183], v[240:243], v[204:207], v[180:183]
    s_waitcnt lgkmcnt(9)
    v_mfma_f32_16x16x32_bf16 v[0:3], v[224:227], v[208:211], v[0:3]
    ds_read_b64_tr_b16 v[240:241], v246 offset:41088
    s_waitcnt lgkmcnt(7)
    v_mfma_f32_16x16x32_bf16 v[48:51], v[224:227], v[212:215], v[48:51]
    ds_read_b64_tr_b16 v[242:243], v246 offset:42368
    s_waitcnt lgkmcnt(5)
    v_mfma_f32_16x16x32_bf16 v[96:99], v[224:227], v[216:219], v[96:99]
    s_waitcnt lgkmcnt(2)
    v_mfma_f32_16x16x32_bf16 v[144:147], v[224:227], v[220:223], v[144:147]
    v_mfma_f32_16x16x32_bf16 v[4:7], v[228:231], v[208:211], v[4:7]
    ds_read_b64_tr_b16 v[224:225], v247 offset:41120
    v_mfma_f32_16x16x32_bf16 v[52:55], v[228:231], v[212:215], v[52:55]
    ds_read_b64_tr_b16 v[226:227], v247 offset:42400
    v_mfma_f32_16x16x32_bf16 v[100:103], v[228:231], v[216:219], v[100:103]
    v_mfma_f32_16x16x32_bf16 v[148:151], v[228:231], v[220:223], v[148:151]
    v_mfma_f32_16x16x32_bf16 v[8:11], v[232:235], v[208:211], v[8:11]
    ds_read_b64_tr_b16 v[228:229], v246 offset:41152
    v_mfma_f32_16x16x32_bf16 v[56:59], v[232:235], v[212:215], v[56:59]
    ds_read_b64_tr_b16 v[230:231], v246 offset:42432
    v_mfma_f32_16x16x32_bf16 v[104:107], v[232:235], v[216:219], v[104:107]
    v_mfma_f32_16x16x32_bf16 v[152:155], v[232:235], v[220:223], v[152:155]
    v_mfma_f32_16x16x32_bf16 v[12:15], v[236:239], v[208:211], v[12:15]
    ds_read_b64_tr_b16 v[232:233], v247 offset:41184
    v_mfma_f32_16x16x32_bf16 v[60:63], v[236:239], v[212:215], v[60:63]
    ds_read_b64_tr_b16 v[234:235], v247 offset:42464
    v_mfma_f32_16x16x32_bf16 v[108:111], v[236:239], v[216:219], v[108:111]
    v_mfma_f32_16x16x32_bf16 v[156:159], v[236:239], v[220:223], v[156:159]
    s_waitcnt lgkmcnt(6)
    v_mfma_f32_16x16x32_bf16 v[16:19], v[240:243], v[208:211], v[16:19]
    ds_read_b64_tr_b16 v[236:237], v246 offset:41216
    v_mfma_f32_16x16x32_bf16 v[64:67], v[240:243], v[212:215], v[64:67]
    ds_read_b64_tr_b16 v[238:239], v246 offset:42496
    v_mfma_f32_16x16x32_bf16 v[112:115], v[240:243], v[216:219], v[112:115]
    v_mfma_f32_16x16x32_bf16 v[160:163], v[240:243], v[220:223], v[160:163]
    s_waitcnt lgkmcnt(6)
    v_mfma_f32_16x16x32_bf16 v[20:23], v[224:227], v[208:211], v[20:23]
    ds_read_b64_tr_b16 v[240:241], v247 offset:41248
    v_mfma_f32_16x16x32_bf16 v[68:71], v[224:227], v[212:215], v[68:71]
    ds_read_b64_tr_b16 v[242:243], v247 offset:42528
    v_mfma_f32_16x16x32_bf16 v[116:119], v[224:227], v[216:219], v[116:119]
    v_mfma_f32_16x16x32_bf16 v[164:167], v[224:227], v[220:223], v[164:167]
    s_waitcnt lgkmcnt(6)
    v_mfma_f32_16x16x32_bf16 v[24:27], v[228:231], v[208:211], v[24:27]
    s_barrier
    ds_read_b64_tr_b16 v[224:225], v246 offset:0
    v_mfma_f32_16x16x32_bf16 v[72:75], v[228:231], v[212:215], v[72:75]
    ds_read_b64_tr_b16 v[226:227], v246 offset:1280
    v_mfma_f32_16x16x32_bf16 v[120:123], v[228:231], v[216:219], v[120:123]
    ds_read_b128 v[192:195], v244 offset:16384
    v_mfma_f32_16x16x32_bf16 v[168:171], v[228:231], v[220:223], v[168:171]
    s_waitcnt lgkmcnt(7)
    v_mfma_f32_16x16x32_bf16 v[28:31], v[232:235], v[208:211], v[28:31]
    ds_read_b64_tr_b16 v[228:229], v247 offset:32
    v_mfma_f32_16x16x32_bf16 v[76:79], v[232:235], v[212:215], v[76:79]
    ds_read_b64_tr_b16 v[230:231], v247 offset:1312
    v_mfma_f32_16x16x32_bf16 v[124:127], v[232:235], v[216:219], v[124:127]
    ds_read_b128 v[196:199], v244 offset:18432
    v_mfma_f32_16x16x32_bf16 v[172:175], v[232:235], v[220:223], v[172:175]
    s_waitcnt lgkmcnt(8)
    v_mfma_f32_16x16x32_bf16 v[32:35], v[236:239], v[208:211], v[32:35]
    ds_read_b64_tr_b16 v[232:233], v246 offset:64
    v_mfma_f32_16x16x32_bf16 v[80:83], v[236:239], v[212:215], v[80:83]
    ds_read_b64_tr_b16 v[234:235], v246 offset:1344
    v_mfma_f32_16x16x32_bf16 v[128:131], v[236:239], v[216:219], v[128:131]
    ds_read_b128 v[200:203], v244 offset:20480
    v_mfma_f32_16x16x32_bf16 v[176:179], v[236:239], v[220:223], v[176:179]
    s_waitcnt lgkmcnt(9)
    v_mfma_f32_16x16x32_bf16 v[36:39], v[240:243], v[208:211], v[36:39]
    ds_read_b64_tr_b16 v[236:237], v247 offset:96
    v_mfma_f32_16x16x32_bf16 v[84:87], v[240:243], v[212:215], v[84:87]
    ds_read_b64_tr_b16 v[238:239], v247 offset:1376
    v_mfma_f32_16x16x32_bf16 v[132:135], v[240:243], v[216:219], v[132:135]
    ds_read_b128 v[204:207], v244 offset:22528
    v_mfma_f32_16x16x32_bf16 v[180:183], v[240:243], v[220:223], v[180:183]
    s_waitcnt lgkmcnt(9)
    v_mfma_f32_16x16x32_bf16 v[0:3], v[224:227], v[192:195], v[0:3]
    ds_read_b64_tr_b16 v[240:241], v246 offset:128
    s_waitcnt lgkmcnt(7)
    v_mfma_f32_16x16x32_bf16 v[48:51], v[224:227], v[196:199], v[48:51]
    ds_read_b64_tr_b16 v[242:243], v246 offset:1408
    s_waitcnt lgkmcnt(5)
    v_mfma_f32_16x16x32_bf16 v[96:99], v[224:227], v[200:203], v[96:99]
    s_waitcnt lgkmcnt(2)
    v_mfma_f32_16x16x32_bf16 v[144:147], v[224:227], v[204:207], v[144:147]
    v_mfma_f32_16x16x32_bf16 v[4:7], v[228:231], v[192:195], v[4:7]
    ds_read_b64_tr_b16 v[224:225], v247 offset:160
    v_mfma_f32_16x16x32_bf16 v[52:55], v[228:231], v[196:199], v[52:55]
    ds_read_b64_tr_b16 v[226:227], v247 offset:1440
    v_mfma_f32_16x16x32_bf16 v[100:103], v[228:231], v[200:203], v[100:103]
    v_mfma_f32_16x16x32_bf16 v[148:151], v[228:231], v[204:207], v[148:151]
    v_mfma_f32_16x16x32_bf16 v[8:11], v[232:235], v[192:195], v[8:11]
    ds_read_b64_tr_b16 v[228:229], v246 offset:192
    v_mfma_f32_16x16x32_bf16 v[56:59], v[232:235], v[196:199], v[56:59]
    ds_read_b64_tr_b16 v[230:231], v246 offset:1472
    v_mfma_f32_16x16x32_bf16 v[104:107], v[232:235], v[200:203], v[104:107]
    v_mfma_f32_16x16x32_bf16 v[152:155], v[232:235], v[204:207], v[152:155]
    v_mfma_f32_16x16x32_bf16 v[12:15], v[236:239], v[192:195], v[12:15]
    ds_read_b64_tr_b16 v[232:233], v247 offset:224
    v_mfma_f32_16x16x32_bf16 v[60:63], v[236:239], v[196:199], v[60:63]
    ds_read_b64_tr_b16 v[234:235], v247 offset:1504
    v_mfma_f32_16x16x32_bf16 v[108:111], v[236:239], v[200:203], v[108:111]
    v_mfma_f32_16x16x32_bf16 v[156:159], v[236:239], v[204:207], v[156:159]
    s_waitcnt lgkmcnt(6)
    v_mfma_f32_16x16x32_bf16 v[16:19], v[240:243], v[192:195], v[16:19]
    ds_read_b64_tr_b16 v[236:237], v246 offset:256
    v_mfma_f32_16x16x32_bf16 v[64:67], v[240:243], v[196:199], v[64:67]
    ds_read_b64_tr_b16 v[238:239], v246 offset:1536
    v_mfma_f32_16x16x32_bf16 v[112:115], v[240:243], v[200:203], v[112:115]
    v_mfma_f32_16x16x32_bf16 v[160:163], v[240:243], v[204:207], v[160:163]
    s_waitcnt lgkmcnt(6)
    v_mfma_f32_16x16x32_bf16 v[20:23], v[224:227], v[192:195], v[20:23]
    ds_read_b64_tr_b16 v[240:241], v247 offset:288
    v_mfma_f32_16x16x32_bf16 v[68:71], v[224:227], v[196:199], v[68:71]
    ds_read_b64_tr_b16 v[242:243], v247 offset:1568
    v_mfma_f32_16x16x32_bf16 v[116:119], v[224:227], v[200:203], v[116:119]
    v_mfma_f32_16x16x32_bf16 v[164:167], v[224:227], v[204:207], v[164:167]
    s_waitcnt lgkmcnt(6)
    v_mfma_f32_16x16x32_bf16 v[24:27], v[228:231], v[192:195], v[24:27]
    s_barrier
    ds_read_b64_tr_b16 v[224:225], v246 offset:10240
    v_mfma_f32_16x16x32_bf16 v[72:75], v[228:231], v[196:199], v[72:75]
    ds_read_b64_tr_b16 v[226:227], v246 offset:11520
    v_mfma_f32_16x16x32_bf16 v[120:123], v[228:231], v[200:203], v[120:123]
    ds_read_b128 v[208:211], v245 offset:16384
    v_mfma_f32_16x16x32_bf16 v[168:171], v[228:231], v[204:207], v[168:171]
    s_waitcnt lgkmcnt(7)
    v_mfma_f32_16x16x32_bf16 v[28:31], v[232:235], v[192:195], v[28:31]
    ds_read_b64_tr_b16 v[228:229], v247 offset:10272
    v_mfma_f32_16x16x32_bf16 v[76:79], v[232:235], v[196:199], v[76:79]
    ds_read_b64_tr_b16 v[230:231], v247 offset:11552
    v_mfma_f32_16x16x32_bf16 v[124:127], v[232:235], v[200:203], v[124:127]
    ds_read_b128 v[212:215], v245 offset:18432
    v_mfma_f32_16x16x32_bf16 v[172:175], v[232:235], v[204:207], v[172:175]
    s_waitcnt lgkmcnt(8)
    v_mfma_f32_16x16x32_bf16 v[32:35], v[236:239], v[192:195], v[32:35]
    ds_read_b64_tr_b16 v[232:233], v246 offset:10304
    v_mfma_f32_16x16x32_bf16 v[80:83], v[236:239], v[196:199], v[80:83]
    ds_read_b64_tr_b16 v[234:235], v246 offset:11584
    v_mfma_f32_16x16x32_bf16 v[128:131], v[236:239], v[200:203], v[128:131]
    ds_read_b128 v[216:219], v245 offset:20480
    v_mfma_f32_16x16x32_bf16 v[176:179], v[236:239], v[204:207], v[176:179]
    s_waitcnt lgkmcnt(9)
    v_mfma_f32_16x16x32_bf16 v[36:39], v[240:243], v[192:195], v[36:39]
    ds_read_b64_tr_b16 v[236:237], v247 offset:10336
    v_mfma_f32_16x16x32_bf16 v[84:87], v[240:243], v[196:199], v[84:87]
    ds_read_b64_tr_b16 v[238:239], v247 offset:11616
    v_mfma_f32_16x16x32_bf16 v[132:135], v[240:243], v[200:203], v[132:135]
    ds_read_b128 v[220:223], v245 offset:22528
    v_mfma_f32_16x16x32_bf16 v[180:183], v[240:243], v[204:207], v[180:183]
    s_waitcnt lgkmcnt(9)
    v_mfma_f32_16x16x32_bf16 v[0:3], v[224:227], v[208:211], v[0:3]
    ds_read_b64_tr_b16 v[240:241], v246 offset:10368
    s_waitcnt lgkmcnt(7)
    v_mfma_f32_16x16x32_bf16 v[48:51], v[224:227], v[212:215], v[48:51]
    ds_read_b64_tr_b16 v[242:243], v246 offset:11648
    s_waitcnt lgkmcnt(5)
    v_mfma_f32_16x16x32_bf16 v[96:99], v[224:227], v[216:219], v[96:99]
    s_waitcnt lgkmcnt(2)
    v_mfma_f32_16x16x32_bf16 v[144:147], v[224:227], v[220:223], v[144:147]
    v_mfma_f32_16x16x32_bf16 v[4:7], v[228:231], v[208:211], v[4:7]
    ds_read_b64_tr_b16 v[224:225], v247 offset:10400
    v_mfma_f32_16x16x32_bf16 v[52:55], v[228:231], v[212:215], v[52:55]
    ds_read_b64_tr_b16 v[226:227], v247 offset:11680
    v_mfma_f32_16x16x32_bf16 v[100:103], v[228:231], v[216:219], v[100:103]
    v_mfma_f32_16x16x32_bf16 v[148:151], v[228:231], v[220:223], v[148:151]
    v_mfma_f32_16x16x32_bf16 v[8:11], v[232:235], v[208:211], v[8:11]
    ds_read_b64_tr_b16 v[228:229], v246 offset:10432
    v_mfma_f32_16x16x32_bf16 v[56:59], v[232:235], v[212:215], v[56:59]
    ds_read_b64_tr_b16 v[230:231], v246 offset:11712
    v_mfma_f32_16x16x32_bf16 v[104:107], v[232:235], v[216:219], v[104:107]
    v_mfma_f32_16x16x32_bf16 v[152:155], v[232:235], v[220:223], v[152:155]
    v_mfma_f32_16x16x32_bf16 v[12:15], v[236:239], v[208:211], v[12:15]
    ds_read_b64_tr_b16 v[232:233], v247 offset:10464
    v_mfma_f32_16x16x32_bf16 v[60:63], v[236:239], v[212:215], v[60:63]
    ds_read_b64_tr_b16 v[234:235], v247 offset:11744
    v_mfma_f32_16x16x32_bf16 v[108:111], v[236:239], v[216:219], v[108:111]
    v_mfma_f32_16x16x32_bf16 v[156:159], v[236:239], v[220:223], v[156:159]
    s_waitcnt lgkmcnt(6)
    v_mfma_f32_16x16x32_bf16 v[16:19], v[240:243], v[208:211], v[16:19]
    ds_read_b64_tr_b16 v[236:237], v246 offset:10496
    v_mfma_f32_16x16x32_bf16 v[64:67], v[240:243], v[212:215], v[64:67]
    ds_read_b64_tr_b16 v[238:239], v246 offset:11776
    v_mfma_f32_16x16x32_bf16 v[112:115], v[240:243], v[216:219], v[112:115]
    v_mfma_f32_16x16x32_bf16 v[160:163], v[240:243], v[220:223], v[160:163]
    s_waitcnt lgkmcnt(6)
    v_mfma_f32_16x16x32_bf16 v[20:23], v[224:227], v[208:211], v[20:23]
    ds_read_b64_tr_b16 v[240:241], v247 offset:10528
    v_mfma_f32_16x16x32_bf16 v[68:71], v[224:227], v[212:215], v[68:71]
    ds_read_b64_tr_b16 v[242:243], v247 offset:11808
    v_mfma_f32_16x16x32_bf16 v[116:119], v[224:227], v[216:219], v[116:119]
    v_mfma_f32_16x16x32_bf16 v[164:167], v[224:227], v[220:223], v[164:167]
    s_waitcnt lgkmcnt(6)
    v_mfma_f32_16x16x32_bf16 v[24:27], v[228:231], v[208:211], v[24:27]
    s_barrier
    ds_read_b64_tr_b16 v[224:225], v246 offset:20480
    v_mfma_f32_16x16x32_bf16 v[72:75], v[228:231], v[212:215], v[72:75]
    ds_read_b64_tr_b16 v[226:227], v246 offset:21760
    v_mfma_f32_16x16x32_bf16 v[120:123], v[228:231], v[216:219], v[120:123]
    ds_read_b128 v[192:195], v244 offset:0
    v_mfma_f32_16x16x32_bf16 v[168:171], v[228:231], v[220:223], v[168:171]
    s_waitcnt lgkmcnt(7)
    v_mfma_f32_16x16x32_bf16 v[28:31], v[232:235], v[208:211], v[28:31]
    ds_read_b64_tr_b16 v[228:229], v247 offset:20512
    v_mfma_f32_16x16x32_bf16 v[76:79], v[232:235], v[212:215], v[76:79]
    ds_read_b64_tr_b16 v[230:231], v247 offset:21792
    v_mfma_f32_16x16x32_bf16 v[124:127], v[232:235], v[216:219], v[124:127]
    ds_read_b128 v[196:199], v244 offset:2048
    v_mfma_f32_16x16x32_bf16 v[172:175], v[232:235], v[220:223], v[172:175]
    s_waitcnt lgkmcnt(8)
    v_mfma_f32_16x16x32_bf16 v[32:35], v[236:239], v[208:211], v[32:35]
    ds_read_b64_tr_b16 v[232:233], v246 offset:20544
    v_mfma_f32_16x16x32_bf16 v[80:83], v[236:239], v[212:215], v[80:83]
    ds_read_b64_tr_b16 v[234:235], v246 offset:21824
    v_mfma_f32_16x16x32_bf16 v[128:131], v[236:239], v[216:219], v[128:131]
    ds_read_b128 v[200:203], v244 offset:4096
    v_mfma_f32_16x16x32_bf16 v[176:179], v[236:239], v[220:223], v[176:179]
    s_waitcnt lgkmcnt(9)
    v_mfma_f32_16x16x32_bf16 v[36:39], v[240:243], v[208:211], v[36:39]
    ds_read_b64_tr_b16 v[236:237], v247 offset:20576
    v_mfma_f32_16x16x32_bf16 v[84:87], v[240:243], v[212:215], v[84:87]
    ds_read_b64_tr_b16 v[238:239], v247 offset:21856
    v_mfma_f32_16x16x32_bf16 v[132:135], v[240:243], v[216:219], v[132:135]
    ds_read_b128 v[204:207], v244 offset:6144
    v_mfma_f32_16x16x32_bf16 v[180:183], v[240:243], v[220:223], v[180:183]
    s_waitcnt lgkmcnt(9)
    v_mfma_f32_16x16x32_bf16 v[0:3], v[224:227], v[192:195], v[0:3]
    ds_read_b64_tr_b16 v[240:241], v246 offset:20608
    s_waitcnt lgkmcnt(7)
    v_mfma_f32_16x16x32_bf16 v[48:51], v[224:227], v[196:199], v[48:51]
    ds_read_b64_tr_b16 v[242:243], v246 offset:21888
    s_waitcnt lgkmcnt(5)
    v_mfma_f32_16x16x32_bf16 v[96:99], v[224:227], v[200:203], v[96:99]
    s_waitcnt lgkmcnt(2)
    v_mfma_f32_16x16x32_bf16 v[144:147], v[224:227], v[204:207], v[144:147]
    v_mfma_f32_16x16x32_bf16 v[4:7], v[228:231], v[192:195], v[4:7]
    ds_read_b64_tr_b16 v[224:225], v247 offset:20640
    v_mfma_f32_16x16x32_bf16 v[52:55], v[228:231], v[196:199], v[52:55]
    ds_read_b64_tr_b16 v[226:227], v247 offset:21920
    v_mfma_f32_16x16x32_bf16 v[100:103], v[228:231], v[200:203], v[100:103]
    v_mfma_f32_16x16x32_bf16 v[148:151], v[228:231], v[204:207], v[148:151]
    v_mfma_f32_16x16x32_bf16 v[8:11], v[232:235], v[192:195], v[8:11]
    ds_read_b64_tr_b16 v[228:229], v246 offset:20672
    v_mfma_f32_16x16x32_bf16 v[56:59], v[232:235], v[196:199], v[56:59]
    ds_read_b64_tr_b16 v[230:231], v246 offset:21952
    v_mfma_f32_16x16x32_bf16 v[104:107], v[232:235], v[200:203], v[104:107]
    v_mfma_f32_16x16x32_bf16 v[152:155], v[232:235], v[204:207], v[152:155]
    v_mfma_f32_16x16x32_bf16 v[12:15], v[236:239], v[192:195], v[12:15]
    ds_read_b64_tr_b16 v[232:233], v247 offset:20704
    v_mfma_f32_16x16x32_bf16 v[60:63], v[236:239], v[196:199], v[60:63]
    ds_read_b64_tr_b16 v[234:235], v247 offset:21984
    v_mfma_f32_16x16x32_bf16 v[108:111], v[236:239], v[200:203], v[108:111]
    v_mfma_f32_16x16x32_bf16 v[156:159], v[236:239], v[204:207], v[156:159]
    s_waitcnt lgkmcnt(6)
    v_mfma_f32_16x16x32_bf16 v[16:19], v[240:243], v[192:195], v[16:19]
    ds_read_b64_tr_b16 v[236:237], v246 offset:20736
    v_mfma_f32_16x16x32_bf16 v[64:67], v[240:243], v[196:199], v[64:67]
    ds_read_b64_tr_b16 v[238:239], v246 offset:22016
    v_mfma_f32_16x16x32_bf16 v[112:115], v[240:243], v[200:203], v[112:115]
    v_mfma_f32_16x16x32_bf16 v[160:163], v[240:243], v[204:207], v[160:163]
    s_waitcnt lgkmcnt(6)
    v_mfma_f32_16x16x32_bf16 v[20:23], v[224:227], v[192:195], v[20:23]
    ds_read_b64_tr_b16 v[240:241], v247 offset:20768
    v_mfma_f32_16x16x32_bf16 v[68:71], v[224:227], v[196:199], v[68:71]
    ds_read_b64_tr_b16 v[242:243], v247 offset:22048
    v_mfma_f32_16x16x32_bf16 v[116:119], v[224:227], v[200:203], v[116:119]
    v_mfma_f32_16x16x32_bf16 v[164:167], v[224:227], v[204:207], v[164:167]
    s_waitcnt lgkmcnt(6)
    v_mfma_f32_16x16x32_bf16 v[24:27], v[228:231], v[192:195], v[24:27]
    s_barrier
    ds_read_b64_tr_b16 v[224:225], v246 offset:30720
    v_mfma_f32_16x16x32_bf16 v[72:75], v[228:231], v[196:199], v[72:75]
    ds_read_b64_tr_b16 v[226:227], v246 offset:32000
    v_mfma_f32_16x16x32_bf16 v[120:123], v[228:231], v[200:203], v[120:123]
    ds_read_b128 v[208:211], v245 offset:0
    v_mfma_f32_16x16x32_bf16 v[168:171], v[228:231], v[204:207], v[168:171]
    s_waitcnt lgkmcnt(7)
    v_mfma_f32_16x16x32_bf16 v[28:31], v[232:235], v[192:195], v[28:31]
    ds_read_b64_tr_b16 v[228:229], v247 offset:30752
    v_mfma_f32_16x16x32_bf16 v[76:79], v[232:235], v[196:199], v[76:79]
    ds_read_b64_tr_b16 v[230:231], v247 offset:32032
    v_mfma_f32_16x16x32_bf16 v[124:127], v[232:235], v[200:203], v[124:127]
    ds_read_b128 v[212:215], v245 offset:2048
    v_mfma_f32_16x16x32_bf16 v[172:175], v[232:235], v[204:207], v[172:175]
    s_waitcnt lgkmcnt(8)
    v_mfma_f32_16x16x32_bf16 v[32:35], v[236:239], v[192:195], v[32:35]
    ds_read_b64_tr_b16 v[232:233], v246 offset:30784
    v_mfma_f32_16x16x32_bf16 v[80:83], v[236:239], v[196:199], v[80:83]
    ds_read_b64_tr_b16 v[234:235], v246 offset:32064
    v_mfma_f32_16x16x32_bf16 v[128:131], v[236:239], v[200:203], v[128:131]
    ds_read_b128 v[216:219], v245 offset:4096
    v_mfma_f32_16x16x32_bf16 v[176:179], v[236:239], v[204:207], v[176:179]
    s_waitcnt lgkmcnt(9)
    v_mfma_f32_16x16x32_bf16 v[36:39], v[240:243], v[192:195], v[36:39]
    ds_read_b64_tr_b16 v[236:237], v247 offset:30816
    v_mfma_f32_16x16x32_bf16 v[84:87], v[240:243], v[196:199], v[84:87]
    ds_read_b64_tr_b16 v[238:239], v247 offset:32096
    v_mfma_f32_16x16x32_bf16 v[132:135], v[240:243], v[200:203], v[132:135]
    ds_read_b128 v[220:223], v245 offset:6144
    v_mfma_f32_16x16x32_bf16 v[180:183], v[240:243], v[204:207], v[180:183]
    s_waitcnt lgkmcnt(9)
    v_mfma_f32_16x16x32_bf16 v[0:3], v[224:227], v[208:211], v[0:3]
    ds_read_b64_tr_b16 v[240:241], v246 offset:30848
    s_waitcnt lgkmcnt(7)
    v_mfma_f32_16x16x32_bf16 v[48:51], v[224:227], v[212:215], v[48:51]
    ds_read_b64_tr_b16 v[242:243], v246 offset:32128
    s_waitcnt lgkmcnt(5)
    v_mfma_f32_16x16x32_bf16 v[96:99], v[224:227], v[216:219], v[96:99]
    s_waitcnt lgkmcnt(2)
    v_mfma_f32_16x16x32_bf16 v[144:147], v[224:227], v[220:223], v[144:147]
    v_mfma_f32_16x16x32_bf16 v[4:7], v[228:231], v[208:211], v[4:7]
    ds_read_b64_tr_b16 v[224:225], v247 offset:30880
    v_mfma_f32_16x16x32_bf16 v[52:55], v[228:231], v[212:215], v[52:55]
    ds_read_b64_tr_b16 v[226:227], v247 offset:32160
    v_mfma_f32_16x16x32_bf16 v[100:103], v[228:231], v[216:219], v[100:103]
    v_mfma_f32_16x16x32_bf16 v[148:151], v[228:231], v[220:223], v[148:151]
    v_mfma_f32_16x16x32_bf16 v[8:11], v[232:235], v[208:211], v[8:11]
    ds_read_b64_tr_b16 v[228:229], v246 offset:30912
    v_mfma_f32_16x16x32_bf16 v[56:59], v[232:235], v[212:215], v[56:59]
    ds_read_b64_tr_b16 v[230:231], v246 offset:32192
    v_mfma_f32_16x16x32_bf16 v[104:107], v[232:235], v[216:219], v[104:107]
    v_mfma_f32_16x16x32_bf16 v[152:155], v[232:235], v[220:223], v[152:155]
    v_mfma_f32_16x16x32_bf16 v[12:15], v[236:239], v[208:211], v[12:15]
    ds_read_b64_tr_b16 v[232:233], v247 offset:30944
    v_mfma_f32_16x16x32_bf16 v[60:63], v[236:239], v[212:215], v[60:63]
    ds_read_b64_tr_b16 v[234:235], v247 offset:32224
    v_mfma_f32_16x16x32_bf16 v[108:111], v[236:239], v[216:219], v[108:111]
    v_mfma_f32_16x16x32_bf16 v[156:159], v[236:239], v[220:223], v[156:159]
    s_waitcnt lgkmcnt(6)
    v_mfma_f32_16x16x32_bf16 v[16:19], v[240:243], v[208:211], v[16:19]
    ds_read_b64_tr_b16 v[236:237], v246 offset:30976
    v_mfma_f32_16x16x32_bf16 v[64:67], v[240:243], v[212:215], v[64:67]
    ds_read_b64_tr_b16 v[238:239], v246 offset:32256
    v_mfma_f32_16x16x32_bf16 v[112:115], v[240:243], v[216:219], v[112:115]
    v_mfma_f32_16x16x32_bf16 v[160:163], v[240:243], v[220:223], v[160:163]
    s_waitcnt lgkmcnt(6)
    v_mfma_f32_16x16x32_bf16 v[20:23], v[224:227], v[208:211], v[20:23]
    ds_read_b64_tr_b16 v[240:241], v247 offset:31008
    v_mfma_f32_16x16x32_bf16 v[68:71], v[224:227], v[212:215], v[68:71]
    ds_read_b64_tr_b16 v[242:243], v247 offset:32288
    v_mfma_f32_16x16x32_bf16 v[116:119], v[224:227], v[216:219], v[116:119]
    v_mfma_f32_16x16x32_bf16 v[164:167], v[224:227], v[220:223], v[164:167]
    s_waitcnt lgkmcnt(6)
    v_mfma_f32_16x16x32_bf16 v[24:27], v[228:231], v[208:211], v[24:27]
    s_barrier
    ds_read_b64_tr_b16 v[224:225], v246 offset:40960
    v_mfma_f32_16x16x32_bf16 v[72:75], v[228:231], v[212:215], v[72:75]
    ds_read_b64_tr_b16 v[226:227], v246 offset:42240
    v_mfma_f32_16x16x32_bf16 v[120:123], v[228:231], v[216:219], v[120:123]
    ds_read_b128 v[192:195], v244 offset:8192
    v_mfma_f32_16x16x32_bf16 v[168:171], v[228:231], v[220:223], v[168:171]
    s_waitcnt lgkmcnt(7)
    v_mfma_f32_16x16x32_bf16 v[28:31], v[232:235], v[208:211], v[28:31]
    ds_read_b64_tr_b16 v[228:229], v247 offset:40992
    v_mfma_f32_16x16x32_bf16 v[76:79], v[232:235], v[212:215], v[76:79]
    ds_read_b64_tr_b16 v[230:231], v247 offset:42272
    v_mfma_f32_16x16x32_bf16 v[124:127], v[232:235], v[216:219], v[124:127]
    ds_read_b128 v[196:199], v244 offset:10240
    v_mfma_f32_16x16x32_bf16 v[172:175], v[232:235], v[220:223], v[172:175]
    s_waitcnt lgkmcnt(8)
    v_mfma_f32_16x16x32_bf16 v[32:35], v[236:239], v[208:211], v[32:35]
    ds_read_b64_tr_b16 v[232:233], v246 offset:41024
    v_mfma_f32_16x16x32_bf16 v[80:83], v[236:239], v[212:215], v[80:83]
    ds_read_b64_tr_b16 v[234:235], v246 offset:42304
    v_mfma_f32_16x16x32_bf16 v[128:131], v[236:239], v[216:219], v[128:131]
    ds_read_b128 v[200:203], v244 offset:12288
    v_mfma_f32_16x16x32_bf16 v[176:179], v[236:239], v[220:223], v[176:179]
    s_waitcnt lgkmcnt(9)
    v_mfma_f32_16x16x32_bf16 v[36:39], v[240:243], v[208:211], v[36:39]
    ds_read_b64_tr_b16 v[236:237], v247 offset:41056
    v_mfma_f32_16x16x32_bf16 v[84:87], v[240:243], v[212:215], v[84:87]
    ds_read_b64_tr_b16 v[238:239], v247 offset:42336
    v_mfma_f32_16x16x32_bf16 v[132:135], v[240:243], v[216:219], v[132:135]
    ds_read_b128 v[204:207], v244 offset:14336
    v_mfma_f32_16x16x32_bf16 v[180:183], v[240:243], v[220:223], v[180:183]
    s_waitcnt lgkmcnt(9)
    v_mfma_f32_16x16x32_bf16 v[0:3], v[224:227], v[192:195], v[0:3]
    ds_read_b64_tr_b16 v[240:241], v246 offset:41088
    s_waitcnt lgkmcnt(7)
    v_mfma_f32_16x16x32_bf16 v[48:51], v[224:227], v[196:199], v[48:51]
    ds_read_b64_tr_b16 v[242:243], v246 offset:42368
    s_waitcnt lgkmcnt(5)
    v_mfma_f32_16x16x32_bf16 v[96:99], v[224:227], v[200:203], v[96:99]
    s_waitcnt lgkmcnt(2)
    v_mfma_f32_16x16x32_bf16 v[144:147], v[224:227], v[204:207], v[144:147]
    v_mfma_f32_16x16x32_bf16 v[4:7], v[228:231], v[192:195], v[4:7]
    ds_read_b64_tr_b16 v[224:225], v247 offset:41120
    v_mfma_f32_16x16x32_bf16 v[52:55], v[228:231], v[196:199], v[52:55]
    ds_read_b64_tr_b16 v[226:227], v247 offset:42400
    v_mfma_f32_16x16x32_bf16 v[100:103], v[228:231], v[200:203], v[100:103]
    v_mfma_f32_16x16x32_bf16 v[148:151], v[228:231], v[204:207], v[148:151]
    v_mfma_f32_16x16x32_bf16 v[8:11], v[232:235], v[192:195], v[8:11]
    ds_read_b64_tr_b16 v[228:229], v246 offset:41152
    v_mfma_f32_16x16x32_bf16 v[56:59], v[232:235], v[196:199], v[56:59]
    ds_read_b64_tr_b16 v[230:231], v246 offset:42432
    v_mfma_f32_16x16x32_bf16 v[104:107], v[232:235], v[200:203], v[104:107]
    v_mfma_f32_16x16x32_bf16 v[152:155], v[232:235], v[204:207], v[152:155]
    v_mfma_f32_16x16x32_bf16 v[12:15], v[236:239], v[192:195], v[12:15]
    ds_read_b64_tr_b16 v[232:233], v247 offset:41184
    v_mfma_f32_16x16x32_bf16 v[60:63], v[236:239], v[196:199], v[60:63]
    ds_read_b64_tr_b16 v[234:235], v247 offset:42464
    v_mfma_f32_16x16x32_bf16 v[108:111], v[236:239], v[200:203], v[108:111]
    v_mfma_f32_16x16x32_bf16 v[156:159], v[236:239], v[204:207], v[156:159]
    s_waitcnt lgkmcnt(6)
    v_mfma_f32_16x16x32_bf16 v[16:19], v[240:243], v[192:195], v[16:19]
    ds_read_b64_tr_b16 v[236:237], v246 offset:41216
    v_mfma_f32_16x16x32_bf16 v[64:67], v[240:243], v[196:199], v[64:67]
    ds_read_b64_tr_b16 v[238:239], v246 offset:42496
    v_mfma_f32_16x16x32_bf16 v[112:115], v[240:243], v[200:203], v[112:115]
    v_mfma_f32_16x16x32_bf16 v[160:163], v[240:243], v[204:207], v[160:163]
    s_waitcnt lgkmcnt(6)
    v_mfma_f32_16x16x32_bf16 v[20:23], v[224:227], v[192:195], v[20:23]
    ds_read_b64_tr_b16 v[240:241], v247 offset:41248
    v_mfma_f32_16x16x32_bf16 v[68:71], v[224:227], v[196:199], v[68:71]
    ds_read_b64_tr_b16 v[242:243], v247 offset:42528
    v_mfma_f32_16x16x32_bf16 v[116:119], v[224:227], v[200:203], v[116:119]
    v_mfma_f32_16x16x32_bf16 v[164:167], v[224:227], v[204:207], v[164:167]
    s_waitcnt lgkmcnt(6)
    v_mfma_f32_16x16x32_bf16 v[24:27], v[228:231], v[192:195], v[24:27]
    s_barrier
    ds_read_b64_tr_b16 v[224:225], v246 offset:0
    v_mfma_f32_16x16x32_bf16 v[72:75], v[228:231], v[196:199], v[72:75]
    ds_read_b64_tr_b16 v[226:227], v246 offset:1280
    v_mfma_f32_16x16x32_bf16 v[120:123], v[228:231], v[200:203], v[120:123]
    ds_read_b128 v[208:211], v245 offset:8192
    v_mfma_f32_16x16x32_bf16 v[168:171], v[228:231], v[204:207], v[168:171]
    s_waitcnt lgkmcnt(7)
    v_mfma_f32_16x16x32_bf16 v[28:31], v[232:235], v[192:195], v[28:31]
    ds_read_b64_tr_b16 v[228:229], v247 offset:32
    v_mfma_f32_16x16x32_bf16 v[76:79], v[232:235], v[196:199], v[76:79]
    ds_read_b64_tr_b16 v[230:231], v247 offset:1312
    v_mfma_f32_16x16x32_bf16 v[124:127], v[232:235], v[200:203], v[124:127]
    ds_read_b128 v[212:215], v245 offset:10240
    v_mfma_f32_16x16x32_bf16 v[172:175], v[232:235], v[204:207], v[172:175]
    s_waitcnt lgkmcnt(8)
    v_mfma_f32_16x16x32_bf16 v[32:35], v[236:239], v[192:195], v[32:35]
    ds_read_b64_tr_b16 v[232:233], v246 offset:64
    v_mfma_f32_16x16x32_bf16 v[80:83], v[236:239], v[196:199], v[80:83]
    ds_read_b64_tr_b16 v[234:235], v246 offset:1344
    v_mfma_f32_16x16x32_bf16 v[128:131], v[236:239], v[200:203], v[128:131]
    ds_read_b128 v[216:219], v245 offset:12288
    v_mfma_f32_16x16x32_bf16 v[176:179], v[236:239], v[204:207], v[176:179]
    s_waitcnt lgkmcnt(9)
    v_mfma_f32_16x16x32_bf16 v[36:39], v[240:243], v[192:195], v[36:39]
    ds_read_b64_tr_b16 v[236:237], v247 offset:96
    v_mfma_f32_16x16x32_bf16 v[84:87], v[240:243], v[196:199], v[84:87]
    ds_read_b64_tr_b16 v[238:239], v247 offset:1376
    v_mfma_f32_16x16x32_bf16 v[132:135], v[240:243], v[200:203], v[132:135]
    ds_read_b128 v[220:223], v245 offset:14336
    v_mfma_f32_16x16x32_bf16 v[180:183], v[240:243], v[204:207], v[180:183]
    s_waitcnt lgkmcnt(9)
    v_mfma_f32_16x16x32_bf16 v[0:3], v[224:227], v[208:211], v[0:3]
    ds_read_b64_tr_b16 v[240:241], v246 offset:128
    s_waitcnt lgkmcnt(7)
    v_mfma_f32_16x16x32_bf16 v[48:51], v[224:227], v[212:215], v[48:51]
    ds_read_b64_tr_b16 v[242:243], v246 offset:1408
    s_waitcnt lgkmcnt(5)
    v_mfma_f32_16x16x32_bf16 v[96:99], v[224:227], v[216:219], v[96:99]
    s_waitcnt lgkmcnt(2)
    v_mfma_f32_16x16x32_bf16 v[144:147], v[224:227], v[220:223], v[144:147]
    v_mfma_f32_16x16x32_bf16 v[4:7], v[228:231], v[208:211], v[4:7]
    ds_read_b64_tr_b16 v[224:225], v247 offset:160
    v_mfma_f32_16x16x32_bf16 v[52:55], v[228:231], v[212:215], v[52:55]
    ds_read_b64_tr_b16 v[226:227], v247 offset:1440
    v_mfma_f32_16x16x32_bf16 v[100:103], v[228:231], v[216:219], v[100:103]
    v_mfma_f32_16x16x32_bf16 v[148:151], v[228:231], v[220:223], v[148:151]
    v_mfma_f32_16x16x32_bf16 v[8:11], v[232:235], v[208:211], v[8:11]
    ds_read_b64_tr_b16 v[228:229], v246 offset:192
    v_mfma_f32_16x16x32_bf16 v[56:59], v[232:235], v[212:215], v[56:59]
    ds_read_b64_tr_b16 v[230:231], v246 offset:1472
    v_mfma_f32_16x16x32_bf16 v[104:107], v[232:235], v[216:219], v[104:107]
    v_mfma_f32_16x16x32_bf16 v[152:155], v[232:235], v[220:223], v[152:155]
    v_mfma_f32_16x16x32_bf16 v[12:15], v[236:239], v[208:211], v[12:15]
    ds_read_b64_tr_b16 v[232:233], v247 offset:224
    v_mfma_f32_16x16x32_bf16 v[60:63], v[236:239], v[212:215], v[60:63]
    ds_read_b64_tr_b16 v[234:235], v247 offset:1504
    v_mfma_f32_16x16x32_bf16 v[108:111], v[236:239], v[216:219], v[108:111]
    v_mfma_f32_16x16x32_bf16 v[156:159], v[236:239], v[220:223], v[156:159]
    s_waitcnt lgkmcnt(6)
    v_mfma_f32_16x16x32_bf16 v[16:19], v[240:243], v[208:211], v[16:19]
    ds_read_b64_tr_b16 v[236:237], v246 offset:256
    v_mfma_f32_16x16x32_bf16 v[64:67], v[240:243], v[212:215], v[64:67]
    ds_read_b64_tr_b16 v[238:239], v246 offset:1536
    v_mfma_f32_16x16x32_bf16 v[112:115], v[240:243], v[216:219], v[112:115]
    v_mfma_f32_16x16x32_bf16 v[160:163], v[240:243], v[220:223], v[160:163]
    s_waitcnt lgkmcnt(6)
    v_mfma_f32_16x16x32_bf16 v[20:23], v[224:227], v[208:211], v[20:23]
    ds_read_b64_tr_b16 v[240:241], v247 offset:288
    v_mfma_f32_16x16x32_bf16 v[68:71], v[224:227], v[212:215], v[68:71]
    ds_read_b64_tr_b16 v[242:243], v247 offset:1568
    v_mfma_f32_16x16x32_bf16 v[116:119], v[224:227], v[216:219], v[116:119]
    v_mfma_f32_16x16x32_bf16 v[164:167], v[224:227], v[220:223], v[164:167]
    s_waitcnt lgkmcnt(6)
    v_mfma_f32_16x16x32_bf16 v[24:27], v[228:231], v[208:211], v[24:27]
    s_barrier
    ds_read_b64_tr_b16 v[224:225], v246 offset:10240
    v_mfma_f32_16x16x32_bf16 v[72:75], v[228:231], v[212:215], v[72:75]
    ds_read_b64_tr_b16 v[226:227], v246 offset:11520
    v_mfma_f32_16x16x32_bf16 v[120:123], v[228:231], v[216:219], v[120:123]
    ds_read_b128 v[192:195], v244 offset:16384
    v_mfma_f32_16x16x32_bf16 v[168:171], v[228:231], v[220:223], v[168:171]
    s_waitcnt lgkmcnt(7)
    v_mfma_f32_16x16x32_bf16 v[28:31], v[232:235], v[208:211], v[28:31]
    ds_read_b64_tr_b16 v[228:229], v247 offset:10272
    v_mfma_f32_16x16x32_bf16 v[76:79], v[232:235], v[212:215], v[76:79]
    ds_read_b64_tr_b16 v[230:231], v247 offset:11552
    v_mfma_f32_16x16x32_bf16 v[124:127], v[232:235], v[216:219], v[124:127]
    ds_read_b128 v[196:199], v244 offset:18432
    v_mfma_f32_16x16x32_bf16 v[172:175], v[232:235], v[220:223], v[172:175]
    s_waitcnt lgkmcnt(8)
    v_mfma_f32_16x16x32_bf16 v[32:35], v[236:239], v[208:211], v[32:35]
    ds_read_b64_tr_b16 v[232:233], v246 offset:10304
    v_mfma_f32_16x16x32_bf16 v[80:83], v[236:239], v[212:215], v[80:83]
    ds_read_b64_tr_b16 v[234:235], v246 offset:11584
    v_mfma_f32_16x16x32_bf16 v[128:131], v[236:239], v[216:219], v[128:131]
    ds_read_b128 v[200:203], v244 offset:20480
    v_mfma_f32_16x16x32_bf16 v[176:179], v[236:239], v[220:223], v[176:179]
    s_waitcnt lgkmcnt(9)
    v_mfma_f32_16x16x32_bf16 v[36:39], v[240:243], v[208:211], v[36:39]
    ds_read_b64_tr_b16 v[236:237], v247 offset:10336
    v_mfma_f32_16x16x32_bf16 v[84:87], v[240:243], v[212:215], v[84:87]
    ds_read_b64_tr_b16 v[238:239], v247 offset:11616
    v_mfma_f32_16x16x32_bf16 v[132:135], v[240:243], v[216:219], v[132:135]
    ds_read_b128 v[204:207], v244 offset:22528
    v_mfma_f32_16x16x32_bf16 v[180:183], v[240:243], v[220:223], v[180:183]
    s_waitcnt lgkmcnt(9)
    v_mfma_f32_16x16x32_bf16 v[0:3], v[224:227], v[192:195], v[0:3]
    ds_read_b64_tr_b16 v[240:241], v246 offset:10368
    s_waitcnt lgkmcnt(7)
    v_mfma_f32_16x16x32_bf16 v[48:51], v[224:227], v[196:199], v[48:51]
    ds_read_b64_tr_b16 v[242:243], v246 offset:11648
    s_waitcnt lgkmcnt(5)
    v_mfma_f32_16x16x32_bf16 v[96:99], v[224:227], v[200:203], v[96:99]
    s_waitcnt lgkmcnt(2)
    v_mfma_f32_16x16x32_bf16 v[144:147], v[224:227], v[204:207], v[144:147]
    v_mfma_f32_16x16x32_bf16 v[4:7], v[228:231], v[192:195], v[4:7]
    ds_read_b64_tr_b16 v[224:225], v247 offset:10400
    v_mfma_f32_16x16x32_bf16 v[52:55], v[228:231], v[196:199], v[52:55]
    ds_read_b64_tr_b16 v[226:227], v247 offset:11680
    v_mfma_f32_16x16x32_bf16 v[100:103], v[228:231], v[200:203], v[100:103]
    v_mfma_f32_16x16x32_bf16 v[148:151], v[228:231], v[204:207], v[148:151]
    v_mfma_f32_16x16x32_bf16 v[8:11], v[232:235], v[192:195], v[8:11]
    ds_read_b64_tr_b16 v[228:229], v246 offset:10432
    v_mfma_f32_16x16x32_bf16 v[56:59], v[232:235], v[196:199], v[56:59]
    ds_read_b64_tr_b16 v[230:231], v246 offset:11712
    v_mfma_f32_16x16x32_bf16 v[104:107], v[232:235], v[200:203], v[104:107]
    v_mfma_f32_16x16x32_bf16 v[152:155], v[232:235], v[204:207], v[152:155]
    v_mfma_f32_16x16x32_bf16 v[12:15], v[236:239], v[192:195], v[12:15]
    ds_read_b64_tr_b16 v[232:233], v247 offset:10464
    v_mfma_f32_16x16x32_bf16 v[60:63], v[236:239], v[196:199], v[60:63]
    ds_read_b64_tr_b16 v[234:235], v247 offset:11744
    v_mfma_f32_16x16x32_bf16 v[108:111], v[236:239], v[200:203], v[108:111]
    v_mfma_f32_16x16x32_bf16 v[156:159], v[236:239], v[204:207], v[156:159]
    s_waitcnt lgkmcnt(6)
    v_mfma_f32_16x16x32_bf16 v[16:19], v[240:243], v[192:195], v[16:19]
    ds_read_b64_tr_b16 v[236:237], v246 offset:10496
    v_mfma_f32_16x16x32_bf16 v[64:67], v[240:243], v[196:199], v[64:67]
    ds_read_b64_tr_b16 v[238:239], v246 offset:11776
    v_mfma_f32_16x16x32_bf16 v[112:115], v[240:243], v[200:203], v[112:115]
    v_mfma_f32_16x16x32_bf16 v[160:163], v[240:243], v[204:207], v[160:163]
    s_waitcnt lgkmcnt(6)
    v_mfma_f32_16x16x32_bf16 v[20:23], v[224:227], v[192:195], v[20:23]
    ds_read_b64_tr_b16 v[240:241], v247 offset:10528
    v_mfma_f32_16x16x32_bf16 v[68:71], v[224:227], v[196:199], v[68:71]
    ds_read_b64_tr_b16 v[242:243], v247 offset:11808
    v_mfma_f32_16x16x32_bf16 v[116:119], v[224:227], v[200:203], v[116:119]
    v_mfma_f32_16x16x32_bf16 v[164:167], v[224:227], v[204:207], v[164:167]
    s_waitcnt lgkmcnt(6)
    v_mfma_f32_16x16x32_bf16 v[24:27], v[228:231], v[192:195], v[24:27]
    s_barrier
    ds_read_b64_tr_b16 v[224:225], v246 offset:20480
    v_mfma_f32_16x16x32_bf16 v[72:75], v[228:231], v[196:199], v[72:75]
    ds_read_b64_tr_b16 v[226:227], v246 offset:21760
    v_mfma_f32_16x16x32_bf16 v[120:123], v[228:231], v[200:203], v[120:123]
    ds_read_b128 v[208:211], v245 offset:16384
    v_mfma_f32_16x16x32_bf16 v[168:171], v[228:231], v[204:207], v[168:171]
    s_waitcnt lgkmcnt(7)
    v_mfma_f32_16x16x32_bf16 v[28:31], v[232:235], v[192:195], v[28:31]
    ds_read_b64_tr_b16 v[228:229], v247 offset:20512
    v_mfma_f32_16x16x32_bf16 v[76:79], v[232:235], v[196:199], v[76:79]
    ds_read_b64_tr_b16 v[230:231], v247 offset:21792
    v_mfma_f32_16x16x32_bf16 v[124:127], v[232:235], v[200:203], v[124:127]
    ds_read_b128 v[212:215], v245 offset:18432
    v_mfma_f32_16x16x32_bf16 v[172:175], v[232:235], v[204:207], v[172:175]
    s_waitcnt lgkmcnt(8)
    v_mfma_f32_16x16x32_bf16 v[32:35], v[236:239], v[192:195], v[32:35]
    ds_read_b64_tr_b16 v[232:233], v246 offset:20544
    v_mfma_f32_16x16x32_bf16 v[80:83], v[236:239], v[196:199], v[80:83]
    ds_read_b64_tr_b16 v[234:235], v246 offset:21824
    v_mfma_f32_16x16x32_bf16 v[128:131], v[236:239], v[200:203], v[128:131]
    ds_read_b128 v[216:219], v245 offset:20480
    v_mfma_f32_16x16x32_bf16 v[176:179], v[236:239], v[204:207], v[176:179]
    s_waitcnt lgkmcnt(9)
    v_mfma_f32_16x16x32_bf16 v[36:39], v[240:243], v[192:195], v[36:39]
    ds_read_b64_tr_b16 v[236:237], v247 offset:20576
    v_mfma_f32_16x16x32_bf16 v[84:87], v[240:243], v[196:199], v[84:87]
    ds_read_b64_tr_b16 v[238:239], v247 offset:21856
    v_mfma_f32_16x16x32_bf16 v[132:135], v[240:243], v[200:203], v[132:135]
    ds_read_b128 v[220:223], v245 offset:22528
    v_mfma_f32_16x16x32_bf16 v[180:183], v[240:243], v[204:207], v[180:183]
    s_waitcnt lgkmcnt(9)
    v_mfma_f32_16x16x32_bf16 v[0:3], v[224:227], v[208:211], v[0:3]
    ds_read_b64_tr_b16 v[240:241], v246 offset:20608
    s_waitcnt lgkmcnt(7)
    v_mfma_f32_16x16x32_bf16 v[48:51], v[224:227], v[212:215], v[48:51]
    ds_read_b64_tr_b16 v[242:243], v246 offset:21888
    s_waitcnt lgkmcnt(5)
    v_mfma_f32_16x16x32_bf16 v[96:99], v[224:227], v[216:219], v[96:99]
    s_waitcnt lgkmcnt(2)
    v_mfma_f32_16x16x32_bf16 v[144:147], v[224:227], v[220:223], v[144:147]
    v_mfma_f32_16x16x32_bf16 v[4:7], v[228:231], v[208:211], v[4:7]
    ds_read_b64_tr_b16 v[224:225], v247 offset:20640
    v_mfma_f32_16x16x32_bf16 v[52:55], v[228:231], v[212:215], v[52:55]
    ds_read_b64_tr_b16 v[226:227], v247 offset:21920
    v_mfma_f32_16x16x32_bf16 v[100:103], v[228:231], v[216:219], v[100:103]
    v_mfma_f32_16x16x32_bf16 v[148:151], v[228:231], v[220:223], v[148:151]
    v_mfma_f32_16x16x32_bf16 v[8:11], v[232:235], v[208:211], v[8:11]
    ds_read_b64_tr_b16 v[228:229], v246 offset:20672
    v_mfma_f32_16x16x32_bf16 v[56:59], v[232:235], v[212:215], v[56:59]
    ds_read_b64_tr_b16 v[230:231], v246 offset:21952
    v_mfma_f32_16x16x32_bf16 v[104:107], v[232:235], v[216:219], v[104:107]
    v_mfma_f32_16x16x32_bf16 v[152:155], v[232:235], v[220:223], v[152:155]
    v_mfma_f32_16x16x32_bf16 v[12:15], v[236:239], v[208:211], v[12:15]
    ds_read_b64_tr_b16 v[232:233], v247 offset:20704
    v_mfma_f32_16x16x32_bf16 v[60:63], v[236:239], v[212:215], v[60:63]
    ds_read_b64_tr_b16 v[234:235], v247 offset:21984
    v_mfma_f32_16x16x32_bf16 v[108:111], v[236:239], v[216:219], v[108:111]
    v_mfma_f32_16x16x32_bf16 v[156:159], v[236:239], v[220:223], v[156:159]
    s_waitcnt lgkmcnt(6)
    v_mfma_f32_16x16x32_bf16 v[16:19], v[240:243], v[208:211], v[16:19]
    ds_read_b64_tr_b16 v[236:237], v246 offset:20736
    v_mfma_f32_16x16x32_bf16 v[64:67], v[240:243], v[212:215], v[64:67]
    ds_read_b64_tr_b16 v[238:239], v246 offset:22016
    v_mfma_f32_16x16x32_bf16 v[112:115], v[240:243], v[216:219], v[112:115]
    v_mfma_f32_16x16x32_bf16 v[160:163], v[240:243], v[220:223], v[160:163]
    s_waitcnt lgkmcnt(6)
    v_mfma_f32_16x16x32_bf16 v[20:23], v[224:227], v[208:211], v[20:23]
    ds_read_b64_tr_b16 v[240:241], v247 offset:20768
    v_mfma_f32_16x16x32_bf16 v[68:71], v[224:227], v[212:215], v[68:71]
    ds_read_b64_tr_b16 v[242:243], v247 offset:22048
    v_mfma_f32_16x16x32_bf16 v[116:119], v[224:227], v[216:219], v[116:119]
    v_mfma_f32_16x16x32_bf16 v[164:167], v[224:227], v[220:223], v[164:167]
    s_waitcnt lgkmcnt(6)
    v_mfma_f32_16x16x32_bf16 v[24:27], v[228:231], v[208:211], v[24:27]
    s_barrier
    ds_read_b64_tr_b16 v[224:225], v246 offset:30720
    v_mfma_f32_16x16x32_bf16 v[72:75], v[228:231], v[212:215], v[72:75]
    ds_read_b64_tr_b16 v[226:227], v246 offset:32000
    v_mfma_f32_16x16x32_bf16 v[120:123], v[228:231], v[216:219], v[120:123]
    ds_read_b128 v[192:195], v244 offset:0
    v_mfma_f32_16x16x32_bf16 v[168:171], v[228:231], v[220:223], v[168:171]
    s_waitcnt lgkmcnt(7)
    v_mfma_f32_16x16x32_bf16 v[28:31], v[232:235], v[208:211], v[28:31]
    ds_read_b64_tr_b16 v[228:229], v247 offset:30752
    v_mfma_f32_16x16x32_bf16 v[76:79], v[232:235], v[212:215], v[76:79]
    ds_read_b64_tr_b16 v[230:231], v247 offset:32032
    v_mfma_f32_16x16x32_bf16 v[124:127], v[232:235], v[216:219], v[124:127]
    ds_read_b128 v[196:199], v244 offset:2048
    v_mfma_f32_16x16x32_bf16 v[172:175], v[232:235], v[220:223], v[172:175]
    s_waitcnt lgkmcnt(8)
    v_mfma_f32_16x16x32_bf16 v[32:35], v[236:239], v[208:211], v[32:35]
    ds_read_b64_tr_b16 v[232:233], v246 offset:30784
    v_mfma_f32_16x16x32_bf16 v[80:83], v[236:239], v[212:215], v[80:83]
    ds_read_b64_tr_b16 v[234:235], v246 offset:32064
    v_mfma_f32_16x16x32_bf16 v[128:131], v[236:239], v[216:219], v[128:131]
    ds_read_b128 v[200:203], v244 offset:4096
    v_mfma_f32_16x16x32_bf16 v[176:179], v[236:239], v[220:223], v[176:179]
    s_waitcnt lgkmcnt(9)
    v_mfma_f32_16x16x32_bf16 v[36:39], v[240:243], v[208:211], v[36:39]
    ds_read_b64_tr_b16 v[236:237], v247 offset:30816
    v_mfma_f32_16x16x32_bf16 v[84:87], v[240:243], v[212:215], v[84:87]
    ds_read_b64_tr_b16 v[238:239], v247 offset:32096
    v_mfma_f32_16x16x32_bf16 v[132:135], v[240:243], v[216:219], v[132:135]
    ds_read_b128 v[204:207], v244 offset:6144
    v_mfma_f32_16x16x32_bf16 v[180:183], v[240:243], v[220:223], v[180:183]
    s_waitcnt lgkmcnt(9)
    v_mfma_f32_16x16x32_bf16 v[0:3], v[224:227], v[192:195], v[0:3]
    ds_read_b64_tr_b16 v[240:241], v246 offset:30848
    s_waitcnt lgkmcnt(7)
    v_mfma_f32_16x16x32_bf16 v[48:51], v[224:227], v[196:199], v[48:51]
    ds_read_b64_tr_b16 v[242:243], v246 offset:32128
    s_waitcnt lgkmcnt(5)
    v_mfma_f32_16x16x32_bf16 v[96:99], v[224:227], v[200:203], v[96:99]
    s_waitcnt lgkmcnt(2)
    v_mfma_f32_16x16x32_bf16 v[144:147], v[224:227], v[204:207], v[144:147]
    v_mfma_f32_16x16x32_bf16 v[4:7], v[228:231], v[192:195], v[4:7]
    ds_read_b64_tr_b16 v[224:225], v247 offset:30880
    v_mfma_f32_16x16x32_bf16 v[52:55], v[228:231], v[196:199], v[52:55]
    ds_read_b64_tr_b16 v[226:227], v247 offset:32160
    v_mfma_f32_16x16x32_bf16 v[100:103], v[228:231], v[200:203], v[100:103]
    v_mfma_f32_16x16x32_bf16 v[148:151], v[228:231], v[204:207], v[148:151]
    v_mfma_f32_16x16x32_bf16 v[8:11], v[232:235], v[192:195], v[8:11]
    ds_read_b64_tr_b16 v[228:229], v246 offset:30912
    v_mfma_f32_16x16x32_bf16 v[56:59], v[232:235], v[196:199], v[56:59]
    ds_read_b64_tr_b16 v[230:231], v246 offset:32192
    v_mfma_f32_16x16x32_bf16 v[104:107], v[232:235], v[200:203], v[104:107]
    v_mfma_f32_16x16x32_bf16 v[152:155], v[232:235], v[204:207], v[152:155]
    v_mfma_f32_16x16x32_bf16 v[12:15], v[236:239], v[192:195], v[12:15]
    ds_read_b64_tr_b16 v[232:233], v247 offset:30944
    v_mfma_f32_16x16x32_bf16 v[60:63], v[236:239], v[196:199], v[60:63]
    ds_read_b64_tr_b16 v[234:235], v247 offset:32224
    v_mfma_f32_16x16x32_bf16 v[108:111], v[236:239], v[200:203], v[108:111]
    v_mfma_f32_16x16x32_bf16 v[156:159], v[236:239], v[204:207], v[156:159]
    s_waitcnt lgkmcnt(6)
    v_mfma_f32_16x16x32_bf16 v[16:19], v[240:243], v[192:195], v[16:19]
    ds_read_b64_tr_b16 v[236:237], v246 offset:30976
    v_mfma_f32_16x16x32_bf16 v[64:67], v[240:243], v[196:199], v[64:67]
    ds_read_b64_tr_b16 v[238:239], v246 offset:32256
    v_mfma_f32_16x16x32_bf16 v[112:115], v[240:243], v[200:203], v[112:115]
    v_mfma_f32_16x16x32_bf16 v[160:163], v[240:243], v[204:207], v[160:163]
    s_waitcnt lgkmcnt(6)
    v_mfma_f32_16x16x32_bf16 v[20:23], v[224:227], v[192:195], v[20:23]
    ds_read_b64_tr_b16 v[240:241], v247 offset:31008
    v_mfma_f32_16x16x32_bf16 v[68:71], v[224:227], v[196:199], v[68:71]
    ds_read_b64_tr_b16 v[242:243], v247 offset:32288
    v_mfma_f32_16x16x32_bf16 v[116:119], v[224:227], v[200:203], v[116:119]
    v_mfma_f32_16x16x32_bf16 v[164:167], v[224:227], v[204:207], v[164:167]
    s_waitcnt lgkmcnt(6)
    v_mfma_f32_16x16x32_bf16 v[24:27], v[228:231], v[192:195], v[24:27]
    s_barrier
    ds_read_b64_tr_b16 v[224:225], v246 offset:40960
    v_mfma_f32_16x16x32_bf16 v[72:75], v[228:231], v[196:199], v[72:75]
    ds_read_b64_tr_b16 v[226:227], v246 offset:42240
    v_mfma_f32_16x16x32_bf16 v[120:123], v[228:231], v[200:203], v[120:123]
    ds_read_b128 v[208:211], v245 offset:0
    v_mfma_f32_16x16x32_bf16 v[168:171], v[228:231], v[204:207], v[168:171]
    s_waitcnt lgkmcnt(7)
    v_mfma_f32_16x16x32_bf16 v[28:31], v[232:235], v[192:195], v[28:31]
    ds_read_b64_tr_b16 v[228:229], v247 offset:40992
    v_mfma_f32_16x16x32_bf16 v[76:79], v[232:235], v[196:199], v[76:79]
    ds_read_b64_tr_b16 v[230:231], v247 offset:42272
    v_mfma_f32_16x16x32_bf16 v[124:127], v[232:235], v[200:203], v[124:127]
    ds_read_b128 v[212:215], v245 offset:2048
    v_mfma_f32_16x16x32_bf16 v[172:175], v[232:235], v[204:207], v[172:175]
    s_waitcnt lgkmcnt(8)
    v_mfma_f32_16x16x32_bf16 v[32:35], v[236:239], v[192:195], v[32:35]
    ds_read_b64_tr_b16 v[232:233], v246 offset:41024
    v_mfma_f32_16x16x32_bf16 v[80:83], v[236:239], v[196:199], v[80:83]
    ds_read_b64_tr_b16 v[234:235], v246 offset:42304
    v_mfma_f32_16x16x32_bf16 v[128:131], v[236:239], v[200:203], v[128:131]
    ds_read_b128 v[216:219], v245 offset:4096
    v_mfma_f32_16x16x32_bf16 v[176:179], v[236:239], v[204:207], v[176:179]
    s_waitcnt lgkmcnt(9)
    v_mfma_f32_16x16x32_bf16 v[36:39], v[240:243], v[192:195], v[36:39]
    ds_read_b64_tr_b16 v[236:237], v247 offset:41056
    v_mfma_f32_16x16x32_bf16 v[84:87], v[240:243], v[196:199], v[84:87]
    ds_read_b64_tr_b16 v[238:239], v247 offset:42336
    v_mfma_f32_16x16x32_bf16 v[132:135], v[240:243], v[200:203], v[132:135]
    ds_read_b128 v[220:223], v245 offset:6144
    v_mfma_f32_16x16x32_bf16 v[180:183], v[240:243], v[204:207], v[180:183]
    s_waitcnt lgkmcnt(9)
    v_mfma_f32_16x16x32_bf16 v[0:3], v[224:227], v[208:211], v[0:3]
    ds_read_b64_tr_b16 v[240:241], v246 offset:41088
    s_waitcnt lgkmcnt(7)
    v_mfma_f32_16x16x32_bf16 v[48:51], v[224:227], v[212:215], v[48:51]
    ds_read_b64_tr_b16 v[242:243], v246 offset:42368
    s_waitcnt lgkmcnt(5)
    v_mfma_f32_16x16x32_bf16 v[96:99], v[224:227], v[216:219], v[96:99]
    s_waitcnt lgkmcnt(2)
    v_mfma_f32_16x16x32_bf16 v[144:147], v[224:227], v[220:223], v[144:147]
    v_mfma_f32_16x16x32_bf16 v[4:7], v[228:231], v[208:211], v[4:7]
    ds_read_b64_tr_b16 v[224:225], v247 offset:41120
    v_mfma_f32_16x16x32_bf16 v[52:55], v[228:231], v[212:215], v[52:55]
    ds_read_b64_tr_b16 v[226:227], v247 offset:42400
    v_mfma_f32_16x16x32_bf16 v[100:103], v[228:231], v[216:219], v[100:103]
    v_mfma_f32_16x16x32_bf16 v[148:151], v[228:231], v[220:223], v[148:151]
    v_mfma_f32_16x16x32_bf16 v[8:11], v[232:235], v[208:211], v[8:11]
    ds_read_b64_tr_b16 v[228:229], v246 offset:41152
    v_mfma_f32_16x16x32_bf16 v[56:59], v[232:235], v[212:215], v[56:59]
    ds_read_b64_tr_b16 v[230:231], v246 offset:42432
    v_mfma_f32_16x16x32_bf16 v[104:107], v[232:235], v[216:219], v[104:107]
    v_mfma_f32_16x16x32_bf16 v[152:155], v[232:235], v[220:223], v[152:155]
    v_mfma_f32_16x16x32_bf16 v[12:15], v[236:239], v[208:211], v[12:15]
    ds_read_b64_tr_b16 v[232:233], v247 offset:41184
    v_mfma_f32_16x16x32_bf16 v[60:63], v[236:239], v[212:215], v[60:63]
    ds_read_b64_tr_b16 v[234:235], v247 offset:42464
    v_mfma_f32_16x16x32_bf16 v[108:111], v[236:239], v[216:219], v[108:111]
    v_mfma_f32_16x16x32_bf16 v[156:159], v[236:239], v[220:223], v[156:159]
    s_waitcnt lgkmcnt(6)
    v_mfma_f32_16x16x32_bf16 v[16:19], v[240:243], v[208:211], v[16:19]
    ds_read_b64_tr_b16 v[236:237], v246 offset:41216
    v_mfma_f32_16x16x32_bf16 v[64:67], v[240:243], v[212:215], v[64:67]
    ds_read_b64_tr_b16 v[238:239], v246 offset:42496
    v_mfma_f32_16x16x32_bf16 v[112:115], v[240:243], v[216:219], v[112:115]
    v_mfma_f32_16x16x32_bf16 v[160:163], v[240:243], v[220:223], v[160:163]
    s_waitcnt lgkmcnt(6)
    v_mfma_f32_16x16x32_bf16 v[20:23], v[224:227], v[208:211], v[20:23]
    ds_read_b64_tr_b16 v[240:241], v247 offset:41248
    v_mfma_f32_16x16x32_bf16 v[68:71], v[224:227], v[212:215], v[68:71]
    ds_read_b64_tr_b16 v[242:243], v247 offset:42528
    v_mfma_f32_16x16x32_bf16 v[116:119], v[224:227], v[216:219], v[116:119]
    v_mfma_f32_16x16x32_bf16 v[164:167], v[224:227], v[220:223], v[164:167]
    s_waitcnt lgkmcnt(6)
    v_mfma_f32_16x16x32_bf16 v[24:27], v[228:231], v[208:211], v[24:27]
    v_mfma_f32_16x16x32_bf16 v[72:75], v[228:231], v[212:215], v[72:75]
    v_mfma_f32_16x16x32_bf16 v[120:123], v[228:231], v[216:219], v[120:123]
    v_mfma_f32_16x16x32_bf16 v[168:171], v[228:231], v[220:223], v[168:171]
    s_waitcnt lgkmcnt(4)
    v_mfma_f32_16x16x32_bf16 v[28:31], v[232:235], v[208:211], v[28:31]
    v_mfma_f32_16x16x32_bf16 v[76:79], v[232:235], v[212:215], v[76:79]
    v_mfma_f32_16x16x32_bf16 v[124:127], v[232:235], v[216:219], v[124:127]
    v_mfma_f32_16x16x32_bf16 v[172:175], v[232:235], v[220:223], v[172:175]
    s_waitcnt lgkmcnt(2)
    v_mfma_f32_16x16x32_bf16 v[32:35], v[236:239], v[208:211], v[32:35]
    v_mfma_f32_16x16x32_bf16 v[80:83], v[236:239], v[212:215], v[80:83]
    v_mfma_f32_16x16x32_bf16 v[128:131], v[236:239], v[216:219], v[128:131]
    v_mfma_f32_16x16x32_bf16 v[176:179], v[236:239], v[220:223], v[176:179]
    s_waitcnt lgkmcnt(0)
    v_mfma_f32_16x16x32_bf16 v[36:39], v[240:243], v[208:211], v[36:39]
    v_mfma_f32_16x16x32_bf16 v[84:87], v[240:243], v[212:215], v[84:87]
    v_mfma_f32_16x16x32_bf16 v[132:135], v[240:243], v[216:219], v[132:135]
    v_mfma_f32_16x16x32_bf16 v[180:183], v[240:243], v[220:223], v[180:183]
    s_cmp_eq_u32 s34, 2
    s_cbranch_scc1 K1_c_q
    v_lshrrev_b32 v249, 4, v248
    v_lshlrev_b32_e64 v249, 4, v249
    v_add_u32 v249, 161792, v249
    v_and_b32 v250, 15, v248
    v_lshlrev_b32 v250, 3, v250
    s_lshl_b32 s51, s3, 9
    s_add_u32 s51, s51, 159744
    v_add_u32 v250, s51, v250
    s_waitcnt vmcnt(0)
    s_barrier
    ds_read_b64 v[140:141], v250 offset:0
    ds_read_b64 v[142:143], v250 offset:128
    ds_read_b64 v[188:189], v250 offset:256
    ds_read_b64 v[190:191], v250 offset:384
    ds_read_b128 v[192:195], v249 offset:0
    ds_read_b128 v[196:199], v249 offset:64
    ds_read_b128 v[200:203], v249 offset:128
    ds_read_b128 v[204:207], v249 offset:192
    ds_read_b128 v[208:211], v249 offset:256
    ds_read_b128 v[40:43], v249 offset:384
    ds_read_b128 v[44:47], v249 offset:448
    ds_read_b128 v[88:91], v249 offset:512
    ds_read_b128 v[92:95], v249 offset:576
    ds_read_b128 v[136:139], v249 offset:640
    v_lshlrev_b32 v249, 4, v248
    s_waitcnt lgkmcnt(0)
DK0:
    v_pk_fma_f32 v[0:1], v[192:193], v[140:141], v[0:1] op_sel_hi:[1,0,1] neg_lo:[1,0,0] neg_hi:[1,0,0]
    v_pk_fma_f32 v[2:3], v[194:195], v[140:141], v[2:3] op_sel_hi:[1,0,1] neg_lo:[1,0,0] neg_hi:[1,0,0]
    v_pk_fma_f32 v[4:5], v[196:197], v[140:141], v[4:5] op_sel_hi:[1,0,1] neg_lo:[1,0,0] neg_hi:[1,0,0]
    v_pk_fma_f32 v[6:7], v[198:199], v[140:141], v[6:7] op_sel_hi:[1,0,1] neg_lo:[1,0,0] neg_hi:[1,0,0]
    v_pk_fma_f32 v[8:9], v[200:201], v[140:141], v[8:9] op_sel_hi:[1,0,1] neg_lo:[1,0,0] neg_hi:[1,0,0]
    v_pk_fma_f32 v[10:11], v[202:203], v[140:141], v[10:11] op_sel_hi:[1,0,1] neg_lo:[1,0,0] neg_hi:[1,0,0]
    v_pk_fma_f32 v[12:13], v[204:205], v[140:141], v[12:13] op_sel_hi:[1,0,1] neg_lo:[1,0,0] neg_hi:[1,0,0]
    v_pk_fma_f32 v[14:15], v[206:207], v[140:141], v[14:15] op_sel_hi:[1,0,1] neg_lo:[1,0,0] neg_hi:[1,0,0]
    v_pk_fma_f32 v[16:17], v[208:209], v[140:141], v[16:17] op_sel_hi:[1,0,1] neg_lo:[1,0,0] neg_hi:[1,0,0]
    v_pk_fma_f32 v[18:19], v[210:211], v[140:141], v[18:19] op_sel_hi:[1,0,1] neg_lo:[1,0,0] neg_hi:[1,0,0]
    v_pk_fma_f32 v[48:49], v[192:193], v[142:143], v[48:49] op_sel_hi:[1,0,1] neg_lo:[1,0,0] neg_hi:[1,0,0]
    v_pk_fma_f32 v[50:51], v[194:195], v[142:143], v[50:51] op_sel_hi:[1,0,1] neg_lo:[1,0,0] neg_hi:[1,0,0]
    v_pk_fma_f32 v[52:53], v[196:197], v[142:143], v[52:53] op_sel_hi:[1,0,1] neg_lo:[1,0,0] neg_hi:[1,0,0]
    v_pk_fma_f32 v[54:55], v[198:199], v[142:143], v[54:55] op_sel_hi:[1,0,1] neg_lo:[1,0,0] neg_hi:[1,0,0]
    v_pk_fma_f32 v[56:57], v[200:201], v[142:143], v[56:57] op_sel_hi:[1,0,1] neg_lo:[1,0,0] neg_hi:[1,0,0]
    v_pk_fma_f32 v[58:59], v[202:203], v[142:143], v[58:59] op_sel_hi:[1,0,1] neg_lo:[1,0,0] neg_hi:[1,0,0]
    v_pk_fma_f32 v[60:61], v[204:205], v[142:143], v[60:61] op_sel_hi:[1,0,1] neg_lo:[1,0,0] neg_hi:[1,0,0]
    v_pk_fma_f32 v[62:63], v[206:207], v[142:143], v[62:63] op_sel_hi:[1,0,1] neg_lo:[1,0,0] neg_hi:[1,0,0]
    v_pk_fma_f32 v[64:65], v[208:209], v[142:143], v[64:65] op_sel_hi:[1,0,1] neg_lo:[1,0,0] neg_hi:[1,0,0]
    v_pk_fma_f32 v[66:67], v[210:211], v[142:143], v[66:67] op_sel_hi:[1,0,1] neg_lo:[1,0,0] neg_hi:[1,0,0]
    v_pk_fma_f32 v[96:97], v[192:193], v[188:189], v[96:97] op_sel_hi:[1,0,1] neg_lo:[1,0,0] neg_hi:[1,0,0]
    v_pk_fma_f32 v[98:99], v[194:195], v[188:189], v[98:99] op_sel_hi:[1,0,1] neg_lo:[1,0,0] neg_hi:[1,0,0]
    v_pk_fma_f32 v[100:101], v[196:197], v[188:189], v[100:101] op_sel_hi:[1,0,1] neg_lo:[1,0,0] neg_hi:[1,0,0]
    v_pk_fma_f32 v[102:103], v[198:199], v[188:189], v[102:103] op_sel_hi:[1,0,1] neg_lo:[1,0,0] neg_hi:[1,0,0]
    v_pk_fma_f32 v[104:105], v[200:201], v[188:189], v[104:105] op_sel_hi:[1,0,1] neg_lo:[1,0,0] neg_hi:[1,0,0]
    v_pk_fma_f32 v[106:107], v[202:203], v[188:189], v[106:107] op_sel_hi:[1,0,1] neg_lo:[1,0,0] neg_hi:[1,0,0]
    v_pk_fma_f32 v[108:109], v[204:205], v[188:189], v[108:109] op_sel_hi:[1,0,1] neg_lo:[1,0,0] neg_hi:[1,0,0]
    v_pk_fma_f32 v[110:111], v[206:207], v[188:189], v[110:111] op_sel_hi:[1,0,1] neg_lo:[1,0,0] neg_hi:[1,0,0]
    v_pk_fma_f32 v[112:113], v[208:209], v[188:189], v[112:113] op_sel_hi:[1,0,1] neg_lo:[1,0,0] neg_hi:[1,0,0]
    v_pk_fma_f32 v[114:115], v[210:211], v[188:189], v[114:115] op_sel_hi:[1,0,1] neg_lo:[1,0,0] neg_hi:[1,0,0]
    v_pk_fma_f32 v[144:145], v[192:193], v[190:191], v[144:145] op_sel_hi:[1,0,1] neg_lo:[1,0,0] neg_hi:[1,0,0]
    v_pk_fma_f32 v[146:147], v[194:195], v[190:191], v[146:147] op_sel_hi:[1,0,1] neg_lo:[1,0,0] neg_hi:[1,0,0]
    v_pk_fma_f32 v[148:149], v[196:197], v[190:191], v[148:149] op_sel_hi:[1,0,1] neg_lo:[1,0,0] neg_hi:[1,0,0]
    v_pk_fma_f32 v[150:151], v[198:199], v[190:191], v[150:151] op_sel_hi:[1,0,1] neg_lo:[1,0,0] neg_hi:[1,0,0]
    v_pk_fma_f32 v[152:153], v[200:201], v[190:191], v[152:153] op_sel_hi:[1,0,1] neg_lo:[1,0,0] neg_hi:[1,0,0]
    v_pk_fma_f32 v[154:155], v[202:203], v[190:191], v[154:155] op_sel_hi:[1,0,1] neg_lo:[1,0,0] neg_hi:[1,0,0]
    v_pk_fma_f32 v[156:157], v[204:205], v[190:191], v[156:157] op_sel_hi:[1,0,1] neg_lo:[1,0,0] neg_hi:[1,0,0]
    v_pk_fma_f32 v[158:159], v[206:207], v[190:191], v[158:159] op_sel_hi:[1,0,1] neg_lo:[1,0,0] neg_hi:[1,0,0]
    v_pk_fma_f32 v[160:161], v[208:209], v[190:191], v[160:161] op_sel_hi:[1,0,1] neg_lo:[1,0,0] neg_hi:[1,0,0]
    v_pk_fma_f32 v[162:163], v[210:211], v[190:191], v[162:163] op_sel_hi:[1,0,1] neg_lo:[1,0,0] neg_hi:[1,0,0]
    v_lshlrev_b32 v250, 4, v248
    ds_read_b128 v[192:195], v250 offset:8192
    ds_read_b128 v[196:199], v250 offset:9216
    ds_read_b64 v[200:201], v250 offset:10240
    ds_read_b128 v[202:205], v250 offset:11264
    ds_read_b128 v[206:209], v250 offset:12288
    ds_read_b64 v[210:211], v250 offset:13312
    ds_read_b128 v[212:215], v250 offset:14336
    ds_read_b128 v[216:219], v250 offset:15360
    ds_read_b64 v[220:221], v250 offset:32768
    ds_read_b128 v[222:225], v250 offset:33792
    ds_read_b128 v[226:229], v250 offset:34816
    ds_read_b64 v[230:231], v250 offset:35840
    ds_read_b128 v[232:235], v250 offset:36864
    ds_read_b128 v[236:239], v250 offset:37888
    ds_read_b64 v[240:241], v250 offset:38912
    v_pk_fma_f32 v[20:21], v[40:41], v[140:141], v[20:21] op_sel_hi:[1,0,1] neg_lo:[1,0,0] neg_hi:[1,0,0]
    s_nop 0
    v_pk_mul_f32 v[20:21], v[20:21], v[140:141] op_sel:[0,1] op_sel_hi:[1,1]
    v_pk_fma_f32 v[22:23], v[42:43], v[140:141], v[22:23] op_sel_hi:[1,0,1] neg_lo:[1,0,0] neg_hi:[1,0,0]
    s_nop 0
    v_pk_mul_f32 v[22:23], v[22:23], v[140:141] op_sel:[0,1] op_sel_hi:[1,1]
    v_cvt_pk_bf16_f32 v20, v20, v21
    v_cvt_pk_bf16_f32 v21, v22, v23
    v_pk_fma_f32 v[24:25], v[44:45], v[140:141], v[24:25] op_sel_hi:[1,0,1] neg_lo:[1,0,0] neg_hi:[1,0,0]
    s_nop 0
    v_pk_mul_f32 v[24:25], v[24:25], v[140:141] op_sel:[0,1] op_sel_hi:[1,1]
    v_pk_fma_f32 v[26:27], v[46:47], v[140:141], v[26:27] op_sel_hi:[1,0,1] neg_lo:[1,0,0] neg_hi:[1,0,0]
    s_nop 0
    v_pk_mul_f32 v[26:27], v[26:27], v[140:141] op_sel:[0,1] op_sel_hi:[1,1]
    v_cvt_pk_bf16_f32 v24, v24, v25
    v_cvt_pk_bf16_f32 v25, v26, v27
    v_pk_fma_f32 v[28:29], v[88:89], v[140:141], v[28:29] op_sel_hi:[1,0,1] neg_lo:[1,0,0] neg_hi:[1,0,0]
    s_nop 0
    v_pk_mul_f32 v[28:29], v[28:29], v[140:141] op_sel:[0,1] op_sel_hi:[1,1]
    v_pk_fma_f32 v[30:31], v[90:91], v[140:141], v[30:31] op_sel_hi:[1,0,1] neg_lo:[1,0,0] neg_hi:[1,0,0]
    s_nop 0
    v_pk_mul_f32 v[30:31], v[30:31], v[140:141] op_sel:[0,1] op_sel_hi:[1,1]
    v_cvt_pk_bf16_f32 v28, v28, v29
    v_cvt_pk_bf16_f32 v29, v30, v31
    v_pk_fma_f32 v[32:33], v[92:93], v[140:141], v[32:33] op_sel_hi:[1,0,1] neg_lo:[1,0,0] neg_hi:[1,0,0]
    s_nop 0
    v_pk_mul_f32 v[32:33], v[32:33], v[140:141] op_sel:[0,1] op_sel_hi:[1,1]
    v_pk_fma_f32 v[34:35], v[94:95], v[140:141], v[34:35] op_sel_hi:[1,0,1] neg_lo:[1,0,0] neg_hi:[1,0,0]
    s_nop 0
    v_pk_mul_f32 v[34:35], v[34:35], v[140:141] op_sel:[0,1] op_sel_hi:[1,1]
    v_cvt_pk_bf16_f32 v32, v32, v33
    v_cvt_pk_bf16_f32 v33, v34, v35
    v_pk_fma_f32 v[36:37], v[136:137], v[140:141], v[36:37] op_sel_hi:[1,0,1] neg_lo:[1,0,0] neg_hi:[1,0,0]
    s_nop 0
    v_pk_mul_f32 v[36:37], v[36:37], v[140:141] op_sel:[0,1] op_sel_hi:[1,1]
    v_pk_fma_f32 v[38:39], v[138:139], v[140:141], v[38:39] op_sel_hi:[1,0,1] neg_lo:[1,0,0] neg_hi:[1,0,0]
    s_nop 0
    v_pk_mul_f32 v[38:39], v[38:39], v[140:141] op_sel:[0,1] op_sel_hi:[1,1]
    v_cvt_pk_bf16_f32 v36, v36, v37
    v_cvt_pk_bf16_f32 v37, v38, v39
    v_pk_fma_f32 v[68:69], v[40:41], v[142:143], v[68:69] op_sel_hi:[1,0,1] neg_lo:[1,0,0] neg_hi:[1,0,0]
    s_nop 0
    v_pk_mul_f32 v[68:69], v[68:69], v[142:143] op_sel:[0,1] op_sel_hi:[1,1]
    v_pk_fma_f32 v[70:71], v[42:43], v[142:143], v[70:71] op_sel_hi:[1,0,1] neg_lo:[1,0,0] neg_hi:[1,0,0]
    s_nop 0
    v_pk_mul_f32 v[70:71], v[70:71], v[142:143] op_sel:[0,1] op_sel_hi:[1,1]
    v_cvt_pk_bf16_f32 v68, v68, v69
    v_cvt_pk_bf16_f32 v69, v70, v71
    v_pk_fma_f32 v[72:73], v[44:45], v[142:143], v[72:73] op_sel_hi:[1,0,1] neg_lo:[1,0,0] neg_hi:[1,0,0]
    s_nop 0
    v_pk_mul_f32 v[72:73], v[72:73], v[142:143] op_sel:[0,1] op_sel_hi:[1,1]
    v_pk_fma_f32 v[74:75], v[46:47], v[142:143], v[74:75] op_sel_hi:[1,0,1] neg_lo:[1,0,0] neg_hi:[1,0,0]
    s_nop 0
    v_pk_mul_f32 v[74:75], v[74:75], v[142:143] op_sel:[0,1] op_sel_hi:[1,1]
    v_cvt_pk_bf16_f32 v72, v72, v73
    v_cvt_pk_bf16_f32 v73, v74, v75
    v_pk_fma_f32 v[76:77], v[88:89], v[142:143], v[76:77] op_sel_hi:[1,0,1] neg_lo:[1,0,0] neg_hi:[1,0,0]
    s_nop 0
    v_pk_mul_f32 v[76:77], v[76:77], v[142:143] op_sel:[0,1] op_sel_hi:[1,1]
    v_pk_fma_f32 v[78:79], v[90:91], v[142:143], v[78:79] op_sel_hi:[1,0,1] neg_lo:[1,0,0] neg_hi:[1,0,0]
    s_nop 0
    v_pk_mul_f32 v[78:79], v[78:79], v[142:143] op_sel:[0,1] op_sel_hi:[1,1]
    v_cvt_pk_bf16_f32 v76, v76, v77
    v_cvt_pk_bf16_f32 v77, v78, v79
    v_pk_fma_f32 v[80:81], v[92:93], v[142:143], v[80:81] op_sel_hi:[1,0,1] neg_lo:[1,0,0] neg_hi:[1,0,0]
    s_nop 0
    v_pk_mul_f32 v[80:81], v[80:81], v[142:143] op_sel:[0,1] op_sel_hi:[1,1]
    v_pk_fma_f32 v[82:83], v[94:95], v[142:143], v[82:83] op_sel_hi:[1,0,1] neg_lo:[1,0,0] neg_hi:[1,0,0]
    s_nop 0
    v_pk_mul_f32 v[82:83], v[82:83], v[142:143] op_sel:[0,1] op_sel_hi:[1,1]
    v_cvt_pk_bf16_f32 v80, v80, v81
    v_cvt_pk_bf16_f32 v81, v82, v83
    v_pk_fma_f32 v[84:85], v[136:137], v[142:143], v[84:85] op_sel_hi:[1,0,1] neg_lo:[1,0,0] neg_hi:[1,0,0]
    s_nop 0
    v_pk_mul_f32 v[84:85], v[84:85], v[142:143] op_sel:[0,1] op_sel_hi:[1,1]
    v_pk_fma_f32 v[86:87], v[138:139], v[142:143], v[86:87] op_sel_hi:[1,0,1] neg_lo:[1,0,0] neg_hi:[1,0,0]
    s_nop 0
    v_pk_mul_f32 v[86:87], v[86:87], v[142:143] op_sel:[0,1] op_sel_hi:[1,1]
    v_cvt_pk_bf16_f32 v84, v84, v85
    v_cvt_pk_bf16_f32 v85, v86, v87
    v_pk_fma_f32 v[116:117], v[40:41], v[188:189], v[116:117] op_sel_hi:[1,0,1] neg_lo:[1,0,0] neg_hi:[1,0,0]
    s_nop 0
    v_pk_mul_f32 v[116:117], v[116:117], v[188:189] op_sel:[0,1] op_sel_hi:[1,1]
    v_pk_fma_f32 v[118:119], v[42:43], v[188:189], v[118:119] op_sel_hi:[1,0,1] neg_lo:[1,0,0] neg_hi:[1,0,0]
    s_nop 0
    v_pk_mul_f32 v[118:119], v[118:119], v[188:189] op_sel:[0,1] op_sel_hi:[1,1]
    v_cvt_pk_bf16_f32 v116, v116, v117
    v_cvt_pk_bf16_f32 v117, v118, v119
    v_pk_fma_f32 v[120:121], v[44:45], v[188:189], v[120:121] op_sel_hi:[1,0,1] neg_lo:[1,0,0] neg_hi:[1,0,0]
    s_nop 0
    v_pk_mul_f32 v[120:121], v[120:121], v[188:189] op_sel:[0,1] op_sel_hi:[1,1]
    v_pk_fma_f32 v[122:123], v[46:47], v[188:189], v[122:123] op_sel_hi:[1,0,1] neg_lo:[1,0,0] neg_hi:[1,0,0]
    s_nop 0
    v_pk_mul_f32 v[122:123], v[122:123], v[188:189] op_sel:[0,1] op_sel_hi:[1,1]
    v_cvt_pk_bf16_f32 v120, v120, v121
    v_cvt_pk_bf16_f32 v121, v122, v123
    v_pk_fma_f32 v[124:125], v[88:89], v[188:189], v[124:125] op_sel_hi:[1,0,1] neg_lo:[1,0,0] neg_hi:[1,0,0]
    s_nop 0
    v_pk_mul_f32 v[124:125], v[124:125], v[188:189] op_sel:[0,1] op_sel_hi:[1,1]
    v_pk_fma_f32 v[126:127], v[90:91], v[188:189], v[126:127] op_sel_hi:[1,0,1] neg_lo:[1,0,0] neg_hi:[1,0,0]
    s_nop 0
    v_pk_mul_f32 v[126:127], v[126:127], v[188:189] op_sel:[0,1] op_sel_hi:[1,1]
    v_cvt_pk_bf16_f32 v124, v124, v125
    v_cvt_pk_bf16_f32 v125, v126, v127
    v_pk_fma_f32 v[128:129], v[92:93], v[188:189], v[128:129] op_sel_hi:[1,0,1] neg_lo:[1,0,0] neg_hi:[1,0,0]
    s_nop 0
    v_pk_mul_f32 v[128:129], v[128:129], v[188:189] op_sel:[0,1] op_sel_hi:[1,1]
    v_pk_fma_f32 v[130:131], v[94:95], v[188:189], v[130:131] op_sel_hi:[1,0,1] neg_lo:[1,0,0] neg_hi:[1,0,0]
    s_nop 0
    v_pk_mul_f32 v[130:131], v[130:131], v[188:189] op_sel:[0,1] op_sel_hi:[1,1]
    v_cvt_pk_bf16_f32 v128, v128, v129
    v_cvt_pk_bf16_f32 v129, v130, v131
    v_pk_fma_f32 v[132:133], v[136:137], v[188:189], v[132:133] op_sel_hi:[1,0,1] neg_lo:[1,0,0] neg_hi:[1,0,0]
    s_nop 0
    v_pk_mul_f32 v[132:133], v[132:133], v[188:189] op_sel:[0,1] op_sel_hi:[1,1]
    v_pk_fma_f32 v[134:135], v[138:139], v[188:189], v[134:135] op_sel_hi:[1,0,1] neg_lo:[1,0,0] neg_hi:[1,0,0]
    s_nop 0
    v_pk_mul_f32 v[134:135], v[134:135], v[188:189] op_sel:[0,1] op_sel_hi:[1,1]
    v_cvt_pk_bf16_f32 v132, v132, v133
    v_cvt_pk_bf16_f32 v133, v134, v135
    v_pk_fma_f32 v[164:165], v[40:41], v[190:191], v[164:165] op_sel_hi:[1,0,1] neg_lo:[1,0,0] neg_hi:[1,0,0]
    s_nop 0
    v_pk_mul_f32 v[164:165], v[164:165], v[190:191] op_sel:[0,1] op_sel_hi:[1,1]
    v_pk_fma_f32 v[166:167], v[42:43], v[190:191], v[166:167] op_sel_hi:[1,0,1] neg_lo:[1,0,0] neg_hi:[1,0,0]
    s_nop 0
    v_pk_mul_f32 v[166:167], v[166:167], v[190:191] op_sel:[0,1] op_sel_hi:[1,1]
    v_cvt_pk_bf16_f32 v164, v164, v165
    v_cvt_pk_bf16_f32 v165, v166, v167
    v_pk_fma_f32 v[168:169], v[44:45], v[190:191], v[168:169] op_sel_hi:[1,0,1] neg_lo:[1,0,0] neg_hi:[1,0,0]
    s_nop 0
    v_pk_mul_f32 v[168:169], v[168:169], v[190:191] op_sel:[0,1] op_sel_hi:[1,1]
    v_pk_fma_f32 v[170:171], v[46:47], v[190:191], v[170:171] op_sel_hi:[1,0,1] neg_lo:[1,0,0] neg_hi:[1,0,0]
    s_nop 0
    v_pk_mul_f32 v[170:171], v[170:171], v[190:191] op_sel:[0,1] op_sel_hi:[1,1]
    v_cvt_pk_bf16_f32 v168, v168, v169
    v_cvt_pk_bf16_f32 v169, v170, v171
    v_pk_fma_f32 v[172:173], v[88:89], v[190:191], v[172:173] op_sel_hi:[1,0,1] neg_lo:[1,0,0] neg_hi:[1,0,0]
    s_nop 0
    v_pk_mul_f32 v[172:173], v[172:173], v[190:191] op_sel:[0,1] op_sel_hi:[1,1]
    v_pk_fma_f32 v[174:175], v[90:91], v[190:191], v[174:175] op_sel_hi:[1,0,1] neg_lo:[1,0,0] neg_hi:[1,0,0]
    s_nop 0
    v_pk_mul_f32 v[174:175], v[174:175], v[190:191] op_sel:[0,1] op_sel_hi:[1,1]
    v_cvt_pk_bf16_f32 v172, v172, v173
    v_cvt_pk_bf16_f32 v173, v174, v175
    v_pk_fma_f32 v[176:177], v[92:93], v[190:191], v[176:177] op_sel_hi:[1,0,1] neg_lo:[1,0,0] neg_hi:[1,0,0]
    s_nop 0
    v_pk_mul_f32 v[176:177], v[176:177], v[190:191] op_sel:[0,1] op_sel_hi:[1,1]
    v_pk_fma_f32 v[178:179], v[94:95], v[190:191], v[178:179] op_sel_hi:[1,0,1] neg_lo:[1,0,0] neg_hi:[1,0,0]
    s_nop 0
    v_pk_mul_f32 v[178:179], v[178:179], v[190:191] op_sel:[0,1] op_sel_hi:[1,1]
    v_cvt_pk_bf16_f32 v176, v176, v177
    v_cvt_pk_bf16_f32 v177, v178, v179
    v_pk_fma_f32 v[180:181], v[136:137], v[190:191], v[180:181] op_sel_hi:[1,0,1] neg_lo:[1,0,0] neg_hi:[1,0,0]
    s_nop 0
    v_pk_mul_f32 v[180:181], v[180:181], v[190:191] op_sel:[0,1] op_sel_hi:[1,1]
    v_pk_fma_f32 v[182:183], v[138:139], v[190:191], v[182:183] op_sel_hi:[1,0,1] neg_lo:[1,0,0] neg_hi:[1,0,0]
    s_nop 0
    s_nop 0
    v_pk_mul_f32 v[182:183], v[182:183], v[190:191] op_sel:[0,1] op_sel_hi:[1,1]
    v_cvt_pk_bf16_f32 v180, v180, v181
    v_cvt_pk_bf16_f32 v181, v182, v183
    v_mul_f32 v252, 1069066811, v141
    v_mul_f32 v253, 1069066811, v143
    v_mul_f32 v254, 1069066811, v189
    v_mul_f32 v255, 1069066811, v191
    v_and_b32 v243, 15, v248
    s_lshl_b32 s51, s3, 6
    v_add_u32 v243, s51, v243
    v_lshrrev_b32 v246, 4, v248
    v_mul_u32_u24 v251, 336, v243
    v_mul_u32_u24 v247, 80, v246
    v_add_u32_e64 v251, v251, v247
    v_mul_u32_u24 v243, 208, v243
    v_add_u32 v243, 86016, v243
    v_mul_u32_u24 v247, 48, v246
    v_add_u32 v242, v243, v247
    v_add_u32_e64 v247, 0, v246
    v_mul_u32_u24 v244, 205, v247
    v_lshrrev_b32 v244, 10, v244
    v_add_u32 v247, v247, v244
    v_lshl_add_u32 v184, v247, 3, v243
    v_add_u32_e64 v247, 4, v246
    v_mul_u32_u24 v244, 205, v247
    v_lshrrev_b32 v244, 10, v244
    v_add_u32 v247, v247, v244
    v_lshl_add_u32 v185, v247, 3, v243
    v_add_u32_e64 v247, 8, v246
    v_mul_u32_u24 v244, 205, v247
    v_lshrrev_b32 v244, 10, v244
    v_add_u32 v247, v247, v244
    v_lshl_add_u32 v186, v247, 3, v243
    v_add_u32_e64 v247, 12, v246
    v_mul_u32_u24 v244, 205, v247
    v_lshrrev_b32 v244, 10, v244
    v_add_u32 v247, v247, v244
    v_lshl_add_u32 v187, v247, 3, v243
    v_add_u32_e64 v247, 16, v246
    v_mul_u32_u24 v244, 205, v247
    v_lshrrev_b32 v244, 10, v244
    v_add_u32 v247, v247, v244
    v_lshl_add_u32 v188, v247, 3, v243
    v_mov_b32 v244, 0x3f80
    v_mov_b32 v245, 0
    s_waitcnt lgkmcnt(0)
    v_mov_b32 v246, 162816
    v_mov_b32 v247, 1
    s_mov_b64 exec, 1
    ds_add_u32 v246, v247 offset:36
    s_mov_b64 exec, -1
    v_mov_b32 v246, 162816
    s_mov_b32 s68, 1000000
K1S_spin:
    ds_read_b32 v247, v246 offset:36
    s_waitcnt lgkmcnt(0)
    v_cmp_ne_u32 vcc, 4, v247
    s_cbranch_vccz K1S_out
    s_sub_u32 s68, s68, 1
    s_sleep 1
    s_cbranch_scc0 K1S_spin
K1S_out:
    v_cvt_pk_bf16_f32 v40, v0, v1
    ds_write_b64 v184, v[20:21] offset:0
    v_cvt_pk_bf16_f32 v41, v2, v3
    ds_write_b64 v185, v[24:25] offset:0
    v_cvt_pk_bf16_f32 v42, v4, v5
    ds_write_b64 v186, v[28:29] offset:0
    v_cvt_pk_bf16_f32 v43, v6, v7
    ds_write_b64 v187, v[32:33] offset:0
    v_cvt_pk_bf16_f32 v44, v8, v9
    ds_write_b64 v188, v[36:37] offset:0
    v_cvt_pk_bf16_f32 v45, v10, v11
    ds_write_b64 v242, v[244:245] offset:40
    v_cvt_pk_bf16_f32 v46, v12, v13
    ds_write_b64 v184, v[68:69] offset:3328
    v_cvt_pk_bf16_f32 v47, v14, v15
    ds_write_b64 v185, v[72:73] offset:3328
    v_cvt_pk_bf16_f32 v16, v16, v17
    ds_write_b64 v186, v[76:77] offset:3328
    v_cvt_pk_bf16_f32 v17, v18, v19
    ds_write_b64 v187, v[80:81] offset:3328
    v_cvt_pk_bf16_f32 v88, v48, v49
    ds_write_b64 v188, v[84:85] offset:3328
    v_cvt_pk_bf16_f32 v89, v50, v51
    ds_write_b64 v242, v[244:245] offset:3368
    v_cvt_pk_bf16_f32 v90, v52, v53
    ds_write_b64 v184, v[116:117] offset:6656
    v_cvt_pk_bf16_f32 v91, v54, v55
    ds_write_b64 v185, v[120:121] offset:6656
    v_cvt_pk_bf16_f32 v92, v56, v57
    ds_write_b64 v186, v[124:125] offset:6656
    v_cvt_pk_bf16_f32 v93, v58, v59
    ds_write_b64 v187, v[128:129] offset:6656
    v_cvt_pk_bf16_f32 v94, v60, v61
    ds_write_b64 v188, v[132:133] offset:6656
    v_cvt_pk_bf16_f32 v95, v62, v63
    ds_write_b64 v242, v[244:245] offset:6696
    v_cvt_pk_bf16_f32 v64, v64, v65
    ds_write_b64 v184, v[164:165] offset:9984
    v_cvt_pk_bf16_f32 v65, v66, v67
    ds_write_b64 v185, v[168:169] offset:9984
    v_cvt_pk_bf16_f32 v136, v96, v97
    ds_write_b64 v186, v[172:173] offset:9984
    v_cvt_pk_bf16_f32 v137, v98, v99
    ds_write_b64 v187, v[176:177] offset:9984
    v_cvt_pk_bf16_f32 v138, v100, v101
    ds_write_b64 v188, v[180:181] offset:9984
    v_cvt_pk_bf16_f32 v139, v102, v103
    ds_write_b64 v242, v[244:245] offset:10024
    s_nop 0
    v_cvt_pk_bf16_f32 v140, v104, v105
    v_cvt_pk_bf16_f32 v141, v106, v107
    v_cvt_pk_bf16_f32 v142, v108, v109
    v_cvt_pk_bf16_f32 v143, v110, v111
    v_cvt_pk_bf16_f32 v112, v112, v113
    v_cvt_pk_bf16_f32 v113, v114, v115
    v_mfma_f32_16x16x32_bf16 v[20:23], v[192:195], v[40:43], 0
    v_mfma_f32_16x16x32_bf16 v[24:27], v[202:205], v[40:43], 0
    v_mfma_f32_16x16x32_bf16 v[28:31], v[212:215], v[40:43], 0
    v_mfma_f32_16x16x32_bf16 v[32:35], v[222:225], v[40:43], 0
    v_mfma_f32_16x16x32_bf16 v[36:39], v[232:235], v[40:43], 0
    v_mfma_f32_16x16x32_bf16 v[20:23], v[196:199], v[44:47], v[20:23]
    v_mfma_f32_16x16x32_bf16 v[24:27], v[206:209], v[44:47], v[24:27]
    v_mfma_f32_16x16x32_bf16 v[28:31], v[216:219], v[44:47], v[28:31]
    v_mfma_f32_16x16x32_bf16 v[32:35], v[226:229], v[44:47], v[32:35]
    v_mfma_f32_16x16x32_bf16 v[36:39], v[236:239], v[44:47], v[36:39]
    v_mfma_f32_16x16x16_bf16 v[20:23], v[200:201], v[16:17], v[20:23]
    v_mfma_f32_16x16x16_bf16 v[24:27], v[210:211], v[16:17], v[24:27]
    v_mfma_f32_16x16x16_bf16 v[28:31], v[220:221], v[16:17], v[28:31]
    v_mfma_f32_16x16x16_bf16 v[32:35], v[230:231], v[16:17], v[32:35]
    v_mfma_f32_16x16x16_bf16 v[36:39], v[240:241], v[16:17], v[36:39]
    v_cvt_pk_bf16_f32 v184, v144, v145
    v_cvt_pk_bf16_f32 v185, v146, v147
    v_cvt_pk_bf16_f32 v186, v148, v149
    v_cvt_pk_bf16_f32 v187, v150, v151
    v_cvt_pk_bf16_f32 v188, v152, v153
    v_cvt_pk_bf16_f32 v189, v154, v155
    v_cvt_pk_bf16_f32 v190, v156, v157
    v_cvt_pk_bf16_f32 v191, v158, v159
    v_cvt_pk_bf16_f32 v160, v160, v161
    v_cvt_pk_bf16_f32 v161, v162, v163
    v_mov_b32_e64 v44, v252
    v_max3_f32 v40, v20, v21, v22
    v_min3_f32 v42, v20, v21, v22
    v_max3_f32 v40, v40, v23, v24
    v_min3_f32 v42, v42, v23, v24
    v_mfma_f32_16x16x32_bf16 v[68:71], v[192:195], v[88:91], 0
    v_max3_f32 v40, v40, v25, v26
    v_min3_f32 v42, v42, v25, v26
    v_max3_f32 v40, v40, v27, v28
    v_min3_f32 v42, v42, v27, v28
    v_max3_f32 v40, v40, v29, v30
    v_min3_f32 v42, v42, v29, v30
    v_mfma_f32_16x16x32_bf16 v[72:75], v[202:205], v[88:91], 0
    v_max3_f32 v40, v40, v31, v32
    v_min3_f32 v42, v42, v31, v32
    v_max3_f32 v40, v40, v33, v34
    v_min3_f32 v42, v42, v33, v34
    v_max3_f32 v40, v40, v35, v36
    v_min3_f32 v42, v42, v35, v36
    v_mfma_f32_16x16x32_bf16 v[76:79], v[212:215], v[88:91], 0
    v_max3_f32 v40, v40, v37, v38
    v_min3_f32 v42, v42, v37, v38
    v_max_f32 v40, v40, v39
    v_min_f32 v42, v42, v39
    v_mul_f32 v40, v44, v40
    v_mul_f32 v42, v44, v42
    v_mfma_f32_16x16x32_bf16 v[80:83], v[222:225], v[88:91], 0
    v_pk_fma_f32 v[0:1], v[20:21], v[44:45], v[42:43] op_sel_hi:[1,0,0] neg_lo:[1,0,0] neg_hi:[1,0,0]
    v_pk_fma_f32 v[20:21], v[20:21], v[44:45], v[40:41] op_sel_hi:[1,0,0] neg_lo:[0,0,1] neg_hi:[0,0,1]
    v_pk_fma_f32 v[2:3], v[22:23], v[44:45], v[42:43] op_sel_hi:[1,0,0] neg_lo:[1,0,0] neg_hi:[1,0,0]
    v_pk_fma_f32 v[22:23], v[22:23], v[44:45], v[40:41] op_sel_hi:[1,0,0] neg_lo:[0,0,1] neg_hi:[0,0,1]
    v_pk_fma_f32 v[4:5], v[24:25], v[44:45], v[42:43] op_sel_hi:[1,0,0] neg_lo:[1,0,0] neg_hi:[1,0,0]
    v_pk_fma_f32 v[24:25], v[24:25], v[44:45], v[40:41] op_sel_hi:[1,0,0] neg_lo:[0,0,1] neg_hi:[0,0,1]
    v_mfma_f32_16x16x32_bf16 v[84:87], v[232:235], v[88:91], 0
    v_pk_fma_f32 v[6:7], v[26:27], v[44:45], v[42:43] op_sel_hi:[1,0,0] neg_lo:[1,0,0] neg_hi:[1,0,0]
    v_pk_fma_f32 v[26:27], v[26:27], v[44:45], v[40:41] op_sel_hi:[1,0,0] neg_lo:[0,0,1] neg_hi:[0,0,1]
    v_pk_fma_f32 v[8:9], v[28:29], v[44:45], v[42:43] op_sel_hi:[1,0,0] neg_lo:[1,0,0] neg_hi:[1,0,0]
    v_pk_fma_f32 v[28:29], v[28:29], v[44:45], v[40:41] op_sel_hi:[1,0,0] neg_lo:[0,0,1] neg_hi:[0,0,1]
    v_pk_fma_f32 v[10:11], v[30:31], v[44:45], v[42:43] op_sel_hi:[1,0,0] neg_lo:[1,0,0] neg_hi:[1,0,0]
    v_pk_fma_f32 v[30:31], v[30:31], v[44:45], v[40:41] op_sel_hi:[1,0,0] neg_lo:[0,0,1] neg_hi:[0,0,1]
    v_mfma_f32_16x16x32_bf16 v[68:71], v[196:199], v[92:95], v[68:71]
    v_pk_fma_f32 v[12:13], v[32:33], v[44:45], v[42:43] op_sel_hi:[1,0,0] neg_lo:[1,0,0] neg_hi:[1,0,0]
    v_pk_fma_f32 v[32:33], v[32:33], v[44:45], v[40:41] op_sel_hi:[1,0,0] neg_lo:[0,0,1] neg_hi:[0,0,1]
    v_pk_fma_f32 v[14:15], v[34:35], v[44:45], v[42:43] op_sel_hi:[1,0,0] neg_lo:[1,0,0] neg_hi:[1,0,0]
    v_pk_fma_f32 v[34:35], v[34:35], v[44:45], v[40:41] op_sel_hi:[1,0,0] neg_lo:[0,0,1] neg_hi:[0,0,1]
    v_pk_fma_f32 v[16:17], v[36:37], v[44:45], v[42:43] op_sel_hi:[1,0,0] neg_lo:[1,0,0] neg_hi:[1,0,0]
    v_pk_fma_f32 v[36:37], v[36:37], v[44:45], v[40:41] op_sel_hi:[1,0,0] neg_lo:[0,0,1] neg_hi:[0,0,1]
    v_mfma_f32_16x16x32_bf16 v[72:75], v[206:209], v[92:95], v[72:75]
    v_pk_fma_f32 v[18:19], v[38:39], v[44:45], v[42:43] op_sel_hi:[1,0,0] neg_lo:[1,0,0] neg_hi:[1,0,0]
    v_pk_fma_f32 v[38:39], v[38:39], v[44:45], v[40:41] op_sel_hi:[1,0,0] neg_lo:[0,0,1] neg_hi:[0,0,1]
    v_exp_f32 v20, v20
    v_exp_f32 v0, v0
    v_exp_f32 v21, v21
    v_exp_f32 v1, v1
    v_mfma_f32_16x16x32_bf16 v[76:79], v[216:219], v[92:95], v[76:79]
    v_exp_f32 v22, v22
    v_exp_f32 v2, v2
    v_exp_f32 v23, v23
    v_exp_f32 v3, v3
    v_exp_f32 v24, v24
    v_exp_f32 v4, v4
    v_mfma_f32_16x16x32_bf16 v[80:83], v[226:229], v[92:95], v[80:83]
    v_exp_f32 v25, v25
    v_exp_f32 v5, v5
    v_exp_f32 v26, v26
    v_exp_f32 v6, v6
    v_exp_f32 v27, v27
    v_exp_f32 v7, v7
    v_mfma_f32_16x16x32_bf16 v[84:87], v[236:239], v[92:95], v[84:87]
    v_exp_f32 v28, v28
    v_exp_f32 v8, v8
    v_exp_f32 v29, v29
    v_exp_f32 v9, v9
    v_exp_f32 v30, v30
    v_exp_f32 v10, v10
    v_mfma_f32_16x16x16_bf16 v[68:71], v[200:201], v[64:65], v[68:71]
    v_exp_f32 v31, v31
    v_exp_f32 v11, v11
    v_exp_f32 v32, v32
    v_exp_f32 v12, v12
    v_exp_f32 v33, v33
    v_exp_f32 v13, v13
    v_mfma_f32_16x16x16_bf16 v[72:75], v[210:211], v[64:65], v[72:75]
    v_exp_f32 v34, v34
    v_exp_f32 v14, v14
    v_exp_f32 v35, v35
    v_exp_f32 v15, v15
    v_exp_f32 v36, v36
    v_exp_f32 v16, v16
    v_mfma_f32_16x16x16_bf16 v[76:79], v[220:221], v[64:65], v[76:79]
    v_exp_f32 v37, v37
    v_exp_f32 v17, v17
    v_exp_f32 v38, v38
    v_exp_f32 v18, v18
    v_exp_f32 v39, v39
    v_exp_f32 v19, v19
    v_mfma_f32_16x16x16_bf16 v[80:83], v[230:231], v[64:65], v[80:83]
    v_pk_add_f32 v[40:41], v[20:21], v[22:23]
    v_pk_add_f32 v[42:43], v[0:1], v[2:3]
    v_pk_add_f32 v[40:41], v[40:41], v[24:25]
    v_pk_add_f32 v[42:43], v[42:43], v[4:5]
    v_pk_add_f32 v[40:41], v[40:41], v[26:27]
    v_pk_add_f32 v[42:43], v[42:43], v[6:7]
    v_mfma_f32_16x16x16_bf16 v[84:87], v[240:241], v[64:65], v[84:87]
    v_pk_add_f32 v[40:41], v[40:41], v[28:29]
    v_pk_add_f32 v[42:43], v[42:43], v[8:9]
    v_pk_add_f32 v[40:41], v[40:41], v[30:31]
    v_pk_add_f32 v[42:43], v[42:43], v[10:11]
    v_pk_add_f32 v[40:41], v[40:41], v[32:33]
    v_pk_add_f32 v[42:43], v[42:43], v[12:13]
    v_pk_add_f32 v[40:41], v[40:41], v[34:35]
    v_pk_add_f32 v[42:43], v[42:43], v[14:15]
    v_pk_add_f32 v[40:41], v[40:41], v[36:37]
    v_pk_add_f32 v[42:43], v[42:43], v[16:17]
    v_pk_add_f32 v[40:41], v[40:41], v[38:39]
    v_pk_add_f32 v[42:43], v[42:43], v[18:19]
    v_add_f32 v40, v40, v41
    v_add_f32 v42, v42, v43
    v_rcp_f32 v40, v40
    v_rcp_f32 v42, v42
    v_pk_mul_f32 v[20:21], v[20:21], v[40:41] op_sel_hi:[1,0]
    v_pk_mul_f32 v[0:1], v[0:1], v[42:43] op_sel_hi:[1,0]
    v_pk_mul_f32 v[22:23], v[22:23], v[40:41] op_sel_hi:[1,0]
    v_pk_mul_f32 v[2:3], v[2:3], v[42:43] op_sel_hi:[1,0]
    v_pk_mul_f32 v[24:25], v[24:25], v[40:41] op_sel_hi:[1,0]
    v_pk_mul_f32 v[4:5], v[4:5], v[42:43] op_sel_hi:[1,0]
    v_pk_mul_f32 v[26:27], v[26:27], v[40:41] op_sel_hi:[1,0]
    v_pk_mul_f32 v[6:7], v[6:7], v[42:43] op_sel_hi:[1,0]
    v_pk_mul_f32 v[28:29], v[28:29], v[40:41] op_sel_hi:[1,0]
    v_pk_mul_f32 v[8:9], v[8:9], v[42:43] op_sel_hi:[1,0]
    v_pk_mul_f32 v[30:31], v[30:31], v[40:41] op_sel_hi:[1,0]
    v_pk_mul_f32 v[10:11], v[10:11], v[42:43] op_sel_hi:[1,0]
    v_pk_mul_f32 v[32:33], v[32:33], v[40:41] op_sel_hi:[1,0]
    v_pk_mul_f32 v[12:13], v[12:13], v[42:43] op_sel_hi:[1,0]
    v_pk_mul_f32 v[34:35], v[34:35], v[40:41] op_sel_hi:[1,0]
    v_pk_mul_f32 v[14:15], v[14:15], v[42:43] op_sel_hi:[1,0]
    v_pk_mul_f32 v[36:37], v[36:37], v[40:41] op_sel_hi:[1,0]
    v_pk_mul_f32 v[16:17], v[16:17], v[42:43] op_sel_hi:[1,0]
    v_pk_mul_f32 v[38:39], v[38:39], v[40:41] op_sel_hi:[1,0]
    v_pk_mul_f32 v[18:19], v[18:19], v[42:43] op_sel_hi:[1,0]
    v_cvt_pk_bf16_f32 v20, v20, v21
    v_cvt_pk_bf16_f32 v21, v22, v23
    v_cvt_pk_bf16_f32 v22, v24, v25
    v_cvt_pk_bf16_f32 v23, v26, v27
    v_cvt_pk_bf16_f32 v24, v28, v29
    v_cvt_pk_bf16_f32 v25, v30, v31
    v_cvt_pk_bf16_f32 v26, v32, v33
    v_cvt_pk_bf16_f32 v27, v34, v35
    v_cvt_pk_bf16_f32 v28, v36, v37
    v_cvt_pk_bf16_f32 v29, v38, v39
    v_cvt_pk_bf16_f32 v30, v0, v1
    v_cvt_pk_bf16_f32 v31, v2, v3
    v_cvt_pk_bf16_f32 v32, v4, v5
    v_cvt_pk_bf16_f32 v33, v6, v7
    v_cvt_pk_bf16_f32 v34, v8, v9
    v_cvt_pk_bf16_f32 v35, v10, v11
    v_cvt_pk_bf16_f32 v36, v12, v13
    v_cvt_pk_bf16_f32 v37, v14, v15
    v_cvt_pk_bf16_f32 v38, v16, v17
    v_cvt_pk_bf16_f32 v39, v18, v19
    v_mov_b32_e64 v92, v253
    v_max3_f32 v88, v68, v69, v70
    v_min3_f32 v90, v68, v69, v70
    v_max3_f32 v88, v88, v71, v72
    v_min3_f32 v90, v90, v71, v72
    v_mfma_f32_16x16x32_bf16 v[116:119], v[192:195], v[136:139], 0
    v_max3_f32 v88, v88, v73, v74
    v_min3_f32 v90, v90, v73, v74
    v_max3_f32 v88, v88, v75, v76
    v_min3_f32 v90, v90, v75, v76
    v_max3_f32 v88, v88, v77, v78
    v_min3_f32 v90, v90, v77, v78
    v_mfma_f32_16x16x32_bf16 v[120:123], v[202:205], v[136:139], 0
    v_max3_f32 v88, v88, v79, v80
    v_min3_f32 v90, v90, v79, v80
    v_max3_f32 v88, v88, v81, v82
    v_min3_f32 v90, v90, v81, v82
    v_max3_f32 v88, v88, v83, v84
    v_min3_f32 v90, v90, v83, v84
    v_mfma_f32_16x16x32_bf16 v[124:127], v[212:215], v[136:139], 0
    v_max3_f32 v88, v88, v85, v86
    v_min3_f32 v90, v90, v85, v86
    v_max_f32 v88, v88, v87
    v_min_f32 v90, v90, v87
    v_mul_f32 v88, v92, v88
    v_mul_f32 v90, v92, v90
    v_mfma_f32_16x16x32_bf16 v[128:131], v[222:225], v[136:139], 0
    v_pk_fma_f32 v[48:49], v[68:69], v[92:93], v[90:91] op_sel_hi:[1,0,0] neg_lo:[1,0,0] neg_hi:[1,0,0]
    v_pk_fma_f32 v[68:69], v[68:69], v[92:93], v[88:89] op_sel_hi:[1,0,0] neg_lo:[0,0,1] neg_hi:[0,0,1]
    v_pk_fma_f32 v[50:51], v[70:71], v[92:93], v[90:91] op_sel_hi:[1,0,0] neg_lo:[1,0,0] neg_hi:[1,0,0]
    v_pk_fma_f32 v[70:71], v[70:71], v[92:93], v[88:89] op_sel_hi:[1,0,0] neg_lo:[0,0,1] neg_hi:[0,0,1]
    v_pk_fma_f32 v[52:53], v[72:73], v[92:93], v[90:91] op_sel_hi:[1,0,0] neg_lo:[1,0,0] neg_hi:[1,0,0]
    v_pk_fma_f32 v[72:73], v[72:73], v[92:93], v[88:89] op_sel_hi:[1,0,0] neg_lo:[0,0,1] neg_hi:[0,0,1]
    v_mfma_f32_16x16x32_bf16 v[132:135], v[232:235], v[136:139], 0
    v_pk_fma_f32 v[54:55], v[74:75], v[92:93], v[90:91] op_sel_hi:[1,0,0] neg_lo:[1,0,0] neg_hi:[1,0,0]
    v_pk_fma_f32 v[74:75], v[74:75], v[92:93], v[88:89] op_sel_hi:[1,0,0] neg_lo:[0,0,1] neg_hi:[0,0,1]
    v_pk_fma_f32 v[56:57], v[76:77], v[92:93], v[90:91] op_sel_hi:[1,0,0] neg_lo:[1,0,0] neg_hi:[1,0,0]
    v_pk_fma_f32 v[76:77], v[76:77], v[92:93], v[88:89] op_sel_hi:[1,0,0] neg_lo:[0,0,1] neg_hi:[0,0,1]
    v_pk_fma_f32 v[58:59], v[78:79], v[92:93], v[90:91] op_sel_hi:[1,0,0] neg_lo:[1,0,0] neg_hi:[1,0,0]
    v_pk_fma_f32 v[78:79], v[78:79], v[92:93], v[88:89] op_sel_hi:[1,0,0] neg_lo:[0,0,1] neg_hi:[0,0,1]
    v_mfma_f32_16x16x32_bf16 v[116:119], v[196:199], v[140:143], v[116:119]
    v_pk_fma_f32 v[60:61], v[80:81], v[92:93], v[90:91] op_sel_hi:[1,0,0] neg_lo:[1,0,0] neg_hi:[1,0,0]
    v_pk_fma_f32 v[80:81], v[80:81], v[92:93], v[88:89] op_sel_hi:[1,0,0] neg_lo:[0,0,1] neg_hi:[0,0,1]
    v_pk_fma_f32 v[62:63], v[82:83], v[92:93], v[90:91] op_sel_hi:[1,0,0] neg_lo:[1,0,0] neg_hi:[1,0,0]
    v_pk_fma_f32 v[82:83], v[82:83], v[92:93], v[88:89] op_sel_hi:[1,0,0] neg_lo:[0,0,1] neg_hi:[0,0,1]
    v_pk_fma_f32 v[64:65], v[84:85], v[92:93], v[90:91] op_sel_hi:[1,0,0] neg_lo:[1,0,0] neg_hi:[1,0,0]
    v_pk_fma_f32 v[84:85], v[84:85], v[92:93], v[88:89] op_sel_hi:[1,0,0] neg_lo:[0,0,1] neg_hi:[0,0,1]
    v_mfma_f32_16x16x32_bf16 v[120:123], v[206:209], v[140:143], v[120:123]
    v_pk_fma_f32 v[66:67], v[86:87], v[92:93], v[90:91] op_sel_hi:[1,0,0] neg_lo:[1,0,0] neg_hi:[1,0,0]
    v_pk_fma_f32 v[86:87], v[86:87], v[92:93], v[88:89] op_sel_hi:[1,0,0] neg_lo:[0,0,1] neg_hi:[0,0,1]
    v_exp_f32 v68, v68
    v_exp_f32 v48, v48
    v_exp_f32 v69, v69
    v_exp_f32 v49, v49
    v_mfma_f32_16x16x32_bf16 v[124:127], v[216:219], v[140:143], v[124:127]
    v_exp_f32 v70, v70
    v_exp_f32 v50, v50
    v_exp_f32 v71, v71
    v_exp_f32 v51, v51
    v_exp_f32 v72, v72
    v_exp_f32 v52, v52
    v_mfma_f32_16x16x32_bf16 v[128:131], v[226:229], v[140:143], v[128:131]
    v_exp_f32 v73, v73
    v_exp_f32 v53, v53
    v_exp_f32 v74, v74
    v_exp_f32 v54, v54
    v_exp_f32 v75, v75
    v_exp_f32 v55, v55
    v_mfma_f32_16x16x32_bf16 v[132:135], v[236:239], v[140:143], v[132:135]
    v_exp_f32 v76, v76
    v_exp_f32 v56, v56
    v_exp_f32 v77, v77
    v_exp_f32 v57, v57
    v_exp_f32 v78, v78
    v_exp_f32 v58, v58
    v_mfma_f32_16x16x16_bf16 v[116:119], v[200:201], v[112:113], v[116:119]
    v_exp_f32 v79, v79
    v_exp_f32 v59, v59
    v_exp_f32 v80, v80
    v_exp_f32 v60, v60
    v_exp_f32 v81, v81
    v_exp_f32 v61, v61
    v_mfma_f32_16x16x16_bf16 v[120:123], v[210:211], v[112:113], v[120:123]
    v_exp_f32 v82, v82
    v_exp_f32 v62, v62
    v_exp_f32 v83, v83
    v_exp_f32 v63, v63
    v_exp_f32 v84, v84
    v_exp_f32 v64, v64
    v_mfma_f32_16x16x16_bf16 v[124:127], v[220:221], v[112:113], v[124:127]
    v_exp_f32 v85, v85
    v_exp_f32 v65, v65
    v_exp_f32 v86, v86
    v_exp_f32 v66, v66
    v_exp_f32 v87, v87
    v_exp_f32 v67, v67
    v_mfma_f32_16x16x16_bf16 v[128:131], v[230:231], v[112:113], v[128:131]
    v_pk_add_f32 v[88:89], v[68:69], v[70:71]
    v_pk_add_f32 v[90:91], v[48:49], v[50:51]
    v_pk_add_f32 v[88:89], v[88:89], v[72:73]
    v_pk_add_f32 v[90:91], v[90:91], v[52:53]
    v_pk_add_f32 v[88:89], v[88:89], v[74:75]
    v_pk_add_f32 v[90:91], v[90:91], v[54:55]
    v_mfma_f32_16x16x16_bf16 v[132:135], v[240:241], v[112:113], v[132:135]
    v_pk_add_f32 v[88:89], v[88:89], v[76:77]
    v_pk_add_f32 v[90:91], v[90:91], v[56:57]
    v_pk_add_f32 v[88:89], v[88:89], v[78:79]
    v_pk_add_f32 v[90:91], v[90:91], v[58:59]
    v_pk_add_f32 v[88:89], v[88:89], v[80:81]
    v_pk_add_f32 v[90:91], v[90:91], v[60:61]
    ds_write_b128 v251, v[20:23] offset:0
    v_pk_add_f32 v[88:89], v[88:89], v[82:83]
    v_pk_add_f32 v[90:91], v[90:91], v[62:63]
    v_pk_add_f32 v[88:89], v[88:89], v[84:85]
    v_pk_add_f32 v[90:91], v[90:91], v[64:65]
    v_pk_add_f32 v[88:89], v[88:89], v[86:87]
    v_pk_add_f32 v[90:91], v[90:91], v[66:67]
    ds_write_b128 v251, v[24:27] offset:16
    v_add_f32 v88, v88, v89
    v_add_f32 v90, v90, v91
    v_rcp_f32 v88, v88
    v_rcp_f32 v90, v90
    v_pk_mul_f32 v[68:69], v[68:69], v[88:89] op_sel_hi:[1,0]
    v_pk_mul_f32 v[48:49], v[48:49], v[90:91] op_sel_hi:[1,0]
    ds_write_b128 v251, v[28:31] offset:32
    v_pk_mul_f32 v[70:71], v[70:71], v[88:89] op_sel_hi:[1,0]
    v_pk_mul_f32 v[50:51], v[50:51], v[90:91] op_sel_hi:[1,0]
    v_pk_mul_f32 v[72:73], v[72:73], v[88:89] op_sel_hi:[1,0]
    v_pk_mul_f32 v[52:53], v[52:53], v[90:91] op_sel_hi:[1,0]
    v_pk_mul_f32 v[74:75], v[74:75], v[88:89] op_sel_hi:[1,0]
    v_pk_mul_f32 v[54:55], v[54:55], v[90:91] op_sel_hi:[1,0]
    ds_write_b128 v251, v[32:35] offset:48
    v_pk_mul_f32 v[76:77], v[76:77], v[88:89] op_sel_hi:[1,0]
    v_pk_mul_f32 v[56:57], v[56:57], v[90:91] op_sel_hi:[1,0]
    v_pk_mul_f32 v[78:79], v[78:79], v[88:89] op_sel_hi:[1,0]
    v_pk_mul_f32 v[58:59], v[58:59], v[90:91] op_sel_hi:[1,0]
    v_pk_mul_f32 v[80:81], v[80:81], v[88:89] op_sel_hi:[1,0]
    v_pk_mul_f32 v[60:61], v[60:61], v[90:91] op_sel_hi:[1,0]
    ds_write_b128 v251, v[36:39] offset:64
    v_pk_mul_f32 v[82:83], v[82:83], v[88:89] op_sel_hi:[1,0]
    v_pk_mul_f32 v[62:63], v[62:63], v[90:91] op_sel_hi:[1,0]
    v_pk_mul_f32 v[84:85], v[84:85], v[88:89] op_sel_hi:[1,0]
    v_pk_mul_f32 v[64:65], v[64:65], v[90:91] op_sel_hi:[1,0]
    v_pk_mul_f32 v[86:87], v[86:87], v[88:89] op_sel_hi:[1,0]
    v_pk_mul_f32 v[66:67], v[66:67], v[90:91] op_sel_hi:[1,0]
    v_cvt_pk_bf16_f32 v68, v68, v69
    v_cvt_pk_bf16_f32 v69, v70, v71
    v_cvt_pk_bf16_f32 v70, v72, v73
    v_cvt_pk_bf16_f32 v71, v74, v75
    v_cvt_pk_bf16_f32 v72, v76, v77
    v_cvt_pk_bf16_f32 v73, v78, v79
    v_cvt_pk_bf16_f32 v74, v80, v81
    v_cvt_pk_bf16_f32 v75, v82, v83
    v_cvt_pk_bf16_f32 v76, v84, v85
    v_cvt_pk_bf16_f32 v77, v86, v87
    v_cvt_pk_bf16_f32 v78, v48, v49
    v_cvt_pk_bf16_f32 v79, v50, v51
    v_cvt_pk_bf16_f32 v80, v52, v53
    v_cvt_pk_bf16_f32 v81, v54, v55
    v_cvt_pk_bf16_f32 v82, v56, v57
    v_cvt_pk_bf16_f32 v83, v58, v59
    v_cvt_pk_bf16_f32 v84, v60, v61
    v_cvt_pk_bf16_f32 v85, v62, v63
    v_cvt_pk_bf16_f32 v86, v64, v65
    v_cvt_pk_bf16_f32 v87, v66, v67
    v_mov_b32_e64 v140, v254
    v_max3_f32 v136, v116, v117, v118
    v_min3_f32 v138, v116, v117, v118
    v_max3_f32 v136, v136, v119, v120
    v_min3_f32 v138, v138, v119, v120
    v_mfma_f32_16x16x32_bf16 v[164:167], v[192:195], v[184:187], 0
    v_max3_f32 v136, v136, v121, v122
    v_min3_f32 v138, v138, v121, v122
    v_max3_f32 v136, v136, v123, v124
    v_min3_f32 v138, v138, v123, v124
    v_max3_f32 v136, v136, v125, v126
    v_min3_f32 v138, v138, v125, v126
    v_mfma_f32_16x16x32_bf16 v[168:171], v[202:205], v[184:187], 0
    v_max3_f32 v136, v136, v127, v128
    v_min3_f32 v138, v138, v127, v128
    v_max3_f32 v136, v136, v129, v130
    v_min3_f32 v138, v138, v129, v130
    v_max3_f32 v136, v136, v131, v132
    v_min3_f32 v138, v138, v131, v132
    v_mfma_f32_16x16x32_bf16 v[172:175], v[212:215], v[184:187], 0
    v_max3_f32 v136, v136, v133, v134
    v_min3_f32 v138, v138, v133, v134
    v_max_f32 v136, v136, v135
    v_min_f32 v138, v138, v135
    v_mul_f32 v136, v140, v136
    v_mul_f32 v138, v140, v138
    v_mfma_f32_16x16x32_bf16 v[176:179], v[222:225], v[184:187], 0
    v_pk_fma_f32 v[96:97], v[116:117], v[140:141], v[138:139] op_sel_hi:[1,0,0] neg_lo:[1,0,0] neg_hi:[1,0,0]
    v_pk_fma_f32 v[116:117], v[116:117], v[140:141], v[136:137] op_sel_hi:[1,0,0] neg_lo:[0,0,1] neg_hi:[0,0,1]
    v_pk_fma_f32 v[98:99], v[118:119], v[140:141], v[138:139] op_sel_hi:[1,0,0] neg_lo:[1,0,0] neg_hi:[1,0,0]
    v_pk_fma_f32 v[118:119], v[118:119], v[140:141], v[136:137] op_sel_hi:[1,0,0] neg_lo:[0,0,1] neg_hi:[0,0,1]
    v_pk_fma_f32 v[100:101], v[120:121], v[140:141], v[138:139] op_sel_hi:[1,0,0] neg_lo:[1,0,0] neg_hi:[1,0,0]
    v_pk_fma_f32 v[120:121], v[120:121], v[140:141], v[136:137] op_sel_hi:[1,0,0] neg_lo:[0,0,1] neg_hi:[0,0,1]
    v_mfma_f32_16x16x32_bf16 v[180:183], v[232:235], v[184:187], 0
    v_pk_fma_f32 v[102:103], v[122:123], v[140:141], v[138:139] op_sel_hi:[1,0,0] neg_lo:[1,0,0] neg_hi:[1,0,0]
    v_pk_fma_f32 v[122:123], v[122:123], v[140:141], v[136:137] op_sel_hi:[1,0,0] neg_lo:[0,0,1] neg_hi:[0,0,1]
    v_pk_fma_f32 v[104:105], v[124:125], v[140:141], v[138:139] op_sel_hi:[1,0,0] neg_lo:[1,0,0] neg_hi:[1,0,0]
    v_pk_fma_f32 v[124:125], v[124:125], v[140:141], v[136:137] op_sel_hi:[1,0,0] neg_lo:[0,0,1] neg_hi:[0,0,1]
    v_pk_fma_f32 v[106:107], v[126:127], v[140:141], v[138:139] op_sel_hi:[1,0,0] neg_lo:[1,0,0] neg_hi:[1,0,0]
    v_pk_fma_f32 v[126:127], v[126:127], v[140:141], v[136:137] op_sel_hi:[1,0,0] neg_lo:[0,0,1] neg_hi:[0,0,1]
    v_mfma_f32_16x16x32_bf16 v[164:167], v[196:199], v[188:191], v[164:167]
    v_pk_fma_f32 v[108:109], v[128:129], v[140:141], v[138:139] op_sel_hi:[1,0,0] neg_lo:[1,0,0] neg_hi:[1,0,0]
    v_pk_fma_f32 v[128:129], v[128:129], v[140:141], v[136:137] op_sel_hi:[1,0,0] neg_lo:[0,0,1] neg_hi:[0,0,1]
    v_pk_fma_f32 v[110:111], v[130:131], v[140:141], v[138:139] op_sel_hi:[1,0,0] neg_lo:[1,0,0] neg_hi:[1,0,0]
    v_pk_fma_f32 v[130:131], v[130:131], v[140:141], v[136:137] op_sel_hi:[1,0,0] neg_lo:[0,0,1] neg_hi:[0,0,1]
    v_pk_fma_f32 v[112:113], v[132:133], v[140:141], v[138:139] op_sel_hi:[1,0,0] neg_lo:[1,0,0] neg_hi:[1,0,0]
    v_pk_fma_f32 v[132:133], v[132:133], v[140:141], v[136:137] op_sel_hi:[1,0,0] neg_lo:[0,0,1] neg_hi:[0,0,1]
    v_mfma_f32_16x16x32_bf16 v[168:171], v[206:209], v[188:191], v[168:171]
    v_pk_fma_f32 v[114:115], v[134:135], v[140:141], v[138:139] op_sel_hi:[1,0,0] neg_lo:[1,0,0] neg_hi:[1,0,0]
    v_pk_fma_f32 v[134:135], v[134:135], v[140:141], v[136:137] op_sel_hi:[1,0,0] neg_lo:[0,0,1] neg_hi:[0,0,1]
    v_exp_f32 v116, v116
    v_exp_f32 v96, v96
    v_exp_f32 v117, v117
    v_exp_f32 v97, v97
    v_mfma_f32_16x16x32_bf16 v[172:175], v[216:219], v[188:191], v[172:175]
    v_exp_f32 v118, v118
    v_exp_f32 v98, v98
    v_exp_f32 v119, v119
    v_exp_f32 v99, v99
    v_exp_f32 v120, v120
    v_exp_f32 v100, v100
    v_mfma_f32_16x16x32_bf16 v[176:179], v[226:229], v[188:191], v[176:179]
    v_exp_f32 v121, v121
    v_exp_f32 v101, v101
    v_exp_f32 v122, v122
    v_exp_f32 v102, v102
    v_exp_f32 v123, v123
    v_exp_f32 v103, v103
    v_mfma_f32_16x16x32_bf16 v[180:183], v[236:239], v[188:191], v[180:183]
    v_exp_f32 v124, v124
    v_exp_f32 v104, v104
    v_exp_f32 v125, v125
    v_exp_f32 v105, v105
    v_exp_f32 v126, v126
    v_exp_f32 v106, v106
    v_mfma_f32_16x16x16_bf16 v[164:167], v[200:201], v[160:161], v[164:167]
    v_exp_f32 v127, v127
    v_exp_f32 v107, v107
    v_exp_f32 v128, v128
    v_exp_f32 v108, v108
    v_exp_f32 v129, v129
    v_exp_f32 v109, v109
    v_mfma_f32_16x16x16_bf16 v[168:171], v[210:211], v[160:161], v[168:171]
    v_exp_f32 v130, v130
    v_exp_f32 v110, v110
    v_exp_f32 v131, v131
    v_exp_f32 v111, v111
    v_exp_f32 v132, v132
    v_exp_f32 v112, v112
    v_mfma_f32_16x16x16_bf16 v[172:175], v[220:221], v[160:161], v[172:175]
    v_exp_f32 v133, v133
    v_exp_f32 v113, v113
    v_exp_f32 v134, v134
    v_exp_f32 v114, v114
    v_exp_f32 v135, v135
    v_exp_f32 v115, v115
    v_mfma_f32_16x16x16_bf16 v[176:179], v[230:231], v[160:161], v[176:179]
    v_pk_add_f32 v[136:137], v[116:117], v[118:119]
    v_pk_add_f32 v[138:139], v[96:97], v[98:99]
    v_pk_add_f32 v[136:137], v[136:137], v[120:121]
    v_pk_add_f32 v[138:139], v[138:139], v[100:101]
    v_pk_add_f32 v[136:137], v[136:137], v[122:123]
    v_pk_add_f32 v[138:139], v[138:139], v[102:103]
    v_mfma_f32_16x16x16_bf16 v[180:183], v[240:241], v[160:161], v[180:183]
    v_pk_add_f32 v[136:137], v[136:137], v[124:125]
    v_pk_add_f32 v[138:139], v[138:139], v[104:105]
    v_pk_add_f32 v[136:137], v[136:137], v[126:127]
    v_pk_add_f32 v[138:139], v[138:139], v[106:107]
    v_pk_add_f32 v[136:137], v[136:137], v[128:129]
    v_pk_add_f32 v[138:139], v[138:139], v[108:109]
    ds_write_b128 v251, v[68:71] offset:5376
    v_pk_add_f32 v[136:137], v[136:137], v[130:131]
    v_pk_add_f32 v[138:139], v[138:139], v[110:111]
    v_pk_add_f32 v[136:137], v[136:137], v[132:133]
    v_pk_add_f32 v[138:139], v[138:139], v[112:113]
    v_pk_add_f32 v[136:137], v[136:137], v[134:135]
    v_pk_add_f32 v[138:139], v[138:139], v[114:115]
    ds_write_b128 v251, v[72:75] offset:5392
    v_add_f32 v136, v136, v137
    v_add_f32 v138, v138, v139
    v_rcp_f32 v136, v136
    v_rcp_f32 v138, v138
    v_pk_mul_f32 v[116:117], v[116:117], v[136:137] op_sel_hi:[1,0]
    v_pk_mul_f32 v[96:97], v[96:97], v[138:139] op_sel_hi:[1,0]
    ds_write_b128 v251, v[76:79] offset:5408
    v_pk_mul_f32 v[118:119], v[118:119], v[136:137] op_sel_hi:[1,0]
    v_pk_mul_f32 v[98:99], v[98:99], v[138:139] op_sel_hi:[1,0]
    v_pk_mul_f32 v[120:121], v[120:121], v[136:137] op_sel_hi:[1,0]
    v_pk_mul_f32 v[100:101], v[100:101], v[138:139] op_sel_hi:[1,0]
    v_pk_mul_f32 v[122:123], v[122:123], v[136:137] op_sel_hi:[1,0]
    v_pk_mul_f32 v[102:103], v[102:103], v[138:139] op_sel_hi:[1,0]
    ds_write_b128 v251, v[80:83] offset:5424
    v_pk_mul_f32 v[124:125], v[124:125], v[136:137] op_sel_hi:[1,0]
    v_pk_mul_f32 v[104:105], v[104:105], v[138:139] op_sel_hi:[1,0]
    v_pk_mul_f32 v[126:127], v[126:127], v[136:137] op_sel_hi:[1,0]
    v_pk_mul_f32 v[106:107], v[106:107], v[138:139] op_sel_hi:[1,0]
    v_pk_mul_f32 v[128:129], v[128:129], v[136:137] op_sel_hi:[1,0]
    v_pk_mul_f32 v[108:109], v[108:109], v[138:139] op_sel_hi:[1,0]
    ds_write_b128 v251, v[84:87] offset:5440
    v_pk_mul_f32 v[130:131], v[130:131], v[136:137] op_sel_hi:[1,0]
    v_pk_mul_f32 v[110:111], v[110:111], v[138:139] op_sel_hi:[1,0]
    v_pk_mul_f32 v[132:133], v[132:133], v[136:137] op_sel_hi:[1,0]
    v_pk_mul_f32 v[112:113], v[112:113], v[138:139] op_sel_hi:[1,0]
    v_pk_mul_f32 v[134:135], v[134:135], v[136:137] op_sel_hi:[1,0]
    v_pk_mul_f32 v[114:115], v[114:115], v[138:139] op_sel_hi:[1,0]
    v_cvt_pk_bf16_f32 v116, v116, v117
    v_cvt_pk_bf16_f32 v117, v118, v119
    v_cvt_pk_bf16_f32 v118, v120, v121
    v_cvt_pk_bf16_f32 v119, v122, v123
    v_cvt_pk_bf16_f32 v120, v124, v125
    v_cvt_pk_bf16_f32 v121, v126, v127
    v_cvt_pk_bf16_f32 v122, v128, v129
    v_cvt_pk_bf16_f32 v123, v130, v131
    v_cvt_pk_bf16_f32 v124, v132, v133
    v_cvt_pk_bf16_f32 v125, v134, v135
    v_cvt_pk_bf16_f32 v126, v96, v97
    v_cvt_pk_bf16_f32 v127, v98, v99
    v_cvt_pk_bf16_f32 v128, v100, v101
    v_cvt_pk_bf16_f32 v129, v102, v103
    v_cvt_pk_bf16_f32 v130, v104, v105
    v_cvt_pk_bf16_f32 v131, v106, v107
    v_cvt_pk_bf16_f32 v132, v108, v109
    v_cvt_pk_bf16_f32 v133, v110, v111
    v_cvt_pk_bf16_f32 v134, v112, v113
    v_cvt_pk_bf16_f32 v135, v114, v115
    v_mov_b32_e64 v188, v255
    v_max3_f32 v184, v164, v165, v166
    v_min3_f32 v186, v164, v165, v166
    v_max3_f32 v184, v184, v167, v168
    v_min3_f32 v186, v186, v167, v168
    ds_write_b128 v251, v[116:119] offset:10752
    v_max3_f32 v184, v184, v169, v170
    v_min3_f32 v186, v186, v169, v170
    v_max3_f32 v184, v184, v171, v172
    v_min3_f32 v186, v186, v171, v172
    v_max3_f32 v184, v184, v173, v174
    v_min3_f32 v186, v186, v173, v174
    ds_write_b128 v251, v[120:123] offset:10768
    v_max3_f32 v184, v184, v175, v176
    v_min3_f32 v186, v186, v175, v176
    v_max3_f32 v184, v184, v177, v178
    v_min3_f32 v186, v186, v177, v178
    v_max3_f32 v184, v184, v179, v180
    v_min3_f32 v186, v186, v179, v180
    ds_write_b128 v251, v[124:127] offset:10784
    v_max3_f32 v184, v184, v181, v182
    v_min3_f32 v186, v186, v181, v182
    v_max_f32 v184, v184, v183
    v_min_f32 v186, v186, v183
    v_mul_f32 v184, v188, v184
    v_mul_f32 v186, v188, v186
    ds_write_b128 v251, v[128:131] offset:10800
    v_pk_fma_f32 v[144:145], v[164:165], v[188:189], v[186:187] op_sel_hi:[1,0,0] neg_lo:[1,0,0] neg_hi:[1,0,0]
    v_pk_fma_f32 v[164:165], v[164:165], v[188:189], v[184:185] op_sel_hi:[1,0,0] neg_lo:[0,0,1] neg_hi:[0,0,1]
    v_pk_fma_f32 v[146:147], v[166:167], v[188:189], v[186:187] op_sel_hi:[1,0,0] neg_lo:[1,0,0] neg_hi:[1,0,0]
    v_pk_fma_f32 v[166:167], v[166:167], v[188:189], v[184:185] op_sel_hi:[1,0,0] neg_lo:[0,0,1] neg_hi:[0,0,1]
    v_pk_fma_f32 v[148:149], v[168:169], v[188:189], v[186:187] op_sel_hi:[1,0,0] neg_lo:[1,0,0] neg_hi:[1,0,0]
    v_pk_fma_f32 v[168:169], v[168:169], v[188:189], v[184:185] op_sel_hi:[1,0,0] neg_lo:[0,0,1] neg_hi:[0,0,1]
    ds_write_b128 v251, v[132:135] offset:10816
    v_pk_fma_f32 v[150:151], v[170:171], v[188:189], v[186:187] op_sel_hi:[1,0,0] neg_lo:[1,0,0] neg_hi:[1,0,0]
    v_pk_fma_f32 v[170:171], v[170:171], v[188:189], v[184:185] op_sel_hi:[1,0,0] neg_lo:[0,0,1] neg_hi:[0,0,1]
    v_pk_fma_f32 v[152:153], v[172:173], v[188:189], v[186:187] op_sel_hi:[1,0,0] neg_lo:[1,0,0] neg_hi:[1,0,0]
    v_pk_fma_f32 v[172:173], v[172:173], v[188:189], v[184:185] op_sel_hi:[1,0,0] neg_lo:[0,0,1] neg_hi:[0,0,1]
    v_pk_fma_f32 v[154:155], v[174:175], v[188:189], v[186:187] op_sel_hi:[1,0,0] neg_lo:[1,0,0] neg_hi:[1,0,0]
    v_pk_fma_f32 v[174:175], v[174:175], v[188:189], v[184:185] op_sel_hi:[1,0,0] neg_lo:[0,0,1] neg_hi:[0,0,1]
    v_pk_fma_f32 v[156:157], v[176:177], v[188:189], v[186:187] op_sel_hi:[1,0,0] neg_lo:[1,0,0] neg_hi:[1,0,0]
    v_pk_fma_f32 v[176:177], v[176:177], v[188:189], v[184:185] op_sel_hi:[1,0,0] neg_lo:[0,0,1] neg_hi:[0,0,1]
    v_pk_fma_f32 v[158:159], v[178:179], v[188:189], v[186:187] op_sel_hi:[1,0,0] neg_lo:[1,0,0] neg_hi:[1,0,0]
    v_pk_fma_f32 v[178:179], v[178:179], v[188:189], v[184:185] op_sel_hi:[1,0,0] neg_lo:[0,0,1] neg_hi:[0,0,1]
    v_pk_fma_f32 v[160:161], v[180:181], v[188:189], v[186:187] op_sel_hi:[1,0,0] neg_lo:[1,0,0] neg_hi:[1,0,0]
    v_pk_fma_f32 v[180:181], v[180:181], v[188:189], v[184:185] op_sel_hi:[1,0,0] neg_lo:[0,0,1] neg_hi:[0,0,1]
    v_pk_fma_f32 v[162:163], v[182:183], v[188:189], v[186:187] op_sel_hi:[1,0,0] neg_lo:[1,0,0] neg_hi:[1,0,0]
    v_pk_fma_f32 v[182:183], v[182:183], v[188:189], v[184:185] op_sel_hi:[1,0,0] neg_lo:[0,0,1] neg_hi:[0,0,1]
    v_exp_f32 v164, v164
    v_exp_f32 v144, v144
    v_exp_f32 v165, v165
    v_exp_f32 v145, v145
    v_exp_f32 v166, v166
    v_exp_f32 v146, v146
    v_exp_f32 v167, v167
    v_exp_f32 v147, v147
    v_exp_f32 v168, v168
    v_exp_f32 v148, v148
    v_exp_f32 v169, v169
    v_exp_f32 v149, v149
    v_exp_f32 v170, v170
    v_exp_f32 v150, v150
    v_exp_f32 v171, v171
    v_exp_f32 v151, v151
    v_exp_f32 v172, v172
    v_exp_f32 v152, v152
    v_exp_f32 v173, v173
    v_exp_f32 v153, v153
    v_exp_f32 v174, v174
    v_exp_f32 v154, v154
    v_exp_f32 v175, v175
    v_exp_f32 v155, v155
    v_exp_f32 v176, v176
    v_exp_f32 v156, v156
    v_exp_f32 v177, v177
    v_exp_f32 v157, v157
    v_exp_f32 v178, v178
    v_exp_f32 v158, v158
    v_exp_f32 v179, v179
    v_exp_f32 v159, v159
    v_exp_f32 v180, v180
    v_exp_f32 v160, v160
    v_exp_f32 v181, v181
    v_exp_f32 v161, v161
    v_exp_f32 v182, v182
    v_exp_f32 v162, v162
    v_exp_f32 v183, v183
    v_exp_f32 v163, v163
    v_pk_add_f32 v[184:185], v[164:165], v[166:167]
    v_pk_add_f32 v[186:187], v[144:145], v[146:147]
    v_pk_add_f32 v[184:185], v[184:185], v[168:169]
    v_pk_add_f32 v[186:187], v[186:187], v[148:149]
    v_pk_add_f32 v[184:185], v[184:185], v[170:171]
    v_pk_add_f32 v[186:187], v[186:187], v[150:151]
    v_pk_add_f32 v[184:185], v[184:185], v[172:173]
    v_pk_add_f32 v[186:187], v[186:187], v[152:153]
    v_pk_add_f32 v[184:185], v[184:185], v[174:175]
    v_pk_add_f32 v[186:187], v[186:187], v[154:155]
    v_pk_add_f32 v[184:185], v[184:185], v[176:177]
    v_pk_add_f32 v[186:187], v[186:187], v[156:157]
    v_pk_add_f32 v[184:185], v[184:185], v[178:179]
    v_pk_add_f32 v[186:187], v[186:187], v[158:159]
    v_pk_add_f32 v[184:185], v[184:185], v[180:181]
    v_pk_add_f32 v[186:187], v[186:187], v[160:161]
    v_pk_add_f32 v[184:185], v[184:185], v[182:183]
    v_pk_add_f32 v[186:187], v[186:187], v[162:163]
    v_add_f32 v184, v184, v185
    v_add_f32 v186, v186, v187
    v_rcp_f32 v184, v184
    v_rcp_f32 v186, v186
    v_pk_mul_f32 v[164:165], v[164:165], v[184:185] op_sel_hi:[1,0]
    v_pk_mul_f32 v[144:145], v[144:145], v[186:187] op_sel_hi:[1,0]
    v_pk_mul_f32 v[166:167], v[166:167], v[184:185] op_sel_hi:[1,0]
    v_pk_mul_f32 v[146:147], v[146:147], v[186:187] op_sel_hi:[1,0]
    v_pk_mul_f32 v[168:169], v[168:169], v[184:185] op_sel_hi:[1,0]
    v_pk_mul_f32 v[148:149], v[148:149], v[186:187] op_sel_hi:[1,0]
    v_pk_mul_f32 v[170:171], v[170:171], v[184:185] op_sel_hi:[1,0]
    v_pk_mul_f32 v[150:151], v[150:151], v[186:187] op_sel_hi:[1,0]
    v_pk_mul_f32 v[172:173], v[172:173], v[184:185] op_sel_hi:[1,0]
    v_pk_mul_f32 v[152:153], v[152:153], v[186:187] op_sel_hi:[1,0]
    v_pk_mul_f32 v[174:175], v[174:175], v[184:185] op_sel_hi:[1,0]
    v_pk_mul_f32 v[154:155], v[154:155], v[186:187] op_sel_hi:[1,0]
    v_pk_mul_f32 v[176:177], v[176:177], v[184:185] op_sel_hi:[1,0]
    v_pk_mul_f32 v[156:157], v[156:157], v[186:187] op_sel_hi:[1,0]
    v_pk_mul_f32 v[178:179], v[178:179], v[184:185] op_sel_hi:[1,0]
    v_pk_mul_f32 v[158:159], v[158:159], v[186:187] op_sel_hi:[1,0]
    v_pk_mul_f32 v[180:181], v[180:181], v[184:185] op_sel_hi:[1,0]
    v_pk_mul_f32 v[160:161], v[160:161], v[186:187] op_sel_hi:[1,0]
    v_pk_mul_f32 v[182:183], v[182:183], v[184:185] op_sel_hi:[1,0]
    v_pk_mul_f32 v[162:163], v[162:163], v[186:187] op_sel_hi:[1,0]
    v_cvt_pk_bf16_f32 v164, v164, v165
    v_cvt_pk_bf16_f32 v165, v166, v167
    v_cvt_pk_bf16_f32 v166, v168, v169
    v_cvt_pk_bf16_f32 v167, v170, v171
    v_cvt_pk_bf16_f32 v168, v172, v173
    v_cvt_pk_bf16_f32 v169, v174, v175
    v_cvt_pk_bf16_f32 v170, v176, v177
    v_cvt_pk_bf16_f32 v171, v178, v179
    v_cvt_pk_bf16_f32 v172, v180, v181
    v_cvt_pk_bf16_f32 v173, v182, v183
    v_cvt_pk_bf16_f32 v174, v144, v145
    v_cvt_pk_bf16_f32 v175, v146, v147
    v_cvt_pk_bf16_f32 v176, v148, v149
    v_cvt_pk_bf16_f32 v177, v150, v151
    v_cvt_pk_bf16_f32 v178, v152, v153
    v_cvt_pk_bf16_f32 v179, v154, v155
    v_cvt_pk_bf16_f32 v180, v156, v157
    v_cvt_pk_bf16_f32 v181, v158, v159
    v_cvt_pk_bf16_f32 v182, v160, v161
    v_cvt_pk_bf16_f32 v183, v162, v163
    ds_write_b128 v251, v[164:167] offset:16128
    ds_write_b128 v251, v[168:171] offset:16144
    ds_write_b128 v251, v[172:175] offset:16160
    ds_write_b128 v251, v[176:179] offset:16176
    ds_write_b128 v251, v[180:183] offset:16192
    v_lshrrev_b32 v241, 5, v248
    v_lshlrev_b32 v241, 3, v241
    v_bfe_u32 v242, v248, 2, 2
    v_add_u32_e64 v241, v241, v242
    v_bfe_u32 v242, v248, 4, 1
    v_lshlrev_b32 v242, 5, v242
    v_and_b32 v243, 3, v248
    v_lshl_add_u32 v242, v243, 3, v242
    v_mul_u32_u24 v237, 336, v241
    v_add_u32 v237, v237, v242
    s_mul_i32 s51, s3, 80
    v_add_u32 v237, s51, v237
    v_add_u32 v239, 43008, v237
    v_mul_u32_u24 v238, 208, v241
    v_add_u32 v238, v238, v242
    s_mul_i32 s51, s3, 48
    s_add_u32 s51, s51, 86016
    v_add_u32 v238, s51, v238
    v_and_b32 v241, 31, v248
    v_lshrrev_b32 v242, 5, v248
    v_lshlrev_b32 v242, 3, v242
    v_mul_u32_u24 v241, 80, v241
    s_lshl_b32 s51, s3, 11
    s_add_u32 s51, s51, 143360
    v_add3_u32 v242, v241, v242, s51
    v_add_u32_e64 v241, s51, v249
    s_waitcnt lgkmcnt(0)
    v_mov_b32 v246, 162816
    v_mov_b32 v247, 1
    s_mov_b64 exec, 1
    ds_add_u32 v246, v247 offset:40
    s_mov_b64 exec, -1
    v_mov_b32 v246, 162816
    s_mov_b32 s68, 1000000
K2S_spin:
    ds_read_b32 v247, v246 offset:40
    s_waitcnt lgkmcnt(0)
    v_cmp_ne_u32 vcc, 4, v247
    s_cbranch_vccz K2S_out
    s_sub_u32 s68, s68, 1
    s_sleep 1
    s_cbranch_scc0 K2S_spin
K2S_out:
    ds_read_b64_tr_b16 v[32:33], v238 offset:0
    ds_read_b64_tr_b16 v[34:35], v238 offset:832
    ds_read_b64_tr_b16 v[36:37], v237 offset:0
    ds_read_b64_tr_b16 v[38:39], v237 offset:1344
    ds_read_b64_tr_b16 v[40:41], v237 offset:64
    ds_read_b64_tr_b16 v[42:43], v237 offset:1408
    ds_read_b64_tr_b16 v[44:45], v238 offset:3328
    ds_read_b64_tr_b16 v[46:47], v238 offset:4160
    ds_read_b64_tr_b16 v[48:49], v237 offset:5376
    ds_read_b64_tr_b16 v[50:51], v237 offset:6720
    ds_read_b64_tr_b16 v[52:53], v237 offset:5440
    ds_read_b64_tr_b16 v[54:55], v237 offset:6784
    s_waitcnt lgkmcnt(6)
    ds_read_b64_tr_b16 v[56:57], v238 offset:6656
    ds_read_b64_tr_b16 v[58:59], v238 offset:7488
    ds_read_b64_tr_b16 v[60:61], v237 offset:10752
    ds_read_b64_tr_b16 v[62:63], v237 offset:12096
    ds_read_b64_tr_b16 v[64:65], v237 offset:10816
    ds_read_b64_tr_b16 v[66:67], v237 offset:12160
    v_mfma_f32_32x32x16_bf16 v[0:15], v[36:39], v[32:35], 0
    v_mfma_f32_32x32x16_bf16 v[16:31], v[40:43], v[32:35], 0
    s_waitcnt lgkmcnt(6)
    ds_read_b64_tr_b16 v[32:33], v238 offset:9984
    ds_read_b64_tr_b16 v[34:35], v238 offset:10816
    ds_read_b64_tr_b16 v[36:37], v237 offset:16128
    ds_read_b64_tr_b16 v[38:39], v237 offset:17472
    ds_read_b64_tr_b16 v[40:41], v237 offset:16192
    ds_read_b64_tr_b16 v[42:43], v237 offset:17536
    v_mfma_f32_32x32x16_bf16 v[0:15], v[48:51], v[44:47], v[0:15]
    v_mfma_f32_32x32x16_bf16 v[16:31], v[52:55], v[44:47], v[16:31]
    s_waitcnt lgkmcnt(6)
    ds_read_b64_tr_b16 v[44:45], v238 offset:13312
    ds_read_b64_tr_b16 v[46:47], v238 offset:14144
    ds_read_b64_tr_b16 v[48:49], v237 offset:21504
    ds_read_b64_tr_b16 v[50:51], v237 offset:22848
    ds_read_b64_tr_b16 v[52:53], v237 offset:21568
    ds_read_b64_tr_b16 v[54:55], v237 offset:22912
    v_mfma_f32_32x32x16_bf16 v[0:15], v[60:63], v[56:59], v[0:15]
    v_mfma_f32_32x32x16_bf16 v[16:31], v[64:67], v[56:59], v[16:31]
    s_waitcnt lgkmcnt(6)
    ds_read_b64_tr_b16 v[56:57], v238 offset:16640
    ds_read_b64_tr_b16 v[58:59], v238 offset:17472
    ds_read_b64_tr_b16 v[60:61], v237 offset:26880
    ds_read_b64_tr_b16 v[62:63], v237 offset:28224
    ds_read_b64_tr_b16 v[64:65], v237 offset:26944
    ds_read_b64_tr_b16 v[66:67], v237 offset:28288
    v_mfma_f32_32x32x16_bf16 v[0:15], v[36:39], v[32:35], v[0:15]
    v_mfma_f32_32x32x16_bf16 v[16:31], v[40:43], v[32:35], v[16:31]
    s_waitcnt lgkmcnt(6)
    ds_read_b64_tr_b16 v[32:33], v238 offset:19968
    ds_read_b64_tr_b16 v[34:35], v238 offset:20800
    ds_read_b64_tr_b16 v[36:37], v237 offset:32256
    ds_read_b64_tr_b16 v[38:39], v237 offset:33600
    ds_read_b64_tr_b16 v[40:41], v237 offset:32320
    ds_read_b64_tr_b16 v[42:43], v237 offset:33664
    v_mfma_f32_32x32x16_bf16 v[0:15], v[48:51], v[44:47], v[0:15]
    v_mfma_f32_32x32x16_bf16 v[16:31], v[52:55], v[44:47], v[16:31]
    s_waitcnt lgkmcnt(6)
    ds_read_b64_tr_b16 v[44:45], v238 offset:23296
    ds_read_b64_tr_b16 v[46:47], v238 offset:24128
    ds_read_b64_tr_b16 v[48:49], v237 offset:37632
    ds_read_b64_tr_b16 v[50:51], v237 offset:38976
    ds_read_b64_tr_b16 v[52:53], v237 offset:37696
    ds_read_b64_tr_b16 v[54:55], v237 offset:39040
    v_mfma_f32_32x32x16_bf16 v[0:15], v[60:63], v[56:59], v[0:15]
    v_mfma_f32_32x32x16_bf16 v[16:31], v[64:67], v[56:59], v[16:31]
    s_waitcnt lgkmcnt(6)
    ds_read_b64_tr_b16 v[56:57], v238 offset:26624
    ds_read_b64_tr_b16 v[58:59], v238 offset:27456
    ds_read_b64_tr_b16 v[60:61], v239 offset:0
    ds_read_b64_tr_b16 v[62:63], v239 offset:1344
    ds_read_b64_tr_b16 v[64:65], v239 offset:64
    ds_read_b64_tr_b16 v[66:67], v239 offset:1408
    v_mfma_f32_32x32x16_bf16 v[0:15], v[36:39], v[32:35], v[0:15]
    v_mfma_f32_32x32x16_bf16 v[16:31], v[40:43], v[32:35], v[16:31]
    s_waitcnt lgkmcnt(6)
    ds_read_b64_tr_b16 v[32:33], v238 offset:29952
    ds_read_b64_tr_b16 v[34:35], v238 offset:30784
    ds_read_b64_tr_b16 v[36:37], v239 offset:5376
    ds_read_b64_tr_b16 v[38:39], v239 offset:6720
    ds_read_b64_tr_b16 v[40:41], v239 offset:5440
    ds_read_b64_tr_b16 v[42:43], v239 offset:6784
    v_mfma_f32_32x32x16_bf16 v[0:15], v[48:51], v[44:47], v[0:15]
    v_mfma_f32_32x32x16_bf16 v[16:31], v[52:55], v[44:47], v[16:31]
    s_waitcnt lgkmcnt(6)
    ds_read_b64_tr_b16 v[44:45], v238 offset:33280
    ds_read_b64_tr_b16 v[46:47], v238 offset:34112
    ds_read_b64_tr_b16 v[48:49], v239 offset:10752
    ds_read_b64_tr_b16 v[50:51], v239 offset:12096
    ds_read_b64_tr_b16 v[52:53], v239 offset:10816
    ds_read_b64_tr_b16 v[54:55], v239 offset:12160
    v_mfma_f32_32x32x16_bf16 v[0:15], v[60:63], v[56:59], v[0:15]
    v_mfma_f32_32x32x16_bf16 v[16:31], v[64:67], v[56:59], v[16:31]
    s_waitcnt lgkmcnt(6)
    ds_read_b64_tr_b16 v[56:57], v238 offset:36608
    ds_read_b64_tr_b16 v[58:59], v238 offset:37440
    ds_read_b64_tr_b16 v[60:61], v239 offset:16128
    ds_read_b64_tr_b16 v[62:63], v239 offset:17472
    ds_read_b64_tr_b16 v[64:65], v239 offset:16192
    ds_read_b64_tr_b16 v[66:67], v239 offset:17536
    v_mfma_f32_32x32x16_bf16 v[0:15], v[36:39], v[32:35], v[0:15]
    v_mfma_f32_32x32x16_bf16 v[16:31], v[40:43], v[32:35], v[16:31]
    s_waitcnt lgkmcnt(6)
    ds_read_b64_tr_b16 v[32:33], v238 offset:39936
    ds_read_b64_tr_b16 v[34:35], v238 offset:40768
    ds_read_b64_tr_b16 v[36:37], v239 offset:21504
    ds_read_b64_tr_b16 v[38:39], v239 offset:22848
    ds_read_b64_tr_b16 v[40:41], v239 offset:21568
    ds_read_b64_tr_b16 v[42:43], v239 offset:22912
    v_mfma_f32_32x32x16_bf16 v[0:15], v[48:51], v[44:47], v[0:15]
    v_mfma_f32_32x32x16_bf16 v[16:31], v[52:55], v[44:47], v[16:31]
    s_waitcnt lgkmcnt(6)
    ds_read_b64_tr_b16 v[44:45], v238 offset:43264
    ds_read_b64_tr_b16 v[46:47], v238 offset:44096
    ds_read_b64_tr_b16 v[48:49], v239 offset:26880
    ds_read_b64_tr_b16 v[50:51], v239 offset:28224
    ds_read_b64_tr_b16 v[52:53], v239 offset:26944
    ds_read_b64_tr_b16 v[54:55], v239 offset:28288
    v_mfma_f32_32x32x16_bf16 v[0:15], v[60:63], v[56:59], v[0:15]
    v_mfma_f32_32x32x16_bf16 v[16:31], v[64:67], v[56:59], v[16:31]
    s_waitcnt lgkmcnt(6)
    ds_read_b64_tr_b16 v[56:57], v238 offset:46592
    ds_read_b64_tr_b16 v[58:59], v238 offset:47424
    ds_read_b64_tr_b16 v[60:61], v239 offset:32256
    ds_read_b64_tr_b16 v[62:63], v239 offset:33600
    ds_read_b64_tr_b16 v[64:65], v239 offset:32320
    ds_read_b64_tr_b16 v[66:67], v239 offset:33664
    v_mfma_f32_32x32x16_bf16 v[0:15], v[36:39], v[32:35], v[0:15]
    v_mfma_f32_32x32x16_bf16 v[16:31], v[40:43], v[32:35], v[16:31]
    s_waitcnt lgkmcnt(6)
    ds_read_b64_tr_b16 v[32:33], v238 offset:49920
    ds_read_b64_tr_b16 v[34:35], v238 offset:50752
    ds_read_b64_tr_b16 v[36:37], v239 offset:37632
    ds_read_b64_tr_b16 v[38:39], v239 offset:38976
    ds_read_b64_tr_b16 v[40:41], v239 offset:37696
    ds_read_b64_tr_b16 v[42:43], v239 offset:39040
    v_mfma_f32_32x32x16_bf16 v[0:15], v[48:51], v[44:47], v[0:15]
    v_mfma_f32_32x32x16_bf16 v[16:31], v[52:55], v[44:47], v[16:31]
    s_waitcnt lgkmcnt(6)
    v_mfma_f32_32x32x16_bf16 v[0:15], v[60:63], v[56:59], v[0:15]
    v_mfma_f32_32x32x16_bf16 v[16:31], v[64:67], v[56:59], v[16:31]
    s_waitcnt lgkmcnt(0)
    v_mfma_f32_32x32x16_bf16 v[0:15], v[36:39], v[32:35], v[0:15]
    v_mfma_f32_32x32x16_bf16 v[16:31], v[40:43], v[32:35], v[16:31]
    v_mov_b32 v246, 162816
    s_mov_b32 s68, 1000000
KCW_spin:
    ds_read_b32 v247, v246 offset:16
    s_waitcnt lgkmcnt(0)
    v_cmp_ne_u32 vcc, 1, v247
    s_cbranch_vccz KCW_out
    s_sub_u32 s68, s68, 1
    s_sleep 1
    s_cbranch_scc0 KCW_spin
KCW_out:
    s_mov_b32 exec_lo, 0xffffff
    s_mov_b32 exec_hi, 0xffffff
    s_nop 2
    v_cvt_pk_bf16_f32 v0, v0, v1
    v_cvt_pk_bf16_f32 v1, v2, v3
    ds_write_b64 v242, v[0:1] offset:0
    v_cvt_pk_bf16_f32 v4, v4, v5
    v_cvt_pk_bf16_f32 v5, v6, v7
    ds_write_b64 v242, v[4:5] offset:16
    v_cvt_pk_bf16_f32 v8, v8, v9
    v_cvt_pk_bf16_f32 v9, v10, v11
    ds_write_b64 v242, v[8:9] offset:32
    v_cvt_pk_bf16_f32 v12, v12, v13
    v_cvt_pk_bf16_f32 v13, v14, v15
    ds_write_b64 v242, v[12:13] offset:48
    v_cvt_pk_bf16_f32 v16, v16, v17
    v_cvt_pk_bf16_f32 v17, v18, v19
    ds_write_b64 v242, v[16:17] offset:64
    s_mov_b64 exec, -1
    s_waitcnt lgkmcnt(0)
    ds_read_b128 v[24:27], v241
    ds_read_b128 v[28:31], v241 offset:1024
    s_waitcnt lgkmcnt(1)
    buffer_store_dwordx4 v[24:27], v249, s[20:23], s57 offen sc1
    s_waitcnt lgkmcnt(0)
    buffer_store_dwordx4 v[28:31], v249, s[20:23], s57 offen offset:1024 sc1
    v_mov_b32 v0, v248
    s_branch P2_aux
K1_c_q:
    s_lshl_b32 s58, s37, 3
    s_lshl_b32 s51, s35, 1
    s_add_u32 s58, s58, s51
    s_mul_i32 s58, s58, 10240
    s_add_u32 s58, s58, 16777216
    v_lshrrev_b32 v249, 4, v248
    v_lshlrev_b32_e64 v249, 4, v249
    v_add_u32 v249, 161792, v249
    v_and_b32 v250, 15, v248
    v_lshlrev_b32 v250, 3, v250
    s_lshl_b32 s51, s3, 9
    s_add_u32 s51, s51, 159744
    v_add_u32 v250, s51, v250
    s_waitcnt vmcnt(0)
    s_barrier
    ds_read_b64 v[240:241], v250 offset:0
    ds_read_b64 v[242:243], v250 offset:128
    ds_read_b64 v[244:245], v250 offset:256
    ds_read_b64 v[246:247], v250 offset:384
    ds_read_b128 v[192:195], v249 offset:0
    ds_read_b128 v[196:199], v249 offset:64
    ds_read_b128 v[200:203], v249 offset:128
    ds_read_b128 v[204:207], v249 offset:192
    ds_read_b128 v[208:211], v249 offset:256
    ds_read_b128 v[212:215], v249 offset:384
    ds_read_b128 v[216:219], v249 offset:448
    ds_read_b128 v[220:223], v249 offset:512
    ds_read_b128 v[224:227], v249 offset:576
    ds_read_b128 v[228:231], v249 offset:640
    v_lshlrev_b32 v249, 4, v248
    s_waitcnt lgkmcnt(0)
    v_pk_fma_f32 v[0:1], v[192:193], v[240:241], v[0:1] op_sel_hi:[1,0,1] neg_lo:[1,0,0] neg_hi:[1,0,0]
    v_pk_fma_f32 v[2:3], v[194:195], v[240:241], v[2:3] op_sel_hi:[1,0,1] neg_lo:[1,0,0] neg_hi:[1,0,0]
    v_pk_fma_f32 v[4:5], v[196:197], v[240:241], v[4:5] op_sel_hi:[1,0,1] neg_lo:[1,0,0] neg_hi:[1,0,0]
    v_pk_fma_f32 v[6:7], v[198:199], v[240:241], v[6:7] op_sel_hi:[1,0,1] neg_lo:[1,0,0] neg_hi:[1,0,0]
    v_pk_fma_f32 v[8:9], v[200:201], v[240:241], v[8:9] op_sel_hi:[1,0,1] neg_lo:[1,0,0] neg_hi:[1,0,0]
    v_pk_fma_f32 v[10:11], v[202:203], v[240:241], v[10:11] op_sel_hi:[1,0,1] neg_lo:[1,0,0] neg_hi:[1,0,0]
    v_pk_fma_f32 v[12:13], v[204:205], v[240:241], v[12:13] op_sel_hi:[1,0,1] neg_lo:[1,0,0] neg_hi:[1,0,0]
    v_pk_fma_f32 v[14:15], v[206:207], v[240:241], v[14:15] op_sel_hi:[1,0,1] neg_lo:[1,0,0] neg_hi:[1,0,0]
    v_pk_fma_f32 v[16:17], v[208:209], v[240:241], v[16:17] op_sel_hi:[1,0,1] neg_lo:[1,0,0] neg_hi:[1,0,0]
    v_pk_fma_f32 v[18:19], v[210:211], v[240:241], v[18:19] op_sel_hi:[1,0,1] neg_lo:[1,0,0] neg_hi:[1,0,0]
    v_pk_fma_f32 v[20:21], v[212:213], v[240:241], v[20:21] op_sel_hi:[1,0,1] neg_lo:[1,0,0] neg_hi:[1,0,0]
    v_pk_fma_f32 v[22:23], v[214:215], v[240:241], v[22:23] op_sel_hi:[1,0,1] neg_lo:[1,0,0] neg_hi:[1,0,0]
    v_pk_fma_f32 v[24:25], v[216:217], v[240:241], v[24:25] op_sel_hi:[1,0,1] neg_lo:[1,0,0] neg_hi:[1,0,0]
    v_pk_fma_f32 v[26:27], v[218:219], v[240:241], v[26:27] op_sel_hi:[1,0,1] neg_lo:[1,0,0] neg_hi:[1,0,0]
    v_pk_fma_f32 v[28:29], v[220:221], v[240:241], v[28:29] op_sel_hi:[1,0,1] neg_lo:[1,0,0] neg_hi:[1,0,0]
    v_pk_fma_f32 v[30:31], v[222:223], v[240:241], v[30:31] op_sel_hi:[1,0,1] neg_lo:[1,0,0] neg_hi:[1,0,0]
    v_pk_fma_f32 v[32:33], v[224:225], v[240:241], v[32:33] op_sel_hi:[1,0,1] neg_lo:[1,0,0] neg_hi:[1,0,0]
    v_pk_fma_f32 v[34:35], v[226:227], v[240:241], v[34:35] op_sel_hi:[1,0,1] neg_lo:[1,0,0] neg_hi:[1,0,0]
    v_pk_fma_f32 v[36:37], v[228:229], v[240:241], v[36:37] op_sel_hi:[1,0,1] neg_lo:[1,0,0] neg_hi:[1,0,0]
    v_pk_fma_f32 v[38:39], v[230:231], v[240:241], v[38:39] op_sel_hi:[1,0,1] neg_lo:[1,0,0] neg_hi:[1,0,0]
    v_pk_mul_f32 v[0:1], v[0:1], v[240:241] op_sel:[0,1] op_sel_hi:[1,1]
    v_pk_mul_f32 v[2:3], v[2:3], v[240:241] op_sel:[0,1] op_sel_hi:[1,1]
    v_pk_mul_f32 v[4:5], v[4:5], v[240:241] op_sel:[0,1] op_sel_hi:[1,1]
    v_pk_mul_f32 v[6:7], v[6:7], v[240:241] op_sel:[0,1] op_sel_hi:[1,1]
    v_pk_mul_f32 v[8:9], v[8:9], v[240:241] op_sel:[0,1] op_sel_hi:[1,1]
    v_pk_mul_f32 v[10:11], v[10:11], v[240:241] op_sel:[0,1] op_sel_hi:[1,1]
    v_pk_mul_f32 v[12:13], v[12:13], v[240:241] op_sel:[0,1] op_sel_hi:[1,1]
    v_pk_mul_f32 v[14:15], v[14:15], v[240:241] op_sel:[0,1] op_sel_hi:[1,1]
    v_pk_mul_f32 v[16:17], v[16:17], v[240:241] op_sel:[0,1] op_sel_hi:[1,1]
    v_pk_mul_f32 v[18:19], v[18:19], v[240:241] op_sel:[0,1] op_sel_hi:[1,1]
    v_pk_mul_f32 v[20:21], v[20:21], v[240:241] op_sel:[0,1] op_sel_hi:[1,1]
    v_pk_mul_f32 v[22:23], v[22:23], v[240:241] op_sel:[0,1] op_sel_hi:[1,1]
    v_pk_mul_f32 v[24:25], v[24:25], v[240:241] op_sel:[0,1] op_sel_hi:[1,1]
    v_pk_mul_f32 v[26:27], v[26:27], v[240:241] op_sel:[0,1] op_sel_hi:[1,1]
    v_pk_mul_f32 v[28:29], v[28:29], v[240:241] op_sel:[0,1] op_sel_hi:[1,1]
    v_pk_mul_f32 v[30:31], v[30:31], v[240:241] op_sel:[0,1] op_sel_hi:[1,1]
    v_pk_mul_f32 v[32:33], v[32:33], v[240:241] op_sel:[0,1] op_sel_hi:[1,1]
    v_pk_mul_f32 v[34:35], v[34:35], v[240:241] op_sel:[0,1] op_sel_hi:[1,1]
    v_pk_mul_f32 v[36:37], v[36:37], v[240:241] op_sel:[0,1] op_sel_hi:[1,1]
    v_pk_mul_f32 v[38:39], v[38:39], v[240:241] op_sel:[0,1] op_sel_hi:[1,1]
    v_pk_fma_f32 v[48:49], v[192:193], v[242:243], v[48:49] op_sel_hi:[1,0,1] neg_lo:[1,0,0] neg_hi:[1,0,0]
    v_pk_fma_f32 v[50:51], v[194:195], v[242:243], v[50:51] op_sel_hi:[1,0,1] neg_lo:[1,0,0] neg_hi:[1,0,0]
    v_pk_fma_f32 v[52:53], v[196:197], v[242:243], v[52:53] op_sel_hi:[1,0,1] neg_lo:[1,0,0] neg_hi:[1,0,0]
    v_pk_fma_f32 v[54:55], v[198:199], v[242:243], v[54:55] op_sel_hi:[1,0,1] neg_lo:[1,0,0] neg_hi:[1,0,0]
    v_pk_fma_f32 v[56:57], v[200:201], v[242:243], v[56:57] op_sel_hi:[1,0,1] neg_lo:[1,0,0] neg_hi:[1,0,0]
    v_pk_fma_f32 v[58:59], v[202:203], v[242:243], v[58:59] op_sel_hi:[1,0,1] neg_lo:[1,0,0] neg_hi:[1,0,0]
    v_pk_fma_f32 v[60:61], v[204:205], v[242:243], v[60:61] op_sel_hi:[1,0,1] neg_lo:[1,0,0] neg_hi:[1,0,0]
    v_pk_fma_f32 v[62:63], v[206:207], v[242:243], v[62:63] op_sel_hi:[1,0,1] neg_lo:[1,0,0] neg_hi:[1,0,0]
    v_pk_fma_f32 v[64:65], v[208:209], v[242:243], v[64:65] op_sel_hi:[1,0,1] neg_lo:[1,0,0] neg_hi:[1,0,0]
    v_pk_fma_f32 v[66:67], v[210:211], v[242:243], v[66:67] op_sel_hi:[1,0,1] neg_lo:[1,0,0] neg_hi:[1,0,0]
    v_pk_fma_f32 v[68:69], v[212:213], v[242:243], v[68:69] op_sel_hi:[1,0,1] neg_lo:[1,0,0] neg_hi:[1,0,0]
    v_pk_fma_f32 v[70:71], v[214:215], v[242:243], v[70:71] op_sel_hi:[1,0,1] neg_lo:[1,0,0] neg_hi:[1,0,0]
    v_pk_fma_f32 v[72:73], v[216:217], v[242:243], v[72:73] op_sel_hi:[1,0,1] neg_lo:[1,0,0] neg_hi:[1,0,0]
    v_pk_fma_f32 v[74:75], v[218:219], v[242:243], v[74:75] op_sel_hi:[1,0,1] neg_lo:[1,0,0] neg_hi:[1,0,0]
    v_pk_fma_f32 v[76:77], v[220:221], v[242:243], v[76:77] op_sel_hi:[1,0,1] neg_lo:[1,0,0] neg_hi:[1,0,0]
    v_pk_fma_f32 v[78:79], v[222:223], v[242:243], v[78:79] op_sel_hi:[1,0,1] neg_lo:[1,0,0] neg_hi:[1,0,0]
    v_pk_fma_f32 v[80:81], v[224:225], v[242:243], v[80:81] op_sel_hi:[1,0,1] neg_lo:[1,0,0] neg_hi:[1,0,0]
    v_pk_fma_f32 v[82:83], v[226:227], v[242:243], v[82:83] op_sel_hi:[1,0,1] neg_lo:[1,0,0] neg_hi:[1,0,0]
    v_pk_fma_f32 v[84:85], v[228:229], v[242:243], v[84:85] op_sel_hi:[1,0,1] neg_lo:[1,0,0] neg_hi:[1,0,0]
    v_pk_fma_f32 v[86:87], v[230:231], v[242:243], v[86:87] op_sel_hi:[1,0,1] neg_lo:[1,0,0] neg_hi:[1,0,0]
    v_pk_mul_f32 v[48:49], v[48:49], v[242:243] op_sel:[0,1] op_sel_hi:[1,1]
    v_pk_mul_f32 v[50:51], v[50:51], v[242:243] op_sel:[0,1] op_sel_hi:[1,1]
    v_pk_mul_f32 v[52:53], v[52:53], v[242:243] op_sel:[0,1] op_sel_hi:[1,1]
    v_pk_mul_f32 v[54:55], v[54:55], v[242:243] op_sel:[0,1] op_sel_hi:[1,1]
    v_pk_mul_f32 v[56:57], v[56:57], v[242:243] op_sel:[0,1] op_sel_hi:[1,1]
    v_pk_mul_f32 v[58:59], v[58:59], v[242:243] op_sel:[0,1] op_sel_hi:[1,1]
    v_pk_mul_f32 v[60:61], v[60:61], v[242:243] op_sel:[0,1] op_sel_hi:[1,1]
    v_pk_mul_f32 v[62:63], v[62:63], v[242:243] op_sel:[0,1] op_sel_hi:[1,1]
    v_pk_mul_f32 v[64:65], v[64:65], v[242:243] op_sel:[0,1] op_sel_hi:[1,1]
    v_pk_mul_f32 v[66:67], v[66:67], v[242:243] op_sel:[0,1] op_sel_hi:[1,1]
    v_pk_mul_f32 v[68:69], v[68:69], v[242:243] op_sel:[0,1] op_sel_hi:[1,1]
    v_pk_mul_f32 v[70:71], v[70:71], v[242:243] op_sel:[0,1] op_sel_hi:[1,1]
    v_pk_mul_f32 v[72:73], v[72:73], v[242:243] op_sel:[0,1] op_sel_hi:[1,1]
    v_pk_mul_f32 v[74:75], v[74:75], v[242:243] op_sel:[0,1] op_sel_hi:[1,1]
    v_pk_mul_f32 v[76:77], v[76:77], v[242:243] op_sel:[0,1] op_sel_hi:[1,1]
    v_pk_mul_f32 v[78:79], v[78:79], v[242:243] op_sel:[0,1] op_sel_hi:[1,1]
    v_pk_mul_f32 v[80:81], v[80:81], v[242:243] op_sel:[0,1] op_sel_hi:[1,1]
    v_pk_mul_f32 v[82:83], v[82:83], v[242:243] op_sel:[0,1] op_sel_hi:[1,1]
    v_pk_mul_f32 v[84:85], v[84:85], v[242:243] op_sel:[0,1] op_sel_hi:[1,1]
    v_pk_mul_f32 v[86:87], v[86:87], v[242:243] op_sel:[0,1] op_sel_hi:[1,1]
    v_pk_fma_f32 v[96:97], v[192:193], v[244:245], v[96:97] op_sel_hi:[1,0,1] neg_lo:[1,0,0] neg_hi:[1,0,0]
    v_pk_fma_f32 v[98:99], v[194:195], v[244:245], v[98:99] op_sel_hi:[1,0,1] neg_lo:[1,0,0] neg_hi:[1,0,0]
    v_pk_fma_f32 v[100:101], v[196:197], v[244:245], v[100:101] op_sel_hi:[1,0,1] neg_lo:[1,0,0] neg_hi:[1,0,0]
    v_pk_fma_f32 v[102:103], v[198:199], v[244:245], v[102:103] op_sel_hi:[1,0,1] neg_lo:[1,0,0] neg_hi:[1,0,0]
    v_pk_fma_f32 v[104:105], v[200:201], v[244:245], v[104:105] op_sel_hi:[1,0,1] neg_lo:[1,0,0] neg_hi:[1,0,0]
    v_pk_fma_f32 v[106:107], v[202:203], v[244:245], v[106:107] op_sel_hi:[1,0,1] neg_lo:[1,0,0] neg_hi:[1,0,0]
    v_pk_fma_f32 v[108:109], v[204:205], v[244:245], v[108:109] op_sel_hi:[1,0,1] neg_lo:[1,0,0] neg_hi:[1,0,0]
    v_pk_fma_f32 v[110:111], v[206:207], v[244:245], v[110:111] op_sel_hi:[1,0,1] neg_lo:[1,0,0] neg_hi:[1,0,0]
    v_pk_fma_f32 v[112:113], v[208:209], v[244:245], v[112:113] op_sel_hi:[1,0,1] neg_lo:[1,0,0] neg_hi:[1,0,0]
    v_pk_fma_f32 v[114:115], v[210:211], v[244:245], v[114:115] op_sel_hi:[1,0,1] neg_lo:[1,0,0] neg_hi:[1,0,0]
    v_pk_fma_f32 v[116:117], v[212:213], v[244:245], v[116:117] op_sel_hi:[1,0,1] neg_lo:[1,0,0] neg_hi:[1,0,0]
    v_pk_fma_f32 v[118:119], v[214:215], v[244:245], v[118:119] op_sel_hi:[1,0,1] neg_lo:[1,0,0] neg_hi:[1,0,0]
    v_pk_fma_f32 v[120:121], v[216:217], v[244:245], v[120:121] op_sel_hi:[1,0,1] neg_lo:[1,0,0] neg_hi:[1,0,0]
    v_pk_fma_f32 v[122:123], v[218:219], v[244:245], v[122:123] op_sel_hi:[1,0,1] neg_lo:[1,0,0] neg_hi:[1,0,0]
    v_pk_fma_f32 v[124:125], v[220:221], v[244:245], v[124:125] op_sel_hi:[1,0,1] neg_lo:[1,0,0] neg_hi:[1,0,0]
    v_pk_fma_f32 v[126:127], v[222:223], v[244:245], v[126:127] op_sel_hi:[1,0,1] neg_lo:[1,0,0] neg_hi:[1,0,0]
    v_pk_fma_f32 v[128:129], v[224:225], v[244:245], v[128:129] op_sel_hi:[1,0,1] neg_lo:[1,0,0] neg_hi:[1,0,0]
    v_pk_fma_f32 v[130:131], v[226:227], v[244:245], v[130:131] op_sel_hi:[1,0,1] neg_lo:[1,0,0] neg_hi:[1,0,0]
    v_pk_fma_f32 v[132:133], v[228:229], v[244:245], v[132:133] op_sel_hi:[1,0,1] neg_lo:[1,0,0] neg_hi:[1,0,0]
    v_pk_fma_f32 v[134:135], v[230:231], v[244:245], v[134:135] op_sel_hi:[1,0,1] neg_lo:[1,0,0] neg_hi:[1,0,0]
    v_pk_mul_f32 v[96:97], v[96:97], v[244:245] op_sel:[0,1] op_sel_hi:[1,1]
    v_pk_mul_f32 v[98:99], v[98:99], v[244:245] op_sel:[0,1] op_sel_hi:[1,1]
    v_pk_mul_f32 v[100:101], v[100:101], v[244:245] op_sel:[0,1] op_sel_hi:[1,1]
    v_pk_mul_f32 v[102:103], v[102:103], v[244:245] op_sel:[0,1] op_sel_hi:[1,1]
    v_pk_mul_f32 v[104:105], v[104:105], v[244:245] op_sel:[0,1] op_sel_hi:[1,1]
    v_pk_mul_f32 v[106:107], v[106:107], v[244:245] op_sel:[0,1] op_sel_hi:[1,1]
    v_pk_mul_f32 v[108:109], v[108:109], v[244:245] op_sel:[0,1] op_sel_hi:[1,1]
    v_pk_mul_f32 v[110:111], v[110:111], v[244:245] op_sel:[0,1] op_sel_hi:[1,1]
    v_pk_mul_f32 v[112:113], v[112:113], v[244:245] op_sel:[0,1] op_sel_hi:[1,1]
    v_pk_mul_f32 v[114:115], v[114:115], v[244:245] op_sel:[0,1] op_sel_hi:[1,1]
    v_pk_mul_f32 v[116:117], v[116:117], v[244:245] op_sel:[0,1] op_sel_hi:[1,1]
    v_pk_mul_f32 v[118:119], v[118:119], v[244:245] op_sel:[0,1] op_sel_hi:[1,1]
    v_pk_mul_f32 v[120:121], v[120:121], v[244:245] op_sel:[0,1] op_sel_hi:[1,1]
    v_pk_mul_f32 v[122:123], v[122:123], v[244:245] op_sel:[0,1] op_sel_hi:[1,1]
    v_pk_mul_f32 v[124:125], v[124:125], v[244:245] op_sel:[0,1] op_sel_hi:[1,1]
    v_pk_mul_f32 v[126:127], v[126:127], v[244:245] op_sel:[0,1] op_sel_hi:[1,1]
    v_pk_mul_f32 v[128:129], v[128:129], v[244:245] op_sel:[0,1] op_sel_hi:[1,1]
    v_pk_mul_f32 v[130:131], v[130:131], v[244:245] op_sel:[0,1] op_sel_hi:[1,1]
    v_pk_mul_f32 v[132:133], v[132:133], v[244:245] op_sel:[0,1] op_sel_hi:[1,1]
    v_pk_mul_f32 v[134:135], v[134:135], v[244:245] op_sel:[0,1] op_sel_hi:[1,1]
    v_pk_fma_f32 v[144:145], v[192:193], v[246:247], v[144:145] op_sel_hi:[1,0,1] neg_lo:[1,0,0] neg_hi:[1,0,0]
    v_pk_fma_f32 v[146:147], v[194:195], v[246:247], v[146:147] op_sel_hi:[1,0,1] neg_lo:[1,0,0] neg_hi:[1,0,0]
    v_pk_fma_f32 v[148:149], v[196:197], v[246:247], v[148:149] op_sel_hi:[1,0,1] neg_lo:[1,0,0] neg_hi:[1,0,0]
    v_pk_fma_f32 v[150:151], v[198:199], v[246:247], v[150:151] op_sel_hi:[1,0,1] neg_lo:[1,0,0] neg_hi:[1,0,0]
    v_pk_fma_f32 v[152:153], v[200:201], v[246:247], v[152:153] op_sel_hi:[1,0,1] neg_lo:[1,0,0] neg_hi:[1,0,0]
    v_pk_fma_f32 v[154:155], v[202:203], v[246:247], v[154:155] op_sel_hi:[1,0,1] neg_lo:[1,0,0] neg_hi:[1,0,0]
    v_pk_fma_f32 v[156:157], v[204:205], v[246:247], v[156:157] op_sel_hi:[1,0,1] neg_lo:[1,0,0] neg_hi:[1,0,0]
    v_pk_fma_f32 v[158:159], v[206:207], v[246:247], v[158:159] op_sel_hi:[1,0,1] neg_lo:[1,0,0] neg_hi:[1,0,0]
    v_pk_fma_f32 v[160:161], v[208:209], v[246:247], v[160:161] op_sel_hi:[1,0,1] neg_lo:[1,0,0] neg_hi:[1,0,0]
    v_pk_fma_f32 v[162:163], v[210:211], v[246:247], v[162:163] op_sel_hi:[1,0,1] neg_lo:[1,0,0] neg_hi:[1,0,0]
    v_pk_fma_f32 v[164:165], v[212:213], v[246:247], v[164:165] op_sel_hi:[1,0,1] neg_lo:[1,0,0] neg_hi:[1,0,0]
    v_pk_fma_f32 v[166:167], v[214:215], v[246:247], v[166:167] op_sel_hi:[1,0,1] neg_lo:[1,0,0] neg_hi:[1,0,0]
    v_pk_fma_f32 v[168:169], v[216:217], v[246:247], v[168:169] op_sel_hi:[1,0,1] neg_lo:[1,0,0] neg_hi:[1,0,0]
    v_pk_fma_f32 v[170:171], v[218:219], v[246:247], v[170:171] op_sel_hi:[1,0,1] neg_lo:[1,0,0] neg_hi:[1,0,0]
    v_pk_fma_f32 v[172:173], v[220:221], v[246:247], v[172:173] op_sel_hi:[1,0,1] neg_lo:[1,0,0] neg_hi:[1,0,0]
    v_pk_fma_f32 v[174:175], v[222:223], v[246:247], v[174:175] op_sel_hi:[1,0,1] neg_lo:[1,0,0] neg_hi:[1,0,0]
    v_pk_fma_f32 v[176:177], v[224:225], v[246:247], v[176:177] op_sel_hi:[1,0,1] neg_lo:[1,0,0] neg_hi:[1,0,0]
    v_pk_fma_f32 v[178:179], v[226:227], v[246:247], v[178:179] op_sel_hi:[1,0,1] neg_lo:[1,0,0] neg_hi:[1,0,0]
    v_pk_fma_f32 v[180:181], v[228:229], v[246:247], v[180:181] op_sel_hi:[1,0,1] neg_lo:[1,0,0] neg_hi:[1,0,0]
    v_pk_fma_f32 v[182:183], v[230:231], v[246:247], v[182:183] op_sel_hi:[1,0,1] neg_lo:[1,0,0] neg_hi:[1,0,0]
    v_pk_mul_f32 v[144:145], v[144:145], v[246:247] op_sel:[0,1] op_sel_hi:[1,1]
    v_pk_mul_f32 v[146:147], v[146:147], v[246:247] op_sel:[0,1] op_sel_hi:[1,1]
    v_pk_mul_f32 v[148:149], v[148:149], v[246:247] op_sel:[0,1] op_sel_hi:[1,1]
    v_pk_mul_f32 v[150:151], v[150:151], v[246:247] op_sel:[0,1] op_sel_hi:[1,1]
    v_pk_mul_f32 v[152:153], v[152:153], v[246:247] op_sel:[0,1] op_sel_hi:[1,1]
    v_pk_mul_f32 v[154:155], v[154:155], v[246:247] op_sel:[0,1] op_sel_hi:[1,1]
    v_pk_mul_f32 v[156:157], v[156:157], v[246:247] op_sel:[0,1] op_sel_hi:[1,1]
    v_pk_mul_f32 v[158:159], v[158:159], v[246:247] op_sel:[0,1] op_sel_hi:[1,1]
    v_pk_mul_f32 v[160:161], v[160:161], v[246:247] op_sel:[0,1] op_sel_hi:[1,1]
    v_pk_mul_f32 v[162:163], v[162:163], v[246:247] op_sel:[0,1] op_sel_hi:[1,1]
    v_pk_mul_f32 v[164:165], v[164:165], v[246:247] op_sel:[0,1] op_sel_hi:[1,1]
    v_pk_mul_f32 v[166:167], v[166:167], v[246:247] op_sel:[0,1] op_sel_hi:[1,1]
    v_pk_mul_f32 v[168:169], v[168:169], v[246:247] op_sel:[0,1] op_sel_hi:[1,1]
    v_pk_mul_f32 v[170:171], v[170:171], v[246:247] op_sel:[0,1] op_sel_hi:[1,1]
    v_pk_mul_f32 v[172:173], v[172:173], v[246:247] op_sel:[0,1] op_sel_hi:[1,1]
    v_pk_mul_f32 v[174:175], v[174:175], v[246:247] op_sel:[0,1] op_sel_hi:[1,1]
    v_pk_mul_f32 v[176:177], v[176:177], v[246:247] op_sel:[0,1] op_sel_hi:[1,1]
    v_pk_mul_f32 v[178:179], v[178:179], v[246:247] op_sel:[0,1] op_sel_hi:[1,1]
    v_pk_mul_f32 v[180:181], v[180:181], v[246:247] op_sel:[0,1] op_sel_hi:[1,1]
    v_pk_mul_f32 v[182:183], v[182:183], v[246:247] op_sel:[0,1] op_sel_hi:[1,1]
    v_mov_b32_e64 v250, v249
    v_add_u32 v251, 49152, v249
    v_lshlrev_b32 v247, 3, v248
    ds_read_b128 v[192:195], v250 offset:8192
    ds_read_b128 v[196:199], v250 offset:9216
    ds_read_b64 v[200:201], v250 offset:10240
    ds_read_b128 v[202:205], v250 offset:11264
    ds_read_b128 v[206:209], v250 offset:12288
    ds_read_b64 v[210:211], v250 offset:13312
    ds_read_b128 v[212:215], v250 offset:14336
    ds_read_b128 v[216:219], v250 offset:15360
    ds_read_b64 v[220:221], v250 offset:32768
    ds_read_b128 v[222:225], v250 offset:33792
    ds_read_b128 v[226:229], v250 offset:34816
    ds_read_b64 v[230:231], v250 offset:35840
    ds_read_b128 v[232:235], v250 offset:36864
    ds_read_b128 v[236:239], v250 offset:37888
    ds_read_b64 v[240:241], v250 offset:38912
    s_nop 0
    v_cvt_pk_bf16_f32 v40, v0, v1
    v_cvt_pk_bf16_f32 v41, v2, v3
    v_cvt_pk_bf16_f32 v42, v4, v5
    v_cvt_pk_bf16_f32 v43, v6, v7
    v_cvt_pk_bf16_f32 v44, v8, v9
    v_cvt_pk_bf16_f32 v45, v10, v11
    v_cvt_pk_bf16_f32 v46, v12, v13
    v_cvt_pk_bf16_f32 v47, v14, v15
    v_cvt_pk_bf16_f32 v242, v16, v17
    v_cvt_pk_bf16_f32 v243, v18, v19
    v_cvt_pk_bf16_f32 v88, v48, v49
    v_cvt_pk_bf16_f32 v89, v50, v51
    v_cvt_pk_bf16_f32 v90, v52, v53
    v_cvt_pk_bf16_f32 v91, v54, v55
    v_cvt_pk_bf16_f32 v92, v56, v57
    v_cvt_pk_bf16_f32 v93, v58, v59
    v_cvt_pk_bf16_f32 v94, v60, v61
    v_cvt_pk_bf16_f32 v95, v62, v63
    v_cvt_pk_bf16_f32 v244, v64, v65
    v_cvt_pk_bf16_f32 v245, v66, v67
    v_cvt_pk_bf16_f32 v136, v96, v97
    v_cvt_pk_bf16_f32 v137, v98, v99
    v_cvt_pk_bf16_f32 v138, v100, v101
    v_cvt_pk_bf16_f32 v139, v102, v103
    v_cvt_pk_bf16_f32 v140, v104, v105
    v_cvt_pk_bf16_f32 v141, v106, v107
    v_cvt_pk_bf16_f32 v142, v108, v109
    v_cvt_pk_bf16_f32 v143, v110, v111
    v_cvt_pk_bf16_f32 v252, v112, v113
    v_cvt_pk_bf16_f32 v253, v114, v115
    v_cvt_pk_bf16_f32 v184, v144, v145
    v_cvt_pk_bf16_f32 v185, v146, v147
    v_cvt_pk_bf16_f32 v186, v148, v149
    v_cvt_pk_bf16_f32 v187, v150, v151
    v_cvt_pk_bf16_f32 v188, v152, v153
    v_cvt_pk_bf16_f32 v189, v154, v155
    v_cvt_pk_bf16_f32 v190, v156, v157
    v_cvt_pk_bf16_f32 v191, v158, v159
    v_cvt_pk_bf16_f32 v254, v160, v161
    v_cvt_pk_bf16_f32 v255, v162, v163
    s_waitcnt lgkmcnt(0)
    v_mfma_f32_16x16x32_bf16 v[0:3], v[192:195], v[40:43], 0
    v_mfma_f32_16x16x32_bf16 v[4:7], v[202:205], v[40:43], 0
    v_mfma_f32_16x16x32_bf16 v[8:11], v[212:215], v[40:43], 0
    v_mfma_f32_16x16x32_bf16 v[12:15], v[222:225], v[40:43], 0
    v_mfma_f32_16x16x32_bf16 v[16:19], v[232:235], v[40:43], 0
    v_mfma_f32_16x16x32_bf16 v[0:3], v[196:199], v[44:47], v[0:3]
    v_mfma_f32_16x16x32_bf16 v[4:7], v[206:209], v[44:47], v[4:7]
    v_mfma_f32_16x16x32_bf16 v[8:11], v[216:219], v[44:47], v[8:11]
    v_mfma_f32_16x16x32_bf16 v[12:15], v[226:229], v[44:47], v[12:15]
    v_mfma_f32_16x16x32_bf16 v[16:19], v[236:239], v[44:47], v[16:19]
    v_mfma_f32_16x16x16_bf16 v[0:3], v[200:201], v[242:243], v[0:3]
    v_mfma_f32_16x16x16_bf16 v[4:7], v[210:211], v[242:243], v[4:7]
    v_mfma_f32_16x16x16_bf16 v[8:11], v[220:221], v[242:243], v[8:11]
    v_mfma_f32_16x16x16_bf16 v[12:15], v[230:231], v[242:243], v[12:15]
    v_mfma_f32_16x16x16_bf16 v[16:19], v[240:241], v[242:243], v[16:19]
    v_mfma_f32_16x16x32_bf16 v[48:51], v[192:195], v[88:91], 0
    v_mfma_f32_16x16x32_bf16 v[52:55], v[202:205], v[88:91], 0
    v_mfma_f32_16x16x32_bf16 v[56:59], v[212:215], v[88:91], 0
    v_mfma_f32_16x16x32_bf16 v[60:63], v[222:225], v[88:91], 0
    v_mfma_f32_16x16x32_bf16 v[64:67], v[232:235], v[88:91], 0
    v_mfma_f32_16x16x32_bf16 v[48:51], v[196:199], v[92:95], v[48:51]
    v_mfma_f32_16x16x32_bf16 v[52:55], v[206:209], v[92:95], v[52:55]
    v_mfma_f32_16x16x32_bf16 v[56:59], v[216:219], v[92:95], v[56:59]
    v_cvt_pk_bf16_f32 v0, v0, v1
    v_cvt_pk_bf16_f32 v1, v2, v3
    v_mfma_f32_16x16x32_bf16 v[60:63], v[226:229], v[92:95], v[60:63]
    v_cvt_pk_bf16_f32 v2, v4, v5
    v_cvt_pk_bf16_f32 v3, v6, v7
    v_mfma_f32_16x16x32_bf16 v[64:67], v[236:239], v[92:95], v[64:67]
    v_cvt_pk_bf16_f32 v4, v8, v9
    v_cvt_pk_bf16_f32 v5, v10, v11
    v_mfma_f32_16x16x16_bf16 v[48:51], v[200:201], v[244:245], v[48:51]
    v_cvt_pk_bf16_f32 v6, v12, v13
    v_cvt_pk_bf16_f32 v7, v14, v15
    v_mfma_f32_16x16x16_bf16 v[52:55], v[210:211], v[244:245], v[52:55]
    v_cvt_pk_bf16_f32 v8, v16, v17
    v_cvt_pk_bf16_f32 v9, v18, v19
    v_mfma_f32_16x16x16_bf16 v[56:59], v[220:221], v[244:245], v[56:59]
    s_add_u32 s51, s58, 0
    buffer_store_dwordx4 v[0:3], v249, s[20:23], s51 offen sc1
    v_mfma_f32_16x16x16_bf16 v[60:63], v[230:231], v[244:245], v[60:63]
    buffer_store_dwordx4 v[4:7], v249, s[20:23], s51 offen offset:1024 sc1
    buffer_store_dwordx2 v[8:9], v247, s[20:23], s51 offen offset:2048 sc1
    v_mfma_f32_16x16x16_bf16 v[64:67], v[240:241], v[244:245], v[64:67]
    v_mfma_f32_16x16x32_bf16 v[96:99], v[192:195], v[136:139], 0
    v_mfma_f32_16x16x32_bf16 v[100:103], v[202:205], v[136:139], 0
    v_mfma_f32_16x16x32_bf16 v[104:107], v[212:215], v[136:139], 0
    v_mfma_f32_16x16x32_bf16 v[108:111], v[222:225], v[136:139], 0
    v_mfma_f32_16x16x32_bf16 v[112:115], v[232:235], v[136:139], 0
    v_mfma_f32_16x16x32_bf16 v[96:99], v[196:199], v[140:143], v[96:99]
    v_mfma_f32_16x16x32_bf16 v[100:103], v[206:209], v[140:143], v[100:103]
    v_mfma_f32_16x16x32_bf16 v[104:107], v[216:219], v[140:143], v[104:107]
    v_cvt_pk_bf16_f32 v48, v48, v49
    v_cvt_pk_bf16_f32 v49, v50, v51
    v_mfma_f32_16x16x32_bf16 v[108:111], v[226:229], v[140:143], v[108:111]
    v_cvt_pk_bf16_f32 v50, v52, v53
    v_cvt_pk_bf16_f32 v51, v54, v55
    v_mfma_f32_16x16x32_bf16 v[112:115], v[236:239], v[140:143], v[112:115]
    v_cvt_pk_bf16_f32 v52, v56, v57
    v_cvt_pk_bf16_f32 v53, v58, v59
    v_mfma_f32_16x16x16_bf16 v[96:99], v[200:201], v[252:253], v[96:99]
    v_cvt_pk_bf16_f32 v54, v60, v61
    v_cvt_pk_bf16_f32 v55, v62, v63
    v_mfma_f32_16x16x16_bf16 v[100:103], v[210:211], v[252:253], v[100:103]
    v_cvt_pk_bf16_f32 v56, v64, v65
    v_cvt_pk_bf16_f32 v57, v66, v67
    v_mfma_f32_16x16x16_bf16 v[104:107], v[220:221], v[252:253], v[104:107]
    s_add_u32 s51, s58, 2560
    buffer_store_dwordx4 v[48:51], v249, s[20:23], s51 offen sc1
    v_mfma_f32_16x16x16_bf16 v[108:111], v[230:231], v[252:253], v[108:111]
    buffer_store_dwordx4 v[52:55], v249, s[20:23], s51 offen offset:1024 sc1
    buffer_store_dwordx2 v[56:57], v247, s[20:23], s51 offen offset:2048 sc1
    v_mfma_f32_16x16x16_bf16 v[112:115], v[240:241], v[252:253], v[112:115]
    v_mfma_f32_16x16x32_bf16 v[144:147], v[192:195], v[184:187], 0
    v_mfma_f32_16x16x32_bf16 v[148:151], v[202:205], v[184:187], 0
    v_mfma_f32_16x16x32_bf16 v[152:155], v[212:215], v[184:187], 0
    v_mfma_f32_16x16x32_bf16 v[156:159], v[222:225], v[184:187], 0
    v_mfma_f32_16x16x32_bf16 v[160:163], v[232:235], v[184:187], 0
    v_mfma_f32_16x16x32_bf16 v[144:147], v[196:199], v[188:191], v[144:147]
    v_mfma_f32_16x16x32_bf16 v[148:151], v[206:209], v[188:191], v[148:151]
    v_mfma_f32_16x16x32_bf16 v[152:155], v[216:219], v[188:191], v[152:155]
    v_cvt_pk_bf16_f32 v96, v96, v97
    v_cvt_pk_bf16_f32 v97, v98, v99
    v_mfma_f32_16x16x32_bf16 v[156:159], v[226:229], v[188:191], v[156:159]
    v_cvt_pk_bf16_f32 v98, v100, v101
    v_cvt_pk_bf16_f32 v99, v102, v103
    v_mfma_f32_16x16x32_bf16 v[160:163], v[236:239], v[188:191], v[160:163]
    v_cvt_pk_bf16_f32 v100, v104, v105
    v_cvt_pk_bf16_f32 v101, v106, v107
    v_mfma_f32_16x16x16_bf16 v[144:147], v[200:201], v[254:255], v[144:147]
    v_cvt_pk_bf16_f32 v102, v108, v109
    v_cvt_pk_bf16_f32 v103, v110, v111
    v_mfma_f32_16x16x16_bf16 v[148:151], v[210:211], v[254:255], v[148:151]
    v_cvt_pk_bf16_f32 v104, v112, v113
    v_cvt_pk_bf16_f32 v105, v114, v115
    v_mfma_f32_16x16x16_bf16 v[152:155], v[220:221], v[254:255], v[152:155]
    s_add_u32 s51, s58, 5120
    buffer_store_dwordx4 v[96:99], v249, s[20:23], s51 offen sc1
    v_mfma_f32_16x16x16_bf16 v[156:159], v[230:231], v[254:255], v[156:159]
    buffer_store_dwordx4 v[100:103], v249, s[20:23], s51 offen offset:1024 sc1
    buffer_store_dwordx2 v[104:105], v247, s[20:23], s51 offen offset:2048 sc1
    v_mfma_f32_16x16x16_bf16 v[160:163], v[240:241], v[254:255], v[160:163]
    v_cvt_pk_bf16_f32 v144, v144, v145
    v_cvt_pk_bf16_f32 v145, v146, v147
    v_cvt_pk_bf16_f32 v146, v148, v149
    v_cvt_pk_bf16_f32 v147, v150, v151
    v_cvt_pk_bf16_f32 v148, v152, v153
    v_cvt_pk_bf16_f32 v149, v154, v155
    v_cvt_pk_bf16_f32 v150, v156, v157
    v_cvt_pk_bf16_f32 v151, v158, v159
    v_cvt_pk_bf16_f32 v152, v160, v161
    v_cvt_pk_bf16_f32 v153, v162, v163
    s_add_u32 s51, s58, 7680
    buffer_store_dwordx4 v[144:147], v249, s[20:23], s51 offen sc1
    buffer_store_dwordx4 v[148:151], v249, s[20:23], s51 offen offset:1024 sc1
    buffer_store_dwordx2 v[152:153], v247, s[20:23], s51 offen offset:2048 sc1
    ds_read_b128 v[192:195], v250 offset:39936
    ds_read_b128 v[196:199], v251 offset:8192
    ds_read_b64 v[200:201], v251 offset:9216
    ds_read_b128 v[202:205], v251 offset:10240
    ds_read_b128 v[206:209], v251 offset:11264
    ds_read_b64 v[210:211], v251 offset:12288
    ds_read_b128 v[212:215], v251 offset:13312
    ds_read_b128 v[216:219], v251 offset:14336
    ds_read_b64 v[220:221], v251 offset:15360
    ds_read_b128 v[222:225], v251 offset:32768
    ds_read_b128 v[226:229], v251 offset:33792
    ds_read_b64 v[230:231], v251 offset:34816
    ds_read_b128 v[232:235], v251 offset:35840
    ds_read_b128 v[236:239], v251 offset:36864
    ds_read_b64 v[240:241], v251 offset:37888
    v_cvt_pk_bf16_f32 v40, v20, v21
    v_cvt_pk_bf16_f32 v41, v22, v23
    v_cvt_pk_bf16_f32 v42, v24, v25
    v_cvt_pk_bf16_f32 v43, v26, v27
    v_cvt_pk_bf16_f32 v44, v28, v29
    v_cvt_pk_bf16_f32 v45, v30, v31
    v_cvt_pk_bf16_f32 v46, v32, v33
    v_cvt_pk_bf16_f32 v47, v34, v35
    v_cvt_pk_bf16_f32 v242, v36, v37
    v_cvt_pk_bf16_f32 v243, v38, v39
    v_cvt_pk_bf16_f32 v88, v68, v69
    v_cvt_pk_bf16_f32 v89, v70, v71
    v_cvt_pk_bf16_f32 v90, v72, v73
    v_cvt_pk_bf16_f32 v91, v74, v75
    v_cvt_pk_bf16_f32 v92, v76, v77
    v_cvt_pk_bf16_f32 v93, v78, v79
    v_cvt_pk_bf16_f32 v94, v80, v81
    v_cvt_pk_bf16_f32 v95, v82, v83
    v_cvt_pk_bf16_f32 v244, v84, v85
    v_cvt_pk_bf16_f32 v245, v86, v87
    v_cvt_pk_bf16_f32 v136, v116, v117
    v_cvt_pk_bf16_f32 v137, v118, v119
    v_cvt_pk_bf16_f32 v138, v120, v121
    v_cvt_pk_bf16_f32 v139, v122, v123
    v_cvt_pk_bf16_f32 v140, v124, v125
    v_cvt_pk_bf16_f32 v141, v126, v127
    v_cvt_pk_bf16_f32 v142, v128, v129
    v_cvt_pk_bf16_f32 v143, v130, v131
    v_cvt_pk_bf16_f32 v252, v132, v133
    v_cvt_pk_bf16_f32 v253, v134, v135
    v_cvt_pk_bf16_f32 v184, v164, v165
    v_cvt_pk_bf16_f32 v185, v166, v167
    v_cvt_pk_bf16_f32 v186, v168, v169
    v_cvt_pk_bf16_f32 v187, v170, v171
    v_cvt_pk_bf16_f32 v188, v172, v173
    v_cvt_pk_bf16_f32 v189, v174, v175
    v_cvt_pk_bf16_f32 v190, v176, v177
    v_cvt_pk_bf16_f32 v191, v178, v179
    v_cvt_pk_bf16_f32 v254, v180, v181
    v_cvt_pk_bf16_f32 v255, v182, v183
    s_waitcnt lgkmcnt(0)
    v_mov_b32 v250, 162816
    v_mov_b32 v251, 1
    s_mov_b64 exec, 1
    ds_add_u32 v250, v251 offset:44
    s_mov_b64 exec, -1
    v_mfma_f32_16x16x32_bf16 v[20:23], v[192:195], v[40:43], 0
    v_mfma_f32_16x16x32_bf16 v[24:27], v[202:205], v[40:43], 0
    v_mfma_f32_16x16x32_bf16 v[28:31], v[212:215], v[40:43], 0
    v_mfma_f32_16x16x32_bf16 v[32:35], v[222:225], v[40:43], 0
    v_mfma_f32_16x16x32_bf16 v[36:39], v[232:235], v[40:43], 0
    v_mfma_f32_16x16x32_bf16 v[20:23], v[196:199], v[44:47], v[20:23]
    v_mfma_f32_16x16x32_bf16 v[24:27], v[206:209], v[44:47], v[24:27]
    v_mfma_f32_16x16x32_bf16 v[28:31], v[216:219], v[44:47], v[28:31]
    v_mfma_f32_16x16x32_bf16 v[32:35], v[226:229], v[44:47], v[32:35]
    v_mfma_f32_16x16x32_bf16 v[36:39], v[236:239], v[44:47], v[36:39]
    v_mfma_f32_16x16x16_bf16 v[20:23], v[200:201], v[242:243], v[20:23]
    v_mfma_f32_16x16x16_bf16 v[24:27], v[210:211], v[242:243], v[24:27]
    v_mfma_f32_16x16x16_bf16 v[28:31], v[220:221], v[242:243], v[28:31]
    v_mfma_f32_16x16x16_bf16 v[32:35], v[230:231], v[242:243], v[32:35]
    v_mfma_f32_16x16x16_bf16 v[36:39], v[240:241], v[242:243], v[36:39]
    v_mfma_f32_16x16x32_bf16 v[68:71], v[192:195], v[88:91], 0
    v_mfma_f32_16x16x32_bf16 v[72:75], v[202:205], v[88:91], 0
    v_mfma_f32_16x16x32_bf16 v[76:79], v[212:215], v[88:91], 0
    v_mfma_f32_16x16x32_bf16 v[80:83], v[222:225], v[88:91], 0
    v_mfma_f32_16x16x32_bf16 v[84:87], v[232:235], v[88:91], 0
    v_mfma_f32_16x16x32_bf16 v[68:71], v[196:199], v[92:95], v[68:71]
    v_mfma_f32_16x16x32_bf16 v[72:75], v[206:209], v[92:95], v[72:75]
    v_mfma_f32_16x16x32_bf16 v[76:79], v[216:219], v[92:95], v[76:79]
    v_cvt_pk_bf16_f32 v20, v20, v21
    v_cvt_pk_bf16_f32 v21, v22, v23
    v_mfma_f32_16x16x32_bf16 v[80:83], v[226:229], v[92:95], v[80:83]
    v_cvt_pk_bf16_f32 v22, v24, v25
    v_cvt_pk_bf16_f32 v23, v26, v27
    v_mfma_f32_16x16x32_bf16 v[84:87], v[236:239], v[92:95], v[84:87]
    v_cvt_pk_bf16_f32 v24, v28, v29
    v_cvt_pk_bf16_f32 v25, v30, v31
    v_mfma_f32_16x16x16_bf16 v[68:71], v[200:201], v[244:245], v[68:71]
    v_cvt_pk_bf16_f32 v26, v32, v33
    v_cvt_pk_bf16_f32 v27, v34, v35
    v_mfma_f32_16x16x16_bf16 v[72:75], v[210:211], v[244:245], v[72:75]
    v_cvt_pk_bf16_f32 v28, v36, v37
    v_cvt_pk_bf16_f32 v29, v38, v39
    v_mfma_f32_16x16x16_bf16 v[76:79], v[220:221], v[244:245], v[76:79]
    s_add_u32 s51, s58, 10240
    buffer_store_dwordx4 v[20:23], v249, s[20:23], s51 offen sc1
    v_mfma_f32_16x16x16_bf16 v[80:83], v[230:231], v[244:245], v[80:83]
    buffer_store_dwordx4 v[24:27], v249, s[20:23], s51 offen offset:1024 sc1
    buffer_store_dwordx2 v[28:29], v247, s[20:23], s51 offen offset:2048 sc1
    v_mfma_f32_16x16x16_bf16 v[84:87], v[240:241], v[244:245], v[84:87]
    v_mfma_f32_16x16x32_bf16 v[116:119], v[192:195], v[136:139], 0
    v_mfma_f32_16x16x32_bf16 v[120:123], v[202:205], v[136:139], 0
    v_mfma_f32_16x16x32_bf16 v[124:127], v[212:215], v[136:139], 0
    v_mfma_f32_16x16x32_bf16 v[128:131], v[222:225], v[136:139], 0
    v_mfma_f32_16x16x32_bf16 v[132:135], v[232:235], v[136:139], 0
    v_mfma_f32_16x16x32_bf16 v[116:119], v[196:199], v[140:143], v[116:119]
    v_mfma_f32_16x16x32_bf16 v[120:123], v[206:209], v[140:143], v[120:123]
    v_mfma_f32_16x16x32_bf16 v[124:127], v[216:219], v[140:143], v[124:127]
    v_cvt_pk_bf16_f32 v68, v68, v69
    v_cvt_pk_bf16_f32 v69, v70, v71
    v_mfma_f32_16x16x32_bf16 v[128:131], v[226:229], v[140:143], v[128:131]
    v_cvt_pk_bf16_f32 v70, v72, v73
    v_cvt_pk_bf16_f32 v71, v74, v75
    v_mfma_f32_16x16x32_bf16 v[132:135], v[236:239], v[140:143], v[132:135]
    v_cvt_pk_bf16_f32 v72, v76, v77
    v_cvt_pk_bf16_f32 v73, v78, v79
    v_mfma_f32_16x16x16_bf16 v[116:119], v[200:201], v[252:253], v[116:119]
    v_cvt_pk_bf16_f32 v74, v80, v81
    v_cvt_pk_bf16_f32 v75, v82, v83
    v_mfma_f32_16x16x16_bf16 v[120:123], v[210:211], v[252:253], v[120:123]
    v_cvt_pk_bf16_f32 v76, v84, v85
    v_cvt_pk_bf16_f32 v77, v86, v87
    v_mfma_f32_16x16x16_bf16 v[124:127], v[220:221], v[252:253], v[124:127]
    s_add_u32 s51, s58, 12800
    buffer_store_dwordx4 v[68:71], v249, s[20:23], s51 offen sc1
    v_mfma_f32_16x16x16_bf16 v[128:131], v[230:231], v[252:253], v[128:131]
    buffer_store_dwordx4 v[72:75], v249, s[20:23], s51 offen offset:1024 sc1
    buffer_store_dwordx2 v[76:77], v247, s[20:23], s51 offen offset:2048 sc1
    v_mfma_f32_16x16x16_bf16 v[132:135], v[240:241], v[252:253], v[132:135]
    v_mfma_f32_16x16x32_bf16 v[164:167], v[192:195], v[184:187], 0
    v_mfma_f32_16x16x32_bf16 v[168:171], v[202:205], v[184:187], 0
    v_mfma_f32_16x16x32_bf16 v[172:175], v[212:215], v[184:187], 0
    v_mfma_f32_16x16x32_bf16 v[176:179], v[222:225], v[184:187], 0
    v_mfma_f32_16x16x32_bf16 v[180:183], v[232:235], v[184:187], 0
    v_mfma_f32_16x16x32_bf16 v[164:167], v[196:199], v[188:191], v[164:167]
    v_mfma_f32_16x16x32_bf16 v[168:171], v[206:209], v[188:191], v[168:171]
    v_mfma_f32_16x16x32_bf16 v[172:175], v[216:219], v[188:191], v[172:175]
    v_cvt_pk_bf16_f32 v116, v116, v117
    v_cvt_pk_bf16_f32 v117, v118, v119
    v_mfma_f32_16x16x32_bf16 v[176:179], v[226:229], v[188:191], v[176:179]
    v_cvt_pk_bf16_f32 v118, v120, v121
    v_cvt_pk_bf16_f32 v119, v122, v123
    v_mfma_f32_16x16x32_bf16 v[180:183], v[236:239], v[188:191], v[180:183]
    v_cvt_pk_bf16_f32 v120, v124, v125
    v_cvt_pk_bf16_f32 v121, v126, v127
    v_mfma_f32_16x16x16_bf16 v[164:167], v[200:201], v[254:255], v[164:167]
    v_cvt_pk_bf16_f32 v122, v128, v129
    v_cvt_pk_bf16_f32 v123, v130, v131
    v_mfma_f32_16x16x16_bf16 v[168:171], v[210:211], v[254:255], v[168:171]
    v_cvt_pk_bf16_f32 v124, v132, v133
    v_cvt_pk_bf16_f32 v125, v134, v135
    v_mfma_f32_16x16x16_bf16 v[172:175], v[220:221], v[254:255], v[172:175]
    s_add_u32 s51, s58, 15360
    buffer_store_dwordx4 v[116:119], v249, s[20:23], s51 offen sc1
    v_mfma_f32_16x16x16_bf16 v[176:179], v[230:231], v[254:255], v[176:179]
    buffer_store_dwordx4 v[120:123], v249, s[20:23], s51 offen offset:1024 sc1
    buffer_store_dwordx2 v[124:125], v247, s[20:23], s51 offen offset:2048 sc1
    v_mfma_f32_16x16x16_bf16 v[180:183], v[240:241], v[254:255], v[180:183]
    v_cvt_pk_bf16_f32 v164, v164, v165
    v_cvt_pk_bf16_f32 v165, v166, v167
    v_cvt_pk_bf16_f32 v166, v168, v169
    v_cvt_pk_bf16_f32 v167, v170, v171
    v_cvt_pk_bf16_f32 v168, v172, v173
    v_cvt_pk_bf16_f32 v169, v174, v175
    v_cvt_pk_bf16_f32 v170, v176, v177
    v_cvt_pk_bf16_f32 v171, v178, v179
    v_cvt_pk_bf16_f32 v172, v180, v181
    v_cvt_pk_bf16_f32 v173, v182, v183
    s_add_u32 s51, s58, 17920
    buffer_store_dwordx4 v[164:167], v249, s[20:23], s51 offen sc1
    buffer_store_dwordx4 v[168:171], v249, s[20:23], s51 offen offset:1024 sc1
    buffer_store_dwordx2 v[172:173], v247, s[20:23], s51 offen offset:2048 sc1
    s_lshl_b32 s57, s37, 7
    s_add_u32 s57, s57, 20049920
    s_mov_b32 s56, 3
    v_mov_b32 v0, v248
P2_stream:
    s_load_dwordx2 s[6:7], s[0:1], 64
    s_setprio 0
    v_mov_b32 v4, 162816
    v_mov_b32 v5, 1
    s_mov_b64 exec, 1
    ds_add_u32 v4, v5 offset:48
    s_mov_b64 exec, -1
    s_cmp_ge_u32 s57, 2146435072
    s_cbranch_scc1 PS_noflag
    s_waitcnt vmcnt(0)
    v_mov_b32 v4, 1
    v_mov_b32 v5, 0
    s_mov_b64 exec, 1
    buffer_atomic_add v4, v5, s[20:23], s57 offen sc0
    s_waitcnt vmcnt(0)
    v_readfirstlane_b32 s36, v4
    v_mov_b32 v4, 1
    s_cmp_lg_u32 s36, s56
    s_cbranch_scc1 PS_notlast
    s_add_u32 s36, s57, 9216
    s_nop 0
    buffer_store_dword v4, v5, s[20:23], s36 offen sc1
PS_notlast:
    s_mov_b64 exec, -1
PS_noflag:
    s_and_b32 s74, s2, 7
    s_lshl_b32 s74, s74, 2
    s_lshr_b32 s75, s2, 3
    s_and_b32 s67, s75, 3
    s_add_u32 s74, s74, s67
    s_lshr_b32 s75, s75, 2
    s_lshl_b32 s67, s67, 1
    s_add_u32 s75, s75, s67
    s_and_b32 s75, s75, 7
    s_and_b32 s76, s3, 3
    s_mov_b32 s67, 0
    s_add_u32 s67, s67, 0
    s_mul_i32 s77, s74, 74
    s_add_u32 s77, s77, s67
    s_lshl_b32 s77, s77, 12
    s_add_u32 s77, s77, 3145728
    s_mul_i32 s78, s75, 74
    s_add_u32 s78, s78, s67
    s_mul_i32 s78, s78, 5120
    s_add_u32 s78, s78, 13631488
    s_and_b32 s67, s74, 3
    s_mul_i32 s67, s67, 0
    s_mul_i32 s79, s75, 0
    s_add_u32 s79, s79, s67
    s_lshr_b32 s79, s79, 2
    s_sub_u32 s67, s79, 54
    s_cselect_b32 s79, s79, s67
    s_add_u32 s79, s79, s76
    s_sub_u32 s67, s79, 54
    s_cselect_b32 s79, s79, s67
    s_mov_b32 s32, s74
    s_mov_b32 s33, s75
    s_mov_b32 s35, s76
    s_mov_b32 s40, s77
    s_mov_b32 s41, s78
    s_mov_b32 s58, s79
    v_lshlrev_b32_e64 v2, 4, v0
    v_add_u32 v3, 4096, v2
    s_cmp_eq_u32 s3, 4
    s_cbranch_scc0 PSW_fol
    v_and_b32 v4, 1, v0
    v_lshlrev_b32 v4, 6, v4
    s_mov_b32 s68, 100000
PSW_spin:
    global_load_dword v5, v4, s[14:15] offset:132 sc1
    s_waitcnt vmcnt(0)
PSW_chk:
    v_cmp_ne_u32 vcc, 1, v5
    s_cbranch_vccz PSW_out
    s_sub_u32 s68, s68, 1
    s_cbranch_scc1 PSW_out
    s_sleep 2
    s_branch PSW_spin
PSW_out:
    v_mov_b32 v4, 162816
    v_mov_b32 v5, 1
    s_mov_b64 exec, 1
    ds_add_u32 v4, v5 offset:16
    s_mov_b64 exec, -1
    s_branch PSW_done
PSW_fol:
    v_mov_b32 v4, 162816
    s_mov_b32 s68, 1000000
PSWF_spin:
    ds_read_b32 v5, v4 offset:16
    s_waitcnt lgkmcnt(0)
    v_cmp_ne_u32 vcc, 1, v5
    s_cbranch_vccz PSWF_out
    s_sub_u32 s68, s68, 1
    s_sleep 1
    s_cbranch_scc0 PSWF_spin
PSWF_out:
PSW_done:
    s_waitcnt lgkmcnt(0)
    s_mov_b32 s24, s6
    s_mov_b32 s25, s7
    s_mov_b32 s26, 2621440
    s_mov_b32 s27, 0x20000
    s_cmp_eq_u32 s34, 1
    s_cbranch_scc1 P2_stream0
    s_add_u32 s59, s58, 0
    s_sub_u32 s43, s59, 54
    s_cselect_b32 s59, s59, s43
    s_mul_i32 s43, s59, 5120
    s_add_u32 s43, s43, s41
    buffer_load_dwordx4 v[148:151], v2, s[20:23], s43 offen offset:0 sc1
    buffer_load_dwordx4 v[152:155], v2, s[20:23], s43 offen offset:1024 sc1
    buffer_load_dwordx4 v[156:159], v2, s[20:23], s43 offen offset:2048 sc1
    buffer_load_dwordx4 v[160:163], v2, s[20:23], s43 offen offset:3072 sc1
    buffer_load_dwordx4 v[164:167], v3, s[20:23], s43 offen sc1
    s_add_u32 s59, s58, 4
    s_sub_u32 s43, s59, 54
    s_cselect_b32 s59, s59, s43
    s_mul_i32 s43, s59, 5120
    s_add_u32 s43, s43, s41
    buffer_load_dwordx4 v[168:171], v2, s[20:23], s43 offen offset:0 sc1
    buffer_load_dwordx4 v[172:175], v2, s[20:23], s43 offen offset:1024 sc1
    buffer_load_dwordx4 v[176:179], v2, s[20:23], s43 offen offset:2048 sc1
    buffer_load_dwordx4 v[180:183], v2, s[20:23], s43 offen offset:3072 sc1
    buffer_load_dwordx4 v[184:187], v3, s[20:23], s43 offen sc1
    s_add_u32 s59, s58, 8
    s_sub_u32 s43, s59, 54
    s_cselect_b32 s59, s59, s43
    s_mul_i32 s43, s59, 5120
    s_add_u32 s43, s43, s41
    buffer_load_dwordx4 v[188:191], v2, s[20:23], s43 offen offset:0 sc1
    buffer_load_dwordx4 v[192:195], v2, s[20:23], s43 offen offset:1024 sc1
    buffer_load_dwordx4 v[196:199], v2, s[20:23], s43 offen offset:2048 sc1
    buffer_load_dwordx4 v[200:203], v2, s[20:23], s43 offen offset:3072 sc1
    buffer_load_dwordx4 v[204:207], v3, s[20:23], s43 offen sc1
    s_add_u32 s59, s58, 12
    s_sub_u32 s43, s59, 54
    s_cselect_b32 s59, s59, s43
    s_mul_i32 s43, s59, 5120
    s_add_u32 s43, s43, s41
    buffer_load_dwordx4 v[208:211], v2, s[20:23], s43 offen offset:0 sc1
    buffer_load_dwordx4 v[212:215], v2, s[20:23], s43 offen offset:1024 sc1
    buffer_load_dwordx4 v[216:219], v2, s[20:23], s43 offen offset:2048 sc1
    buffer_load_dwordx4 v[220:223], v2, s[20:23], s43 offen offset:3072 sc1
    buffer_load_dwordx4 v[224:227], v3, s[20:23], s43 offen sc1
    s_cmp_eq_u32 s35, 0
    s_cbranch_scc0 SAH_fol
    s_lshl_b32 s36, s32, 7
    s_add_u32 s36, s36, 20055040
    v_mov_b32 v4, 0
    s_mov_b32 s68, 100000
SAH_spin:
    buffer_load_dword v5, v4, s[20:23], s36 offen sc1
    s_waitcnt vmcnt(0)
SAH_chk:
    v_cmp_ne_u32 vcc, 1, v5
    s_cbranch_vccz SAH_out
    s_sub_u32 s68, s68, 1
    s_cbranch_scc1 SAH_out
    s_sleep 2
    s_branch SAH_spin
SAH_out:
    v_mov_b32 v4, 162816
    v_mov_b32 v5, 1
    s_mov_b64 exec, 1
    ds_add_u32 v4, v5 offset:12
    s_mov_b64 exec, -1
    s_branch SAH_done
SAH_fol:
    v_mov_b32 v4, 162816
    s_mov_b32 s68, 1000000
SAHF_spin:
    ds_read_b32 v5, v4 offset:12
    s_waitcnt lgkmcnt(0)
    v_cmp_ne_u32 vcc, 1, v5
    s_cbranch_vccz SAHF_out
    s_sub_u32 s68, s68, 1
    s_sleep 1
    s_cbranch_scc0 SAHF_spin
SAHF_out:
SAH_done:
    s_add_u32 s59, s58, 0
    s_sub_u32 s42, s59, 54
    s_cselect_b32 s59, s59, s42
    s_mul_i32 s42, s59, 4096
    s_add_u32 s42, s42, s40
    buffer_load_dwordx4 v[84:87], v2, s[20:23], s42 offen offset:0 sc1
    buffer_load_dwordx4 v[88:91], v2, s[20:23], s42 offen offset:1024 sc1
    buffer_load_dwordx4 v[92:95], v2, s[20:23], s42 offen offset:2048 sc1
    buffer_load_dwordx4 v[96:99], v2, s[20:23], s42 offen offset:3072 sc1
    s_add_u32 s59, s58, 4
    s_sub_u32 s42, s59, 54
    s_cselect_b32 s59, s59, s42
    s_mul_i32 s42, s59, 4096
    s_add_u32 s42, s42, s40
    buffer_load_dwordx4 v[100:103], v2, s[20:23], s42 offen offset:0 sc1
    buffer_load_dwordx4 v[104:107], v2, s[20:23], s42 offen offset:1024 sc1
    buffer_load_dwordx4 v[108:111], v2, s[20:23], s42 offen offset:2048 sc1
    buffer_load_dwordx4 v[112:115], v2, s[20:23], s42 offen offset:3072 sc1
    s_add_u32 s59, s58, 8
    s_sub_u32 s42, s59, 54
    s_cselect_b32 s59, s59, s42
    s_mul_i32 s42, s59, 4096
    s_add_u32 s42, s42, s40
    buffer_load_dwordx4 v[116:119], v2, s[20:23], s42 offen offset:0 sc1
    buffer_load_dwordx4 v[120:123], v2, s[20:23], s42 offen offset:1024 sc1
    buffer_load_dwordx4 v[124:127], v2, s[20:23], s42 offen offset:2048 sc1
    buffer_load_dwordx4 v[128:131], v2, s[20:23], s42 offen offset:3072 sc1
    s_add_u32 s59, s58, 12
    s_sub_u32 s42, s59, 54
    s_cselect_b32 s59, s59, s42
    s_mul_i32 s42, s59, 4096
    s_add_u32 s42, s42, s40
    buffer_load_dwordx4 v[132:135], v2, s[20:23], s42 offen offset:0 sc1
    buffer_load_dwordx4 v[136:139], v2, s[20:23], s42 offen offset:1024 sc1
    buffer_load_dwordx4 v[140:143], v2, s[20:23], s42 offen offset:2048 sc1
    buffer_load_dwordx4 v[144:147], v2, s[20:23], s42 offen offset:3072 sc1
    s_mov_b32 s68, 100000
    s_mul_i32 s36, s35, 5120
    v_add_u32 v248, s36, v2
    v_add_u32 v249, 61440, v248
    v_add_u32 v250, 122880, v248
    s_waitcnt vmcnt(12)
    v_mfma_f32_16x16x32_bf16 v[4:7], v[148:151], v[84:87], 0
    v_mfma_f32_16x16x32_bf16 v[24:27], v[148:151], v[88:91], 0
    v_mfma_f32_16x16x32_bf16 v[44:47], v[148:151], v[92:95], 0
    v_mfma_f32_16x16x32_bf16 v[64:67], v[148:151], v[96:99], 0
    v_mfma_f32_16x16x32_bf16 v[8:11], v[152:155], v[84:87], 0
    v_mfma_f32_16x16x32_bf16 v[28:31], v[152:155], v[88:91], 0
    v_mfma_f32_16x16x32_bf16 v[48:51], v[152:155], v[92:95], 0
    v_mfma_f32_16x16x32_bf16 v[68:71], v[152:155], v[96:99], 0
    v_mfma_f32_16x16x32_bf16 v[12:15], v[156:159], v[84:87], 0
    v_mfma_f32_16x16x32_bf16 v[32:35], v[156:159], v[88:91], 0
    v_mfma_f32_16x16x32_bf16 v[52:55], v[156:159], v[92:95], 0
    v_mfma_f32_16x16x32_bf16 v[72:75], v[156:159], v[96:99], 0
    v_mfma_f32_16x16x32_bf16 v[16:19], v[160:163], v[84:87], 0
    v_mfma_f32_16x16x32_bf16 v[36:39], v[160:163], v[88:91], 0
    v_mfma_f32_16x16x32_bf16 v[56:59], v[160:163], v[92:95], 0
    v_mfma_f32_16x16x32_bf16 v[76:79], v[160:163], v[96:99], 0
    v_mfma_f32_16x16x32_bf16 v[20:23], v[164:167], v[84:87], 0
    v_mfma_f32_16x16x32_bf16 v[40:43], v[164:167], v[88:91], 0
    v_mfma_f32_16x16x32_bf16 v[60:63], v[164:167], v[92:95], 0
    v_mfma_f32_16x16x32_bf16 v[80:83], v[164:167], v[96:99], 0
    s_waitcnt vmcnt(8)
    v_mfma_f32_16x16x32_bf16 v[4:7], v[168:171], v[100:103], v[4:7]
    s_add_u32 s59, s58, 16
    s_sub_u32 s42, s59, 54
    s_cselect_b32 s59, s59, s42
    s_mul_i32 s42, s59, 4096
    s_add_u32 s42, s42, s40
    buffer_load_dwordx4 v[84:87], v2, s[20:23], s42 offen offset:0 sc1
    v_mfma_f32_16x16x32_bf16 v[24:27], v[168:171], v[104:107], v[24:27]
    v_mfma_f32_16x16x32_bf16 v[44:47], v[168:171], v[108:111], v[44:47]
    buffer_load_dwordx4 v[88:91], v2, s[20:23], s42 offen offset:1024 sc1
    v_mfma_f32_16x16x32_bf16 v[64:67], v[168:171], v[112:115], v[64:67]
    v_mfma_f32_16x16x32_bf16 v[8:11], v[172:175], v[100:103], v[8:11]
    buffer_load_dwordx4 v[92:95], v2, s[20:23], s42 offen offset:2048 sc1
    v_mfma_f32_16x16x32_bf16 v[28:31], v[172:175], v[104:107], v[28:31]
    v_mfma_f32_16x16x32_bf16 v[48:51], v[172:175], v[108:111], v[48:51]
    buffer_load_dwordx4 v[96:99], v2, s[20:23], s42 offen offset:3072 sc1
    v_mfma_f32_16x16x32_bf16 v[68:71], v[172:175], v[112:115], v[68:71]
    v_mfma_f32_16x16x32_bf16 v[12:15], v[176:179], v[100:103], v[12:15]
    s_add_u32 s59, s58, 44
    s_sub_u32 s43, s59, 54
    s_cselect_b32 s59, s59, s43
    s_mul_i32 s43, s59, 5120
    s_add_u32 s43, s43, s41
    buffer_load_dwordx4 v[148:151], v2, s[20:23], s43 offen offset:0 sc1
    v_mfma_f32_16x16x32_bf16 v[32:35], v[176:179], v[104:107], v[32:35]
    v_mfma_f32_16x16x32_bf16 v[52:55], v[176:179], v[108:111], v[52:55]
    buffer_load_dwordx4 v[152:155], v2, s[20:23], s43 offen offset:1024 sc1
    v_mfma_f32_16x16x32_bf16 v[72:75], v[176:179], v[112:115], v[72:75]
    v_mfma_f32_16x16x32_bf16 v[16:19], v[180:183], v[100:103], v[16:19]
    buffer_load_dwordx4 v[156:159], v2, s[20:23], s43 offen offset:2048 sc1
    v_mfma_f32_16x16x32_bf16 v[36:39], v[180:183], v[104:107], v[36:39]
    v_mfma_f32_16x16x32_bf16 v[56:59], v[180:183], v[108:111], v[56:59]
    buffer_load_dwordx4 v[160:163], v2, s[20:23], s43 offen offset:3072 sc1
    v_mfma_f32_16x16x32_bf16 v[76:79], v[180:183], v[112:115], v[76:79]
    v_mfma_f32_16x16x32_bf16 v[20:23], v[184:187], v[100:103], v[20:23]
    buffer_load_dwordx4 v[164:167], v3, s[20:23], s43 offen sc1
    v_mfma_f32_16x16x32_bf16 v[40:43], v[184:187], v[104:107], v[40:43]
    v_mfma_f32_16x16x32_bf16 v[60:63], v[184:187], v[108:111], v[60:63]
    v_mfma_f32_16x16x32_bf16 v[80:83], v[184:187], v[112:115], v[80:83]
    s_waitcnt vmcnt(13)
    v_mfma_f32_16x16x32_bf16 v[4:7], v[188:191], v[116:119], v[4:7]
    s_add_u32 s59, s58, 20
    s_sub_u32 s42, s59, 54
    s_cselect_b32 s59, s59, s42
    s_mul_i32 s42, s59, 4096
    s_add_u32 s42, s42, s40
    buffer_load_dwordx4 v[100:103], v2, s[20:23], s42 offen offset:0 sc1
    v_mfma_f32_16x16x32_bf16 v[24:27], v[188:191], v[120:123], v[24:27]
    v_mfma_f32_16x16x32_bf16 v[44:47], v[188:191], v[124:127], v[44:47]
    buffer_load_dwordx4 v[104:107], v2, s[20:23], s42 offen offset:1024 sc1
    v_mfma_f32_16x16x32_bf16 v[64:67], v[188:191], v[128:131], v[64:67]
    v_mfma_f32_16x16x32_bf16 v[8:11], v[192:195], v[116:119], v[8:11]
    buffer_load_dwordx4 v[108:111], v2, s[20:23], s42 offen offset:2048 sc1
    v_mfma_f32_16x16x32_bf16 v[28:31], v[192:195], v[120:123], v[28:31]
    v_mfma_f32_16x16x32_bf16 v[48:51], v[192:195], v[124:127], v[48:51]
    buffer_load_dwordx4 v[112:115], v2, s[20:23], s42 offen offset:3072 sc1
    v_mfma_f32_16x16x32_bf16 v[68:71], v[192:195], v[128:131], v[68:71]
    v_mfma_f32_16x16x32_bf16 v[12:15], v[196:199], v[116:119], v[12:15]
    s_add_u32 s59, s58, 48
    s_sub_u32 s43, s59, 54
    s_cselect_b32 s59, s59, s43
    s_mul_i32 s43, s59, 5120
    s_add_u32 s43, s43, s41
    buffer_load_dwordx4 v[168:171], v2, s[20:23], s43 offen offset:0 sc1
    v_mfma_f32_16x16x32_bf16 v[32:35], v[196:199], v[120:123], v[32:35]
    v_mfma_f32_16x16x32_bf16 v[52:55], v[196:199], v[124:127], v[52:55]
    buffer_load_dwordx4 v[172:175], v2, s[20:23], s43 offen offset:1024 sc1
    v_mfma_f32_16x16x32_bf16 v[72:75], v[196:199], v[128:131], v[72:75]
    v_mfma_f32_16x16x32_bf16 v[16:19], v[200:203], v[116:119], v[16:19]
    buffer_load_dwordx4 v[176:179], v2, s[20:23], s43 offen offset:2048 sc1
    v_mfma_f32_16x16x32_bf16 v[36:39], v[200:203], v[120:123], v[36:39]
    v_mfma_f32_16x16x32_bf16 v[56:59], v[200:203], v[124:127], v[56:59]
    buffer_load_dwordx4 v[180:183], v2, s[20:23], s43 offen offset:3072 sc1
    v_mfma_f32_16x16x32_bf16 v[76:79], v[200:203], v[128:131], v[76:79]
    v_mfma_f32_16x16x32_bf16 v[20:23], v[204:207], v[116:119], v[20:23]
    buffer_load_dwordx4 v[184:187], v3, s[20:23], s43 offen sc1
    v_mfma_f32_16x16x32_bf16 v[40:43], v[204:207], v[120:123], v[40:43]
    v_mfma_f32_16x16x32_bf16 v[60:63], v[204:207], v[124:127], v[60:63]
    v_mfma_f32_16x16x32_bf16 v[80:83], v[204:207], v[128:131], v[80:83]
    v_mov_b32 v251, 162816
    s_mov_b32 s68, 1000000
SAL_spin:
    ds_read_b32 v252, v251 offset:4
    s_waitcnt lgkmcnt(0)
    v_cmp_ne_u32 vcc, 4, v252
    s_cbranch_vccz SAL_out
    s_sub_u32 s68, s68, 1
    s_sleep 1
    s_cbranch_scc0 SAL_spin
SAL_out:
    s_mov_b32 s68, 100000
    ds_read_b128 v[228:231], v248 offset:0
    ds_read_b128 v[232:235], v248 offset:1024
    ds_read_b128 v[236:239], v248 offset:2048
    ds_read_b128 v[240:243], v248 offset:3072
    ds_read_b128 v[244:247], v248 offset:4096
    s_waitcnt vmcnt(18)
    v_mfma_f32_16x16x32_bf16 v[4:7], v[208:211], v[132:135], v[4:7]
    s_add_u32 s59, s58, 24
    s_sub_u32 s42, s59, 54
    s_cselect_b32 s59, s59, s42
    s_mul_i32 s42, s59, 4096
    s_add_u32 s42, s42, s40
    buffer_load_dwordx4 v[116:119], v2, s[20:23], s42 offen offset:0 sc1
    v_mfma_f32_16x16x32_bf16 v[24:27], v[208:211], v[136:139], v[24:27]
    v_mfma_f32_16x16x32_bf16 v[44:47], v[208:211], v[140:143], v[44:47]
    buffer_load_dwordx4 v[120:123], v2, s[20:23], s42 offen offset:1024 sc1
    v_mfma_f32_16x16x32_bf16 v[64:67], v[208:211], v[144:147], v[64:67]
    v_mfma_f32_16x16x32_bf16 v[8:11], v[212:215], v[132:135], v[8:11]
    buffer_load_dwordx4 v[124:127], v2, s[20:23], s42 offen offset:2048 sc1
    v_mfma_f32_16x16x32_bf16 v[28:31], v[212:215], v[136:139], v[28:31]
    v_mfma_f32_16x16x32_bf16 v[48:51], v[212:215], v[140:143], v[48:51]
    buffer_load_dwordx4 v[128:131], v2, s[20:23], s42 offen offset:3072 sc1
    v_mfma_f32_16x16x32_bf16 v[68:71], v[212:215], v[144:147], v[68:71]
    v_mfma_f32_16x16x32_bf16 v[12:15], v[216:219], v[132:135], v[12:15]
    s_add_u32 s59, s58, 52
    s_sub_u32 s43, s59, 54
    s_cselect_b32 s59, s59, s43
    s_mul_i32 s43, s59, 5120
    s_add_u32 s43, s43, s41
    s_cmp_lt_u32 s35, 2
    s_cselect_b32 s43, s43, 2146435072
    buffer_load_dwordx4 v[188:191], v2, s[20:23], s43 offen offset:0 sc1
    v_mfma_f32_16x16x32_bf16 v[32:35], v[216:219], v[136:139], v[32:35]
    v_mfma_f32_16x16x32_bf16 v[52:55], v[216:219], v[140:143], v[52:55]
    buffer_load_dwordx4 v[192:195], v2, s[20:23], s43 offen offset:1024 sc1
    v_mfma_f32_16x16x32_bf16 v[72:75], v[216:219], v[144:147], v[72:75]
    v_mfma_f32_16x16x32_bf16 v[16:19], v[220:223], v[132:135], v[16:19]
    buffer_load_dwordx4 v[196:199], v2, s[20:23], s43 offen offset:2048 sc1
    v_mfma_f32_16x16x32_bf16 v[36:39], v[220:223], v[136:139], v[36:39]
    v_mfma_f32_16x16x32_bf16 v[56:59], v[220:223], v[140:143], v[56:59]
    buffer_load_dwordx4 v[200:203], v2, s[20:23], s43 offen offset:3072 sc1
    v_mfma_f32_16x16x32_bf16 v[76:79], v[220:223], v[144:147], v[76:79]
    v_mfma_f32_16x16x32_bf16 v[20:23], v[224:227], v[132:135], v[20:23]
    buffer_load_dwordx4 v[204:207], v3, s[20:23], s43 offen sc1
    v_mfma_f32_16x16x32_bf16 v[40:43], v[224:227], v[136:139], v[40:43]
    v_mfma_f32_16x16x32_bf16 v[60:63], v[224:227], v[140:143], v[60:63]
    v_mfma_f32_16x16x32_bf16 v[80:83], v[224:227], v[144:147], v[80:83]
    s_waitcnt vmcnt(23)
    s_waitcnt lgkmcnt(0)
    v_mfma_f32_16x16x32_bf16 v[4:7], v[228:231], v[84:87], v[4:7]
    ds_read_b128 v[208:211], v248 offset:20480
    v_mfma_f32_16x16x32_bf16 v[24:27], v[228:231], v[88:91], v[24:27]
    v_mfma_f32_16x16x32_bf16 v[44:47], v[228:231], v[92:95], v[44:47]
    ds_read_b128 v[212:215], v248 offset:21504
    v_mfma_f32_16x16x32_bf16 v[64:67], v[228:231], v[96:99], v[64:67]
    v_mfma_f32_16x16x32_bf16 v[8:11], v[232:235], v[84:87], v[8:11]
    ds_read_b128 v[216:219], v248 offset:22528
    v_mfma_f32_16x16x32_bf16 v[28:31], v[232:235], v[88:91], v[28:31]
    v_mfma_f32_16x16x32_bf16 v[48:51], v[232:235], v[92:95], v[48:51]
    ds_read_b128 v[220:223], v248 offset:23552
    v_mfma_f32_16x16x32_bf16 v[68:71], v[232:235], v[96:99], v[68:71]
    v_mfma_f32_16x16x32_bf16 v[12:15], v[236:239], v[84:87], v[12:15]
    ds_read_b128 v[224:227], v248 offset:24576
    v_mfma_f32_16x16x32_bf16 v[32:35], v[236:239], v[88:91], v[32:35]
    v_mfma_f32_16x16x32_bf16 v[52:55], v[236:239], v[92:95], v[52:55]
    s_add_u32 s59, s58, 28
    s_sub_u32 s42, s59, 54
    s_cselect_b32 s59, s59, s42
    s_mul_i32 s42, s59, 4096
    s_add_u32 s42, s42, s40
    buffer_load_dwordx4 v[132:135], v2, s[20:23], s42 offen offset:0 sc1
    v_mfma_f32_16x16x32_bf16 v[72:75], v[236:239], v[96:99], v[72:75]
    v_mfma_f32_16x16x32_bf16 v[16:19], v[240:243], v[84:87], v[16:19]
    buffer_load_dwordx4 v[136:139], v2, s[20:23], s42 offen offset:1024 sc1
    v_mfma_f32_16x16x32_bf16 v[36:39], v[240:243], v[88:91], v[36:39]
    v_mfma_f32_16x16x32_bf16 v[56:59], v[240:243], v[92:95], v[56:59]
    buffer_load_dwordx4 v[140:143], v2, s[20:23], s42 offen offset:2048 sc1
    v_mfma_f32_16x16x32_bf16 v[76:79], v[240:243], v[96:99], v[76:79]
    v_mfma_f32_16x16x32_bf16 v[20:23], v[244:247], v[84:87], v[20:23]
    buffer_load_dwordx4 v[144:147], v2, s[20:23], s42 offen offset:3072 sc1
    v_mfma_f32_16x16x32_bf16 v[40:43], v[244:247], v[88:91], v[40:43]
    v_mfma_f32_16x16x32_bf16 v[60:63], v[244:247], v[92:95], v[60:63]
    v_mfma_f32_16x16x32_bf16 v[80:83], v[244:247], v[96:99], v[80:83]
    s_waitcnt vmcnt(18)
    s_waitcnt lgkmcnt(0)
    v_mfma_f32_16x16x32_bf16 v[4:7], v[208:211], v[100:103], v[4:7]
    ds_read_b128 v[228:231], v248 offset:40960
    v_mfma_f32_16x16x32_bf16 v[24:27], v[208:211], v[104:107], v[24:27]
    v_mfma_f32_16x16x32_bf16 v[44:47], v[208:211], v[108:111], v[44:47]
    ds_read_b128 v[232:235], v248 offset:41984
    v_mfma_f32_16x16x32_bf16 v[64:67], v[208:211], v[112:115], v[64:67]
    v_mfma_f32_16x16x32_bf16 v[8:11], v[212:215], v[100:103], v[8:11]
    ds_read_b128 v[236:239], v248 offset:43008
    v_mfma_f32_16x16x32_bf16 v[28:31], v[212:215], v[104:107], v[28:31]
    v_mfma_f32_16x16x32_bf16 v[48:51], v[212:215], v[108:111], v[48:51]
    ds_read_b128 v[240:243], v248 offset:44032
    v_mfma_f32_16x16x32_bf16 v[68:71], v[212:215], v[112:115], v[68:71]
    v_mfma_f32_16x16x32_bf16 v[12:15], v[216:219], v[100:103], v[12:15]
    ds_read_b128 v[244:247], v248 offset:45056
    v_mfma_f32_16x16x32_bf16 v[32:35], v[216:219], v[104:107], v[32:35]
    v_mfma_f32_16x16x32_bf16 v[52:55], v[216:219], v[108:111], v[52:55]
    s_add_u32 s59, s58, 32
    s_sub_u32 s42, s59, 54
    s_cselect_b32 s59, s59, s42
    s_mul_i32 s42, s59, 4096
    s_add_u32 s42, s42, s40
    buffer_load_dwordx4 v[84:87], v2, s[20:23], s42 offen offset:0 sc1
    v_mfma_f32_16x16x32_bf16 v[72:75], v[216:219], v[112:115], v[72:75]
    v_mfma_f32_16x16x32_bf16 v[16:19], v[220:223], v[100:103], v[16:19]
    buffer_load_dwordx4 v[88:91], v2, s[20:23], s42 offen offset:1024 sc1
    v_mfma_f32_16x16x32_bf16 v[36:39], v[220:223], v[104:107], v[36:39]
    v_mfma_f32_16x16x32_bf16 v[56:59], v[220:223], v[108:111], v[56:59]
    buffer_load_dwordx4 v[92:95], v2, s[20:23], s42 offen offset:2048 sc1
    v_mfma_f32_16x16x32_bf16 v[76:79], v[220:223], v[112:115], v[76:79]
    v_mfma_f32_16x16x32_bf16 v[20:23], v[224:227], v[100:103], v[20:23]
    buffer_load_dwordx4 v[96:99], v2, s[20:23], s42 offen offset:3072 sc1
    v_mfma_f32_16x16x32_bf16 v[40:43], v[224:227], v[104:107], v[40:43]
    v_mfma_f32_16x16x32_bf16 v[60:63], v[224:227], v[108:111], v[60:63]
    v_mfma_f32_16x16x32_bf16 v[80:83], v[224:227], v[112:115], v[80:83]
    s_waitcnt vmcnt(13)
    s_waitcnt lgkmcnt(0)
    v_mfma_f32_16x16x32_bf16 v[4:7], v[228:231], v[116:119], v[4:7]
    ds_read_b128 v[208:211], v249 offset:0
    v_mfma_f32_16x16x32_bf16 v[24:27], v[228:231], v[120:123], v[24:27]
    v_mfma_f32_16x16x32_bf16 v[44:47], v[228:231], v[124:127], v[44:47]
    ds_read_b128 v[212:215], v249 offset:1024
    v_mfma_f32_16x16x32_bf16 v[64:67], v[228:231], v[128:131], v[64:67]
    v_mfma_f32_16x16x32_bf16 v[8:11], v[232:235], v[116:119], v[8:11]
    ds_read_b128 v[216:219], v249 offset:2048
    v_mfma_f32_16x16x32_bf16 v[28:31], v[232:235], v[120:123], v[28:31]
    v_mfma_f32_16x16x32_bf16 v[48:51], v[232:235], v[124:127], v[48:51]
    ds_read_b128 v[220:223], v249 offset:3072
    v_mfma_f32_16x16x32_bf16 v[68:71], v[232:235], v[128:131], v[68:71]
    v_mfma_f32_16x16x32_bf16 v[12:15], v[236:239], v[116:119], v[12:15]
    ds_read_b128 v[224:227], v249 offset:4096
    v_mfma_f32_16x16x32_bf16 v[32:35], v[236:239], v[120:123], v[32:35]
    v_mfma_f32_16x16x32_bf16 v[52:55], v[236:239], v[124:127], v[52:55]
    s_add_u32 s59, s58, 36
    s_sub_u32 s42, s59, 54
    s_cselect_b32 s59, s59, s42
    s_mul_i32 s42, s59, 4096
    s_add_u32 s42, s42, s40
    buffer_load_dwordx4 v[100:103], v2, s[20:23], s42 offen offset:0 sc1
    v_mfma_f32_16x16x32_bf16 v[72:75], v[236:239], v[128:131], v[72:75]
    v_mfma_f32_16x16x32_bf16 v[16:19], v[240:243], v[116:119], v[16:19]
    buffer_load_dwordx4 v[104:107], v2, s[20:23], s42 offen offset:1024 sc1
    v_mfma_f32_16x16x32_bf16 v[36:39], v[240:243], v[120:123], v[36:39]
    v_mfma_f32_16x16x32_bf16 v[56:59], v[240:243], v[124:127], v[56:59]
    buffer_load_dwordx4 v[108:111], v2, s[20:23], s42 offen offset:2048 sc1
    v_mfma_f32_16x16x32_bf16 v[76:79], v[240:243], v[128:131], v[76:79]
    v_mfma_f32_16x16x32_bf16 v[20:23], v[244:247], v[116:119], v[20:23]
    buffer_load_dwordx4 v[112:115], v2, s[20:23], s42 offen offset:3072 sc1
    v_mfma_f32_16x16x32_bf16 v[40:43], v[244:247], v[120:123], v[40:43]
    v_mfma_f32_16x16x32_bf16 v[60:63], v[244:247], v[124:127], v[60:63]
    v_mfma_f32_16x16x32_bf16 v[80:83], v[244:247], v[128:131], v[80:83]
    s_waitcnt vmcnt(8)
    s_waitcnt lgkmcnt(0)
    v_mfma_f32_16x16x32_bf16 v[4:7], v[208:211], v[132:135], v[4:7]
    ds_read_b128 v[228:231], v249 offset:20480
    v_mfma_f32_16x16x32_bf16 v[24:27], v[208:211], v[136:139], v[24:27]
    v_mfma_f32_16x16x32_bf16 v[44:47], v[208:211], v[140:143], v[44:47]
    ds_read_b128 v[232:235], v249 offset:21504
    v_mfma_f32_16x16x32_bf16 v[64:67], v[208:211], v[144:147], v[64:67]
    v_mfma_f32_16x16x32_bf16 v[8:11], v[212:215], v[132:135], v[8:11]
    ds_read_b128 v[236:239], v249 offset:22528
    v_mfma_f32_16x16x32_bf16 v[28:31], v[212:215], v[136:139], v[28:31]
    v_mfma_f32_16x16x32_bf16 v[48:51], v[212:215], v[140:143], v[48:51]
    ds_read_b128 v[240:243], v249 offset:23552
    v_mfma_f32_16x16x32_bf16 v[68:71], v[212:215], v[144:147], v[68:71]
    v_mfma_f32_16x16x32_bf16 v[12:15], v[216:219], v[132:135], v[12:15]
    ds_read_b128 v[244:247], v249 offset:24576
    v_mfma_f32_16x16x32_bf16 v[32:35], v[216:219], v[136:139], v[32:35]
    v_mfma_f32_16x16x32_bf16 v[52:55], v[216:219], v[140:143], v[52:55]
    s_add_u32 s59, s58, 40
    s_sub_u32 s42, s59, 54
    s_cselect_b32 s59, s59, s42
    s_mul_i32 s42, s59, 4096
    s_add_u32 s42, s42, s40
    buffer_load_dwordx4 v[116:119], v2, s[20:23], s42 offen offset:0 sc1
    v_mfma_f32_16x16x32_bf16 v[72:75], v[216:219], v[144:147], v[72:75]
    v_mfma_f32_16x16x32_bf16 v[16:19], v[220:223], v[132:135], v[16:19]
    buffer_load_dwordx4 v[120:123], v2, s[20:23], s42 offen offset:1024 sc1
    v_mfma_f32_16x16x32_bf16 v[36:39], v[220:223], v[136:139], v[36:39]
    v_mfma_f32_16x16x32_bf16 v[56:59], v[220:223], v[140:143], v[56:59]
    buffer_load_dwordx4 v[124:127], v2, s[20:23], s42 offen offset:2048 sc1
    v_mfma_f32_16x16x32_bf16 v[76:79], v[220:223], v[144:147], v[76:79]
    v_mfma_f32_16x16x32_bf16 v[20:23], v[224:227], v[132:135], v[20:23]
    buffer_load_dwordx4 v[128:131], v2, s[20:23], s42 offen offset:3072 sc1
    v_mfma_f32_16x16x32_bf16 v[40:43], v[224:227], v[136:139], v[40:43]
    v_mfma_f32_16x16x32_bf16 v[60:63], v[224:227], v[140:143], v[60:63]
    v_mfma_f32_16x16x32_bf16 v[80:83], v[224:227], v[144:147], v[80:83]
    s_waitcnt vmcnt(8)
    s_waitcnt lgkmcnt(0)
    v_mfma_f32_16x16x32_bf16 v[4:7], v[228:231], v[84:87], v[4:7]
    ds_read_b128 v[208:211], v249 offset:40960
    v_mfma_f32_16x16x32_bf16 v[24:27], v[228:231], v[88:91], v[24:27]
    v_mfma_f32_16x16x32_bf16 v[44:47], v[228:231], v[92:95], v[44:47]
    ds_read_b128 v[212:215], v249 offset:41984
    v_mfma_f32_16x16x32_bf16 v[64:67], v[228:231], v[96:99], v[64:67]
    v_mfma_f32_16x16x32_bf16 v[8:11], v[232:235], v[84:87], v[8:11]
    ds_read_b128 v[216:219], v249 offset:43008
    v_mfma_f32_16x16x32_bf16 v[28:31], v[232:235], v[88:91], v[28:31]
    v_mfma_f32_16x16x32_bf16 v[48:51], v[232:235], v[92:95], v[48:51]
    ds_read_b128 v[220:223], v249 offset:44032
    v_mfma_f32_16x16x32_bf16 v[68:71], v[232:235], v[96:99], v[68:71]
    v_mfma_f32_16x16x32_bf16 v[12:15], v[236:239], v[84:87], v[12:15]
    ds_read_b128 v[224:227], v249 offset:45056
    v_mfma_f32_16x16x32_bf16 v[32:35], v[236:239], v[88:91], v[32:35]
    v_mfma_f32_16x16x32_bf16 v[52:55], v[236:239], v[92:95], v[52:55]
    s_add_u32 s59, s58, 44
    s_sub_u32 s42, s59, 54
    s_cselect_b32 s59, s59, s42
    s_mul_i32 s42, s59, 4096
    s_add_u32 s42, s42, s40
    buffer_load_dwordx4 v[132:135], v2, s[20:23], s42 offen offset:0 sc1
    v_mfma_f32_16x16x32_bf16 v[72:75], v[236:239], v[96:99], v[72:75]
    v_mfma_f32_16x16x32_bf16 v[16:19], v[240:243], v[84:87], v[16:19]
    buffer_load_dwordx4 v[136:139], v2, s[20:23], s42 offen offset:1024 sc1
    v_mfma_f32_16x16x32_bf16 v[36:39], v[240:243], v[88:91], v[36:39]
    v_mfma_f32_16x16x32_bf16 v[56:59], v[240:243], v[92:95], v[56:59]
    buffer_load_dwordx4 v[140:143], v2, s[20:23], s42 offen offset:2048 sc1
    v_mfma_f32_16x16x32_bf16 v[76:79], v[240:243], v[96:99], v[76:79]
    v_mfma_f32_16x16x32_bf16 v[20:23], v[244:247], v[84:87], v[20:23]
    buffer_load_dwordx4 v[144:147], v2, s[20:23], s42 offen offset:3072 sc1
    v_mfma_f32_16x16x32_bf16 v[40:43], v[244:247], v[88:91], v[40:43]
    v_mfma_f32_16x16x32_bf16 v[60:63], v[244:247], v[92:95], v[60:63]
    v_mfma_f32_16x16x32_bf16 v[80:83], v[244:247], v[96:99], v[80:83]
    s_waitcnt vmcnt(8)
    s_waitcnt lgkmcnt(0)
    v_mfma_f32_16x16x32_bf16 v[4:7], v[208:211], v[100:103], v[4:7]
    ds_read_b128 v[228:231], v250 offset:0
    v_mfma_f32_16x16x32_bf16 v[24:27], v[208:211], v[104:107], v[24:27]
    v_mfma_f32_16x16x32_bf16 v[44:47], v[208:211], v[108:111], v[44:47]
    ds_read_b128 v[232:235], v250 offset:1024
    v_mfma_f32_16x16x32_bf16 v[64:67], v[208:211], v[112:115], v[64:67]
    v_mfma_f32_16x16x32_bf16 v[8:11], v[212:215], v[100:103], v[8:11]
    ds_read_b128 v[236:239], v250 offset:2048
    v_mfma_f32_16x16x32_bf16 v[28:31], v[212:215], v[104:107], v[28:31]
    v_mfma_f32_16x16x32_bf16 v[48:51], v[212:215], v[108:111], v[48:51]
    ds_read_b128 v[240:243], v250 offset:3072
    v_mfma_f32_16x16x32_bf16 v[68:71], v[212:215], v[112:115], v[68:71]
    v_mfma_f32_16x16x32_bf16 v[12:15], v[216:219], v[100:103], v[12:15]
    ds_read_b128 v[244:247], v250 offset:4096
    v_mfma_f32_16x16x32_bf16 v[32:35], v[216:219], v[104:107], v[32:35]
    v_mfma_f32_16x16x32_bf16 v[52:55], v[216:219], v[108:111], v[52:55]
    s_add_u32 s59, s58, 48
    s_sub_u32 s42, s59, 54
    s_cselect_b32 s59, s59, s42
    s_mul_i32 s42, s59, 4096
    s_add_u32 s42, s42, s40
    buffer_load_dwordx4 v[84:87], v2, s[20:23], s42 offen offset:0 sc1
    v_mfma_f32_16x16x32_bf16 v[72:75], v[216:219], v[112:115], v[72:75]
    v_mfma_f32_16x16x32_bf16 v[16:19], v[220:223], v[100:103], v[16:19]
    buffer_load_dwordx4 v[88:91], v2, s[20:23], s42 offen offset:1024 sc1
    v_mfma_f32_16x16x32_bf16 v[36:39], v[220:223], v[104:107], v[36:39]
    v_mfma_f32_16x16x32_bf16 v[56:59], v[220:223], v[108:111], v[56:59]
    buffer_load_dwordx4 v[92:95], v2, s[20:23], s42 offen offset:2048 sc1
    v_mfma_f32_16x16x32_bf16 v[76:79], v[220:223], v[112:115], v[76:79]
    v_mfma_f32_16x16x32_bf16 v[20:23], v[224:227], v[100:103], v[20:23]
    buffer_load_dwordx4 v[96:99], v2, s[20:23], s42 offen offset:3072 sc1
    v_mfma_f32_16x16x32_bf16 v[40:43], v[224:227], v[104:107], v[40:43]
    v_mfma_f32_16x16x32_bf16 v[60:63], v[224:227], v[108:111], v[60:63]
    v_mfma_f32_16x16x32_bf16 v[80:83], v[224:227], v[112:115], v[80:83]
    s_waitcnt vmcnt(8)
    s_waitcnt lgkmcnt(0)
    v_mfma_f32_16x16x32_bf16 v[4:7], v[228:231], v[116:119], v[4:7]
    s_add_u32 s59, s58, 52
    s_sub_u32 s42, s59, 54
    s_cselect_b32 s59, s59, s42
    s_mul_i32 s42, s59, 4096
    s_add_u32 s42, s42, s40
    s_cmp_lt_u32 s35, 2
    s_cselect_b32 s42, s42, 2146435072
    buffer_load_dwordx4 v[100:103], v2, s[20:23], s42 offen offset:0 sc1
    v_mfma_f32_16x16x32_bf16 v[24:27], v[228:231], v[120:123], v[24:27]
    v_mfma_f32_16x16x32_bf16 v[44:47], v[228:231], v[124:127], v[44:47]
    v_mfma_f32_16x16x32_bf16 v[64:67], v[228:231], v[128:131], v[64:67]
    v_mfma_f32_16x16x32_bf16 v[8:11], v[232:235], v[116:119], v[8:11]
    buffer_load_dwordx4 v[104:107], v2, s[20:23], s42 offen offset:1024 sc1
    v_mfma_f32_16x16x32_bf16 v[28:31], v[232:235], v[120:123], v[28:31]
    v_mfma_f32_16x16x32_bf16 v[48:51], v[232:235], v[124:127], v[48:51]
    v_mfma_f32_16x16x32_bf16 v[68:71], v[232:235], v[128:131], v[68:71]
    v_mfma_f32_16x16x32_bf16 v[12:15], v[236:239], v[116:119], v[12:15]
    buffer_load_dwordx4 v[108:111], v2, s[20:23], s42 offen offset:2048 sc1
    v_mfma_f32_16x16x32_bf16 v[32:35], v[236:239], v[120:123], v[32:35]
    v_mfma_f32_16x16x32_bf16 v[52:55], v[236:239], v[124:127], v[52:55]
    v_mfma_f32_16x16x32_bf16 v[72:75], v[236:239], v[128:131], v[72:75]
    v_mfma_f32_16x16x32_bf16 v[16:19], v[240:243], v[116:119], v[16:19]
    buffer_load_dwordx4 v[112:115], v2, s[20:23], s42 offen offset:3072 sc1
    v_mfma_f32_16x16x32_bf16 v[36:39], v[240:243], v[120:123], v[36:39]
    v_mfma_f32_16x16x32_bf16 v[56:59], v[240:243], v[124:127], v[56:59]
    v_mfma_f32_16x16x32_bf16 v[76:79], v[240:243], v[128:131], v[76:79]
    v_mfma_f32_16x16x32_bf16 v[20:23], v[244:247], v[116:119], v[20:23]
    v_mfma_f32_16x16x32_bf16 v[40:43], v[244:247], v[120:123], v[40:43]
    v_mfma_f32_16x16x32_bf16 v[60:63], v[244:247], v[124:127], v[60:63]
    v_mfma_f32_16x16x32_bf16 v[80:83], v[244:247], v[128:131], v[80:83]
    s_waitcnt vmcnt(8)
    v_mfma_f32_16x16x32_bf16 v[4:7], v[148:151], v[132:135], v[4:7]
    v_mfma_f32_16x16x32_bf16 v[24:27], v[148:151], v[136:139], v[24:27]
    v_mfma_f32_16x16x32_bf16 v[44:47], v[148:151], v[140:143], v[44:47]
    v_mfma_f32_16x16x32_bf16 v[64:67], v[148:151], v[144:147], v[64:67]
    v_mfma_f32_16x16x32_bf16 v[8:11], v[152:155], v[132:135], v[8:11]
    v_mfma_f32_16x16x32_bf16 v[28:31], v[152:155], v[136:139], v[28:31]
    v_mfma_f32_16x16x32_bf16 v[48:51], v[152:155], v[140:143], v[48:51]
    v_mfma_f32_16x16x32_bf16 v[68:71], v[152:155], v[144:147], v[68:71]
    v_mfma_f32_16x16x32_bf16 v[12:15], v[156:159], v[132:135], v[12:15]
    v_mfma_f32_16x16x32_bf16 v[32:35], v[156:159], v[136:139], v[32:35]
    v_mfma_f32_16x16x32_bf16 v[52:55], v[156:159], v[140:143], v[52:55]
    v_mfma_f32_16x16x32_bf16 v[72:75], v[156:159], v[144:147], v[72:75]
    v_mfma_f32_16x16x32_bf16 v[16:19], v[160:163], v[132:135], v[16:19]
    v_mfma_f32_16x16x32_bf16 v[36:39], v[160:163], v[136:139], v[36:39]
    v_mfma_f32_16x16x32_bf16 v[56:59], v[160:163], v[140:143], v[56:59]
    v_mfma_f32_16x16x32_bf16 v[76:79], v[160:163], v[144:147], v[76:79]
    v_mfma_f32_16x16x32_bf16 v[20:23], v[164:167], v[132:135], v[20:23]
    v_mfma_f32_16x16x32_bf16 v[40:43], v[164:167], v[136:139], v[40:43]
    v_mfma_f32_16x16x32_bf16 v[60:63], v[164:167], v[140:143], v[60:63]
    v_mfma_f32_16x16x32_bf16 v[80:83], v[164:167], v[144:147], v[80:83]
    s_waitcnt vmcnt(4)
    v_mfma_f32_16x16x32_bf16 v[4:7], v[168:171], v[84:87], v[4:7]
    v_mfma_f32_16x16x32_bf16 v[24:27], v[168:171], v[88:91], v[24:27]
    v_mfma_f32_16x16x32_bf16 v[44:47], v[168:171], v[92:95], v[44:47]
    v_mfma_f32_16x16x32_bf16 v[64:67], v[168:171], v[96:99], v[64:67]
    v_mfma_f32_16x16x32_bf16 v[8:11], v[172:175], v[84:87], v[8:11]
    v_mfma_f32_16x16x32_bf16 v[28:31], v[172:175], v[88:91], v[28:31]
    v_mfma_f32_16x16x32_bf16 v[48:51], v[172:175], v[92:95], v[48:51]
    v_mfma_f32_16x16x32_bf16 v[68:71], v[172:175], v[96:99], v[68:71]
    v_mfma_f32_16x16x32_bf16 v[12:15], v[176:179], v[84:87], v[12:15]
    v_mfma_f32_16x16x32_bf16 v[32:35], v[176:179], v[88:91], v[32:35]
    v_mfma_f32_16x16x32_bf16 v[52:55], v[176:179], v[92:95], v[52:55]
    v_mfma_f32_16x16x32_bf16 v[72:75], v[176:179], v[96:99], v[72:75]
    v_mfma_f32_16x16x32_bf16 v[16:19], v[180:183], v[84:87], v[16:19]
    v_mfma_f32_16x16x32_bf16 v[36:39], v[180:183], v[88:91], v[36:39]
    v_mfma_f32_16x16x32_bf16 v[56:59], v[180:183], v[92:95], v[56:59]
    v_mfma_f32_16x16x32_bf16 v[76:79], v[180:183], v[96:99], v[76:79]
    v_mfma_f32_16x16x32_bf16 v[20:23], v[184:187], v[84:87], v[20:23]
    v_mfma_f32_16x16x32_bf16 v[40:43], v[184:187], v[88:91], v[40:43]
    v_mfma_f32_16x16x32_bf16 v[60:63], v[184:187], v[92:95], v[60:63]
    v_mfma_f32_16x16x32_bf16 v[80:83], v[184:187], v[96:99], v[80:83]
    s_waitcnt vmcnt(0)
    v_mfma_f32_16x16x32_bf16 v[4:7], v[188:191], v[100:103], v[4:7]
    v_mfma_f32_16x16x32_bf16 v[24:27], v[188:191], v[104:107], v[24:27]
    v_mfma_f32_16x16x32_bf16 v[44:47], v[188:191], v[108:111], v[44:47]
    v_mfma_f32_16x16x32_bf16 v[64:67], v[188:191], v[112:115], v[64:67]
    v_mfma_f32_16x16x32_bf16 v[8:11], v[192:195], v[100:103], v[8:11]
    v_mfma_f32_16x16x32_bf16 v[28:31], v[192:195], v[104:107], v[28:31]
    v_mfma_f32_16x16x32_bf16 v[48:51], v[192:195], v[108:111], v[48:51]
    v_mfma_f32_16x16x32_bf16 v[68:71], v[192:195], v[112:115], v[68:71]
    v_mfma_f32_16x16x32_bf16 v[12:15], v[196:199], v[100:103], v[12:15]
    v_mfma_f32_16x16x32_bf16 v[32:35], v[196:199], v[104:107], v[32:35]
    v_mfma_f32_16x16x32_bf16 v[52:55], v[196:199], v[108:111], v[52:55]
    v_mfma_f32_16x16x32_bf16 v[72:75], v[196:199], v[112:115], v[72:75]
    v_mfma_f32_16x16x32_bf16 v[16:19], v[200:203], v[100:103], v[16:19]
    v_mfma_f32_16x16x32_bf16 v[36:39], v[200:203], v[104:107], v[36:39]
    v_mfma_f32_16x16x32_bf16 v[56:59], v[200:203], v[108:111], v[56:59]
    v_mfma_f32_16x16x32_bf16 v[76:79], v[200:203], v[112:115], v[76:79]
    v_mfma_f32_16x16x32_bf16 v[20:23], v[204:207], v[100:103], v[20:23]
    v_mfma_f32_16x16x32_bf16 v[40:43], v[204:207], v[104:107], v[40:43]
    v_mfma_f32_16x16x32_bf16 v[60:63], v[204:207], v[108:111], v[60:63]
    v_mfma_f32_16x16x32_bf16 v[80:83], v[204:207], v[112:115], v[80:83]
    s_branch P2_red
P2_stream0:
    s_add_u32 s59, s58, 0
    s_sub_u32 s43, s59, 54
    s_cselect_b32 s59, s59, s43
    s_mul_i32 s43, s59, 5120
    s_add_u32 s43, s43, s41
    buffer_load_dwordx4 v[148:151], v2, s[20:23], s43 offen offset:0 sc1
    buffer_load_dwordx4 v[152:155], v2, s[20:23], s43 offen offset:1024 sc1
    buffer_load_dwordx4 v[156:159], v2, s[20:23], s43 offen offset:2048 sc1
    buffer_load_dwordx4 v[160:163], v2, s[20:23], s43 offen offset:3072 sc1
    buffer_load_dwordx4 v[164:167], v3, s[20:23], s43 offen sc1
    s_add_u32 s59, s58, 4
    s_sub_u32 s43, s59, 54
    s_cselect_b32 s59, s59, s43
    s_mul_i32 s43, s59, 5120
    s_add_u32 s43, s43, s41
    buffer_load_dwordx4 v[168:171], v2, s[20:23], s43 offen offset:0 sc1
    buffer_load_dwordx4 v[172:175], v2, s[20:23], s43 offen offset:1024 sc1
    buffer_load_dwordx4 v[176:179], v2, s[20:23], s43 offen offset:2048 sc1
    buffer_load_dwordx4 v[180:183], v2, s[20:23], s43 offen offset:3072 sc1
    buffer_load_dwordx4 v[184:187], v3, s[20:23], s43 offen sc1
    s_add_u32 s59, s58, 8
    s_sub_u32 s43, s59, 54
    s_cselect_b32 s59, s59, s43
    s_mul_i32 s43, s59, 5120
    s_add_u32 s43, s43, s41
    buffer_load_dwordx4 v[188:191], v2, s[20:23], s43 offen offset:0 sc1
    buffer_load_dwordx4 v[192:195], v2, s[20:23], s43 offen offset:1024 sc1
    buffer_load_dwordx4 v[196:199], v2, s[20:23], s43 offen offset:2048 sc1
    buffer_load_dwordx4 v[200:203], v2, s[20:23], s43 offen offset:3072 sc1
    buffer_load_dwordx4 v[204:207], v3, s[20:23], s43 offen sc1
    s_add_u32 s59, s58, 12
    s_sub_u32 s43, s59, 54
    s_cselect_b32 s59, s59, s43
    s_mul_i32 s43, s59, 5120
    s_add_u32 s43, s43, s41
    buffer_load_dwordx4 v[208:211], v2, s[20:23], s43 offen offset:0 sc1
    buffer_load_dwordx4 v[212:215], v2, s[20:23], s43 offen offset:1024 sc1
    buffer_load_dwordx4 v[216:219], v2, s[20:23], s43 offen offset:2048 sc1
    buffer_load_dwordx4 v[220:223], v2, s[20:23], s43 offen offset:3072 sc1
    buffer_load_dwordx4 v[224:227], v3, s[20:23], s43 offen sc1
    s_add_u32 s59, s58, 16
    s_sub_u32 s43, s59, 54
    s_cselect_b32 s59, s59, s43
    s_mul_i32 s43, s59, 5120
    s_add_u32 s43, s43, s41
    buffer_load_dwordx4 v[228:231], v2, s[20:23], s43 offen offset:0 sc1
    buffer_load_dwordx4 v[232:235], v2, s[20:23], s43 offen offset:1024 sc1
    buffer_load_dwordx4 v[236:239], v2, s[20:23], s43 offen offset:2048 sc1
    buffer_load_dwordx4 v[240:243], v2, s[20:23], s43 offen offset:3072 sc1
    buffer_load_dwordx4 v[244:247], v3, s[20:23], s43 offen sc1
    s_cmp_eq_u32 s35, 0
    s_cbranch_scc0 SBH_fol
    s_lshl_b32 s36, s32, 7
    s_add_u32 s36, s36, 20055040
    v_mov_b32 v4, 0
    s_mov_b32 s68, 100000
SBH_spin:
    buffer_load_dword v5, v4, s[20:23], s36 offen sc1
    s_waitcnt vmcnt(0)
SBH_chk:
    v_cmp_ne_u32 vcc, 1, v5
    s_cbranch_vccz SBH_out
    s_sub_u32 s68, s68, 1
    s_cbranch_scc1 SBH_out
    s_sleep 2
    s_branch SBH_spin
SBH_out:
    v_mov_b32 v4, 162816
    v_mov_b32 v5, 1
    s_mov_b64 exec, 1
    ds_add_u32 v4, v5 offset:12
    s_mov_b64 exec, -1
    s_branch SBH_done
SBH_fol:
    v_mov_b32 v4, 162816
    s_mov_b32 s68, 1000000
SBHF_spin:
    ds_read_b32 v5, v4 offset:12
    s_waitcnt lgkmcnt(0)
    v_cmp_ne_u32 vcc, 1, v5
    s_cbranch_vccz SBHF_out
    s_sub_u32 s68, s68, 1
    s_sleep 1
    s_cbranch_scc0 SBHF_spin
SBHF_out:
SBH_done:
    s_add_u32 s59, s58, 0
    s_sub_u32 s42, s59, 54
    s_cselect_b32 s59, s59, s42
    s_mul_i32 s42, s59, 4096
    s_add_u32 s42, s42, s40
    buffer_load_dwordx4 v[84:87], v2, s[20:23], s42 offen offset:0 sc1
    buffer_load_dwordx4 v[88:91], v2, s[20:23], s42 offen offset:1024 sc1
    buffer_load_dwordx4 v[92:95], v2, s[20:23], s42 offen offset:2048 sc1
    buffer_load_dwordx4 v[96:99], v2, s[20:23], s42 offen offset:3072 sc1
    s_add_u32 s59, s58, 4
    s_sub_u32 s42, s59, 54
    s_cselect_b32 s59, s59, s42
    s_mul_i32 s42, s59, 4096
    s_add_u32 s42, s42, s40
    buffer_load_dwordx4 v[100:103], v2, s[20:23], s42 offen offset:0 sc1
    buffer_load_dwordx4 v[104:107], v2, s[20:23], s42 offen offset:1024 sc1
    buffer_load_dwordx4 v[108:111], v2, s[20:23], s42 offen offset:2048 sc1
    buffer_load_dwordx4 v[112:115], v2, s[20:23], s42 offen offset:3072 sc1
    s_add_u32 s59, s58, 8
    s_sub_u32 s42, s59, 54
    s_cselect_b32 s59, s59, s42
    s_mul_i32 s42, s59, 4096
    s_add_u32 s42, s42, s40
    buffer_load_dwordx4 v[116:119], v2, s[20:23], s42 offen offset:0 sc1
    buffer_load_dwordx4 v[120:123], v2, s[20:23], s42 offen offset:1024 sc1
    buffer_load_dwordx4 v[124:127], v2, s[20:23], s42 offen offset:2048 sc1
    buffer_load_dwordx4 v[128:131], v2, s[20:23], s42 offen offset:3072 sc1
    s_add_u32 s59, s58, 12
    s_sub_u32 s42, s59, 54
    s_cselect_b32 s59, s59, s42
    s_mul_i32 s42, s59, 4096
    s_add_u32 s42, s42, s40
    buffer_load_dwordx4 v[132:135], v2, s[20:23], s42 offen offset:0 sc1
    buffer_load_dwordx4 v[136:139], v2, s[20:23], s42 offen offset:1024 sc1
    buffer_load_dwordx4 v[140:143], v2, s[20:23], s42 offen offset:2048 sc1
    buffer_load_dwordx4 v[144:147], v2, s[20:23], s42 offen offset:3072 sc1
    s_mov_b32 s68, 100000
    s_waitcnt vmcnt(12)
    v_mfma_f32_16x16x32_bf16 v[4:7], v[148:151], v[84:87], 0
    v_mfma_f32_16x16x32_bf16 v[24:27], v[148:151], v[88:91], 0
    v_mfma_f32_16x16x32_bf16 v[44:47], v[148:151], v[92:95], 0
    v_mfma_f32_16x16x32_bf16 v[64:67], v[148:151], v[96:99], 0
    v_mfma_f32_16x16x32_bf16 v[8:11], v[152:155], v[84:87], 0
    v_mfma_f32_16x16x32_bf16 v[28:31], v[152:155], v[88:91], 0
    v_mfma_f32_16x16x32_bf16 v[48:51], v[152:155], v[92:95], 0
    v_mfma_f32_16x16x32_bf16 v[68:71], v[152:155], v[96:99], 0
    v_mfma_f32_16x16x32_bf16 v[12:15], v[156:159], v[84:87], 0
    v_mfma_f32_16x16x32_bf16 v[32:35], v[156:159], v[88:91], 0
    v_mfma_f32_16x16x32_bf16 v[52:55], v[156:159], v[92:95], 0
    v_mfma_f32_16x16x32_bf16 v[72:75], v[156:159], v[96:99], 0
    v_mfma_f32_16x16x32_bf16 v[16:19], v[160:163], v[84:87], 0
    v_mfma_f32_16x16x32_bf16 v[36:39], v[160:163], v[88:91], 0
    v_mfma_f32_16x16x32_bf16 v[56:59], v[160:163], v[92:95], 0
    v_mfma_f32_16x16x32_bf16 v[76:79], v[160:163], v[96:99], 0
    v_mfma_f32_16x16x32_bf16 v[20:23], v[164:167], v[84:87], 0
    v_mfma_f32_16x16x32_bf16 v[40:43], v[164:167], v[88:91], 0
    v_mfma_f32_16x16x32_bf16 v[60:63], v[164:167], v[92:95], 0
    v_mfma_f32_16x16x32_bf16 v[80:83], v[164:167], v[96:99], 0
    s_waitcnt vmcnt(8)
    v_mfma_f32_16x16x32_bf16 v[4:7], v[168:171], v[100:103], v[4:7]
    s_add_u32 s59, s58, 16
    s_sub_u32 s42, s59, 54
    s_cselect_b32 s59, s59, s42
    s_mul_i32 s42, s59, 4096
    s_add_u32 s42, s42, s40
    buffer_load_dwordx4 v[84:87], v2, s[20:23], s42 offen offset:0 sc1
    v_mfma_f32_16x16x32_bf16 v[24:27], v[168:171], v[104:107], v[24:27]
    v_mfma_f32_16x16x32_bf16 v[44:47], v[168:171], v[108:111], v[44:47]
    buffer_load_dwordx4 v[88:91], v2, s[20:23], s42 offen offset:1024 sc1
    v_mfma_f32_16x16x32_bf16 v[64:67], v[168:171], v[112:115], v[64:67]
    v_mfma_f32_16x16x32_bf16 v[8:11], v[172:175], v[100:103], v[8:11]
    buffer_load_dwordx4 v[92:95], v2, s[20:23], s42 offen offset:2048 sc1
    v_mfma_f32_16x16x32_bf16 v[28:31], v[172:175], v[104:107], v[28:31]
    v_mfma_f32_16x16x32_bf16 v[48:51], v[172:175], v[108:111], v[48:51]
    buffer_load_dwordx4 v[96:99], v2, s[20:23], s42 offen offset:3072 sc1
    v_mfma_f32_16x16x32_bf16 v[68:71], v[172:175], v[112:115], v[68:71]
    v_mfma_f32_16x16x32_bf16 v[12:15], v[176:179], v[100:103], v[12:15]
    s_add_u32 s59, s58, 20
    s_sub_u32 s43, s59, 54
    s_cselect_b32 s59, s59, s43
    s_mul_i32 s43, s59, 5120
    s_add_u32 s43, s43, s41
    buffer_load_dwordx4 v[148:151], v2, s[20:23], s43 offen offset:0 sc1
    v_mfma_f32_16x16x32_bf16 v[32:35], v[176:179], v[104:107], v[32:35]
    v_mfma_f32_16x16x32_bf16 v[52:55], v[176:179], v[108:111], v[52:55]
    buffer_load_dwordx4 v[152:155], v2, s[20:23], s43 offen offset:1024 sc1
    v_mfma_f32_16x16x32_bf16 v[72:75], v[176:179], v[112:115], v[72:75]
    v_mfma_f32_16x16x32_bf16 v[16:19], v[180:183], v[100:103], v[16:19]
    buffer_load_dwordx4 v[156:159], v2, s[20:23], s43 offen offset:2048 sc1
    v_mfma_f32_16x16x32_bf16 v[36:39], v[180:183], v[104:107], v[36:39]
    v_mfma_f32_16x16x32_bf16 v[56:59], v[180:183], v[108:111], v[56:59]
    buffer_load_dwordx4 v[160:163], v2, s[20:23], s43 offen offset:3072 sc1
    v_mfma_f32_16x16x32_bf16 v[76:79], v[180:183], v[112:115], v[76:79]
    v_mfma_f32_16x16x32_bf16 v[20:23], v[184:187], v[100:103], v[20:23]
    buffer_load_dwordx4 v[164:167], v3, s[20:23], s43 offen sc1
    v_mfma_f32_16x16x32_bf16 v[40:43], v[184:187], v[104:107], v[40:43]
    v_mfma_f32_16x16x32_bf16 v[60:63], v[184:187], v[108:111], v[60:63]
    v_mfma_f32_16x16x32_bf16 v[80:83], v[184:187], v[112:115], v[80:83]
    s_waitcnt vmcnt(13)
    v_mfma_f32_16x16x32_bf16 v[4:7], v[188:191], v[116:119], v[4:7]
    s_add_u32 s59, s58, 20
    s_sub_u32 s42, s59, 54
    s_cselect_b32 s59, s59, s42
    s_mul_i32 s42, s59, 4096
    s_add_u32 s42, s42, s40
    buffer_load_dwordx4 v[100:103], v2, s[20:23], s42 offen offset:0 sc1
    v_mfma_f32_16x16x32_bf16 v[24:27], v[188:191], v[120:123], v[24:27]
    v_mfma_f32_16x16x32_bf16 v[44:47], v[188:191], v[124:127], v[44:47]
    buffer_load_dwordx4 v[104:107], v2, s[20:23], s42 offen offset:1024 sc1
    v_mfma_f32_16x16x32_bf16 v[64:67], v[188:191], v[128:131], v[64:67]
    v_mfma_f32_16x16x32_bf16 v[8:11], v[192:195], v[116:119], v[8:11]
    buffer_load_dwordx4 v[108:111], v2, s[20:23], s42 offen offset:2048 sc1
    v_mfma_f32_16x16x32_bf16 v[28:31], v[192:195], v[120:123], v[28:31]
    v_mfma_f32_16x16x32_bf16 v[48:51], v[192:195], v[124:127], v[48:51]
    buffer_load_dwordx4 v[112:115], v2, s[20:23], s42 offen offset:3072 sc1
    v_mfma_f32_16x16x32_bf16 v[68:71], v[192:195], v[128:131], v[68:71]
    v_mfma_f32_16x16x32_bf16 v[12:15], v[196:199], v[116:119], v[12:15]
    s_add_u32 s59, s58, 24
    s_sub_u32 s43, s59, 54
    s_cselect_b32 s59, s59, s43
    s_mul_i32 s43, s59, 5120
    s_add_u32 s43, s43, s41
    buffer_load_dwordx4 v[168:171], v2, s[20:23], s43 offen offset:0 sc1
    v_mfma_f32_16x16x32_bf16 v[32:35], v[196:199], v[120:123], v[32:35]
    v_mfma_f32_16x16x32_bf16 v[52:55], v[196:199], v[124:127], v[52:55]
    buffer_load_dwordx4 v[172:175], v2, s[20:23], s43 offen offset:1024 sc1
    v_mfma_f32_16x16x32_bf16 v[72:75], v[196:199], v[128:131], v[72:75]
    v_mfma_f32_16x16x32_bf16 v[16:19], v[200:203], v[116:119], v[16:19]
    buffer_load_dwordx4 v[176:179], v2, s[20:23], s43 offen offset:2048 sc1
    v_mfma_f32_16x16x32_bf16 v[36:39], v[200:203], v[120:123], v[36:39]
    v_mfma_f32_16x16x32_bf16 v[56:59], v[200:203], v[124:127], v[56:59]
    buffer_load_dwordx4 v[180:183], v2, s[20:23], s43 offen offset:3072 sc1
    v_mfma_f32_16x16x32_bf16 v[76:79], v[200:203], v[128:131], v[76:79]
    v_mfma_f32_16x16x32_bf16 v[20:23], v[204:207], v[116:119], v[20:23]
    buffer_load_dwordx4 v[184:187], v3, s[20:23], s43 offen sc1
    v_mfma_f32_16x16x32_bf16 v[40:43], v[204:207], v[120:123], v[40:43]
    v_mfma_f32_16x16x32_bf16 v[60:63], v[204:207], v[124:127], v[60:63]
    v_mfma_f32_16x16x32_bf16 v[80:83], v[204:207], v[128:131], v[80:83]
    s_waitcnt vmcnt(18)
    v_mfma_f32_16x16x32_bf16 v[4:7], v[208:211], v[132:135], v[4:7]
    s_add_u32 s59, s58, 24
    s_sub_u32 s42, s59, 54
    s_cselect_b32 s59, s59, s42
    s_mul_i32 s42, s59, 4096
    s_add_u32 s42, s42, s40
    buffer_load_dwordx4 v[116:119], v2, s[20:23], s42 offen offset:0 sc1
    v_mfma_f32_16x16x32_bf16 v[24:27], v[208:211], v[136:139], v[24:27]
    v_mfma_f32_16x16x32_bf16 v[44:47], v[208:211], v[140:143], v[44:47]
    buffer_load_dwordx4 v[120:123], v2, s[20:23], s42 offen offset:1024 sc1
    v_mfma_f32_16x16x32_bf16 v[64:67], v[208:211], v[144:147], v[64:67]
    v_mfma_f32_16x16x32_bf16 v[8:11], v[212:215], v[132:135], v[8:11]
    buffer_load_dwordx4 v[124:127], v2, s[20:23], s42 offen offset:2048 sc1
    v_mfma_f32_16x16x32_bf16 v[28:31], v[212:215], v[136:139], v[28:31]
    v_mfma_f32_16x16x32_bf16 v[48:51], v[212:215], v[140:143], v[48:51]
    buffer_load_dwordx4 v[128:131], v2, s[20:23], s42 offen offset:3072 sc1
    v_mfma_f32_16x16x32_bf16 v[68:71], v[212:215], v[144:147], v[68:71]
    v_mfma_f32_16x16x32_bf16 v[12:15], v[216:219], v[132:135], v[12:15]
    s_add_u32 s59, s58, 28
    s_sub_u32 s43, s59, 54
    s_cselect_b32 s59, s59, s43
    s_mul_i32 s43, s59, 5120
    s_add_u32 s43, s43, s41
    buffer_load_dwordx4 v[188:191], v2, s[20:23], s43 offen offset:0 sc1
    v_mfma_f32_16x16x32_bf16 v[32:35], v[216:219], v[136:139], v[32:35]
    v_mfma_f32_16x16x32_bf16 v[52:55], v[216:219], v[140:143], v[52:55]
    buffer_load_dwordx4 v[192:195], v2, s[20:23], s43 offen offset:1024 sc1
    v_mfma_f32_16x16x32_bf16 v[72:75], v[216:219], v[144:147], v[72:75]
    v_mfma_f32_16x16x32_bf16 v[16:19], v[220:223], v[132:135], v[16:19]
    buffer_load_dwordx4 v[196:199], v2, s[20:23], s43 offen offset:2048 sc1
    v_mfma_f32_16x16x32_bf16 v[36:39], v[220:223], v[136:139], v[36:39]
    v_mfma_f32_16x16x32_bf16 v[56:59], v[220:223], v[140:143], v[56:59]
    buffer_load_dwordx4 v[200:203], v2, s[20:23], s43 offen offset:3072 sc1
    v_mfma_f32_16x16x32_bf16 v[76:79], v[220:223], v[144:147], v[76:79]
    v_mfma_f32_16x16x32_bf16 v[20:23], v[224:227], v[132:135], v[20:23]
    buffer_load_dwordx4 v[204:207], v3, s[20:23], s43 offen sc1
    v_mfma_f32_16x16x32_bf16 v[40:43], v[224:227], v[136:139], v[40:43]
    v_mfma_f32_16x16x32_bf16 v[60:63], v[224:227], v[140:143], v[60:63]
    v_mfma_f32_16x16x32_bf16 v[80:83], v[224:227], v[144:147], v[80:83]
    s_waitcnt vmcnt(23)
    v_mfma_f32_16x16x32_bf16 v[4:7], v[228:231], v[84:87], v[4:7]
    s_add_u32 s59, s58, 28
    s_sub_u32 s42, s59, 54
    s_cselect_b32 s59, s59, s42
    s_mul_i32 s42, s59, 4096
    s_add_u32 s42, s42, s40
    buffer_load_dwordx4 v[132:135], v2, s[20:23], s42 offen offset:0 sc1
    v_mfma_f32_16x16x32_bf16 v[24:27], v[228:231], v[88:91], v[24:27]
    v_mfma_f32_16x16x32_bf16 v[44:47], v[228:231], v[92:95], v[44:47]
    buffer_load_dwordx4 v[136:139], v2, s[20:23], s42 offen offset:1024 sc1
    v_mfma_f32_16x16x32_bf16 v[64:67], v[228:231], v[96:99], v[64:67]
    v_mfma_f32_16x16x32_bf16 v[8:11], v[232:235], v[84:87], v[8:11]
    buffer_load_dwordx4 v[140:143], v2, s[20:23], s42 offen offset:2048 sc1
    v_mfma_f32_16x16x32_bf16 v[28:31], v[232:235], v[88:91], v[28:31]
    v_mfma_f32_16x16x32_bf16 v[48:51], v[232:235], v[92:95], v[48:51]
    buffer_load_dwordx4 v[144:147], v2, s[20:23], s42 offen offset:3072 sc1
    v_mfma_f32_16x16x32_bf16 v[68:71], v[232:235], v[96:99], v[68:71]
    v_mfma_f32_16x16x32_bf16 v[12:15], v[236:239], v[84:87], v[12:15]
    s_add_u32 s59, s58, 32
    s_sub_u32 s43, s59, 54
    s_cselect_b32 s59, s59, s43
    s_mul_i32 s43, s59, 5120
    s_add_u32 s43, s43, s41
    buffer_load_dwordx4 v[208:211], v2, s[20:23], s43 offen offset:0 sc1
    v_mfma_f32_16x16x32_bf16 v[32:35], v[236:239], v[88:91], v[32:35]
    v_mfma_f32_16x16x32_bf16 v[52:55], v[236:239], v[92:95], v[52:55]
    buffer_load_dwordx4 v[212:215], v2, s[20:23], s43 offen offset:1024 sc1
    v_mfma_f32_16x16x32_bf16 v[72:75], v[236:239], v[96:99], v[72:75]
    v_mfma_f32_16x16x32_bf16 v[16:19], v[240:243], v[84:87], v[16:19]
    buffer_load_dwordx4 v[216:219], v2, s[20:23], s43 offen offset:2048 sc1
    v_mfma_f32_16x16x32_bf16 v[36:39], v[240:243], v[88:91], v[36:39]
    v_mfma_f32_16x16x32_bf16 v[56:59], v[240:243], v[92:95], v[56:59]
    buffer_load_dwordx4 v[220:223], v2, s[20:23], s43 offen offset:3072 sc1
    v_mfma_f32_16x16x32_bf16 v[76:79], v[240:243], v[96:99], v[76:79]
    v_mfma_f32_16x16x32_bf16 v[20:23], v[244:247], v[84:87], v[20:23]
    buffer_load_dwordx4 v[224:227], v3, s[20:23], s43 offen sc1
    v_mfma_f32_16x16x32_bf16 v[40:43], v[244:247], v[88:91], v[40:43]
    v_mfma_f32_16x16x32_bf16 v[60:63], v[244:247], v[92:95], v[60:63]
    v_mfma_f32_16x16x32_bf16 v[80:83], v[244:247], v[96:99], v[80:83]
    s_waitcnt vmcnt(23)
    v_mfma_f32_16x16x32_bf16 v[4:7], v[148:151], v[100:103], v[4:7]
    s_add_u32 s59, s58, 32
    s_sub_u32 s42, s59, 54
    s_cselect_b32 s59, s59, s42
    s_mul_i32 s42, s59, 4096
    s_add_u32 s42, s42, s40
    buffer_load_dwordx4 v[84:87], v2, s[20:23], s42 offen offset:0 sc1
    v_mfma_f32_16x16x32_bf16 v[24:27], v[148:151], v[104:107], v[24:27]
    v_mfma_f32_16x16x32_bf16 v[44:47], v[148:151], v[108:111], v[44:47]
    buffer_load_dwordx4 v[88:91], v2, s[20:23], s42 offen offset:1024 sc1
    v_mfma_f32_16x16x32_bf16 v[64:67], v[148:151], v[112:115], v[64:67]
    v_mfma_f32_16x16x32_bf16 v[8:11], v[152:155], v[100:103], v[8:11]
    buffer_load_dwordx4 v[92:95], v2, s[20:23], s42 offen offset:2048 sc1
    v_mfma_f32_16x16x32_bf16 v[28:31], v[152:155], v[104:107], v[28:31]
    v_mfma_f32_16x16x32_bf16 v[48:51], v[152:155], v[108:111], v[48:51]
    buffer_load_dwordx4 v[96:99], v2, s[20:23], s42 offen offset:3072 sc1
    v_mfma_f32_16x16x32_bf16 v[68:71], v[152:155], v[112:115], v[68:71]
    v_mfma_f32_16x16x32_bf16 v[12:15], v[156:159], v[100:103], v[12:15]
    s_add_u32 s59, s58, 36
    s_sub_u32 s43, s59, 54
    s_cselect_b32 s59, s59, s43
    s_mul_i32 s43, s59, 5120
    s_add_u32 s43, s43, s41
    buffer_load_dwordx4 v[228:231], v2, s[20:23], s43 offen offset:0 sc1
    v_mfma_f32_16x16x32_bf16 v[32:35], v[156:159], v[104:107], v[32:35]
    v_mfma_f32_16x16x32_bf16 v[52:55], v[156:159], v[108:111], v[52:55]
    buffer_load_dwordx4 v[232:235], v2, s[20:23], s43 offen offset:1024 sc1
    v_mfma_f32_16x16x32_bf16 v[72:75], v[156:159], v[112:115], v[72:75]
    v_mfma_f32_16x16x32_bf16 v[16:19], v[160:163], v[100:103], v[16:19]
    buffer_load_dwordx4 v[236:239], v2, s[20:23], s43 offen offset:2048 sc1
    v_mfma_f32_16x16x32_bf16 v[36:39], v[160:163], v[104:107], v[36:39]
    v_mfma_f32_16x16x32_bf16 v[56:59], v[160:163], v[108:111], v[56:59]
    buffer_load_dwordx4 v[240:243], v2, s[20:23], s43 offen offset:3072 sc1
    v_mfma_f32_16x16x32_bf16 v[76:79], v[160:163], v[112:115], v[76:79]
    v_mfma_f32_16x16x32_bf16 v[20:23], v[164:167], v[100:103], v[20:23]
    buffer_load_dwordx4 v[244:247], v3, s[20:23], s43 offen sc1
    v_mfma_f32_16x16x32_bf16 v[40:43], v[164:167], v[104:107], v[40:43]
    v_mfma_f32_16x16x32_bf16 v[60:63], v[164:167], v[108:111], v[60:63]
    v_mfma_f32_16x16x32_bf16 v[80:83], v[164:167], v[112:115], v[80:83]
    s_waitcnt vmcnt(23)
    v_mfma_f32_16x16x32_bf16 v[4:7], v[168:171], v[116:119], v[4:7]
    s_add_u32 s59, s58, 36
    s_sub_u32 s42, s59, 54
    s_cselect_b32 s59, s59, s42
    s_mul_i32 s42, s59, 4096
    s_add_u32 s42, s42, s40
    buffer_load_dwordx4 v[100:103], v2, s[20:23], s42 offen offset:0 sc1
    v_mfma_f32_16x16x32_bf16 v[24:27], v[168:171], v[120:123], v[24:27]
    v_mfma_f32_16x16x32_bf16 v[44:47], v[168:171], v[124:127], v[44:47]
    buffer_load_dwordx4 v[104:107], v2, s[20:23], s42 offen offset:1024 sc1
    v_mfma_f32_16x16x32_bf16 v[64:67], v[168:171], v[128:131], v[64:67]
    v_mfma_f32_16x16x32_bf16 v[8:11], v[172:175], v[116:119], v[8:11]
    buffer_load_dwordx4 v[108:111], v2, s[20:23], s42 offen offset:2048 sc1
    v_mfma_f32_16x16x32_bf16 v[28:31], v[172:175], v[120:123], v[28:31]
    v_mfma_f32_16x16x32_bf16 v[48:51], v[172:175], v[124:127], v[48:51]
    buffer_load_dwordx4 v[112:115], v2, s[20:23], s42 offen offset:3072 sc1
    v_mfma_f32_16x16x32_bf16 v[68:71], v[172:175], v[128:131], v[68:71]
    v_mfma_f32_16x16x32_bf16 v[12:15], v[176:179], v[116:119], v[12:15]
    s_add_u32 s59, s58, 40
    s_sub_u32 s43, s59, 54
    s_cselect_b32 s59, s59, s43
    s_mul_i32 s43, s59, 5120
    s_add_u32 s43, s43, s41
    buffer_load_dwordx4 v[148:151], v2, s[20:23], s43 offen offset:0 sc1
    v_mfma_f32_16x16x32_bf16 v[32:35], v[176:179], v[120:123], v[32:35]
    v_mfma_f32_16x16x32_bf16 v[52:55], v[176:179], v[124:127], v[52:55]
    buffer_load_dwordx4 v[152:155], v2, s[20:23], s43 offen offset:1024 sc1
    v_mfma_f32_16x16x32_bf16 v[72:75], v[176:179], v[128:131], v[72:75]
    v_mfma_f32_16x16x32_bf16 v[16:19], v[180:183], v[116:119], v[16:19]
    buffer_load_dwordx4 v[156:159], v2, s[20:23], s43 offen offset:2048 sc1
    v_mfma_f32_16x16x32_bf16 v[36:39], v[180:183], v[120:123], v[36:39]
    v_mfma_f32_16x16x32_bf16 v[56:59], v[180:183], v[124:127], v[56:59]
    buffer_load_dwordx4 v[160:163], v2, s[20:23], s43 offen offset:3072 sc1
    v_mfma_f32_16x16x32_bf16 v[76:79], v[180:183], v[128:131], v[76:79]
    v_mfma_f32_16x16x32_bf16 v[20:23], v[184:187], v[116:119], v[20:23]
    buffer_load_dwordx4 v[164:167], v3, s[20:23], s43 offen sc1
    v_mfma_f32_16x16x32_bf16 v[40:43], v[184:187], v[120:123], v[40:43]
    v_mfma_f32_16x16x32_bf16 v[60:63], v[184:187], v[124:127], v[60:63]
    v_mfma_f32_16x16x32_bf16 v[80:83], v[184:187], v[128:131], v[80:83]
    s_waitcnt vmcnt(23)
    v_mfma_f32_16x16x32_bf16 v[4:7], v[188:191], v[132:135], v[4:7]
    s_add_u32 s59, s58, 40
    s_sub_u32 s42, s59, 54
    s_cselect_b32 s59, s59, s42
    s_mul_i32 s42, s59, 4096
    s_add_u32 s42, s42, s40
    buffer_load_dwordx4 v[116:119], v2, s[20:23], s42 offen offset:0 sc1
    v_mfma_f32_16x16x32_bf16 v[24:27], v[188:191], v[136:139], v[24:27]
    v_mfma_f32_16x16x32_bf16 v[44:47], v[188:191], v[140:143], v[44:47]
    buffer_load_dwordx4 v[120:123], v2, s[20:23], s42 offen offset:1024 sc1
    v_mfma_f32_16x16x32_bf16 v[64:67], v[188:191], v[144:147], v[64:67]
    v_mfma_f32_16x16x32_bf16 v[8:11], v[192:195], v[132:135], v[8:11]
    buffer_load_dwordx4 v[124:127], v2, s[20:23], s42 offen offset:2048 sc1
    v_mfma_f32_16x16x32_bf16 v[28:31], v[192:195], v[136:139], v[28:31]
    v_mfma_f32_16x16x32_bf16 v[48:51], v[192:195], v[140:143], v[48:51]
    buffer_load_dwordx4 v[128:131], v2, s[20:23], s42 offen offset:3072 sc1
    v_mfma_f32_16x16x32_bf16 v[68:71], v[192:195], v[144:147], v[68:71]
    v_mfma_f32_16x16x32_bf16 v[12:15], v[196:199], v[132:135], v[12:15]
    s_add_u32 s59, s58, 44
    s_sub_u32 s43, s59, 54
    s_cselect_b32 s59, s59, s43
    s_mul_i32 s43, s59, 5120
    s_add_u32 s43, s43, s41
    buffer_load_dwordx4 v[168:171], v2, s[20:23], s43 offen offset:0 sc1
    v_mfma_f32_16x16x32_bf16 v[32:35], v[196:199], v[136:139], v[32:35]
    v_mfma_f32_16x16x32_bf16 v[52:55], v[196:199], v[140:143], v[52:55]
    buffer_load_dwordx4 v[172:175], v2, s[20:23], s43 offen offset:1024 sc1
    v_mfma_f32_16x16x32_bf16 v[72:75], v[196:199], v[144:147], v[72:75]
    v_mfma_f32_16x16x32_bf16 v[16:19], v[200:203], v[132:135], v[16:19]
    buffer_load_dwordx4 v[176:179], v2, s[20:23], s43 offen offset:2048 sc1
    v_mfma_f32_16x16x32_bf16 v[36:39], v[200:203], v[136:139], v[36:39]
    v_mfma_f32_16x16x32_bf16 v[56:59], v[200:203], v[140:143], v[56:59]
    buffer_load_dwordx4 v[180:183], v2, s[20:23], s43 offen offset:3072 sc1
    v_mfma_f32_16x16x32_bf16 v[76:79], v[200:203], v[144:147], v[76:79]
    v_mfma_f32_16x16x32_bf16 v[20:23], v[204:207], v[132:135], v[20:23]
    buffer_load_dwordx4 v[184:187], v3, s[20:23], s43 offen sc1
    v_mfma_f32_16x16x32_bf16 v[40:43], v[204:207], v[136:139], v[40:43]
    v_mfma_f32_16x16x32_bf16 v[60:63], v[204:207], v[140:143], v[60:63]
    v_mfma_f32_16x16x32_bf16 v[80:83], v[204:207], v[144:147], v[80:83]
    s_waitcnt vmcnt(23)
    v_mfma_f32_16x16x32_bf16 v[4:7], v[208:211], v[84:87], v[4:7]
    s_add_u32 s59, s58, 44
    s_sub_u32 s42, s59, 54
    s_cselect_b32 s59, s59, s42
    s_mul_i32 s42, s59, 4096
    s_add_u32 s42, s42, s40
    buffer_load_dwordx4 v[132:135], v2, s[20:23], s42 offen offset:0 sc1
    v_mfma_f32_16x16x32_bf16 v[24:27], v[208:211], v[88:91], v[24:27]
    v_mfma_f32_16x16x32_bf16 v[44:47], v[208:211], v[92:95], v[44:47]
    buffer_load_dwordx4 v[136:139], v2, s[20:23], s42 offen offset:1024 sc1
    v_mfma_f32_16x16x32_bf16 v[64:67], v[208:211], v[96:99], v[64:67]
    v_mfma_f32_16x16x32_bf16 v[8:11], v[212:215], v[84:87], v[8:11]
    buffer_load_dwordx4 v[140:143], v2, s[20:23], s42 offen offset:2048 sc1
    v_mfma_f32_16x16x32_bf16 v[28:31], v[212:215], v[88:91], v[28:31]
    v_mfma_f32_16x16x32_bf16 v[48:51], v[212:215], v[92:95], v[48:51]
    buffer_load_dwordx4 v[144:147], v2, s[20:23], s42 offen offset:3072 sc1
    v_mfma_f32_16x16x32_bf16 v[68:71], v[212:215], v[96:99], v[68:71]
    v_mfma_f32_16x16x32_bf16 v[12:15], v[216:219], v[84:87], v[12:15]
    s_add_u32 s59, s58, 48
    s_sub_u32 s43, s59, 54
    s_cselect_b32 s59, s59, s43
    s_mul_i32 s43, s59, 5120
    s_add_u32 s43, s43, s41
    buffer_load_dwordx4 v[188:191], v2, s[20:23], s43 offen offset:0 sc1
    v_mfma_f32_16x16x32_bf16 v[32:35], v[216:219], v[88:91], v[32:35]
    v_mfma_f32_16x16x32_bf16 v[52:55], v[216:219], v[92:95], v[52:55]
    buffer_load_dwordx4 v[192:195], v2, s[20:23], s43 offen offset:1024 sc1
    v_mfma_f32_16x16x32_bf16 v[72:75], v[216:219], v[96:99], v[72:75]
    v_mfma_f32_16x16x32_bf16 v[16:19], v[220:223], v[84:87], v[16:19]
    buffer_load_dwordx4 v[196:199], v2, s[20:23], s43 offen offset:2048 sc1
    v_mfma_f32_16x16x32_bf16 v[36:39], v[220:223], v[88:91], v[36:39]
    v_mfma_f32_16x16x32_bf16 v[56:59], v[220:223], v[92:95], v[56:59]
    buffer_load_dwordx4 v[200:203], v2, s[20:23], s43 offen offset:3072 sc1
    v_mfma_f32_16x16x32_bf16 v[76:79], v[220:223], v[96:99], v[76:79]
    v_mfma_f32_16x16x32_bf16 v[20:23], v[224:227], v[84:87], v[20:23]
    buffer_load_dwordx4 v[204:207], v3, s[20:23], s43 offen sc1
    v_mfma_f32_16x16x32_bf16 v[40:43], v[224:227], v[88:91], v[40:43]
    v_mfma_f32_16x16x32_bf16 v[60:63], v[224:227], v[92:95], v[60:63]
    v_mfma_f32_16x16x32_bf16 v[80:83], v[224:227], v[96:99], v[80:83]
    s_waitcnt vmcnt(23)
    v_mfma_f32_16x16x32_bf16 v[4:7], v[228:231], v[100:103], v[4:7]
    s_add_u32 s59, s58, 48
    s_sub_u32 s42, s59, 54
    s_cselect_b32 s59, s59, s42
    s_mul_i32 s42, s59, 4096
    s_add_u32 s42, s42, s40
    buffer_load_dwordx4 v[84:87], v2, s[20:23], s42 offen offset:0 sc1
    v_mfma_f32_16x16x32_bf16 v[24:27], v[228:231], v[104:107], v[24:27]
    v_mfma_f32_16x16x32_bf16 v[44:47], v[228:231], v[108:111], v[44:47]
    buffer_load_dwordx4 v[88:91], v2, s[20:23], s42 offen offset:1024 sc1
    v_mfma_f32_16x16x32_bf16 v[64:67], v[228:231], v[112:115], v[64:67]
    v_mfma_f32_16x16x32_bf16 v[8:11], v[232:235], v[100:103], v[8:11]
    buffer_load_dwordx4 v[92:95], v2, s[20:23], s42 offen offset:2048 sc1
    v_mfma_f32_16x16x32_bf16 v[28:31], v[232:235], v[104:107], v[28:31]
    v_mfma_f32_16x16x32_bf16 v[48:51], v[232:235], v[108:111], v[48:51]
    buffer_load_dwordx4 v[96:99], v2, s[20:23], s42 offen offset:3072 sc1
    v_mfma_f32_16x16x32_bf16 v[68:71], v[232:235], v[112:115], v[68:71]
    v_mfma_f32_16x16x32_bf16 v[12:15], v[236:239], v[100:103], v[12:15]
    s_add_u32 s59, s58, 52
    s_sub_u32 s43, s59, 54
    s_cselect_b32 s59, s59, s43
    s_mul_i32 s43, s59, 5120
    s_add_u32 s43, s43, s41
    s_cmp_lt_u32 s35, 2
    s_cselect_b32 s43, s43, 2146435072
    buffer_load_dwordx4 v[208:211], v2, s[20:23], s43 offen offset:0 sc1
    v_mfma_f32_16x16x32_bf16 v[32:35], v[236:239], v[104:107], v[32:35]
    v_mfma_f32_16x16x32_bf16 v[52:55], v[236:239], v[108:111], v[52:55]
    buffer_load_dwordx4 v[212:215], v2, s[20:23], s43 offen offset:1024 sc1
    v_mfma_f32_16x16x32_bf16 v[72:75], v[236:239], v[112:115], v[72:75]
    v_mfma_f32_16x16x32_bf16 v[16:19], v[240:243], v[100:103], v[16:19]
    buffer_load_dwordx4 v[216:219], v2, s[20:23], s43 offen offset:2048 sc1
    v_mfma_f32_16x16x32_bf16 v[36:39], v[240:243], v[104:107], v[36:39]
    v_mfma_f32_16x16x32_bf16 v[56:59], v[240:243], v[108:111], v[56:59]
    buffer_load_dwordx4 v[220:223], v2, s[20:23], s43 offen offset:3072 sc1
    v_mfma_f32_16x16x32_bf16 v[76:79], v[240:243], v[112:115], v[76:79]
    v_mfma_f32_16x16x32_bf16 v[20:23], v[244:247], v[100:103], v[20:23]
    buffer_load_dwordx4 v[224:227], v3, s[20:23], s43 offen sc1
    v_mfma_f32_16x16x32_bf16 v[40:43], v[244:247], v[104:107], v[40:43]
    v_mfma_f32_16x16x32_bf16 v[60:63], v[244:247], v[108:111], v[60:63]
    v_mfma_f32_16x16x32_bf16 v[80:83], v[244:247], v[112:115], v[80:83]
    s_waitcnt vmcnt(23)
    v_mfma_f32_16x16x32_bf16 v[4:7], v[148:151], v[116:119], v[4:7]
    s_add_u32 s59, s58, 52
    s_sub_u32 s42, s59, 54
    s_cselect_b32 s59, s59, s42
    s_mul_i32 s42, s59, 4096
    s_add_u32 s42, s42, s40
    s_cmp_lt_u32 s35, 2
    s_cselect_b32 s42, s42, 2146435072
    buffer_load_dwordx4 v[100:103], v2, s[20:23], s42 offen offset:0 sc1
    v_mfma_f32_16x16x32_bf16 v[24:27], v[148:151], v[120:123], v[24:27]
    v_mfma_f32_16x16x32_bf16 v[44:47], v[148:151], v[124:127], v[44:47]
    v_mfma_f32_16x16x32_bf16 v[64:67], v[148:151], v[128:131], v[64:67]
    v_mfma_f32_16x16x32_bf16 v[8:11], v[152:155], v[116:119], v[8:11]
    buffer_load_dwordx4 v[104:107], v2, s[20:23], s42 offen offset:1024 sc1
    v_mfma_f32_16x16x32_bf16 v[28:31], v[152:155], v[120:123], v[28:31]
    v_mfma_f32_16x16x32_bf16 v[48:51], v[152:155], v[124:127], v[48:51]
    v_mfma_f32_16x16x32_bf16 v[68:71], v[152:155], v[128:131], v[68:71]
    v_mfma_f32_16x16x32_bf16 v[12:15], v[156:159], v[116:119], v[12:15]
    buffer_load_dwordx4 v[108:111], v2, s[20:23], s42 offen offset:2048 sc1
    v_mfma_f32_16x16x32_bf16 v[32:35], v[156:159], v[120:123], v[32:35]
    v_mfma_f32_16x16x32_bf16 v[52:55], v[156:159], v[124:127], v[52:55]
    v_mfma_f32_16x16x32_bf16 v[72:75], v[156:159], v[128:131], v[72:75]
    v_mfma_f32_16x16x32_bf16 v[16:19], v[160:163], v[116:119], v[16:19]
    buffer_load_dwordx4 v[112:115], v2, s[20:23], s42 offen offset:3072 sc1
    v_mfma_f32_16x16x32_bf16 v[36:39], v[160:163], v[120:123], v[36:39]
    v_mfma_f32_16x16x32_bf16 v[56:59], v[160:163], v[124:127], v[56:59]
    v_mfma_f32_16x16x32_bf16 v[76:79], v[160:163], v[128:131], v[76:79]
    v_mfma_f32_16x16x32_bf16 v[20:23], v[164:167], v[116:119], v[20:23]
    v_mfma_f32_16x16x32_bf16 v[40:43], v[164:167], v[120:123], v[40:43]
    v_mfma_f32_16x16x32_bf16 v[60:63], v[164:167], v[124:127], v[60:63]
    v_mfma_f32_16x16x32_bf16 v[80:83], v[164:167], v[128:131], v[80:83]
    s_waitcnt vmcnt(18)
    v_mfma_f32_16x16x32_bf16 v[4:7], v[168:171], v[132:135], v[4:7]
    v_mfma_f32_16x16x32_bf16 v[24:27], v[168:171], v[136:139], v[24:27]
    v_mfma_f32_16x16x32_bf16 v[44:47], v[168:171], v[140:143], v[44:47]
    v_mfma_f32_16x16x32_bf16 v[64:67], v[168:171], v[144:147], v[64:67]
    v_mfma_f32_16x16x32_bf16 v[8:11], v[172:175], v[132:135], v[8:11]
    v_mfma_f32_16x16x32_bf16 v[28:31], v[172:175], v[136:139], v[28:31]
    v_mfma_f32_16x16x32_bf16 v[48:51], v[172:175], v[140:143], v[48:51]
    v_mfma_f32_16x16x32_bf16 v[68:71], v[172:175], v[144:147], v[68:71]
    v_mfma_f32_16x16x32_bf16 v[12:15], v[176:179], v[132:135], v[12:15]
    v_mfma_f32_16x16x32_bf16 v[32:35], v[176:179], v[136:139], v[32:35]
    v_mfma_f32_16x16x32_bf16 v[52:55], v[176:179], v[140:143], v[52:55]
    v_mfma_f32_16x16x32_bf16 v[72:75], v[176:179], v[144:147], v[72:75]
    v_mfma_f32_16x16x32_bf16 v[16:19], v[180:183], v[132:135], v[16:19]
    v_mfma_f32_16x16x32_bf16 v[36:39], v[180:183], v[136:139], v[36:39]
    v_mfma_f32_16x16x32_bf16 v[56:59], v[180:183], v[140:143], v[56:59]
    v_mfma_f32_16x16x32_bf16 v[76:79], v[180:183], v[144:147], v[76:79]
    v_mfma_f32_16x16x32_bf16 v[20:23], v[184:187], v[132:135], v[20:23]
    v_mfma_f32_16x16x32_bf16 v[40:43], v[184:187], v[136:139], v[40:43]
    v_mfma_f32_16x16x32_bf16 v[60:63], v[184:187], v[140:143], v[60:63]
    v_mfma_f32_16x16x32_bf16 v[80:83], v[184:187], v[144:147], v[80:83]
    s_waitcnt vmcnt(9)
    v_mfma_f32_16x16x32_bf16 v[4:7], v[188:191], v[84:87], v[4:7]
    v_mfma_f32_16x16x32_bf16 v[24:27], v[188:191], v[88:91], v[24:27]
    v_mfma_f32_16x16x32_bf16 v[44:47], v[188:191], v[92:95], v[44:47]
    v_mfma_f32_16x16x32_bf16 v[64:67], v[188:191], v[96:99], v[64:67]
    v_mfma_f32_16x16x32_bf16 v[8:11], v[192:195], v[84:87], v[8:11]
    v_mfma_f32_16x16x32_bf16 v[28:31], v[192:195], v[88:91], v[28:31]
    v_mfma_f32_16x16x32_bf16 v[48:51], v[192:195], v[92:95], v[48:51]
    v_mfma_f32_16x16x32_bf16 v[68:71], v[192:195], v[96:99], v[68:71]
    v_mfma_f32_16x16x32_bf16 v[12:15], v[196:199], v[84:87], v[12:15]
    v_mfma_f32_16x16x32_bf16 v[32:35], v[196:199], v[88:91], v[32:35]
    v_mfma_f32_16x16x32_bf16 v[52:55], v[196:199], v[92:95], v[52:55]
    v_mfma_f32_16x16x32_bf16 v[72:75], v[196:199], v[96:99], v[72:75]
    v_mfma_f32_16x16x32_bf16 v[16:19], v[200:203], v[84:87], v[16:19]
    v_mfma_f32_16x16x32_bf16 v[36:39], v[200:203], v[88:91], v[36:39]
    v_mfma_f32_16x16x32_bf16 v[56:59], v[200:203], v[92:95], v[56:59]
    v_mfma_f32_16x16x32_bf16 v[76:79], v[200:203], v[96:99], v[76:79]
    v_mfma_f32_16x16x32_bf16 v[20:23], v[204:207], v[84:87], v[20:23]
    v_mfma_f32_16x16x32_bf16 v[40:43], v[204:207], v[88:91], v[40:43]
    v_mfma_f32_16x16x32_bf16 v[60:63], v[204:207], v[92:95], v[60:63]
    v_mfma_f32_16x16x32_bf16 v[80:83], v[204:207], v[96:99], v[80:83]
    s_waitcnt vmcnt(0)
    v_mfma_f32_16x16x32_bf16 v[4:7], v[208:211], v[100:103], v[4:7]
    v_mfma_f32_16x16x32_bf16 v[24:27], v[208:211], v[104:107], v[24:27]
    v_mfma_f32_16x16x32_bf16 v[44:47], v[208:211], v[108:111], v[44:47]
    v_mfma_f32_16x16x32_bf16 v[64:67], v[208:211], v[112:115], v[64:67]
    v_mfma_f32_16x16x32_bf16 v[8:11], v[212:215], v[100:103], v[8:11]
    v_mfma_f32_16x16x32_bf16 v[28:31], v[212:215], v[104:107], v[28:31]
    v_mfma_f32_16x16x32_bf16 v[48:51], v[212:215], v[108:111], v[48:51]
    v_mfma_f32_16x16x32_bf16 v[68:71], v[212:215], v[112:115], v[68:71]
    v_mfma_f32_16x16x32_bf16 v[12:15], v[216:219], v[100:103], v[12:15]
    v_mfma_f32_16x16x32_bf16 v[32:35], v[216:219], v[104:107], v[32:35]
    v_mfma_f32_16x16x32_bf16 v[52:55], v[216:219], v[108:111], v[52:55]
    v_mfma_f32_16x16x32_bf16 v[72:75], v[216:219], v[112:115], v[72:75]
    v_mfma_f32_16x16x32_bf16 v[16:19], v[220:223], v[100:103], v[16:19]
    v_mfma_f32_16x16x32_bf16 v[36:39], v[220:223], v[104:107], v[36:39]
    v_mfma_f32_16x16x32_bf16 v[56:59], v[220:223], v[108:111], v[56:59]
    v_mfma_f32_16x16x32_bf16 v[76:79], v[220:223], v[112:115], v[76:79]
    v_mfma_f32_16x16x32_bf16 v[20:23], v[224:227], v[100:103], v[20:23]
    v_mfma_f32_16x16x32_bf16 v[40:43], v[224:227], v[104:107], v[40:43]
    v_mfma_f32_16x16x32_bf16 v[60:63], v[224:227], v[108:111], v[60:63]
    v_mfma_f32_16x16x32_bf16 v[80:83], v[224:227], v[112:115], v[80:83]
    v_mov_b32 v251, 162816
    s_mov_b32 s68, 1000000
SK_spin:
    ds_read_b32 v252, v251 offset:0
    s_waitcnt lgkmcnt(0)
    v_cmp_ne_u32 vcc, 4, v252
    s_cbranch_vccz SK_out
    s_sub_u32 s68, s68, 1
    s_sleep 1
    s_cbranch_scc0 SK_spin
SK_out:
P2_red:
    s_lshl_b32 s44, s32, 2
    s_add_u32 s44, s44, s35
    s_mul_i32 s44, s44, 20480
    s_mul_i32 s45, s33, 160
    s_add_u32 s44, s44, s45
    v_mov_b32 v93, 0x7ffffff0
    v_add_u32_e64 v90, 0, v0
    v_mul_u32_u24 v91, 205, v90
    v_lshrrev_b32 v91, 11, v91
    v_mul_u32_u24 v92, 10, v91
    v_sub_u32_e64 v92, v90, v92
    v_mul_u32_u24 v84, 1280, v91
    v_lshl_add_u32 v84, v92, 4, v84
    v_lshlrev_b32 v87, 9, v92
    v_add_u32 v91, v91, v92
    v_and_b32_e64 v91, 15, v91
    v_lshl_add_u32 v87, v91, 4, v87
    buffer_load_dwordx4 v[140:143], v84, s[16:19], s44 offen
    v_add_u32_e64 v90, 64, v0
    v_mul_u32_u24 v91, 205, v90
    v_lshrrev_b32 v91, 11, v91
    v_mul_u32_u24 v92, 10, v91
    v_sub_u32_e64 v92, v90, v92
    v_mul_u32_u24 v85, 1280, v91
    v_lshl_add_u32 v85, v92, 4, v85
    v_lshlrev_b32 v88, 9, v92
    v_add_u32 v91, v91, v92
    v_and_b32_e64 v91, 15, v91
    v_lshl_add_u32 v88, v91, 4, v88
    buffer_load_dwordx4 v[144:147], v85, s[16:19], s44 offen
    v_add_u32 v90, 128, v0
    v_mul_u32_u24 v91, 205, v90
    v_lshrrev_b32 v91, 11, v91
    v_mul_u32_u24 v92, 10, v91
    v_sub_u32_e64 v92, v90, v92
    v_mul_u32_u24 v86, 1280, v91
    v_lshl_add_u32 v86, v92, 4, v86
    v_lshlrev_b32 v89, 9, v92
    v_add_u32 v91, v91, v92
    v_and_b32_e64 v91, 15, v91
    v_lshl_add_u32 v89, v91, 4, v89
    v_cmp_gt_u32 vcc, 32, v0
    s_nop 1
    v_cndmask_b32 v86, v93, v86, vcc
    v_cndmask_b32 v89, 0, v89, vcc
    buffer_load_dwordx4 v[148:151], v86, s[16:19], s44 offen
    v_mov_b32 v96, 162816
    v_mov_b32 v97, 1
    s_mov_b64 exec, 1
    ds_add_u32 v96, v97 offset:24
    s_mov_b64 exec, -1
    v_mov_b32 v96, 162816
    s_mov_b32 s68, 1000000
R1_spin:
    ds_read_b32 v97, v96 offset:24
    s_waitcnt lgkmcnt(0)
    v_cmp_ne_u32 vcc, 4, v97
    s_cbranch_vccz R1_out
    s_sub_u32 s68, s68, 1
    s_sleep 1
    s_cbranch_scc0 R1_spin
R1_out:
    s_sub_u32 s36, s35, 1
    s_and_b32 s36, s36, 3
    s_cmp_eq_u32 s36, 3
    s_cbranch_scc1 R_own0
    s_add_u32 s36, s36, 0
    s_mul_i32 s36, s36, 5120
    v_add_u32 v1, s36, v2
    ds_write_b128 v1, v[4:7] offset:0
    ds_write_b128 v1, v[8:11] offset:1024
    ds_write_b128 v1, v[12:15] offset:2048
    ds_write_b128 v1, v[16:19] offset:3072
    ds_write_b128 v1, v[20:23] offset:4096
    s_branch R_nxt0
R_own0:
    v_pk_mul_f32 v[100:101], v[4:5], 1.0 op_sel_hi:[1,0]
    v_pk_mul_f32 v[102:103], v[6:7], 1.0 op_sel_hi:[1,0]
    v_pk_mul_f32 v[104:105], v[8:9], 1.0 op_sel_hi:[1,0]
    v_pk_mul_f32 v[106:107], v[10:11], 1.0 op_sel_hi:[1,0]
    v_pk_mul_f32 v[108:109], v[12:13], 1.0 op_sel_hi:[1,0]
    v_pk_mul_f32 v[110:111], v[14:15], 1.0 op_sel_hi:[1,0]
    v_pk_mul_f32 v[112:113], v[16:17], 1.0 op_sel_hi:[1,0]
    v_pk_mul_f32 v[114:115], v[18:19], 1.0 op_sel_hi:[1,0]
    v_pk_mul_f32 v[116:117], v[20:21], 1.0 op_sel_hi:[1,0]
    v_pk_mul_f32 v[118:119], v[22:23], 1.0 op_sel_hi:[1,0]
R_nxt0:
    s_sub_u32 s36, s35, 2
    s_and_b32 s36, s36, 3
    s_cmp_eq_u32 s36, 3
    s_cbranch_scc1 R_own1
    s_add_u32 s36, s36, 3
    s_mul_i32 s36, s36, 5120
    v_add_u32 v1, s36, v2
    ds_write_b128 v1, v[24:27] offset:0
    ds_write_b128 v1, v[28:31] offset:1024
    ds_write_b128 v1, v[32:35] offset:2048
    ds_write_b128 v1, v[36:39] offset:3072
    ds_write_b128 v1, v[40:43] offset:4096
    s_branch R_nxt1
R_own1:
    s_nop 0
    v_pk_mul_f32 v[100:101], v[24:25], 1.0 op_sel_hi:[1,0]
    v_pk_mul_f32 v[102:103], v[26:27], 1.0 op_sel_hi:[1,0]
    v_pk_mul_f32 v[104:105], v[28:29], 1.0 op_sel_hi:[1,0]
    v_pk_mul_f32 v[106:107], v[30:31], 1.0 op_sel_hi:[1,0]
    v_pk_mul_f32 v[108:109], v[32:33], 1.0 op_sel_hi:[1,0]
    v_pk_mul_f32 v[110:111], v[34:35], 1.0 op_sel_hi:[1,0]
    v_pk_mul_f32 v[112:113], v[36:37], 1.0 op_sel_hi:[1,0]
    v_pk_mul_f32 v[114:115], v[38:39], 1.0 op_sel_hi:[1,0]
    v_pk_mul_f32 v[116:117], v[40:41], 1.0 op_sel_hi:[1,0]
    v_pk_mul_f32 v[118:119], v[42:43], 1.0 op_sel_hi:[1,0]
R_nxt1:
    s_sub_u32 s36, s35, 3
    s_and_b32 s36, s36, 3
    s_cmp_eq_u32 s36, 3
    s_cbranch_scc1 R_own2
    s_add_u32 s36, s36, 6
    s_mul_i32 s36, s36, 5120
    v_add_u32 v1, s36, v2
    ds_write_b128 v1, v[44:47] offset:0
    ds_write_b128 v1, v[48:51] offset:1024
    ds_write_b128 v1, v[52:55] offset:2048
    ds_write_b128 v1, v[56:59] offset:3072
    ds_write_b128 v1, v[60:63] offset:4096
    s_branch R_nxt2
R_own2:
    s_nop 0
    v_pk_mul_f32 v[100:101], v[44:45], 1.0 op_sel_hi:[1,0]
    v_pk_mul_f32 v[102:103], v[46:47], 1.0 op_sel_hi:[1,0]
    v_pk_mul_f32 v[104:105], v[48:49], 1.0 op_sel_hi:[1,0]
    v_pk_mul_f32 v[106:107], v[50:51], 1.0 op_sel_hi:[1,0]
    v_pk_mul_f32 v[108:109], v[52:53], 1.0 op_sel_hi:[1,0]
    v_pk_mul_f32 v[110:111], v[54:55], 1.0 op_sel_hi:[1,0]
    v_pk_mul_f32 v[112:113], v[56:57], 1.0 op_sel_hi:[1,0]
    v_pk_mul_f32 v[114:115], v[58:59], 1.0 op_sel_hi:[1,0]
    v_pk_mul_f32 v[116:117], v[60:61], 1.0 op_sel_hi:[1,0]
    v_pk_mul_f32 v[118:119], v[62:63], 1.0 op_sel_hi:[1,0]
R_nxt2:
    s_sub_u32 s36, s35, 4
    s_and_b32 s36, s36, 3
    s_cmp_eq_u32 s36, 3
    s_cbranch_scc1 R_own3
    s_add_u32 s36, s36, 9
    s_mul_i32 s36, s36, 5120
    v_add_u32 v1, s36, v2
    ds_write_b128 v1, v[64:67] offset:0
    ds_write_b128 v1, v[68:71] offset:1024
    ds_write_b128 v1, v[72:75] offset:2048
    ds_write_b128 v1, v[76:79] offset:3072
    ds_write_b128 v1, v[80:83] offset:4096
    s_branch R_nxt3
R_own3:
    s_nop 0
    v_pk_mul_f32 v[100:101], v[64:65], 1.0 op_sel_hi:[1,0]
    v_pk_mul_f32 v[102:103], v[66:67], 1.0 op_sel_hi:[1,0]
    v_pk_mul_f32 v[104:105], v[68:69], 1.0 op_sel_hi:[1,0]
    v_pk_mul_f32 v[106:107], v[70:71], 1.0 op_sel_hi:[1,0]
    v_pk_mul_f32 v[108:109], v[72:73], 1.0 op_sel_hi:[1,0]
    v_pk_mul_f32 v[110:111], v[74:75], 1.0 op_sel_hi:[1,0]
    v_pk_mul_f32 v[112:113], v[76:77], 1.0 op_sel_hi:[1,0]
    v_pk_mul_f32 v[114:115], v[78:79], 1.0 op_sel_hi:[1,0]
    v_pk_mul_f32 v[116:117], v[80:81], 1.0 op_sel_hi:[1,0]
    v_pk_mul_f32 v[118:119], v[82:83], 1.0 op_sel_hi:[1,0]
R_nxt3:
    s_mul_i32 s36, s35, 15360
    v_add_u32 v1, s36, v2
    s_mov_b32 s52, 3216550459
    s_mov_b32 s53, 3216550459
    s_mov_b32 s54, 1.0
    s_mov_b32 s55, 1.0
    s_waitcnt lgkmcnt(0)
    v_mov_b32 v96, 162816
    v_mov_b32 v97, 1
    s_mov_b64 exec, 1
    ds_add_u32 v96, v97 offset:28
    s_mov_b64 exec, -1
    v_mov_b32 v96, 162816
    s_mov_b32 s68, 1000000
R2_spin:
    ds_read_b32 v97, v96 offset:28
    s_waitcnt lgkmcnt(0)
    v_cmp_ne_u32 vcc, 4, v97
    s_cbranch_vccz R2_out
    s_sub_u32 s68, s68, 1
    s_sleep 1
    s_cbranch_scc0 R2_spin
R2_out:
    ds_read_b128 v[4:7], v1 offset:0
    ds_read_b128 v[8:11], v1 offset:1024
    ds_read_b128 v[12:15], v1 offset:2048
    ds_read_b128 v[16:19], v1 offset:3072
    ds_read_b128 v[20:23], v1 offset:4096
    ds_read_b128 v[24:27], v1 offset:5120
    ds_read_b128 v[28:31], v1 offset:6144
    ds_read_b128 v[32:35], v1 offset:7168
    ds_read_b128 v[36:39], v1 offset:8192
    ds_read_b128 v[40:43], v1 offset:9216
    ds_read_b128 v[44:47], v1 offset:10240
    ds_read_b128 v[48:51], v1 offset:11264
    ds_read_b128 v[52:55], v1 offset:12288
    ds_read_b128 v[56:59], v1 offset:13312
    ds_read_b128 v[60:63], v1 offset:14336
    s_waitcnt lgkmcnt(5)
    v_pk_add_f32 v[4:5], v[4:5], v[24:25]
    v_pk_add_f32 v[6:7], v[6:7], v[26:27]
    v_pk_add_f32 v[8:9], v[8:9], v[28:29]
    v_pk_add_f32 v[10:11], v[10:11], v[30:31]
    v_pk_add_f32 v[12:13], v[12:13], v[32:33]
    v_pk_add_f32 v[14:15], v[14:15], v[34:35]
    v_pk_add_f32 v[16:17], v[16:17], v[36:37]
    v_pk_add_f32 v[18:19], v[18:19], v[38:39]
    v_pk_add_f32 v[20:21], v[20:21], v[40:41]
    v_pk_add_f32 v[22:23], v[22:23], v[42:43]
    s_waitcnt lgkmcnt(0)
    s_nop 0
    v_pk_add_f32 v[100:101], v[100:101], v[44:45]
    v_pk_add_f32 v[102:103], v[102:103], v[46:47]
    v_pk_add_f32 v[104:105], v[104:105], v[48:49]
    v_pk_add_f32 v[106:107], v[106:107], v[50:51]
    v_pk_add_f32 v[108:109], v[108:109], v[52:53]
    v_pk_add_f32 v[110:111], v[110:111], v[54:55]
    v_pk_add_f32 v[112:113], v[112:113], v[56:57]
    v_pk_add_f32 v[114:115], v[114:115], v[58:59]
    v_pk_add_f32 v[116:117], v[116:117], v[60:61]
    v_pk_add_f32 v[118:119], v[118:119], v[62:63]
    v_pk_add_f32 v[100:101], v[100:101], v[4:5]
    v_pk_add_f32 v[102:103], v[102:103], v[6:7]
    v_pk_add_f32 v[104:105], v[104:105], v[8:9]
    v_pk_add_f32 v[106:107], v[106:107], v[10:11]
    v_pk_add_f32 v[108:109], v[108:109], v[12:13]
    v_pk_add_f32 v[110:111], v[110:111], v[14:15]
    v_pk_add_f32 v[112:113], v[112:113], v[16:17]
    v_pk_add_f32 v[114:115], v[114:115], v[18:19]
    v_pk_add_f32 v[116:117], v[116:117], v[20:21]
    v_pk_add_f32 v[118:119], v[118:119], v[22:23]
    v_pk_mul_f32 v[120:121], v[100:101], s[52:53]
    v_pk_mul_f32 v[122:123], v[102:103], s[52:53]
    v_pk_mul_f32 v[124:125], v[104:105], s[52:53]
    v_pk_mul_f32 v[126:127], v[106:107], s[52:53]
    v_pk_mul_f32 v[128:129], v[108:109], s[52:53]
    v_pk_mul_f32 v[130:131], v[110:111], s[52:53]
    v_pk_mul_f32 v[132:133], v[112:113], s[52:53]
    v_pk_mul_f32 v[134:135], v[114:115], s[52:53]
    v_pk_mul_f32 v[136:137], v[116:117], s[52:53]
    v_pk_mul_f32 v[138:139], v[118:119], s[52:53]
    v_exp_f32 v120, v120
    v_exp_f32 v121, v121
    v_exp_f32 v122, v122
    v_exp_f32 v123, v123
    v_exp_f32 v124, v124
    v_exp_f32 v125, v125
    v_exp_f32 v126, v126
    v_exp_f32 v127, v127
    v_exp_f32 v128, v128
    v_exp_f32 v129, v129
    v_exp_f32 v130, v130
    v_exp_f32 v131, v131
    v_exp_f32 v132, v132
    v_exp_f32 v133, v133
    v_exp_f32 v134, v134
    v_exp_f32 v135, v135
    v_exp_f32 v136, v136
    v_exp_f32 v137, v137
    v_exp_f32 v138, v138
    v_exp_f32 v139, v139
    v_pk_add_f32 v[120:121], v[120:121], s[54:55]
    v_pk_add_f32 v[122:123], v[122:123], s[54:55]
    v_pk_add_f32 v[124:125], v[124:125], s[54:55]
    v_pk_add_f32 v[126:127], v[126:127], s[54:55]
    v_pk_add_f32 v[128:129], v[128:129], s[54:55]
    v_pk_add_f32 v[130:131], v[130:131], s[54:55]
    v_pk_add_f32 v[132:133], v[132:133], s[54:55]
    v_pk_add_f32 v[134:135], v[134:135], s[54:55]
    v_pk_add_f32 v[136:137], v[136:137], s[54:55]
    v_pk_add_f32 v[138:139], v[138:139], s[54:55]
    v_rcp_f32 v120, v120
    v_rcp_f32 v121, v121
    v_rcp_f32 v122, v122
    v_rcp_f32 v123, v123
    v_rcp_f32 v124, v124
    v_rcp_f32 v125, v125
    v_rcp_f32 v126, v126
    v_rcp_f32 v127, v127
    v_rcp_f32 v128, v128
    v_rcp_f32 v129, v129
    v_rcp_f32 v130, v130
    v_rcp_f32 v131, v131
    v_rcp_f32 v132, v132
    v_rcp_f32 v133, v133
    v_rcp_f32 v134, v134
    v_rcp_f32 v135, v135
    v_rcp_f32 v136, v136
    v_rcp_f32 v137, v137
    v_rcp_f32 v138, v138
    v_rcp_f32 v139, v139
    v_pk_mul_f32 v[100:101], v[100:101], v[120:121]
    v_pk_mul_f32 v[102:103], v[102:103], v[122:123]
    v_pk_mul_f32 v[104:105], v[104:105], v[124:125]
    v_pk_mul_f32 v[106:107], v[106:107], v[126:127]
    v_pk_mul_f32 v[108:109], v[108:109], v[128:129]
    v_pk_mul_f32 v[110:111], v[110:111], v[130:131]
    v_pk_mul_f32 v[112:113], v[112:113], v[132:133]
    v_pk_mul_f32 v[114:115], v[114:115], v[134:135]
    v_pk_mul_f32 v[116:117], v[116:117], v[136:137]
    v_pk_mul_f32 v[118:119], v[118:119], v[138:139]
    v_lshrrev_b32 v130, 5, v0
    v_add_u32 v130, v130, v0
    v_lshrrev_b32 v131, 4, v0
    v_lshlrev_b32 v131, 8, v131
    v_add_u32 v131, s36, v131
    v_add_u32 v124, 0, v130
    v_and_b32_e64 v124, 15, v124
    v_lshl_add_u32 v124, v124, 4, v131
    v_add_u32 v125, 2, v130
    v_and_b32 v125, 15, v125
    v_lshl_add_u32 v125, v125, 4, v131
    v_add_u32 v126, 4, v130
    v_and_b32 v126, 15, v126
    v_lshl_add_u32 v126, v126, 4, v131
    v_add_u32 v127, 6, v130
    v_and_b32 v127, 15, v127
    v_lshl_add_u32 v127, v127, 4, v131
    v_add_u32 v128, 8, v130
    v_and_b32 v128, 15, v128
    v_lshl_add_u32 v128, v128, 4, v131
    ds_write_b128 v124, v[100:103] offset:0
    ds_write_b128 v125, v[104:107] offset:1024
    ds_write_b128 v126, v[108:111] offset:2048
    ds_write_b128 v127, v[112:115] offset:3072
    ds_write_b128 v128, v[116:119] offset:4096
    s_waitcnt lgkmcnt(0)
    v_add_u32 v90, s36, v87
    ds_read_b128 v[100:103], v90 offset:0
    ds_read_b128 v[104:107], v90 offset:256
    v_add_u32 v90, s36, v88
    ds_read_b128 v[108:111], v90 offset:0
    ds_read_b128 v[112:115], v90 offset:256
    v_add_u32 v90, s36, v89
    ds_read_b128 v[116:119], v90 offset:0
    ds_read_b128 v[120:123], v90 offset:256
    s_mul_i32 s36, s35, 5120
    s_add_u32 s36, s36, 61440
    v_add_u32_e64 v87, s36, v87
    v_add_u32 v90, 40960, v87
    v_add_u32_e64 v88, s36, v88
    v_add_u32 v91, 40960, v88
    v_add_u32_e64 v89, s36, v89
    v_add_u32 v92, 40960, v89
    s_waitcnt vmcnt(0)
    v_lshlrev_b32 v152, 16, v140
    v_and_b32 v153, 0xffff0000, v140
    v_lshlrev_b32_e64 v154, 16, v141
    v_and_b32 v155, 0xffff0000, v141
    v_lshlrev_b32_e64 v156, 16, v142
    v_and_b32 v157, 0xffff0000, v142
    v_lshlrev_b32_e64 v158, 16, v143
    v_and_b32 v159, 0xffff0000, v143
    v_lshlrev_b32_e64 v160, 16, v144
    v_and_b32 v161, 0xffff0000, v144
    v_lshlrev_b32_e64 v162, 16, v145
    v_and_b32 v163, 0xffff0000, v145
    v_lshlrev_b32_e64 v164, 16, v146
    v_and_b32 v165, 0xffff0000, v146
    v_lshlrev_b32_e64 v166, 16, v147
    v_and_b32 v167, 0xffff0000, v147
    v_lshlrev_b32_e64 v168, 16, v148
    v_and_b32 v169, 0xffff0000, v148
    v_lshlrev_b32_e64 v170, 16, v149
    v_and_b32 v171, 0xffff0000, v149
    v_lshlrev_b32_e64 v172, 16, v150
    v_and_b32 v173, 0xffff0000, v150
    v_lshlrev_b32_e64 v174, 16, v151
    v_and_b32 v175, 0xffff0000, v151
    s_setprio 3
    v_mov_b32 v96, 162816
    s_mov_b32 s68, 1000000
R3_spin:
    ds_read_b32 v97, v96 offset:32
    s_waitcnt lgkmcnt(0)
    v_cmp_ne_u32 vcc, 4, v97
    s_cbranch_vccz R3_out
    s_sub_u32 s68, s68, 1
    s_sleep 1
    s_cbranch_scc0 R3_spin
R3_out:
    ds_read_b128 v[4:7], v87 offset:0
    ds_read_b128 v[8:11], v87 offset:256
    ds_read_b128 v[12:15], v87 offset:20480
    ds_read_b128 v[16:19], v87 offset:20736
    ds_read_b128 v[20:23], v90 offset:0
    ds_read_b128 v[24:27], v90 offset:256
    ds_read_b128 v[28:31], v90 offset:20480
    ds_read_b128 v[32:35], v90 offset:20736
    s_waitcnt lgkmcnt(0)
    ds_read_b128 v[36:39], v88 offset:0
    ds_read_b128 v[40:43], v88 offset:256
    ds_read_b128 v[44:47], v88 offset:20480
    ds_read_b128 v[48:51], v88 offset:20736
    ds_read_b128 v[52:55], v91 offset:0
    ds_read_b128 v[56:59], v91 offset:256
    ds_read_b128 v[60:63], v91 offset:20480
    ds_read_b128 v[64:67], v91 offset:20736
    v_pk_add_f32 v[4:5], v[4:5], v[12:13]
    v_pk_add_f32 v[20:21], v[20:21], v[28:29]
    v_pk_add_f32 v[6:7], v[6:7], v[14:15]
    v_pk_add_f32 v[22:23], v[22:23], v[30:31]
    v_pk_add_f32 v[8:9], v[8:9], v[16:17]
    v_pk_add_f32 v[24:25], v[24:25], v[32:33]
    v_pk_add_f32 v[10:11], v[10:11], v[18:19]
    v_pk_add_f32 v[26:27], v[26:27], v[34:35]
    v_pk_add_f32 v[4:5], v[4:5], v[20:21]
    v_pk_add_f32 v[6:7], v[6:7], v[22:23]
    v_pk_add_f32 v[8:9], v[8:9], v[24:25]
    v_pk_add_f32 v[10:11], v[10:11], v[26:27]
    v_pk_fma_f32 v[4:5], v[4:5], v[100:101], v[152:153]
    v_pk_fma_f32 v[6:7], v[6:7], v[102:103], v[154:155]
    v_pk_fma_f32 v[8:9], v[8:9], v[104:105], v[156:157]
    v_pk_fma_f32 v[10:11], v[10:11], v[106:107], v[158:159]
    v_cvt_pk_bf16_f32 v12, v4, v5
    v_cvt_pk_bf16_f32 v13, v6, v7
    v_cvt_pk_bf16_f32 v14, v8, v9
    v_cvt_pk_bf16_f32 v15, v10, v11
    buffer_store_dwordx4 v[12:15], v84, s[24:27], s44 offen
    s_waitcnt lgkmcnt(0)
    ds_read_b128 v[180:183], v89 offset:0
    ds_read_b128 v[184:187], v89 offset:256
    ds_read_b128 v[188:191], v89 offset:20480
    ds_read_b128 v[192:195], v89 offset:20736
    ds_read_b128 v[196:199], v92 offset:0
    ds_read_b128 v[200:203], v92 offset:256
    ds_read_b128 v[204:207], v92 offset:20480
    ds_read_b128 v[208:211], v92 offset:20736
    s_nop 0
    v_pk_add_f32 v[36:37], v[36:37], v[44:45]
    v_pk_add_f32 v[52:53], v[52:53], v[60:61]
    v_pk_add_f32 v[38:39], v[38:39], v[46:47]
    v_pk_add_f32 v[54:55], v[54:55], v[62:63]
    v_pk_add_f32 v[40:41], v[40:41], v[48:49]
    v_pk_add_f32 v[56:57], v[56:57], v[64:65]
    v_pk_add_f32 v[42:43], v[42:43], v[50:51]
    v_pk_add_f32 v[58:59], v[58:59], v[66:67]
    v_pk_add_f32 v[36:37], v[36:37], v[52:53]
    v_pk_add_f32 v[38:39], v[38:39], v[54:55]
    v_pk_add_f32 v[40:41], v[40:41], v[56:57]
    v_pk_add_f32 v[42:43], v[42:43], v[58:59]
    v_pk_fma_f32 v[36:37], v[36:37], v[108:109], v[160:161]
    v_pk_fma_f32 v[38:39], v[38:39], v[110:111], v[162:163]
    v_pk_fma_f32 v[40:41], v[40:41], v[112:113], v[164:165]
    v_pk_fma_f32 v[42:43], v[42:43], v[114:115], v[166:167]
    v_cvt_pk_bf16_f32 v44, v36, v37
    v_cvt_pk_bf16_f32 v45, v38, v39
    v_cvt_pk_bf16_f32 v46, v40, v41
    v_cvt_pk_bf16_f32 v47, v42, v43
    buffer_store_dwordx4 v[44:47], v85, s[24:27], s44 offen
    s_waitcnt lgkmcnt(0)
    s_nop 0
    v_pk_add_f32 v[180:181], v[180:181], v[188:189]
    v_pk_add_f32 v[196:197], v[196:197], v[204:205]
    v_pk_add_f32 v[182:183], v[182:183], v[190:191]
    v_pk_add_f32 v[198:199], v[198:199], v[206:207]
    v_pk_add_f32 v[184:185], v[184:185], v[192:193]
    v_pk_add_f32 v[200:201], v[200:201], v[208:209]
    v_pk_add_f32 v[186:187], v[186:187], v[194:195]
    v_pk_add_f32 v[202:203], v[202:203], v[210:211]
    v_pk_add_f32 v[180:181], v[180:181], v[196:197]
    v_pk_add_f32 v[182:183], v[182:183], v[198:199]
    v_pk_add_f32 v[184:185], v[184:185], v[200:201]
    v_pk_add_f32 v[186:187], v[186:187], v[202:203]
    v_pk_fma_f32 v[180:181], v[180:181], v[116:117], v[168:169]
    v_pk_fma_f32 v[182:183], v[182:183], v[118:119], v[170:171]
    v_pk_fma_f32 v[184:185], v[184:185], v[120:121], v[172:173]
    v_pk_fma_f32 v[186:187], v[186:187], v[122:123], v[174:175]
    v_cvt_pk_bf16_f32 v188, v180, v181
    v_cvt_pk_bf16_f32 v189, v182, v183
    v_cvt_pk_bf16_f32 v190, v184, v185
    v_cvt_pk_bf16_f32 v191, v186, v187
    buffer_store_dwordx4 v[188:191], v86, s[24:27], s44 offen
    s_endpgm
P2_aux:
    s_and_b32 s74, s2, 7
    s_lshl_b32 s74, s74, 2
    s_lshr_b32 s75, s2, 3
    s_and_b32 s67, s75, 3
    s_add_u32 s74, s74, s67
    s_lshr_b32 s75, s75, 2
    s_lshl_b32 s67, s67, 1
    s_add_u32 s75, s75, s67
    s_and_b32 s75, s75, 7
    s_and_b32 s76, s3, 3
    s_mul_i32 s67, s76, 5
    s_add_u32 s67, s67, 54
    s_mul_i32 s77, s74, 74
    s_add_u32 s77, s77, s67
    s_lshl_b32 s77, s77, 12
    s_add_u32 s77, s77, 3145728
    s_mul_i32 s78, s75, 74
    s_add_u32 s78, s78, s67
    s_mul_i32 s78, s78, 5120
    s_add_u32 s78, s78, 13631488
    s_and_b32 s67, s74, 3
    s_mul_i32 s67, s67, 0
    s_mul_i32 s79, s75, 0
    s_add_u32 s79, s79, s67
    s_lshr_b32 s79, s79, 2
    s_sub_u32 s67, s79, 54
    s_cselect_b32 s79, s79, s67
    s_add_u32 s79, s79, s76
    s_sub_u32 s67, s79, 54
    s_cselect_b32 s79, s79, s67
    s_mov_b32 s32, s74
    s_mov_b32 s33, s75
    s_mov_b32 s35, s76
    s_mov_b32 s40, s77
    s_mov_b32 s41, s78
    s_mov_b32 s58, s79
    v_lshlrev_b32_e64 v2, 4, v0
    v_add_u32 v3, 4096, v2
    s_cmp_eq_u32 s3, 4
    s_cbranch_scc0 PAW_fol
    v_and_b32 v4, 1, v0
    v_lshlrev_b32 v4, 6, v4
    s_mov_b32 s68, 100000
PAW_spin:
    global_load_dword v5, v4, s[14:15] offset:132 sc1
    s_waitcnt vmcnt(0)
PAW_chk:
    v_cmp_ne_u32 vcc, 1, v5
    s_cbranch_vccz PAW_out
    s_sub_u32 s68, s68, 1
    s_cbranch_scc1 PAW_out
    s_sleep 2
    s_branch PAW_spin
PAW_out:
    v_mov_b32 v4, 162816
    v_mov_b32 v5, 1
    s_mov_b64 exec, 1
    ds_add_u32 v4, v5 offset:16
    s_mov_b64 exec, -1
    s_branch PAW_done
PAW_fol:
    v_mov_b32 v4, 162816
    s_mov_b32 s68, 1000000
PAWF_spin:
    ds_read_b32 v5, v4 offset:16
    s_waitcnt lgkmcnt(0)
    v_cmp_ne_u32 vcc, 1, v5
    s_cbranch_vccz PAWF_out
    s_sub_u32 s68, s68, 1
    s_sleep 1
    s_cbranch_scc0 PAWF_spin
PAWF_out:
PAW_done:
    s_cmp_eq_u32 s34, 1
    s_cbranch_scc1 P2_a_2
    s_cmp_eq_u32 s34, 2
    s_cbranch_scc0 P2_a_noq
    v_mov_b32 v4, 162816
    s_mov_b32 s68, 1000000
AQ_spin:
    ds_read_b32 v5, v4 offset:44
    s_waitcnt lgkmcnt(0)
    v_cmp_ne_u32 vcc, 4, v5
    s_cbranch_vccz AQ_out
    s_sub_u32 s68, s68, 1
    s_sleep 1
    s_cbranch_scc0 AQ_spin
AQ_out:
P2_a_noq:
    s_mul_i32 s45, s33, 378880
    s_add_u32 s45, s45, 13631488
    s_mul_i32 s44, s35, 5120
    s_add_u32 s59, s58, 16
    s_sub_u32 s43, s59, 54
    s_cselect_b32 s59, s59, s43
    s_mul_i32 s43, s59, 5120
    s_add_u32 s43, s43, s45
    s_waitcnt vmcnt(4)
    s_add_u32 m0, s44, 0
    s_nop 0
    buffer_load_dwordx4 v2, s[20:23], s43 offen offset:0 sc1 lds
    buffer_load_dwordx4 v2, s[20:23], s43 offen offset:1024 sc1 lds
    buffer_load_dwordx4 v2, s[20:23], s43 offen offset:2048 sc1 lds
    buffer_load_dwordx4 v2, s[20:23], s43 offen offset:3072 sc1 lds
    s_add_u32 m0, s44, 4096
    s_nop 0
    buffer_load_dwordx4 v3, s[20:23], s43 offen sc1 lds
    s_add_u32 s59, s58, 20
    s_sub_u32 s43, s59, 54
    s_cselect_b32 s59, s59, s43
    s_mul_i32 s43, s59, 5120
    s_add_u32 s43, s43, s45
    s_waitcnt vmcnt(4)
    s_add_u32 m0, s44, 20480
    s_nop 0
    buffer_load_dwordx4 v2, s[20:23], s43 offen offset:0 sc1 lds
    buffer_load_dwordx4 v2, s[20:23], s43 offen offset:1024 sc1 lds
    buffer_load_dwordx4 v2, s[20:23], s43 offen offset:2048 sc1 lds
    buffer_load_dwordx4 v2, s[20:23], s43 offen offset:3072 sc1 lds
    s_add_u32 m0, s44, 24576
    s_nop 0
    buffer_load_dwordx4 v3, s[20:23], s43 offen sc1 lds
    s_add_u32 s59, s58, 24
    s_sub_u32 s43, s59, 54
    s_cselect_b32 s59, s59, s43
    s_mul_i32 s43, s59, 5120
    s_add_u32 s43, s43, s45
    s_waitcnt vmcnt(4)
    s_add_u32 m0, s44, 40960
    s_nop 0
    buffer_load_dwordx4 v2, s[20:23], s43 offen offset:0 sc1 lds
    buffer_load_dwordx4 v2, s[20:23], s43 offen offset:1024 sc1 lds
    buffer_load_dwordx4 v2, s[20:23], s43 offen offset:2048 sc1 lds
    buffer_load_dwordx4 v2, s[20:23], s43 offen offset:3072 sc1 lds
    s_add_u32 m0, s44, 45056
    s_nop 0
    buffer_load_dwordx4 v3, s[20:23], s43 offen sc1 lds
    s_add_u32 s59, s58, 28
    s_sub_u32 s43, s59, 54
    s_cselect_b32 s59, s59, s43
    s_mul_i32 s43, s59, 5120
    s_add_u32 s43, s43, s45
    s_waitcnt vmcnt(4)
    s_add_u32 m0, s44, 61440
    s_nop 0
    buffer_load_dwordx4 v2, s[20:23], s43 offen offset:0 sc1 lds
    buffer_load_dwordx4 v2, s[20:23], s43 offen offset:1024 sc1 lds
    buffer_load_dwordx4 v2, s[20:23], s43 offen offset:2048 sc1 lds
    buffer_load_dwordx4 v2, s[20:23], s43 offen offset:3072 sc1 lds
    s_add_u32 m0, s44, 65536
    s_nop 0
    buffer_load_dwordx4 v3, s[20:23], s43 offen sc1 lds
    s_add_u32 s59, s58, 32
    s_sub_u32 s43, s59, 54
    s_cselect_b32 s59, s59, s43
    s_mul_i32 s43, s59, 5120
    s_add_u32 s43, s43, s45
    v_mov_b32 v4, 162816
    s_mov_b32 s68, 1000000
AE_spin:
    ds_read_b32 v5, v4 offset:48
    s_waitcnt lgkmcnt(0)
    v_cmp_ne_u32 vcc, 4, v5
    s_cbranch_vccz AE_out
    s_sub_u32 s68, s68, 1
    s_sleep 1
    s_cbranch_scc0 AE_spin
AE_out:
    s_waitcnt vmcnt(30)
    s_add_u32 m0, s44, 81920
    s_nop 0
    buffer_load_dwordx4 v2, s[20:23], s43 offen offset:0 sc1 lds
    buffer_load_dwordx4 v2, s[20:23], s43 offen offset:1024 sc1 lds
    buffer_load_dwordx4 v2, s[20:23], s43 offen offset:2048 sc1 lds
    buffer_load_dwordx4 v2, s[20:23], s43 offen offset:3072 sc1 lds
    s_add_u32 m0, s44, 86016
    s_nop 0
    buffer_load_dwordx4 v3, s[20:23], s43 offen sc1 lds
    s_add_u32 s59, s58, 36
    s_sub_u32 s43, s59, 54
    s_cselect_b32 s59, s59, s43
    s_mul_i32 s43, s59, 5120
    s_add_u32 s43, s43, s45
    s_waitcnt vmcnt(30)
    s_add_u32 m0, s44, 102400
    s_nop 0
    buffer_load_dwordx4 v2, s[20:23], s43 offen offset:0 sc1 lds
    buffer_load_dwordx4 v2, s[20:23], s43 offen offset:1024 sc1 lds
    buffer_load_dwordx4 v2, s[20:23], s43 offen offset:2048 sc1 lds
    buffer_load_dwordx4 v2, s[20:23], s43 offen offset:3072 sc1 lds
    s_add_u32 m0, s44, 106496
    s_nop 0
    buffer_load_dwordx4 v3, s[20:23], s43 offen sc1 lds
    s_add_u32 s59, s58, 40
    s_sub_u32 s43, s59, 54
    s_cselect_b32 s59, s59, s43
    s_mul_i32 s43, s59, 5120
    s_add_u32 s43, s43, s45
    s_waitcnt vmcnt(30)
    s_add_u32 m0, s44, 122880
    s_nop 0
    buffer_load_dwordx4 v2, s[20:23], s43 offen offset:0 sc1 lds
    buffer_load_dwordx4 v2, s[20:23], s43 offen offset:1024 sc1 lds
    buffer_load_dwordx4 v2, s[20:23], s43 offen offset:2048 sc1 lds
    buffer_load_dwordx4 v2, s[20:23], s43 offen offset:3072 sc1 lds
    s_add_u32 m0, s44, 126976
    s_nop 0
    buffer_load_dwordx4 v3, s[20:23], s43 offen sc1 lds
    s_add_u32 s67, s78, 5120
    buffer_load_dwordx4 v[160:163], v2, s[20:23], s67 offen offset:0 sc1
    buffer_load_dwordx4 v[164:167], v2, s[20:23], s67 offen offset:1024 sc1
    buffer_load_dwordx4 v[168:171], v2, s[20:23], s67 offen offset:2048 sc1
    buffer_load_dwordx4 v[172:175], v2, s[20:23], s67 offen offset:3072 sc1
    buffer_load_dwordx4 v[176:179], v3, s[20:23], s67 offen sc1
    s_add_u32 s67, s78, 10240
    buffer_load_dwordx4 v[180:183], v2, s[20:23], s67 offen offset:0 sc1
    buffer_load_dwordx4 v[184:187], v2, s[20:23], s67 offen offset:1024 sc1
    buffer_load_dwordx4 v[188:191], v2, s[20:23], s67 offen offset:2048 sc1
    buffer_load_dwordx4 v[192:195], v2, s[20:23], s67 offen offset:3072 sc1
    buffer_load_dwordx4 v[196:199], v3, s[20:23], s67 offen sc1
P2_a_2:
    s_setprio 3
    s_cmp_eq_u32 s34, 1
    s_cbranch_scc1 P2_a_3
    s_lshr_b32 s36, s2, 5
    s_cmp_ge_u32 s36, 6
    s_cselect_b32 s65, 1, 0
    s_sub_u32 s64, s32, 1
    s_and_b32 s64, s64, 3
    s_and_b32 s36, s32, 28
    s_or_b32 s64, s64, s36
    s_cmp_eq_u32 s65, 1
    s_cselect_b32 s64, s64, s32
    s_cmp_eq_u32 s35, 0
    s_cbranch_scc0 AP_fol
    s_lshl_b32 s37, s32, 7
    s_lshl_b32 s38, s64, 7
    v_mov_b32 v4, s37
    v_writelane_b32 v4, s38, 0
    s_mov_b32 s37, 20059136
    s_mov_b32 s68, 100000
AP_spin:
    buffer_load_dword v5, v4, s[20:23], s37 offen sc1
    s_waitcnt vmcnt(0)
AP_chk:
    v_cmp_ne_u32 vcc, 1, v5
    s_cbranch_vccz AP_out
    s_sub_u32 s68, s68, 1
    s_cbranch_scc1 AP_out
    s_sleep 2
    s_branch AP_spin
AP_out:
    v_mov_b32 v4, 162816
    v_mov_b32 v5, 1
    s_mov_b64 exec, 1
    ds_add_u32 v4, v5 offset:20
    s_mov_b64 exec, -1
    s_branch AP_done
AP_fol:
    v_mov_b32 v4, 162816
    s_mov_b32 s68, 1000000
APF_spin:
    ds_read_b32 v5, v4 offset:20
    s_waitcnt lgkmcnt(0)
    v_cmp_ne_u32 vcc, 1, v5
    s_cbranch_vccz APF_out
    s_sub_u32 s68, s68, 1
    s_sleep 1
    s_cbranch_scc0 APF_spin
APF_out:
AP_done:
    v_lshrrev_b32 v20, 4, v0
    v_mul_u32_u24 v20, 2560, v20
    v_and_b32 v21, 15, v0
    s_lshl_b32 s36, s35, 4
    v_add_u32_e64 v21, s36, v21
    v_lshl_add_u32 v6, v21, 4, v20
    v_lshl_add_u32 v7, v21, 3, v20
    s_lshl_b32 s36, s32, 3
    s_add_u32 s36, s36, s33
    s_mul_i32 s36, s36, 10240
    s_add_u32 s36, s36, 16777216
    buffer_load_dwordx4 v[8:11], v6, s[20:23], s36 offen sc1
    buffer_load_dwordx4 v[12:15], v6, s[20:23], s36 offen offset:1024 sc1
    buffer_load_dwordx2 v[16:17], v7, s[20:23], s36 offen offset:2048 sc1
    s_lshl_b32 s36, s64, 3
    s_add_u32 s36, s36, s33
    s_mul_i32 s36, s36, 10240
    s_add_u32 s36, s36, 16777216
    buffer_load_dwordx4 v[24:27], v6, s[20:23], s36 offen sc1
    buffer_load_dwordx4 v[28:31], v6, s[20:23], s36 offen offset:1024 sc1
    buffer_load_dwordx2 v[32:33], v7, s[20:23], s36 offen offset:2048 sc1
    s_lshl_b32 s47, s33, 16
    s_lshl_b32 s38, s35, 11
    s_add_u32 s47, s47, s38
    s_add_u32 s47, s47, 20971520
    s_add_u32 s48, s47, 32768
    s_add_u32 s38, s38, 143360
    v_and_b32 v20, 15, v0
    v_lshrrev_b32 v21, 4, v0
    v_lshlrev_b32 v19, 4, v20
    v_lshl_add_u32 v19, v21, 3, v19
    v_add_u32 v19, s38, v19
    v_and_b32 v18, 3, v0
    v_mul_u32_u24 v18, 80, v18
    v_add_u32 v18, s38, v18
    s_mov_b32 s52, 1069066811
    s_mov_b32 s53, 1069066811
    s_lshr_b32 s46, s33, 1
    s_mul_i32 s46, s46, 5
    s_mul_i32 s45, s32, 74
    s_add_u32 s46, s46, s45
    s_add_u32 s46, s46, 54
    s_lshl_b32 s46, s46, 4
    s_add_u32 s46, s46, s35
    s_lshl_b32 s46, s46, 8
    s_add_u32 s46, s46, 3145728
    s_and_b32 s67, s33, 1
    s_mul_i32 s44, s67, 12288
    s_add_u32 s44, s44, s46
    s_add_u32 s45, s44, 4096
    s_lshl_b32 s67, s67, 9
    s_add_u32 s46, s46, s67
    s_lshl_b32 s67, s35, 7
    s_sub_u32 s46, s46, s67
    s_add_u32 s46, s46, 8192
    s_lshr_b32 s62, s33, 1
    s_mul_i32 s62, s62, 5
    s_mul_i32 s61, s64, 74
    s_add_u32 s62, s62, s61
    s_add_u32 s62, s62, 54
    s_lshl_b32 s62, s62, 4
    s_add_u32 s62, s62, s35
    s_lshl_b32 s62, s62, 8
    s_add_u32 s62, s62, 3145728
    s_and_b32 s67, s33, 1
    s_mul_i32 s60, s67, 12288
    s_add_u32 s60, s60, s62
    s_add_u32 s61, s60, 4096
    s_lshl_b32 s67, s67, 9
    s_add_u32 s62, s62, s67
    s_lshl_b32 s67, s35, 7
    s_sub_u32 s62, s62, s67
    s_add_u32 s62, s62, 8192
    s_add_u32 s67, s78, 15360
    buffer_load_dwordx4 v[200:203], v2, s[20:23], s67 offen offset:0 sc1
    buffer_load_dwordx4 v[204:207], v2, s[20:23], s67 offen offset:1024 sc1
    buffer_load_dwordx4 v[208:211], v2, s[20:23], s67 offen offset:2048 sc1
    buffer_load_dwordx4 v[212:215], v2, s[20:23], s67 offen offset:3072 sc1
    buffer_load_dwordx4 v[216:219], v3, s[20:23], s67 offen sc1
    s_add_u32 s67, s78, 20480
    buffer_load_dwordx4 v[220:223], v2, s[20:23], s67 offen offset:0 sc1
    buffer_load_dwordx4 v[224:227], v2, s[20:23], s67 offen offset:1024 sc1
    buffer_load_dwordx4 v[228:231], v2, s[20:23], s67 offen offset:2048 sc1
    buffer_load_dwordx4 v[232:235], v2, s[20:23], s67 offen offset:3072 sc1
    buffer_load_dwordx4 v[236:239], v3, s[20:23], s67 offen sc1
    s_waitcnt vmcnt(10)
    v_mov_b32 v4, 162816
    v_mov_b32 v5, 1
    s_mov_b64 exec, 1
    ds_add_u32 v4, v5 offset:4
    s_mov_b64 exec, -1
    v_lshlrev_b32 v40, 16, v8
    v_and_b32 v41, 0xffff0000, v8
    v_lshlrev_b32_e64 v42, 16, v9
    v_and_b32 v43, 0xffff0000, v9
    v_lshlrev_b32_e64 v44, 16, v10
    v_and_b32 v45, 0xffff0000, v10
    v_lshlrev_b32_e64 v46, 16, v11
    v_and_b32 v47, 0xffff0000, v11
    v_lshlrev_b32_e64 v48, 16, v12
    v_and_b32 v49, 0xffff0000, v12
    v_lshlrev_b32_e64 v50, 16, v13
    v_and_b32 v51, 0xffff0000, v13
    v_lshlrev_b32_e64 v52, 16, v14
    v_and_b32 v53, 0xffff0000, v14
    v_lshlrev_b32_e64 v54, 16, v15
    v_and_b32 v55, 0xffff0000, v15
    v_lshlrev_b32_e64 v56, 16, v16
    v_and_b32 v57, 0xffff0000, v16
    v_lshlrev_b32_e64 v58, 16, v17
    v_and_b32 v59, 0xffff0000, v17
    v_max3_f32 v240, v40, v41, v42
    v_min3_f32 v242, v40, v41, v42
    v_max3_f32 v240, v240, v43, v44
    v_min3_f32 v242, v242, v43, v44
    v_max3_f32 v240, v240, v45, v46
    v_min3_f32 v242, v242, v45, v46
    v_max3_f32 v240, v240, v47, v48
    v_min3_f32 v242, v242, v47, v48
    v_max3_f32 v240, v240, v49, v50
    v_min3_f32 v242, v242, v49, v50
    v_max3_f32 v240, v240, v51, v52
    v_min3_f32 v242, v242, v51, v52
    v_max3_f32 v240, v240, v53, v54
    v_min3_f32 v242, v242, v53, v54
    v_max3_f32 v240, v240, v55, v56
    v_min3_f32 v242, v242, v55, v56
    v_max3_f32 v240, v240, v57, v58
    v_min3_f32 v242, v242, v57, v58
    v_max_f32 v240, v240, v59
    v_min_f32 v242, v242, v59
    v_mul_f32 v240, s52, v240
    v_mul_f32 v242, s52, v242
    v_pk_fma_f32 v[60:61], v[40:41], s[52:53], v[240:241] op_sel_hi:[1,0,0] neg_lo:[0,0,1] neg_hi:[0,0,1]
    v_pk_fma_f32 v[80:81], v[40:41], s[52:53], v[242:243] op_sel_hi:[1,0,0] neg_lo:[1,0,0] neg_hi:[1,0,0]
    v_pk_fma_f32 v[62:63], v[42:43], s[52:53], v[240:241] op_sel_hi:[1,0,0] neg_lo:[0,0,1] neg_hi:[0,0,1]
    v_pk_fma_f32 v[82:83], v[42:43], s[52:53], v[242:243] op_sel_hi:[1,0,0] neg_lo:[1,0,0] neg_hi:[1,0,0]
    v_pk_fma_f32 v[64:65], v[44:45], s[52:53], v[240:241] op_sel_hi:[1,0,0] neg_lo:[0,0,1] neg_hi:[0,0,1]
    v_pk_fma_f32 v[84:85], v[44:45], s[52:53], v[242:243] op_sel_hi:[1,0,0] neg_lo:[1,0,0] neg_hi:[1,0,0]
    v_pk_fma_f32 v[66:67], v[46:47], s[52:53], v[240:241] op_sel_hi:[1,0,0] neg_lo:[0,0,1] neg_hi:[0,0,1]
    v_pk_fma_f32 v[86:87], v[46:47], s[52:53], v[242:243] op_sel_hi:[1,0,0] neg_lo:[1,0,0] neg_hi:[1,0,0]
    v_pk_fma_f32 v[68:69], v[48:49], s[52:53], v[240:241] op_sel_hi:[1,0,0] neg_lo:[0,0,1] neg_hi:[0,0,1]
    v_pk_fma_f32 v[88:89], v[48:49], s[52:53], v[242:243] op_sel_hi:[1,0,0] neg_lo:[1,0,0] neg_hi:[1,0,0]
    v_pk_fma_f32 v[70:71], v[50:51], s[52:53], v[240:241] op_sel_hi:[1,0,0] neg_lo:[0,0,1] neg_hi:[0,0,1]
    v_pk_fma_f32 v[90:91], v[50:51], s[52:53], v[242:243] op_sel_hi:[1,0,0] neg_lo:[1,0,0] neg_hi:[1,0,0]
    v_pk_fma_f32 v[72:73], v[52:53], s[52:53], v[240:241] op_sel_hi:[1,0,0] neg_lo:[0,0,1] neg_hi:[0,0,1]
    v_pk_fma_f32 v[92:93], v[52:53], s[52:53], v[242:243] op_sel_hi:[1,0,0] neg_lo:[1,0,0] neg_hi:[1,0,0]
    v_pk_fma_f32 v[74:75], v[54:55], s[52:53], v[240:241] op_sel_hi:[1,0,0] neg_lo:[0,0,1] neg_hi:[0,0,1]
    v_pk_fma_f32 v[94:95], v[54:55], s[52:53], v[242:243] op_sel_hi:[1,0,0] neg_lo:[1,0,0] neg_hi:[1,0,0]
    v_pk_fma_f32 v[76:77], v[56:57], s[52:53], v[240:241] op_sel_hi:[1,0,0] neg_lo:[0,0,1] neg_hi:[0,0,1]
    v_pk_fma_f32 v[96:97], v[56:57], s[52:53], v[242:243] op_sel_hi:[1,0,0] neg_lo:[1,0,0] neg_hi:[1,0,0]
    v_pk_fma_f32 v[78:79], v[58:59], s[52:53], v[240:241] op_sel_hi:[1,0,0] neg_lo:[0,0,1] neg_hi:[0,0,1]
    v_pk_fma_f32 v[98:99], v[58:59], s[52:53], v[242:243] op_sel_hi:[1,0,0] neg_lo:[1,0,0] neg_hi:[1,0,0]
    v_exp_f32 v60, v60
    v_exp_f32 v61, v61
    v_exp_f32 v62, v62
    v_exp_f32 v63, v63
    v_exp_f32 v64, v64
    v_exp_f32 v65, v65
    v_exp_f32 v66, v66
    v_exp_f32 v67, v67
    v_exp_f32 v68, v68
    v_exp_f32 v69, v69
    v_exp_f32 v70, v70
    v_exp_f32 v71, v71
    v_exp_f32 v72, v72
    v_exp_f32 v73, v73
    v_exp_f32 v74, v74
    v_exp_f32 v75, v75
    v_exp_f32 v76, v76
    v_exp_f32 v77, v77
    v_exp_f32 v78, v78
    v_exp_f32 v79, v79
    v_exp_f32 v80, v80
    v_exp_f32 v81, v81
    v_exp_f32 v82, v82
    v_exp_f32 v83, v83
    v_exp_f32 v84, v84
    v_exp_f32 v85, v85
    v_exp_f32 v86, v86
    v_exp_f32 v87, v87
    v_exp_f32 v88, v88
    v_exp_f32 v89, v89
    v_exp_f32 v90, v90
    v_exp_f32 v91, v91
    v_exp_f32 v92, v92
    v_exp_f32 v93, v93
    v_exp_f32 v94, v94
    v_exp_f32 v95, v95
    v_exp_f32 v96, v96
    v_exp_f32 v97, v97
    v_exp_f32 v98, v98
    v_exp_f32 v99, v99
    v_pk_add_f32 v[240:241], v[60:61], v[62:63]
    v_pk_add_f32 v[242:243], v[80:81], v[82:83]
    v_pk_add_f32 v[240:241], v[240:241], v[64:65]
    v_pk_add_f32 v[242:243], v[242:243], v[84:85]
    v_pk_add_f32 v[240:241], v[240:241], v[66:67]
    v_pk_add_f32 v[242:243], v[242:243], v[86:87]
    v_pk_add_f32 v[240:241], v[240:241], v[68:69]
    v_pk_add_f32 v[242:243], v[242:243], v[88:89]
    v_pk_add_f32 v[240:241], v[240:241], v[70:71]
    v_pk_add_f32 v[242:243], v[242:243], v[90:91]
    v_pk_add_f32 v[240:241], v[240:241], v[72:73]
    v_pk_add_f32 v[242:243], v[242:243], v[92:93]
    v_pk_add_f32 v[240:241], v[240:241], v[74:75]
    v_pk_add_f32 v[242:243], v[242:243], v[94:95]
    v_pk_add_f32 v[240:241], v[240:241], v[76:77]
    v_pk_add_f32 v[242:243], v[242:243], v[96:97]
    v_pk_add_f32 v[240:241], v[240:241], v[78:79]
    v_pk_add_f32 v[242:243], v[242:243], v[98:99]
    v_add_f32 v240, v240, v241
    v_add_f32 v242, v242, v243
    v_rcp_f32 v240, v240
    v_rcp_f32 v242, v242
    v_pk_mul_f32 v[60:61], v[60:61], v[240:241] op_sel_hi:[1,0]
    v_pk_mul_f32 v[80:81], v[80:81], v[242:243] op_sel_hi:[1,0]
    v_pk_mul_f32 v[62:63], v[62:63], v[240:241] op_sel_hi:[1,0]
    v_pk_mul_f32 v[82:83], v[82:83], v[242:243] op_sel_hi:[1,0]
    v_pk_mul_f32 v[64:65], v[64:65], v[240:241] op_sel_hi:[1,0]
    v_pk_mul_f32 v[84:85], v[84:85], v[242:243] op_sel_hi:[1,0]
    v_pk_mul_f32 v[66:67], v[66:67], v[240:241] op_sel_hi:[1,0]
    v_pk_mul_f32 v[86:87], v[86:87], v[242:243] op_sel_hi:[1,0]
    v_pk_mul_f32 v[68:69], v[68:69], v[240:241] op_sel_hi:[1,0]
    v_pk_mul_f32 v[88:89], v[88:89], v[242:243] op_sel_hi:[1,0]
    v_pk_mul_f32 v[70:71], v[70:71], v[240:241] op_sel_hi:[1,0]
    v_pk_mul_f32 v[90:91], v[90:91], v[242:243] op_sel_hi:[1,0]
    v_pk_mul_f32 v[72:73], v[72:73], v[240:241] op_sel_hi:[1,0]
    v_pk_mul_f32 v[92:93], v[92:93], v[242:243] op_sel_hi:[1,0]
    v_pk_mul_f32 v[74:75], v[74:75], v[240:241] op_sel_hi:[1,0]
    v_pk_mul_f32 v[94:95], v[94:95], v[242:243] op_sel_hi:[1,0]
    v_pk_mul_f32 v[76:77], v[76:77], v[240:241] op_sel_hi:[1,0]
    v_pk_mul_f32 v[96:97], v[96:97], v[242:243] op_sel_hi:[1,0]
    v_pk_mul_f32 v[78:79], v[78:79], v[240:241] op_sel_hi:[1,0]
    v_pk_mul_f32 v[98:99], v[98:99], v[242:243] op_sel_hi:[1,0]
    v_cvt_pk_bf16_f32 v100, v60, v61
    v_cvt_pk_bf16_f32 v101, v62, v63
    v_cvt_pk_bf16_f32 v102, v64, v65
    v_cvt_pk_bf16_f32 v103, v66, v67
    v_cvt_pk_bf16_f32 v104, v68, v69
    v_cvt_pk_bf16_f32 v105, v70, v71
    v_cvt_pk_bf16_f32 v106, v72, v73
    v_cvt_pk_bf16_f32 v107, v74, v75
    v_cvt_pk_bf16_f32 v108, v76, v77
    v_cvt_pk_bf16_f32 v109, v78, v79
    v_cvt_pk_bf16_f32 v110, v80, v81
    v_cvt_pk_bf16_f32 v111, v82, v83
    v_cvt_pk_bf16_f32 v112, v84, v85
    v_cvt_pk_bf16_f32 v113, v86, v87
    v_cvt_pk_bf16_f32 v114, v88, v89
    v_cvt_pk_bf16_f32 v115, v90, v91
    v_cvt_pk_bf16_f32 v116, v92, v93
    v_cvt_pk_bf16_f32 v117, v94, v95
    v_cvt_pk_bf16_f32 v118, v96, v97
    v_cvt_pk_bf16_f32 v119, v98, v99
    s_cmp_eq_u32 s65, 0
    s_cbranch_scc1 P2_a_p1
    v_lshlrev_b32_e64 v40, 16, v24
    v_and_b32 v41, 0xffff0000, v24
    v_lshlrev_b32_e64 v42, 16, v25
    v_and_b32 v43, 0xffff0000, v25
    v_lshlrev_b32_e64 v44, 16, v26
    v_and_b32 v45, 0xffff0000, v26
    v_lshlrev_b32_e64 v46, 16, v27
    v_and_b32 v47, 0xffff0000, v27
    v_lshlrev_b32_e64 v48, 16, v28
    v_and_b32 v49, 0xffff0000, v28
    v_lshlrev_b32_e64 v50, 16, v29
    v_and_b32 v51, 0xffff0000, v29
    v_lshlrev_b32_e64 v52, 16, v30
    v_and_b32 v53, 0xffff0000, v30
    v_lshlrev_b32_e64 v54, 16, v31
    v_and_b32 v55, 0xffff0000, v31
    v_lshlrev_b32_e64 v56, 16, v32
    v_and_b32 v57, 0xffff0000, v32
    v_lshlrev_b32_e64 v58, 16, v33
    v_and_b32 v59, 0xffff0000, v33
    v_max3_f32 v240, v40, v41, v42
    v_min3_f32 v242, v40, v41, v42
    v_max3_f32 v240, v240, v43, v44
    v_min3_f32 v242, v242, v43, v44
    v_max3_f32 v240, v240, v45, v46
    v_min3_f32 v242, v242, v45, v46
    v_max3_f32 v240, v240, v47, v48
    v_min3_f32 v242, v242, v47, v48
    v_max3_f32 v240, v240, v49, v50
    v_min3_f32 v242, v242, v49, v50
    v_max3_f32 v240, v240, v51, v52
    v_min3_f32 v242, v242, v51, v52
    v_max3_f32 v240, v240, v53, v54
    v_min3_f32 v242, v242, v53, v54
    v_max3_f32 v240, v240, v55, v56
    v_min3_f32 v242, v242, v55, v56
    v_max3_f32 v240, v240, v57, v58
    v_min3_f32 v242, v242, v57, v58
    v_max_f32 v240, v240, v59
    v_min_f32 v242, v242, v59
    v_mul_f32 v240, s52, v240
    v_mul_f32 v242, s52, v242
    v_pk_fma_f32 v[60:61], v[40:41], s[52:53], v[240:241] op_sel_hi:[1,0,0] neg_lo:[0,0,1] neg_hi:[0,0,1]
    v_pk_fma_f32 v[80:81], v[40:41], s[52:53], v[242:243] op_sel_hi:[1,0,0] neg_lo:[1,0,0] neg_hi:[1,0,0]
    v_pk_fma_f32 v[62:63], v[42:43], s[52:53], v[240:241] op_sel_hi:[1,0,0] neg_lo:[0,0,1] neg_hi:[0,0,1]
    v_pk_fma_f32 v[82:83], v[42:43], s[52:53], v[242:243] op_sel_hi:[1,0,0] neg_lo:[1,0,0] neg_hi:[1,0,0]
    v_pk_fma_f32 v[64:65], v[44:45], s[52:53], v[240:241] op_sel_hi:[1,0,0] neg_lo:[0,0,1] neg_hi:[0,0,1]
    v_pk_fma_f32 v[84:85], v[44:45], s[52:53], v[242:243] op_sel_hi:[1,0,0] neg_lo:[1,0,0] neg_hi:[1,0,0]
    v_pk_fma_f32 v[66:67], v[46:47], s[52:53], v[240:241] op_sel_hi:[1,0,0] neg_lo:[0,0,1] neg_hi:[0,0,1]
    v_pk_fma_f32 v[86:87], v[46:47], s[52:53], v[242:243] op_sel_hi:[1,0,0] neg_lo:[1,0,0] neg_hi:[1,0,0]
    v_pk_fma_f32 v[68:69], v[48:49], s[52:53], v[240:241] op_sel_hi:[1,0,0] neg_lo:[0,0,1] neg_hi:[0,0,1]
    v_pk_fma_f32 v[88:89], v[48:49], s[52:53], v[242:243] op_sel_hi:[1,0,0] neg_lo:[1,0,0] neg_hi:[1,0,0]
    v_pk_fma_f32 v[70:71], v[50:51], s[52:53], v[240:241] op_sel_hi:[1,0,0] neg_lo:[0,0,1] neg_hi:[0,0,1]
    v_pk_fma_f32 v[90:91], v[50:51], s[52:53], v[242:243] op_sel_hi:[1,0,0] neg_lo:[1,0,0] neg_hi:[1,0,0]
    v_pk_fma_f32 v[72:73], v[52:53], s[52:53], v[240:241] op_sel_hi:[1,0,0] neg_lo:[0,0,1] neg_hi:[0,0,1]
    v_pk_fma_f32 v[92:93], v[52:53], s[52:53], v[242:243] op_sel_hi:[1,0,0] neg_lo:[1,0,0] neg_hi:[1,0,0]
    v_pk_fma_f32 v[74:75], v[54:55], s[52:53], v[240:241] op_sel_hi:[1,0,0] neg_lo:[0,0,1] neg_hi:[0,0,1]
    v_pk_fma_f32 v[94:95], v[54:55], s[52:53], v[242:243] op_sel_hi:[1,0,0] neg_lo:[1,0,0] neg_hi:[1,0,0]
    v_pk_fma_f32 v[76:77], v[56:57], s[52:53], v[240:241] op_sel_hi:[1,0,0] neg_lo:[0,0,1] neg_hi:[0,0,1]
    v_pk_fma_f32 v[96:97], v[56:57], s[52:53], v[242:243] op_sel_hi:[1,0,0] neg_lo:[1,0,0] neg_hi:[1,0,0]
    v_pk_fma_f32 v[78:79], v[58:59], s[52:53], v[240:241] op_sel_hi:[1,0,0] neg_lo:[0,0,1] neg_hi:[0,0,1]
    v_pk_fma_f32 v[98:99], v[58:59], s[52:53], v[242:243] op_sel_hi:[1,0,0] neg_lo:[1,0,0] neg_hi:[1,0,0]
    v_exp_f32 v60, v60
    v_exp_f32 v61, v61
    v_exp_f32 v62, v62
    v_exp_f32 v63, v63
    v_exp_f32 v64, v64
    v_exp_f32 v65, v65
    v_exp_f32 v66, v66
    v_exp_f32 v67, v67
    v_exp_f32 v68, v68
    v_exp_f32 v69, v69
    v_exp_f32 v70, v70
    v_exp_f32 v71, v71
    v_exp_f32 v72, v72
    v_exp_f32 v73, v73
    v_exp_f32 v74, v74
    v_exp_f32 v75, v75
    v_exp_f32 v76, v76
    v_exp_f32 v77, v77
    v_exp_f32 v78, v78
    v_exp_f32 v79, v79
    v_exp_f32 v80, v80
    v_exp_f32 v81, v81
    v_exp_f32 v82, v82
    v_exp_f32 v83, v83
    v_exp_f32 v84, v84
    v_exp_f32 v85, v85
    v_exp_f32 v86, v86
    v_exp_f32 v87, v87
    v_exp_f32 v88, v88
    v_exp_f32 v89, v89
    v_exp_f32 v90, v90
    v_exp_f32 v91, v91
    v_exp_f32 v92, v92
    v_exp_f32 v93, v93
    v_exp_f32 v94, v94
    v_exp_f32 v95, v95
    v_exp_f32 v96, v96
    v_exp_f32 v97, v97
    v_exp_f32 v98, v98
    v_exp_f32 v99, v99
    v_pk_add_f32 v[240:241], v[60:61], v[62:63]
    v_pk_add_f32 v[242:243], v[80:81], v[82:83]
    v_pk_add_f32 v[240:241], v[240:241], v[64:65]
    v_pk_add_f32 v[242:243], v[242:243], v[84:85]
    v_pk_add_f32 v[240:241], v[240:241], v[66:67]
    v_pk_add_f32 v[242:243], v[242:243], v[86:87]
    v_pk_add_f32 v[240:241], v[240:241], v[68:69]
    v_pk_add_f32 v[242:243], v[242:243], v[88:89]
    v_pk_add_f32 v[240:241], v[240:241], v[70:71]
    v_pk_add_f32 v[242:243], v[242:243], v[90:91]
    v_pk_add_f32 v[240:241], v[240:241], v[72:73]
    v_pk_add_f32 v[242:243], v[242:243], v[92:93]
    v_pk_add_f32 v[240:241], v[240:241], v[74:75]
    v_pk_add_f32 v[242:243], v[242:243], v[94:95]
    v_pk_add_f32 v[240:241], v[240:241], v[76:77]
    v_pk_add_f32 v[242:243], v[242:243], v[96:97]
    v_pk_add_f32 v[240:241], v[240:241], v[78:79]
    v_pk_add_f32 v[242:243], v[242:243], v[98:99]
    v_add_f32 v240, v240, v241
    v_add_f32 v242, v242, v243
    v_rcp_f32 v240, v240
    v_rcp_f32 v242, v242
    v_pk_mul_f32 v[60:61], v[60:61], v[240:241] op_sel_hi:[1,0]
    v_pk_mul_f32 v[80:81], v[80:81], v[242:243] op_sel_hi:[1,0]
    v_pk_mul_f32 v[62:63], v[62:63], v[240:241] op_sel_hi:[1,0]
    v_pk_mul_f32 v[82:83], v[82:83], v[242:243] op_sel_hi:[1,0]
    v_pk_mul_f32 v[64:65], v[64:65], v[240:241] op_sel_hi:[1,0]
    v_pk_mul_f32 v[84:85], v[84:85], v[242:243] op_sel_hi:[1,0]
    v_pk_mul_f32 v[66:67], v[66:67], v[240:241] op_sel_hi:[1,0]
    v_pk_mul_f32 v[86:87], v[86:87], v[242:243] op_sel_hi:[1,0]
    v_pk_mul_f32 v[68:69], v[68:69], v[240:241] op_sel_hi:[1,0]
    v_pk_mul_f32 v[88:89], v[88:89], v[242:243] op_sel_hi:[1,0]
    v_pk_mul_f32 v[70:71], v[70:71], v[240:241] op_sel_hi:[1,0]
    v_pk_mul_f32 v[90:91], v[90:91], v[242:243] op_sel_hi:[1,0]
    v_pk_mul_f32 v[72:73], v[72:73], v[240:241] op_sel_hi:[1,0]
    v_pk_mul_f32 v[92:93], v[92:93], v[242:243] op_sel_hi:[1,0]
    v_pk_mul_f32 v[74:75], v[74:75], v[240:241] op_sel_hi:[1,0]
    v_pk_mul_f32 v[94:95], v[94:95], v[242:243] op_sel_hi:[1,0]
    v_pk_mul_f32 v[76:77], v[76:77], v[240:241] op_sel_hi:[1,0]
    v_pk_mul_f32 v[96:97], v[96:97], v[242:243] op_sel_hi:[1,0]
    v_pk_mul_f32 v[78:79], v[78:79], v[240:241] op_sel_hi:[1,0]
    v_pk_mul_f32 v[98:99], v[98:99], v[242:243] op_sel_hi:[1,0]
    v_cvt_pk_bf16_f32 v120, v60, v61
    v_cvt_pk_bf16_f32 v121, v62, v63
    v_cvt_pk_bf16_f32 v122, v64, v65
    v_cvt_pk_bf16_f32 v123, v66, v67
    v_cvt_pk_bf16_f32 v124, v68, v69
    v_cvt_pk_bf16_f32 v125, v70, v71
    v_cvt_pk_bf16_f32 v126, v72, v73
    v_cvt_pk_bf16_f32 v127, v74, v75
    v_cvt_pk_bf16_f32 v128, v76, v77
    v_cvt_pk_bf16_f32 v129, v78, v79
    v_cvt_pk_bf16_f32 v130, v80, v81
    v_cvt_pk_bf16_f32 v131, v82, v83
    v_cvt_pk_bf16_f32 v132, v84, v85
    v_cvt_pk_bf16_f32 v133, v86, v87
    v_cvt_pk_bf16_f32 v134, v88, v89
    v_cvt_pk_bf16_f32 v135, v90, v91
    v_cvt_pk_bf16_f32 v136, v92, v93
    v_cvt_pk_bf16_f32 v137, v94, v95
    v_cvt_pk_bf16_f32 v138, v96, v97
    v_cvt_pk_bf16_f32 v139, v98, v99
P2_a_p1:
    v_and_b32 v20, 15, v0
    v_lshrrev_b32 v21, 4, v0
    v_lshlrev_b32_e64 v16, 4, v20
    v_lshl_add_u32 v16, v21, 13, v16
    v_mov_b32 v21, 0x7ffffff0
    v_cmp_gt_u32 vcc, 8, v20
    s_nop 1
    v_cndmask_b32 v17, v21, v16, vcc
    v_mov_b32 v21, 0x3f80
    v_mov_b32 v22, 0x3f800000
    v_cmp_eq_u32 vcc, 0, v20
    s_nop 1
    v_cndmask_b32 v84, 0, v21, vcc
    v_cmp_eq_u32 vcc, 1, v20
    s_nop 1
    v_cndmask_b32 v84, v84, v22, vcc
    v_cmp_eq_u32 vcc, 2, v20
    s_nop 1
    v_cndmask_b32 v85, 0, v21, vcc
    v_cmp_eq_u32 vcc, 3, v20
    s_nop 1
    v_cndmask_b32 v85, v85, v22, vcc
    v_cmp_eq_u32 vcc, 4, v20
    s_nop 1
    v_cndmask_b32 v86, 0, v21, vcc
    v_cmp_eq_u32 vcc, 5, v20
    s_nop 1
    v_cndmask_b32 v86, v86, v22, vcc
    v_cmp_eq_u32 vcc, 6, v20
    s_nop 1
    v_cndmask_b32 v87, 0, v21, vcc
    v_cmp_eq_u32 vcc, 7, v20
    s_nop 1
    v_cndmask_b32 v87, v87, v22, vcc
    v_lshrrev_b32 v6, 4, v0
    v_lshlrev_b32 v6, 10, v6
    v_and_b32_e64 v7, 15, v0
    v_lshl_add_u32 v6, v7, 4, v6
    v_lshlrev_b32 v7, 3, v7
    v_sub_u32 v7, v6, v7
    v_mov_b32 v140, 0
    v_mov_b32 v141, 0
    v_mov_b32 v142, 0
    v_mov_b32 v143, 0
    v_mov_b32 v144, 0
    v_mov_b32 v145, 0
    v_mov_b32 v146, 0
    v_mov_b32 v147, 0
    v_mov_b32 v148, 0
    v_mov_b32 v149, 0
    v_mov_b32 v150, 0
    v_mov_b32 v151, 0
    v_mov_b32 v152, 0
    v_mov_b32 v153, 0
    v_mov_b32 v154, 0
    v_mov_b32 v155, 0
    v_mov_b32 v156, 0
    v_mov_b32 v157, 0
    v_mov_b32 v158, 0
    v_mov_b32 v159, 0
    v_mov_b32 v240, 0
    v_mov_b32 v241, 0
    v_mov_b32 v242, 0
    v_mov_b32 v243, 0
    v_mov_b32 v244, 0
    v_mov_b32 v245, 0
    v_mov_b32 v246, 0
    v_mov_b32 v247, 0
    v_mov_b32 v248, 0
    v_mov_b32 v249, 0
    v_mov_b32 v250, 0
    v_mov_b32 v251, 0
    v_mov_b32 v252, 0
    v_mov_b32 v253, 0
    v_mov_b32 v254, 0
    v_mov_b32 v255, 0
    v_mov_b32 v8, 0
    v_mov_b32 v9, 0
    v_mov_b32 v10, 0
    v_mov_b32 v11, 0
    v_mov_b32 v12, 0
    v_mov_b32 v13, 0
    v_mov_b32 v14, 0
    v_mov_b32 v15, 0
    s_cmp_eq_u32 s35, 0
    s_cbranch_scc0 AK_fol
    s_lshl_b32 s37, s33, 16
    s_add_u32 s37, s37, 20973436
    v_and_b32 v4, 31, v0
    v_lshlrev_b32 v4, 11, v4
    s_mov_b32 s68, 100000
AK_spin:
    buffer_load_dword v5, v4, s[20:23], s37 offen sc1
    s_waitcnt vmcnt(0)
AK_chk:
    v_cmp_eq_u32 vcc, -1, v5
    s_cbranch_vccz AK_out
    s_sub_u32 s68, s68, 1
    s_cbranch_scc1 AK_out
    s_sleep 2
    s_branch AK_spin
AK_out:
    v_mov_b32 v4, 162816
    v_mov_b32 v5, 1
    s_mov_b64 exec, 1
    ds_add_u32 v4, v5 offset:8
    s_mov_b64 exec, -1
    s_branch AK_done
AK_fol:
    v_mov_b32 v4, 162816
    s_mov_b32 s68, 1000000
AKF_spin:
    ds_read_b32 v5, v4 offset:8
    s_waitcnt lgkmcnt(0)
    v_cmp_ne_u32 vcc, 1, v5
    s_cbranch_vccz AKF_out
    s_sub_u32 s68, s68, 1
    s_sleep 1
    s_cbranch_scc0 AKF_spin
AKF_out:
AK_done:
    s_mov_b32 s68, 100000
KV_rty:
    buffer_load_dwordx4 v[20:23], v16, s[20:23], s47 offen offset:0 sc1
    buffer_load_dwordx4 v[24:27], v16, s[20:23], s48 offen offset:0 sc1
    buffer_load_dwordx4 v[28:31], v16, s[20:23], s47 offen offset:256 sc1
    buffer_load_dwordx4 v[32:35], v16, s[20:23], s48 offen offset:256 sc1
    buffer_load_dwordx4 v[36:39], v16, s[20:23], s47 offen offset:512 sc1
    buffer_load_dwordx4 v[40:43], v16, s[20:23], s48 offen offset:512 sc1
    buffer_load_dwordx4 v[44:47], v16, s[20:23], s47 offen offset:768 sc1
    buffer_load_dwordx4 v[48:51], v16, s[20:23], s48 offen offset:768 sc1
    buffer_load_dwordx4 v[52:55], v16, s[20:23], s47 offen offset:1024 sc1
    buffer_load_dwordx4 v[56:59], v16, s[20:23], s48 offen offset:1024 sc1
    buffer_load_dwordx4 v[60:63], v16, s[20:23], s47 offen offset:1280 sc1
    buffer_load_dwordx4 v[64:67], v16, s[20:23], s48 offen offset:1280 sc1
    buffer_load_dwordx4 v[68:71], v16, s[20:23], s47 offen offset:1536 sc1
    buffer_load_dwordx4 v[72:75], v16, s[20:23], s48 offen offset:1536 sc1
    buffer_load_dwordx4 v[76:79], v17, s[20:23], s47 offen offset:1792 sc1
    buffer_load_dwordx4 v[80:83], v17, s[20:23], s48 offen offset:1792 sc1
    s_waitcnt vmcnt(14)
    v_max3_u32 v96, v20, v21, v27
    v_max3_u32 v96, v22, v23, v96
    v_max3_u32 v96, v24, v25, v96
    v_max_u32 v96, v26, v96
    v_mfma_f32_16x16x32_bf16 v[88:91], v[84:87], v[20:23], 0
    v_mfma_f32_16x16x32_bf16 v[88:91], v[84:87], v[24:27], v[88:91]
    s_waitcnt vmcnt(12)
    v_max3_u32 v96, v28, v29, v96
    v_max3_u32 v96, v30, v31, v96
    v_max3_u32 v96, v32, v33, v96
    v_max3_u32 v96, v34, v35, v96
    v_mfma_f32_16x16x32_bf16 v[92:95], v[84:87], v[28:31], 0
    v_mfma_f32_16x16x32_bf16 v[92:95], v[84:87], v[32:35], v[92:95]
    s_nop 0
    v_cvt_pk_bf16_f32 v20, v88, v89
    v_cvt_pk_bf16_f32 v21, v90, v91
    s_mov_b64 exec, 0xffffffff
    ds_write_b64 v19, v[20:21] offset:0
    s_mov_b64 exec, -1
    s_waitcnt vmcnt(10)
    v_max3_u32 v96, v36, v37, v96
    v_max3_u32 v96, v38, v39, v96
    v_max3_u32 v96, v40, v41, v96
    v_max3_u32 v96, v42, v43, v96
    v_mfma_f32_16x16x32_bf16 v[88:91], v[84:87], v[36:39], 0
    v_mfma_f32_16x16x32_bf16 v[88:91], v[84:87], v[40:43], v[88:91]
    v_cvt_pk_bf16_f32 v28, v92, v93
    v_cvt_pk_bf16_f32 v29, v94, v95
    s_mov_b64 exec, 0xffffffff
    ds_write_b64 v19, v[28:29] offset:256
    s_mov_b64 exec, -1
    s_waitcnt vmcnt(8)
    v_max3_u32 v96, v44, v45, v96
    v_max3_u32 v96, v46, v47, v96
    v_max3_u32 v96, v48, v49, v96
    v_max3_u32 v96, v50, v51, v96
    v_mfma_f32_16x16x32_bf16 v[92:95], v[84:87], v[44:47], 0
    v_mfma_f32_16x16x32_bf16 v[92:95], v[84:87], v[48:51], v[92:95]
    v_cvt_pk_bf16_f32 v36, v88, v89
    v_cvt_pk_bf16_f32 v37, v90, v91
    s_mov_b64 exec, 0xffffffff
    ds_write_b64 v19, v[36:37] offset:512
    s_mov_b64 exec, -1
    s_waitcnt vmcnt(6)
    v_max3_u32 v96, v52, v53, v96
    v_max3_u32 v96, v54, v55, v96
    v_max3_u32 v96, v56, v57, v96
    v_max3_u32 v96, v58, v59, v96
    v_mfma_f32_16x16x32_bf16 v[88:91], v[84:87], v[52:55], 0
    v_mfma_f32_16x16x32_bf16 v[88:91], v[84:87], v[56:59], v[88:91]
    v_cvt_pk_bf16_f32 v44, v92, v93
    v_cvt_pk_bf16_f32 v45, v94, v95
    s_mov_b64 exec, 0xffffffff
    ds_write_b64 v19, v[44:45] offset:768
    s_mov_b64 exec, -1
    s_waitcnt vmcnt(4)
    v_max3_u32 v96, v60, v61, v96
    v_max3_u32 v96, v62, v63, v96
    v_max3_u32 v96, v64, v65, v96
    v_max3_u32 v96, v66, v67, v96
    v_mfma_f32_16x16x32_bf16 v[92:95], v[84:87], v[60:63], 0
    v_mfma_f32_16x16x32_bf16 v[92:95], v[84:87], v[64:67], v[92:95]
    v_cvt_pk_bf16_f32 v52, v88, v89
    v_cvt_pk_bf16_f32 v53, v90, v91
    s_mov_b64 exec, 0xffffffff
    ds_write_b64 v19, v[52:53] offset:1024
    s_mov_b64 exec, -1
    s_waitcnt vmcnt(2)
    v_max3_u32 v96, v68, v69, v96
    v_max3_u32 v96, v70, v71, v96
    v_max3_u32 v96, v72, v73, v96
    v_max3_u32 v96, v74, v75, v96
    v_mfma_f32_16x16x32_bf16 v[88:91], v[84:87], v[68:71], 0
    v_mfma_f32_16x16x32_bf16 v[88:91], v[84:87], v[72:75], v[88:91]
    v_cvt_pk_bf16_f32 v60, v92, v93
    v_cvt_pk_bf16_f32 v61, v94, v95
    s_mov_b64 exec, 0xffffffff
    ds_write_b64 v19, v[60:61] offset:1280
    s_mov_b64 exec, -1
    s_waitcnt vmcnt(0)
    v_max3_u32 v96, v76, v77, v96
    v_max3_u32 v96, v78, v79, v96
    v_max3_u32 v96, v80, v81, v96
    v_max3_u32 v96, v82, v83, v96
    v_mfma_f32_16x16x32_bf16 v[92:95], v[84:87], v[76:79], 0
    v_mfma_f32_16x16x32_bf16 v[92:95], v[84:87], v[80:83], v[92:95]
    v_cvt_pk_bf16_f32 v68, v88, v89
    v_cvt_pk_bf16_f32 v69, v90, v91
    s_mov_b64 exec, 0xffffffff
    ds_write_b64 v19, v[68:69] offset:1536
    s_mov_b64 exec, -1
    s_nop 2
    v_cvt_pk_bf16_f32 v76, v92, v93
    v_cvt_pk_bf16_f32 v77, v94, v95
    s_mov_b64 exec, 0xffffffff
    ds_write_b64 v19, v[76:77] offset:1792
    s_mov_b64 exec, -1
    v_cmp_eq_u32 vcc, -1, v96
    s_cbranch_vccz KV_ok
    s_sub_u32 s68, s68, 1
    s_cbranch_scc0 KV_rty
KV_ok:
    v_mov_b32 v4, 162816
    v_mov_b32 v5, 1
    s_mov_b64 exec, 1
    ds_add_u32 v4, v5 offset:56
    s_mov_b64 exec, -1
    s_mov_b32 s50, 0x00f0000f
    s_mov_b32 s51, 0xf0000f00
    s_waitcnt lgkmcnt(0)
    s_cmp_eq_u32 s65, 0
    s_cbranch_scc1 P2_a_s1
    s_mov_b64 exec, s[50:51]
    ds_read_b128 v[140:143], v18 offset:1600
    ds_read_b128 v[144:147], v18 offset:1616
    ds_read_b128 v[148:151], v18 offset:1632
    ds_read_b128 v[152:155], v18 offset:1648
    ds_read_b128 v[156:159], v18 offset:1664
    ds_read_b128 v[240:243], v18 offset:0
    ds_read_b128 v[244:247], v18 offset:16
    ds_read_b128 v[248:251], v18 offset:32
    ds_read_b128 v[252:255], v18 offset:48
    ds_read_b128 v[8:11], v18 offset:64
    s_mov_b64 exec, -1
    s_waitcnt lgkmcnt(9)
    v_mfma_f32_16x16x32_bf16 v[60:63], v[140:143], v[100:103], 0
    v_mfma_f32_16x16x32_bf16 v[84:87], v[140:143], v[120:123], 0
    s_waitcnt lgkmcnt(8)
    v_mfma_f32_16x16x32_bf16 v[60:63], v[144:147], v[104:107], v[60:63]
    v_mfma_f32_16x16x32_bf16 v[84:87], v[144:147], v[124:127], v[84:87]
    s_waitcnt lgkmcnt(7)
    v_mfma_f32_16x16x32_bf16 v[60:63], v[148:151], v[108:111], v[60:63]
    v_mfma_f32_16x16x32_bf16 v[84:87], v[148:151], v[128:131], v[84:87]
    s_waitcnt lgkmcnt(6)
    v_mfma_f32_16x16x32_bf16 v[60:63], v[152:155], v[112:115], v[60:63]
    v_mfma_f32_16x16x32_bf16 v[84:87], v[152:155], v[132:135], v[84:87]
    s_waitcnt lgkmcnt(5)
    v_mfma_f32_16x16x32_bf16 v[60:63], v[156:159], v[116:119], v[60:63]
    v_mfma_f32_16x16x32_bf16 v[84:87], v[156:159], v[136:139], v[84:87]
    s_mov_b64 exec, s[50:51]
    ds_read_b128 v[12:15], v18 offset:320
    ds_read_b128 v[140:143], v18 offset:336
    ds_read_b128 v[144:147], v18 offset:352
    ds_read_b128 v[148:151], v18 offset:368
    ds_read_b128 v[152:155], v18 offset:384
    s_mov_b64 exec, -1
    s_waitcnt lgkmcnt(9)
    v_mfma_f32_16x16x32_bf16 v[40:43], v[240:243], v[100:103], 0
    v_mfma_f32_16x16x32_bf16 v[64:67], v[240:243], v[120:123], 0
    s_waitcnt lgkmcnt(8)
    v_mfma_f32_16x16x32_bf16 v[40:43], v[244:247], v[104:107], v[40:43]
    v_mfma_f32_16x16x32_bf16 v[64:67], v[244:247], v[124:127], v[64:67]
    s_waitcnt lgkmcnt(7)
    v_mfma_f32_16x16x32_bf16 v[40:43], v[248:251], v[108:111], v[40:43]
    v_mfma_f32_16x16x32_bf16 v[64:67], v[248:251], v[128:131], v[64:67]
    s_waitcnt lgkmcnt(6)
    v_mfma_f32_16x16x32_bf16 v[40:43], v[252:255], v[112:115], v[40:43]
    v_mfma_f32_16x16x32_bf16 v[64:67], v[252:255], v[132:135], v[64:67]
    s_waitcnt lgkmcnt(5)
    v_mfma_f32_16x16x32_bf16 v[40:43], v[8:11], v[116:119], v[40:43]
    v_mfma_f32_16x16x32_bf16 v[64:67], v[8:11], v[136:139], v[64:67]
    s_mov_b64 exec, s[50:51]
    ds_read_b128 v[156:159], v18 offset:640
    ds_read_b128 v[240:243], v18 offset:656
    ds_read_b128 v[244:247], v18 offset:672
    ds_read_b128 v[248:251], v18 offset:688
    ds_read_b128 v[252:255], v18 offset:704
    s_mov_b64 exec, -1
    s_waitcnt lgkmcnt(9)
    v_mfma_f32_16x16x32_bf16 v[44:47], v[12:15], v[100:103], 0
    v_mfma_f32_16x16x32_bf16 v[68:71], v[12:15], v[120:123], 0
    s_waitcnt lgkmcnt(8)
    v_mfma_f32_16x16x32_bf16 v[44:47], v[140:143], v[104:107], v[44:47]
    v_mfma_f32_16x16x32_bf16 v[68:71], v[140:143], v[124:127], v[68:71]
    s_waitcnt lgkmcnt(7)
    v_mfma_f32_16x16x32_bf16 v[44:47], v[144:147], v[108:111], v[44:47]
    v_mfma_f32_16x16x32_bf16 v[68:71], v[144:147], v[128:131], v[68:71]
    s_waitcnt lgkmcnt(6)
    v_mfma_f32_16x16x32_bf16 v[44:47], v[148:151], v[112:115], v[44:47]
    v_mfma_f32_16x16x32_bf16 v[68:71], v[148:151], v[132:135], v[68:71]
    s_waitcnt lgkmcnt(5)
    v_mfma_f32_16x16x32_bf16 v[44:47], v[152:155], v[116:119], v[44:47]
    v_mfma_f32_16x16x32_bf16 v[68:71], v[152:155], v[136:139], v[68:71]
    s_mov_b64 exec, s[50:51]
    ds_read_b128 v[8:11], v18 offset:960
    ds_read_b128 v[12:15], v18 offset:976
    ds_read_b128 v[140:143], v18 offset:992
    ds_read_b128 v[144:147], v18 offset:1008
    ds_read_b128 v[148:151], v18 offset:1024
    s_mov_b64 exec, -1
    v_add_f32 v60, 0x358637bd, v60
    v_rcp_f32_e64 v60, v60
    v_add_f32 v84, 0x358637bd, v84
    v_rcp_f32 v84, v84
    s_waitcnt lgkmcnt(9)
    v_mfma_f32_16x16x32_bf16 v[48:51], v[156:159], v[100:103], 0
    v_mfma_f32_16x16x32_bf16 v[72:75], v[156:159], v[120:123], 0
    s_waitcnt lgkmcnt(8)
    v_mfma_f32_16x16x32_bf16 v[48:51], v[240:243], v[104:107], v[48:51]
    v_mfma_f32_16x16x32_bf16 v[72:75], v[240:243], v[124:127], v[72:75]
    s_waitcnt lgkmcnt(7)
    v_mfma_f32_16x16x32_bf16 v[48:51], v[244:247], v[108:111], v[48:51]
    v_mfma_f32_16x16x32_bf16 v[72:75], v[244:247], v[128:131], v[72:75]
    s_waitcnt lgkmcnt(6)
    v_mfma_f32_16x16x32_bf16 v[48:51], v[248:251], v[112:115], v[48:51]
    v_mfma_f32_16x16x32_bf16 v[72:75], v[248:251], v[132:135], v[72:75]
    s_waitcnt lgkmcnt(5)
    v_mfma_f32_16x16x32_bf16 v[48:51], v[252:255], v[116:119], v[48:51]
    v_mfma_f32_16x16x32_bf16 v[72:75], v[252:255], v[136:139], v[72:75]
    s_mov_b64 exec, s[50:51]
    ds_read_b128 v[152:155], v18 offset:1280
    ds_read_b128 v[156:159], v18 offset:1296
    ds_read_b128 v[240:243], v18 offset:1312
    ds_read_b128 v[244:247], v18 offset:1328
    ds_read_b128 v[248:251], v18 offset:1344
    s_mov_b64 exec, -1
    s_waitcnt lgkmcnt(9)
    v_mfma_f32_16x16x32_bf16 v[52:55], v[8:11], v[100:103], 0
    v_mfma_f32_16x16x32_bf16 v[76:79], v[8:11], v[120:123], 0
    s_waitcnt lgkmcnt(8)
    v_mfma_f32_16x16x32_bf16 v[52:55], v[12:15], v[104:107], v[52:55]
    v_mfma_f32_16x16x32_bf16 v[76:79], v[12:15], v[124:127], v[76:79]
    s_waitcnt lgkmcnt(7)
    v_mfma_f32_16x16x32_bf16 v[52:55], v[140:143], v[108:111], v[52:55]
    v_mfma_f32_16x16x32_bf16 v[76:79], v[140:143], v[128:131], v[76:79]
    s_waitcnt lgkmcnt(6)
    v_mfma_f32_16x16x32_bf16 v[52:55], v[144:147], v[112:115], v[52:55]
    v_mfma_f32_16x16x32_bf16 v[76:79], v[144:147], v[132:135], v[76:79]
    s_waitcnt lgkmcnt(5)
    v_mfma_f32_16x16x32_bf16 v[52:55], v[148:151], v[116:119], v[52:55]
    v_mfma_f32_16x16x32_bf16 v[76:79], v[148:151], v[136:139], v[76:79]
    s_waitcnt lgkmcnt(4)
    v_mfma_f32_16x16x32_bf16 v[56:59], v[152:155], v[100:103], 0
    v_mfma_f32_16x16x32_bf16 v[80:83], v[152:155], v[120:123], 0
    s_waitcnt lgkmcnt(3)
    v_mfma_f32_16x16x32_bf16 v[56:59], v[156:159], v[104:107], v[56:59]
    v_mfma_f32_16x16x32_bf16 v[80:83], v[156:159], v[124:127], v[80:83]
    s_waitcnt lgkmcnt(2)
    v_mfma_f32_16x16x32_bf16 v[56:59], v[240:243], v[108:111], v[56:59]
    v_mfma_f32_16x16x32_bf16 v[80:83], v[240:243], v[128:131], v[80:83]
    s_waitcnt lgkmcnt(1)
    v_mfma_f32_16x16x32_bf16 v[56:59], v[244:247], v[112:115], v[56:59]
    v_mfma_f32_16x16x32_bf16 v[80:83], v[244:247], v[132:135], v[80:83]
    s_waitcnt lgkmcnt(0)
    v_mfma_f32_16x16x32_bf16 v[56:59], v[248:251], v[116:119], v[56:59]
    v_mfma_f32_16x16x32_bf16 v[80:83], v[248:251], v[136:139], v[80:83]
    v_pk_mul_f32 v[40:41], v[40:41], v[60:61] op_sel_hi:[1,0]
    s_nop 0
    v_cvt_pk_bf16_f32 v20, v40, v41
    v_pk_mul_f32 v[42:43], v[42:43], v[60:61] op_sel_hi:[1,0]
    s_nop 0
    v_cvt_pk_bf16_f32 v21, v42, v43
    v_pk_mul_f32 v[44:45], v[44:45], v[60:61] op_sel_hi:[1,0]
    s_nop 0
    v_cvt_pk_bf16_f32 v22, v44, v45
    v_pk_mul_f32 v[46:47], v[46:47], v[60:61] op_sel_hi:[1,0]
    s_nop 0
    v_cvt_pk_bf16_f32 v23, v46, v47
    v_pk_mul_f32 v[48:49], v[48:49], v[60:61] op_sel_hi:[1,0]
    s_nop 0
    v_cvt_pk_bf16_f32 v24, v48, v49
    v_pk_mul_f32 v[50:51], v[50:51], v[60:61] op_sel_hi:[1,0]
    s_nop 0
    v_cvt_pk_bf16_f32 v25, v50, v51
    v_pk_mul_f32 v[52:53], v[52:53], v[60:61] op_sel_hi:[1,0]
    s_nop 0
    v_cvt_pk_bf16_f32 v26, v52, v53
    v_pk_mul_f32 v[54:55], v[54:55], v[60:61] op_sel_hi:[1,0]
    s_nop 0
    v_cvt_pk_bf16_f32 v27, v54, v55
    v_pk_mul_f32 v[56:57], v[56:57], v[60:61] op_sel_hi:[1,0]
    s_nop 0
    v_cvt_pk_bf16_f32 v28, v56, v57
    v_pk_mul_f32 v[58:59], v[58:59], v[60:61] op_sel_hi:[1,0]
    s_nop 0
    v_cvt_pk_bf16_f32 v29, v58, v59
    buffer_store_dwordx4 v[20:23], v6, s[20:23], s44 offen sc1
    buffer_store_dwordx4 v[24:27], v6, s[20:23], s45 offen sc1
    buffer_store_dwordx2 v[28:29], v7, s[20:23], s46 offen sc1
    v_pk_mul_f32 v[64:65], v[64:65], v[84:85] op_sel_hi:[1,0]
    s_nop 0
    v_cvt_pk_bf16_f32 v30, v64, v65
    v_pk_mul_f32 v[66:67], v[66:67], v[84:85] op_sel_hi:[1,0]
    s_nop 0
    v_cvt_pk_bf16_f32 v31, v66, v67
    v_pk_mul_f32 v[68:69], v[68:69], v[84:85] op_sel_hi:[1,0]
    s_nop 0
    v_cvt_pk_bf16_f32 v32, v68, v69
    v_pk_mul_f32 v[70:71], v[70:71], v[84:85] op_sel_hi:[1,0]
    s_nop 0
    v_cvt_pk_bf16_f32 v33, v70, v71
    v_pk_mul_f32 v[72:73], v[72:73], v[84:85] op_sel_hi:[1,0]
    s_nop 0
    v_cvt_pk_bf16_f32 v34, v72, v73
    v_pk_mul_f32 v[74:75], v[74:75], v[84:85] op_sel_hi:[1,0]
    s_nop 0
    v_cvt_pk_bf16_f32 v35, v74, v75
    v_pk_mul_f32 v[76:77], v[76:77], v[84:85] op_sel_hi:[1,0]
    s_nop 0
    v_cvt_pk_bf16_f32 v36, v76, v77
    v_pk_mul_f32 v[78:79], v[78:79], v[84:85] op_sel_hi:[1,0]
    s_nop 0
    v_cvt_pk_bf16_f32 v37, v78, v79
    v_pk_mul_f32 v[80:81], v[80:81], v[84:85] op_sel_hi:[1,0]
    s_nop 0
    v_cvt_pk_bf16_f32 v38, v80, v81
    v_pk_mul_f32 v[82:83], v[82:83], v[84:85] op_sel_hi:[1,0]
    s_nop 0
    v_cvt_pk_bf16_f32 v39, v82, v83
    buffer_store_dwordx4 v[30:33], v6, s[20:23], s60 offen sc1
    buffer_store_dwordx4 v[34:37], v6, s[20:23], s61 offen sc1
    buffer_store_dwordx2 v[38:39], v7, s[20:23], s62 offen sc1
    s_branch P2_a_4
P2_a_s1:
    s_mov_b64 exec, s[50:51]
    ds_read_b128 v[140:143], v18 offset:1600
    ds_read_b128 v[144:147], v18 offset:1616
    ds_read_b128 v[148:151], v18 offset:1632
    ds_read_b128 v[152:155], v18 offset:1648
    ds_read_b128 v[156:159], v18 offset:1664
    ds_read_b128 v[240:243], v18 offset:0
    ds_read_b128 v[244:247], v18 offset:16
    ds_read_b128 v[248:251], v18 offset:32
    ds_read_b128 v[252:255], v18 offset:48
    ds_read_b128 v[8:11], v18 offset:64
    s_mov_b64 exec, -1
    s_waitcnt lgkmcnt(9)
    v_mfma_f32_16x16x32_bf16 v[60:63], v[140:143], v[100:103], 0
    s_waitcnt lgkmcnt(8)
    v_mfma_f32_16x16x32_bf16 v[60:63], v[144:147], v[104:107], v[60:63]
    s_waitcnt lgkmcnt(7)
    v_mfma_f32_16x16x32_bf16 v[60:63], v[148:151], v[108:111], v[60:63]
    s_waitcnt lgkmcnt(6)
    v_mfma_f32_16x16x32_bf16 v[60:63], v[152:155], v[112:115], v[60:63]
    s_waitcnt lgkmcnt(5)
    v_mfma_f32_16x16x32_bf16 v[60:63], v[156:159], v[116:119], v[60:63]
    s_mov_b64 exec, s[50:51]
    ds_read_b128 v[12:15], v18 offset:320
    ds_read_b128 v[140:143], v18 offset:336
    ds_read_b128 v[144:147], v18 offset:352
    ds_read_b128 v[148:151], v18 offset:368
    ds_read_b128 v[152:155], v18 offset:384
    s_mov_b64 exec, -1
    s_waitcnt lgkmcnt(9)
    v_mfma_f32_16x16x32_bf16 v[40:43], v[240:243], v[100:103], 0
    s_waitcnt lgkmcnt(8)
    v_mfma_f32_16x16x32_bf16 v[40:43], v[244:247], v[104:107], v[40:43]
    s_waitcnt lgkmcnt(7)
    v_mfma_f32_16x16x32_bf16 v[40:43], v[248:251], v[108:111], v[40:43]
    s_waitcnt lgkmcnt(6)
    v_mfma_f32_16x16x32_bf16 v[40:43], v[252:255], v[112:115], v[40:43]
    s_waitcnt lgkmcnt(5)
    v_mfma_f32_16x16x32_bf16 v[40:43], v[8:11], v[116:119], v[40:43]
    s_mov_b64 exec, s[50:51]
    ds_read_b128 v[156:159], v18 offset:640
    ds_read_b128 v[240:243], v18 offset:656
    ds_read_b128 v[244:247], v18 offset:672
    ds_read_b128 v[248:251], v18 offset:688
    ds_read_b128 v[252:255], v18 offset:704
    s_mov_b64 exec, -1
    s_waitcnt lgkmcnt(9)
    v_mfma_f32_16x16x32_bf16 v[44:47], v[12:15], v[100:103], 0
    s_waitcnt lgkmcnt(8)
    v_mfma_f32_16x16x32_bf16 v[44:47], v[140:143], v[104:107], v[44:47]
    s_waitcnt lgkmcnt(7)
    v_mfma_f32_16x16x32_bf16 v[44:47], v[144:147], v[108:111], v[44:47]
    s_waitcnt lgkmcnt(6)
    v_mfma_f32_16x16x32_bf16 v[44:47], v[148:151], v[112:115], v[44:47]
    s_waitcnt lgkmcnt(5)
    v_mfma_f32_16x16x32_bf16 v[44:47], v[152:155], v[116:119], v[44:47]
    s_mov_b64 exec, s[50:51]
    ds_read_b128 v[8:11], v18 offset:960
    ds_read_b128 v[12:15], v18 offset:976
    ds_read_b128 v[140:143], v18 offset:992
    ds_read_b128 v[144:147], v18 offset:1008
    ds_read_b128 v[148:151], v18 offset:1024
    s_mov_b64 exec, -1
    v_add_f32 v60, 0x358637bd, v60
    v_rcp_f32 v60, v60
    s_waitcnt lgkmcnt(9)
    v_mfma_f32_16x16x32_bf16 v[48:51], v[156:159], v[100:103], 0
    s_waitcnt lgkmcnt(8)
    v_mfma_f32_16x16x32_bf16 v[48:51], v[240:243], v[104:107], v[48:51]
    s_waitcnt lgkmcnt(7)
    v_mfma_f32_16x16x32_bf16 v[48:51], v[244:247], v[108:111], v[48:51]
    s_waitcnt lgkmcnt(6)
    v_mfma_f32_16x16x32_bf16 v[48:51], v[248:251], v[112:115], v[48:51]
    s_waitcnt lgkmcnt(5)
    v_mfma_f32_16x16x32_bf16 v[48:51], v[252:255], v[116:119], v[48:51]
    s_mov_b64 exec, s[50:51]
    ds_read_b128 v[152:155], v18 offset:1280
    ds_read_b128 v[156:159], v18 offset:1296
    ds_read_b128 v[240:243], v18 offset:1312
    ds_read_b128 v[244:247], v18 offset:1328
    ds_read_b128 v[248:251], v18 offset:1344
    s_mov_b64 exec, -1
    s_waitcnt lgkmcnt(9)
    v_mfma_f32_16x16x32_bf16 v[52:55], v[8:11], v[100:103], 0
    s_waitcnt lgkmcnt(8)
    v_mfma_f32_16x16x32_bf16 v[52:55], v[12:15], v[104:107], v[52:55]
    s_waitcnt lgkmcnt(7)
    v_mfma_f32_16x16x32_bf16 v[52:55], v[140:143], v[108:111], v[52:55]
    s_waitcnt lgkmcnt(6)
    v_mfma_f32_16x16x32_bf16 v[52:55], v[144:147], v[112:115], v[52:55]
    s_waitcnt lgkmcnt(5)
    v_mfma_f32_16x16x32_bf16 v[52:55], v[148:151], v[116:119], v[52:55]
    s_waitcnt lgkmcnt(4)
    v_mfma_f32_16x16x32_bf16 v[56:59], v[152:155], v[100:103], 0
    s_waitcnt lgkmcnt(3)
    v_mfma_f32_16x16x32_bf16 v[56:59], v[156:159], v[104:107], v[56:59]
    s_waitcnt lgkmcnt(2)
    v_mfma_f32_16x16x32_bf16 v[56:59], v[240:243], v[108:111], v[56:59]
    s_waitcnt lgkmcnt(1)
    v_mfma_f32_16x16x32_bf16 v[56:59], v[244:247], v[112:115], v[56:59]
    s_waitcnt lgkmcnt(0)
    v_mfma_f32_16x16x32_bf16 v[56:59], v[248:251], v[116:119], v[56:59]
    v_pk_mul_f32 v[40:41], v[40:41], v[60:61] op_sel_hi:[1,0]
    s_nop 0
    v_cvt_pk_bf16_f32 v20, v40, v41
    v_pk_mul_f32 v[42:43], v[42:43], v[60:61] op_sel_hi:[1,0]
    s_nop 0
    v_cvt_pk_bf16_f32 v21, v42, v43
    v_pk_mul_f32 v[44:45], v[44:45], v[60:61] op_sel_hi:[1,0]
    s_nop 0
    v_cvt_pk_bf16_f32 v22, v44, v45
    v_pk_mul_f32 v[46:47], v[46:47], v[60:61] op_sel_hi:[1,0]
    s_nop 0
    v_cvt_pk_bf16_f32 v23, v46, v47
    v_pk_mul_f32 v[48:49], v[48:49], v[60:61] op_sel_hi:[1,0]
    s_nop 0
    v_cvt_pk_bf16_f32 v24, v48, v49
    v_pk_mul_f32 v[50:51], v[50:51], v[60:61] op_sel_hi:[1,0]
    s_nop 0
    v_cvt_pk_bf16_f32 v25, v50, v51
    v_pk_mul_f32 v[52:53], v[52:53], v[60:61] op_sel_hi:[1,0]
    s_nop 0
    v_cvt_pk_bf16_f32 v26, v52, v53
    v_pk_mul_f32 v[54:55], v[54:55], v[60:61] op_sel_hi:[1,0]
    s_nop 0
    v_cvt_pk_bf16_f32 v27, v54, v55
    v_pk_mul_f32 v[56:57], v[56:57], v[60:61] op_sel_hi:[1,0]
    s_nop 0
    v_cvt_pk_bf16_f32 v28, v56, v57
    v_pk_mul_f32 v[58:59], v[58:59], v[60:61] op_sel_hi:[1,0]
    s_nop 0
    v_cvt_pk_bf16_f32 v29, v58, v59
    buffer_store_dwordx4 v[20:23], v6, s[20:23], s44 offen sc1
    buffer_store_dwordx4 v[24:27], v6, s[20:23], s45 offen sc1
    buffer_store_dwordx2 v[28:29], v7, s[20:23], s46 offen sc1
    s_branch P2_a_4
P2_a_3:
    s_add_u32 s67, s78, 5120
    buffer_load_dwordx4 v[160:163], v2, s[20:23], s67 offen offset:0 sc1
    buffer_load_dwordx4 v[164:167], v2, s[20:23], s67 offen offset:1024 sc1
    buffer_load_dwordx4 v[168:171], v2, s[20:23], s67 offen offset:2048 sc1
    buffer_load_dwordx4 v[172:175], v2, s[20:23], s67 offen offset:3072 sc1
    buffer_load_dwordx4 v[176:179], v3, s[20:23], s67 offen sc1
    s_add_u32 s67, s78, 10240
    buffer_load_dwordx4 v[180:183], v2, s[20:23], s67 offen offset:0 sc1
    buffer_load_dwordx4 v[184:187], v2, s[20:23], s67 offen offset:1024 sc1
    buffer_load_dwordx4 v[188:191], v2, s[20:23], s67 offen offset:2048 sc1
    buffer_load_dwordx4 v[192:195], v2, s[20:23], s67 offen offset:3072 sc1
    buffer_load_dwordx4 v[196:199], v3, s[20:23], s67 offen sc1
    s_add_u32 s67, s78, 15360
    buffer_load_dwordx4 v[200:203], v2, s[20:23], s67 offen offset:0 sc1
    buffer_load_dwordx4 v[204:207], v2, s[20:23], s67 offen offset:1024 sc1
    buffer_load_dwordx4 v[208:211], v2, s[20:23], s67 offen offset:2048 sc1
    buffer_load_dwordx4 v[212:215], v2, s[20:23], s67 offen offset:3072 sc1
    buffer_load_dwordx4 v[216:219], v3, s[20:23], s67 offen sc1
    s_add_u32 s67, s78, 20480
    buffer_load_dwordx4 v[220:223], v2, s[20:23], s67 offen offset:0 sc1
    buffer_load_dwordx4 v[224:227], v2, s[20:23], s67 offen offset:1024 sc1
    buffer_load_dwordx4 v[228:231], v2, s[20:23], s67 offen offset:2048 sc1
    buffer_load_dwordx4 v[232:235], v2, s[20:23], s67 offen offset:3072 sc1
    buffer_load_dwordx4 v[236:239], v3, s[20:23], s67 offen sc1
    v_mov_b32 v4, 162816
    v_mov_b32 v5, 1
    s_mov_b64 exec, 1
    ds_add_u32 v4, v5 offset:0
    s_mov_b64 exec, -1
P2_a_4:
    s_add_u32 s67, s78, 0
    buffer_load_dwordx4 v[140:143], v2, s[20:23], s67 offen offset:0 sc1
    buffer_load_dwordx4 v[144:147], v2, s[20:23], s67 offen offset:1024 sc1
    buffer_load_dwordx4 v[148:151], v2, s[20:23], s67 offen offset:2048 sc1
    buffer_load_dwordx4 v[152:155], v2, s[20:23], s67 offen offset:3072 sc1
    buffer_load_dwordx4 v[156:159], v3, s[20:23], s67 offen sc1
    s_cmp_eq_u32 s35, 0
    s_cbranch_scc0 AO_fol
    s_mul_i32 s37, s32, 303104
    s_add_u32 s37, s37, 3378300
    v_bfe_u32 v4, v0, 3, 2
    v_mul_u32_u24 v4, 20480, v4
    v_bfe_u32 v5, v0, 2, 1
    v_lshl_add_u32 v4, v5, 9, v4
    v_and_b32 v5, 3, v0
    v_lshl_add_u32 v4, v5, 7, v4
    s_mov_b32 s68, 100000
AO_spin:
    buffer_load_dword v5, v4, s[20:23], s37 offen sc1
    s_waitcnt vmcnt(0)
AO_chk:
    v_cmp_eq_u32 vcc, -1, v5
    s_cbranch_vccz AO_out
    s_sub_u32 s68, s68, 1
    s_cbranch_scc1 AO_out
    s_sleep 2
    s_branch AO_spin
AO_out:
    v_mov_b32 v4, 162816
    v_mov_b32 v5, 1
    s_mov_b64 exec, 1
    ds_add_u32 v4, v5 offset:52
    s_mov_b64 exec, -1
    s_branch AO_done
AO_fol:
    v_mov_b32 v4, 162816
    s_mov_b32 s68, 1000000
AOF_spin:
    ds_read_b32 v5, v4 offset:52
    s_waitcnt lgkmcnt(0)
    v_cmp_ne_u32 vcc, 1, v5
    s_cbranch_vccz AOF_out
    s_sub_u32 s68, s68, 1
    s_sleep 1
    s_cbranch_scc0 AOF_spin
AOF_out:
AO_done:
    s_mov_b32 s68, 100000
    v_lshlrev_b32 v139, 3, v0
    s_add_u32 s42, s40, 4096
    buffer_load_dwordx4 v[84:87], v2, s[20:23], s42 offen offset:0 sc1
    buffer_load_dwordx4 v[88:91], v2, s[20:23], s42 offen offset:1024 sc1
    buffer_load_dwordx4 v[92:95], v2, s[20:23], s42 offen offset:2048 sc1
    buffer_load_dwordx4 v[96:99], v2, s[20:23], s42 offen offset:3072 sc1
    s_add_u32 s42, s40, 8192
    buffer_load_dwordx2 v[100:101], v139, s[20:23], s42 offen offset:0 sc1
    buffer_load_dwordx2 v[102:103], v139, s[20:23], s42 offen offset:512 sc1
    buffer_load_dwordx2 v[104:105], v139, s[20:23], s42 offen offset:1024 sc1
    buffer_load_dwordx2 v[106:107], v139, s[20:23], s42 offen offset:1536 sc1
    buffer_load_dwordx2 v[108:109], v139, s[20:23], s42 offen offset:2048 sc1
    buffer_load_dwordx2 v[110:111], v139, s[20:23], s42 offen offset:2560 sc1
    buffer_load_dwordx2 v[112:113], v139, s[20:23], s42 offen offset:3072 sc1
    buffer_load_dwordx2 v[114:115], v139, s[20:23], s42 offen offset:3584 sc1
    s_add_u32 s42, s40, 12288
    buffer_load_dwordx4 v[116:119], v2, s[20:23], s42 offen offset:0 sc1
    buffer_load_dwordx4 v[120:123], v2, s[20:23], s42 offen offset:1024 sc1
    buffer_load_dwordx4 v[124:127], v2, s[20:23], s42 offen offset:2048 sc1
    buffer_load_dwordx4 v[128:131], v2, s[20:23], s42 offen offset:3072 sc1
    s_mul_i32 s36, s35, 20480
    s_add_u32 s36, s36, 61440
    v_lshrrev_b32 v132, 5, v0
    v_add_u32 v132, v132, v0
    v_lshrrev_b32 v133, 4, v0
    v_lshlrev_b32 v133, 8, v133
    v_add_u32 v133, s36, v133
    v_add_u32 v134, 0, v132
    v_and_b32_e64 v134, 15, v134
    v_lshl_add_u32 v134, v134, 4, v133
    v_add_u32 v135, 2, v132
    v_and_b32 v135, 15, v135
    v_lshl_add_u32 v135, v135, 4, v133
    v_add_u32 v136, 4, v132
    v_and_b32 v136, 15, v136
    v_lshl_add_u32 v136, v136, 4, v133
    v_add_u32 v137, 6, v132
    v_and_b32 v137, 15, v137
    v_lshl_add_u32 v137, v137, 4, v133
    v_add_u32 v138, 8, v132
    v_and_b32 v138, 15, v138
    v_lshl_add_u32 v138, v138, 4, v133
    s_waitcnt vmcnt(12)
    s_branch P2_chk0
P2_rty0:
    s_sub_u32 s68, s68, 1
    s_cbranch_scc1 P2_ok0
    s_sleep 2
    s_add_u32 s42, s40, 4096
    buffer_load_dwordx4 v[84:87], v2, s[20:23], s42 offen offset:0 sc1
    buffer_load_dwordx4 v[88:91], v2, s[20:23], s42 offen offset:1024 sc1
    buffer_load_dwordx4 v[92:95], v2, s[20:23], s42 offen offset:2048 sc1
    buffer_load_dwordx4 v[96:99], v2, s[20:23], s42 offen offset:3072 sc1
    s_waitcnt vmcnt(0)
P2_chk0:
    v_max3_u32 v132, v84, v85, v86
    v_max3_u32 v132, v132, v87, v88
    v_max3_u32 v132, v132, v89, v90
    v_max3_u32 v132, v132, v91, v92
    v_max3_u32 v132, v132, v93, v94
    v_max3_u32 v132, v132, v95, v96
    v_max3_u32 v132, v132, v97, v98
    v_max_u32 v132, v132, v99
    v_cmp_eq_u32 vcc, -1, v132
    s_cbranch_vccnz P2_rty0
P2_ok0:
    v_mfma_f32_16x16x32_bf16 v[4:7], v[160:163], v[84:87], 0
    v_mfma_f32_16x16x32_bf16 v[24:27], v[160:163], v[88:91], 0
    v_mfma_f32_16x16x32_bf16 v[44:47], v[160:163], v[92:95], 0
    v_mfma_f32_16x16x32_bf16 v[64:67], v[160:163], v[96:99], 0
    v_mfma_f32_16x16x32_bf16 v[8:11], v[164:167], v[84:87], 0
    v_mfma_f32_16x16x32_bf16 v[28:31], v[164:167], v[88:91], 0
    v_mfma_f32_16x16x32_bf16 v[48:51], v[164:167], v[92:95], 0
    v_mfma_f32_16x16x32_bf16 v[68:71], v[164:167], v[96:99], 0
    v_mfma_f32_16x16x32_bf16 v[12:15], v[168:171], v[84:87], 0
    v_mfma_f32_16x16x32_bf16 v[32:35], v[168:171], v[88:91], 0
    v_mfma_f32_16x16x32_bf16 v[52:55], v[168:171], v[92:95], 0
    v_mfma_f32_16x16x32_bf16 v[72:75], v[168:171], v[96:99], 0
    v_mfma_f32_16x16x32_bf16 v[16:19], v[172:175], v[84:87], 0
    v_mfma_f32_16x16x32_bf16 v[36:39], v[172:175], v[88:91], 0
    v_mfma_f32_16x16x32_bf16 v[56:59], v[172:175], v[92:95], 0
    v_mfma_f32_16x16x32_bf16 v[76:79], v[172:175], v[96:99], 0
    v_mfma_f32_16x16x32_bf16 v[20:23], v[176:179], v[84:87], 0
    v_mfma_f32_16x16x32_bf16 v[40:43], v[176:179], v[88:91], 0
    v_mfma_f32_16x16x32_bf16 v[60:63], v[176:179], v[92:95], 0
    v_mfma_f32_16x16x32_bf16 v[80:83], v[176:179], v[96:99], 0
    s_waitcnt vmcnt(4)
    s_branch P2_chk1
P2_rty1:
    s_sub_u32 s68, s68, 1
    s_cbranch_scc1 P2_ok1
    s_sleep 2
    s_add_u32 s42, s40, 8192
    buffer_load_dwordx2 v[100:101], v139, s[20:23], s42 offen offset:0 sc1
    buffer_load_dwordx2 v[102:103], v139, s[20:23], s42 offen offset:512 sc1
    buffer_load_dwordx2 v[104:105], v139, s[20:23], s42 offen offset:1024 sc1
    buffer_load_dwordx2 v[106:107], v139, s[20:23], s42 offen offset:1536 sc1
    buffer_load_dwordx2 v[108:109], v139, s[20:23], s42 offen offset:2048 sc1
    buffer_load_dwordx2 v[110:111], v139, s[20:23], s42 offen offset:2560 sc1
    buffer_load_dwordx2 v[112:113], v139, s[20:23], s42 offen offset:3072 sc1
    buffer_load_dwordx2 v[114:115], v139, s[20:23], s42 offen offset:3584 sc1
    s_waitcnt vmcnt(0)
P2_chk1:
    s_nop 0
    v_max3_u32 v132, v100, v101, v102
    v_max3_u32 v132, v132, v103, v104
    v_max3_u32 v132, v132, v105, v106
    v_max3_u32 v132, v132, v107, v108
    v_max3_u32 v132, v132, v109, v110
    v_max3_u32 v132, v132, v111, v112
    v_max3_u32 v132, v132, v113, v114
    v_max_u32 v132, v132, v115
    v_cmp_eq_u32 vcc, -1, v132
    s_cbranch_vccnz P2_rty1
P2_ok1:
    v_mfma_f32_16x16x32_bf16 v[4:7], v[180:183], v[100:103], v[4:7]
    s_add_u32 s42, s40, 16384
    v_mfma_f32_16x16x32_bf16 v[24:27], v[180:183], v[104:107], v[24:27]
    v_mfma_f32_16x16x32_bf16 v[44:47], v[180:183], v[108:111], v[44:47]
    buffer_load_dwordx4 v[84:87], v2, s[20:23], s42 offen offset:0 sc1
    v_mfma_f32_16x16x32_bf16 v[64:67], v[180:183], v[112:115], v[64:67]
    v_mfma_f32_16x16x32_bf16 v[8:11], v[184:187], v[100:103], v[8:11]
    buffer_load_dwordx4 v[88:91], v2, s[20:23], s42 offen offset:1024 sc1
    v_mfma_f32_16x16x32_bf16 v[28:31], v[184:187], v[104:107], v[28:31]
    v_mfma_f32_16x16x32_bf16 v[48:51], v[184:187], v[108:111], v[48:51]
    buffer_load_dwordx4 v[92:95], v2, s[20:23], s42 offen offset:2048 sc1
    v_mfma_f32_16x16x32_bf16 v[68:71], v[184:187], v[112:115], v[68:71]
    v_mfma_f32_16x16x32_bf16 v[12:15], v[188:191], v[100:103], v[12:15]
    buffer_load_dwordx4 v[96:99], v2, s[20:23], s42 offen offset:3072 sc1
    v_mfma_f32_16x16x32_bf16 v[32:35], v[188:191], v[104:107], v[32:35]
    v_mfma_f32_16x16x32_bf16 v[52:55], v[188:191], v[108:111], v[52:55]
    v_mfma_f32_16x16x32_bf16 v[72:75], v[188:191], v[112:115], v[72:75]
    v_mfma_f32_16x16x32_bf16 v[16:19], v[192:195], v[100:103], v[16:19]
    v_mfma_f32_16x16x32_bf16 v[36:39], v[192:195], v[104:107], v[36:39]
    v_mfma_f32_16x16x32_bf16 v[56:59], v[192:195], v[108:111], v[56:59]
    v_mfma_f32_16x16x32_bf16 v[76:79], v[192:195], v[112:115], v[76:79]
    v_mfma_f32_16x16x32_bf16 v[20:23], v[196:199], v[100:103], v[20:23]
    v_mfma_f32_16x16x32_bf16 v[40:43], v[196:199], v[104:107], v[40:43]
    v_mfma_f32_16x16x32_bf16 v[60:63], v[196:199], v[108:111], v[60:63]
    v_mfma_f32_16x16x32_bf16 v[80:83], v[196:199], v[112:115], v[80:83]
    s_waitcnt vmcnt(4)
    s_branch P2_chk2
P2_rty2:
    s_sub_u32 s68, s68, 1
    s_cbranch_scc1 P2_ok2
    s_sleep 2
    s_add_u32 s42, s40, 12288
    buffer_load_dwordx4 v[116:119], v2, s[20:23], s42 offen offset:0 sc1
    buffer_load_dwordx4 v[120:123], v2, s[20:23], s42 offen offset:1024 sc1
    buffer_load_dwordx4 v[124:127], v2, s[20:23], s42 offen offset:2048 sc1
    buffer_load_dwordx4 v[128:131], v2, s[20:23], s42 offen offset:3072 sc1
    s_waitcnt vmcnt(0)
P2_chk2:
    s_nop 0
    v_max3_u32 v132, v116, v117, v118
    v_max3_u32 v132, v132, v119, v120
    v_max3_u32 v132, v132, v121, v122
    v_max3_u32 v132, v132, v123, v124
    v_max3_u32 v132, v132, v125, v126
    v_max3_u32 v132, v132, v127, v128
    v_max3_u32 v132, v132, v129, v130
    v_max_u32 v132, v132, v131
    v_cmp_eq_u32 vcc, -1, v132
    s_cbranch_vccnz P2_rty2
P2_ok2:
    v_mfma_f32_16x16x32_bf16 v[4:7], v[200:203], v[116:119], v[4:7]
    s_add_u32 s42, s40, 0
    v_mfma_f32_16x16x32_bf16 v[24:27], v[200:203], v[120:123], v[24:27]
    v_mfma_f32_16x16x32_bf16 v[44:47], v[200:203], v[124:127], v[44:47]
    buffer_load_dwordx4 v[100:103], v2, s[20:23], s42 offen offset:0 sc1
    v_mfma_f32_16x16x32_bf16 v[64:67], v[200:203], v[128:131], v[64:67]
    v_mfma_f32_16x16x32_bf16 v[8:11], v[204:207], v[116:119], v[8:11]
    buffer_load_dwordx4 v[104:107], v2, s[20:23], s42 offen offset:1024 sc1
    v_mfma_f32_16x16x32_bf16 v[28:31], v[204:207], v[120:123], v[28:31]
    v_mfma_f32_16x16x32_bf16 v[48:51], v[204:207], v[124:127], v[48:51]
    buffer_load_dwordx4 v[108:111], v2, s[20:23], s42 offen offset:2048 sc1
    v_mfma_f32_16x16x32_bf16 v[68:71], v[204:207], v[128:131], v[68:71]
    v_mfma_f32_16x16x32_bf16 v[12:15], v[208:211], v[116:119], v[12:15]
    buffer_load_dwordx4 v[112:115], v2, s[20:23], s42 offen offset:3072 sc1
    v_mfma_f32_16x16x32_bf16 v[32:35], v[208:211], v[120:123], v[32:35]
    v_mfma_f32_16x16x32_bf16 v[52:55], v[208:211], v[124:127], v[52:55]
    v_mfma_f32_16x16x32_bf16 v[72:75], v[208:211], v[128:131], v[72:75]
    v_mfma_f32_16x16x32_bf16 v[16:19], v[212:215], v[116:119], v[16:19]
    v_mfma_f32_16x16x32_bf16 v[36:39], v[212:215], v[120:123], v[36:39]
    v_mfma_f32_16x16x32_bf16 v[56:59], v[212:215], v[124:127], v[56:59]
    v_mfma_f32_16x16x32_bf16 v[76:79], v[212:215], v[128:131], v[76:79]
    v_mfma_f32_16x16x32_bf16 v[20:23], v[216:219], v[116:119], v[20:23]
    v_mfma_f32_16x16x32_bf16 v[40:43], v[216:219], v[120:123], v[40:43]
    v_mfma_f32_16x16x32_bf16 v[60:63], v[216:219], v[124:127], v[60:63]
    v_mfma_f32_16x16x32_bf16 v[80:83], v[216:219], v[128:131], v[80:83]
    s_waitcnt vmcnt(4)
    s_branch P2_chk3
P2_rty3:
    s_sub_u32 s68, s68, 1
    s_cbranch_scc1 P2_ok3
    s_sleep 2
    s_add_u32 s42, s40, 16384
    buffer_load_dwordx4 v[84:87], v2, s[20:23], s42 offen offset:0 sc1
    buffer_load_dwordx4 v[88:91], v2, s[20:23], s42 offen offset:1024 sc1
    buffer_load_dwordx4 v[92:95], v2, s[20:23], s42 offen offset:2048 sc1
    buffer_load_dwordx4 v[96:99], v2, s[20:23], s42 offen offset:3072 sc1
    s_waitcnt vmcnt(0)
P2_chk3:
    v_max3_u32 v132, v84, v85, v86
    v_max3_u32 v132, v132, v87, v88
    v_max3_u32 v132, v132, v89, v90
    v_max3_u32 v132, v132, v91, v92
    v_max3_u32 v132, v132, v93, v94
    v_max3_u32 v132, v132, v95, v96
    v_max3_u32 v132, v132, v97, v98
    v_max_u32 v132, v132, v99
    v_cmp_eq_u32 vcc, -1, v132
    s_cbranch_vccnz P2_rty3
P2_ok3:
    v_mfma_f32_16x16x32_bf16 v[4:7], v[220:223], v[84:87], v[4:7]
    v_mfma_f32_16x16x32_bf16 v[24:27], v[220:223], v[88:91], v[24:27]
    v_mfma_f32_16x16x32_bf16 v[44:47], v[220:223], v[92:95], v[44:47]
    v_mfma_f32_16x16x32_bf16 v[64:67], v[220:223], v[96:99], v[64:67]
    v_mfma_f32_16x16x32_bf16 v[8:11], v[224:227], v[84:87], v[8:11]
    v_mfma_f32_16x16x32_bf16 v[28:31], v[224:227], v[88:91], v[28:31]
    v_mfma_f32_16x16x32_bf16 v[48:51], v[224:227], v[92:95], v[48:51]
    v_mfma_f32_16x16x32_bf16 v[68:71], v[224:227], v[96:99], v[68:71]
    v_mfma_f32_16x16x32_bf16 v[12:15], v[228:231], v[84:87], v[12:15]
    v_mfma_f32_16x16x32_bf16 v[32:35], v[228:231], v[88:91], v[32:35]
    v_mfma_f32_16x16x32_bf16 v[52:55], v[228:231], v[92:95], v[52:55]
    v_mfma_f32_16x16x32_bf16 v[72:75], v[228:231], v[96:99], v[72:75]
    v_mfma_f32_16x16x32_bf16 v[16:19], v[232:235], v[84:87], v[16:19]
    v_mfma_f32_16x16x32_bf16 v[36:39], v[232:235], v[88:91], v[36:39]
    v_mfma_f32_16x16x32_bf16 v[56:59], v[232:235], v[92:95], v[56:59]
    v_mfma_f32_16x16x32_bf16 v[76:79], v[232:235], v[96:99], v[76:79]
    v_mfma_f32_16x16x32_bf16 v[20:23], v[236:239], v[84:87], v[20:23]
    v_mfma_f32_16x16x32_bf16 v[40:43], v[236:239], v[88:91], v[40:43]
    v_mfma_f32_16x16x32_bf16 v[60:63], v[236:239], v[92:95], v[60:63]
    v_mfma_f32_16x16x32_bf16 v[80:83], v[236:239], v[96:99], v[80:83]
    s_waitcnt vmcnt(0)
    s_branch P2_chk4
P2_rty4:
    s_sub_u32 s68, s68, 1
    s_cbranch_scc1 P2_ok4
    s_sleep 2
    s_add_u32 s42, s40, 0
    buffer_load_dwordx4 v[100:103], v2, s[20:23], s42 offen offset:0 sc1
    buffer_load_dwordx4 v[104:107], v2, s[20:23], s42 offen offset:1024 sc1
    buffer_load_dwordx4 v[108:111], v2, s[20:23], s42 offen offset:2048 sc1
    buffer_load_dwordx4 v[112:115], v2, s[20:23], s42 offen offset:3072 sc1
    s_waitcnt vmcnt(0)
P2_chk4:
    v_max3_u32 v132, v100, v101, v102
    v_max3_u32 v132, v132, v103, v104
    v_max3_u32 v132, v132, v105, v106
    v_max3_u32 v132, v132, v107, v108
    v_max3_u32 v132, v132, v109, v110
    v_max3_u32 v132, v132, v111, v112
    v_max3_u32 v132, v132, v113, v114
    v_max_u32 v132, v132, v115
    v_cmp_eq_u32 vcc, -1, v132
    s_cbranch_vccnz P2_rty4
P2_ok4:
    v_mfma_f32_16x16x32_bf16 v[4:7], v[140:143], v[100:103], v[4:7]
    v_mfma_f32_16x16x32_bf16 v[24:27], v[140:143], v[104:107], v[24:27]
    v_mfma_f32_16x16x32_bf16 v[44:47], v[140:143], v[108:111], v[44:47]
    v_mfma_f32_16x16x32_bf16 v[64:67], v[140:143], v[112:115], v[64:67]
    v_mfma_f32_16x16x32_bf16 v[8:11], v[144:147], v[100:103], v[8:11]
    v_mfma_f32_16x16x32_bf16 v[28:31], v[144:147], v[104:107], v[28:31]
    v_mfma_f32_16x16x32_bf16 v[48:51], v[144:147], v[108:111], v[48:51]
    v_mfma_f32_16x16x32_bf16 v[68:71], v[144:147], v[112:115], v[68:71]
    v_mfma_f32_16x16x32_bf16 v[12:15], v[148:151], v[100:103], v[12:15]
    v_mfma_f32_16x16x32_bf16 v[32:35], v[148:151], v[104:107], v[32:35]
    v_mfma_f32_16x16x32_bf16 v[52:55], v[148:151], v[108:111], v[52:55]
    v_mfma_f32_16x16x32_bf16 v[72:75], v[148:151], v[112:115], v[72:75]
    v_mfma_f32_16x16x32_bf16 v[16:19], v[152:155], v[100:103], v[16:19]
    v_mfma_f32_16x16x32_bf16 v[36:39], v[152:155], v[104:107], v[36:39]
    v_mfma_f32_16x16x32_bf16 v[56:59], v[152:155], v[108:111], v[56:59]
    v_mfma_f32_16x16x32_bf16 v[76:79], v[152:155], v[112:115], v[76:79]
    v_mfma_f32_16x16x32_bf16 v[20:23], v[156:159], v[100:103], v[20:23]
    v_mfma_f32_16x16x32_bf16 v[40:43], v[156:159], v[104:107], v[40:43]
    v_mfma_f32_16x16x32_bf16 v[60:63], v[156:159], v[108:111], v[60:63]
    v_mfma_f32_16x16x32_bf16 v[80:83], v[156:159], v[112:115], v[80:83]
    v_mov_b32 v132, 162816
    s_mov_b32 s68, 1000000
AS_spin:
    ds_read_b32 v133, v132 offset:24
    s_waitcnt lgkmcnt(0)
    v_cmp_ne_u32 vcc, 4, v133
    s_cbranch_vccz AS_out
    s_sub_u32 s68, s68, 1
    s_sleep 1
    s_cbranch_scc0 AS_spin
AS_out:
    ds_write_b128 v134, v[4:7] offset:0
    ds_write_b128 v135, v[8:11] offset:1024
    ds_write_b128 v136, v[12:15] offset:2048
    ds_write_b128 v137, v[16:19] offset:3072
    ds_write_b128 v138, v[20:23] offset:4096
    ds_write_b128 v134, v[24:27] offset:5120
    ds_write_b128 v135, v[28:31] offset:6144
    ds_write_b128 v136, v[32:35] offset:7168
    ds_write_b128 v137, v[36:39] offset:8192
    ds_write_b128 v138, v[40:43] offset:9216
    ds_write_b128 v134, v[44:47] offset:10240
    ds_write_b128 v135, v[48:51] offset:11264
    ds_write_b128 v136, v[52:55] offset:12288
    ds_write_b128 v137, v[56:59] offset:13312
    ds_write_b128 v138, v[60:63] offset:14336
    ds_write_b128 v134, v[64:67] offset:15360
    ds_write_b128 v135, v[68:71] offset:16384
    ds_write_b128 v136, v[72:75] offset:17408
    ds_write_b128 v137, v[76:79] offset:18432
    ds_write_b128 v138, v[80:83] offset:19456
    s_waitcnt lgkmcnt(0)
    v_mov_b32 v132, 162816
    v_mov_b32 v133, 1
    s_mov_b64 exec, 1
    ds_add_u32 v132, v133 offset:32
    s_mov_b64 exec, -1
    s_endpgm
K1_end:
    s_endpgm
.section .rodata,"a"
.p2align 6
.amdhsa_kernel recurrent_scan__linear_kernel_hedgehog__swiglu_ffn__prompt_kernel
  .amdhsa_next_free_vgpr 256
  .amdhsa_next_free_sgpr 100
  .amdhsa_accum_offset 256
  .amdhsa_group_segment_fixed_size 0
  .amdhsa_kernarg_size 88
  .amdhsa_user_sgpr_count 2
  .amdhsa_user_sgpr_kernarg_segment_ptr 1
  .amdhsa_system_sgpr_workgroup_id_x 1
.end_amdhsa_kernel
```
